```python
import torch

def _softmax(x, axis=-1):
    return torch.softmax(x, dim=axis)

def _gelu(x):
    return torch.nn.functional.gelu(x, approximate='tanh')

def _silu(x):
    return torch.nn.functional.silu(x)

def _sigmoid(x):
    return torch.sigmoid(x)

def _layernorm(x, axis=-1, eps=1e-05):
    m = x.mean(dim=axis, keepdim=True)
    v = x.var(dim=axis, keepdim=True, unbiased=False)
    return (x - m) / torch.sqrt(v + eps)

def _scatter_add(tgt, idx, src, axis=0):
    return tgt.clone().index_add_(axis, idx, src)

def _segment_sum(src, seg, n):
    out = torch.zeros((n,) + src.shape[1:], dtype=src.dtype)
    return out.index_add_(0, seg, src)

def _pad(x, pw):
    flat = tuple((v for pair in reversed(pw) for v in pair))
    return torch.nn.functional.pad(x, flat)
kernel_name = 'standalone__dit_block__diffusion'

def setup_inputs():

    _w = lambda a: (lambda t: t.to(torch.bfloat16) if t.is_floating_point() else t)(torch.as_tensor(a))
    B, N, D = (2, 1024, 768)
    F = 4 * D
    return {'x': _w((lambda *s: torch.randn(*s, dtype=torch.bfloat16) * 0.05)(B, N, D)), 'c': _w((lambda *s: torch.randn(*s, dtype=torch.bfloat16) * 0.2)(B, D)), 'wqkv': _w((lambda *s: torch.randn(*s, dtype=torch.bfloat16) * 0.05)(D, 3 * D)), 'wo': _w((lambda *s: torch.randn(*s, dtype=torch.bfloat16) * 0.05)(D, D)), 'w_mod': _w((lambda *s: torch.randn(*s, dtype=torch.bfloat16) * 0.2)(D, 6 * D)), 'w_fc1': _w((lambda *s: torch.randn(*s, dtype=torch.bfloat16) * 0.05)(D, F)), 'w_fc2': _w((lambda *s: torch.randn(*s, dtype=torch.bfloat16) * 0.05)(F, D))}

def reference(x, c, wqkv, wo, w_mod, w_fc1, w_fc2):
    B, N, D = x.shape
    H = 2
    Dh = D // H
    mod = (_silu(c) @ w_mod).reshape(B, 6, 1, D)
    shift_a, scale_a, gate_a, shift_m, scale_m, gate_m = [mod[:, i] for i in range(6)]
    h = _layernorm(x, axis=-1) * (1 + scale_a) + shift_a
    qkv = (h @ wqkv).reshape(B, N, 3, H, Dh)
    q, k, v = (qkv[:, :, 0].clone(), qkv[:, :, 1].clone(), qkv[:, :, 2].clone())
    attn = _softmax(torch.einsum('bqhd,bkhd->bhqk', q, k) * Dh ** (-0.5), axis=-1)
    a = torch.einsum('bhqk,bkhd->bqhd', attn, v).reshape(B, N, D) @ wo
    x = x + gate_a * a
    h2 = _layernorm(x, axis=-1) * (1 + scale_m) + shift_m
    m = _gelu(h2 @ w_fc1) @ w_fc2
    return x + gate_m * m
```

```asm
; @launch kernel=mod_kernel grid=(72,1,1) block=(256,1,1) lds=24576
; @launch kernel=ln1_kernel grid=(512,1,1) block=(256,1,1) lds=0
; @launch kernel=qkv_kernel grid=(256,1,1) block=(256,1,1) lds=110592
; @launch kernel=s_kernel grid=(256,1,1) block=(256,1,1) lds=98304
; @launch kernel=sm_kernel grid=(1024,1,1) block=(256,1,1) lds=0
; @launch kernel=pv_kernel grid=(256,1,1) block=(256,1,1) lds=147456
; @launch kernel=wo_kernel grid=(256,1,1) block=(256,1,1) lds=147456
; @launch kernel=ln2_kernel grid=(512,1,1) block=(256,1,1) lds=0
; @launch kernel=fc1_kernel grid=(256,1,1) block=(256,1,1) lds=135168
; @launch kernel=fc2_kernel grid=(256,1,1) block=(256,1,1) lds=147456
.amdgcn_target "amdgcn-amd-amdhsa--gfx950"
.text
.globl mod_kernel
.p2align 8
.type mod_kernel,@function
mod_kernel:
    s_cmp_ge_u32 s2, 72
    s_cbranch_scc1 mod_kernel_end
    s_load_dwordx2 s[20:21], s[0:1], 8
    s_load_dwordx2 s[22:23], s[0:1], 32
    s_load_dwordx2 s[24:25], s[0:1], 72
    s_waitcnt lgkmcnt(0)
    s_mov_b32 s8, s20
    s_mov_b32 s9, s21
    s_mov_b32 s10, 3072
    s_mov_b32 s11, 0x00020000
    s_mov_b32 s12, s22
    s_mov_b32 s13, s23
    s_mov_b32 s14, 7077888
    s_mov_b32 s15, 0x00020000
    s_mov_b32 s16, s24
    s_mov_b32 s17, s25
    s_mov_b32 s18, 36864
    s_mov_b32 s19, 0x00020000
    v_lshlrev_b32 v2, 1, v0
    buffer_load_ushort v4, v2, s[8:11], 0 offen offset:0
    v_lshlrev_b32 v2, 1, v0
    buffer_load_ushort v5, v2, s[8:11], 0 offen offset:512
    v_lshlrev_b32 v2, 1, v0
    buffer_load_ushort v6, v2, s[8:11], 0 offen offset:1024
    v_lshlrev_b32 v2, 1, v0
    buffer_load_ushort v7, v2, s[8:11], 0 offen offset:1536
    v_lshlrev_b32 v2, 1, v0
    buffer_load_ushort v8, v2, s[8:11], 0 offen offset:2048
    v_lshlrev_b32 v2, 1, v0
    buffer_load_ushort v9, v2, s[8:11], 0 offen offset:2560
    s_waitcnt vmcnt(0)
    v_lshlrev_b32 v4, 16, v4
    v_mul_f32 v10, 0xbfb8aa3b, v4
    v_exp_f32 v10, v10
    s_nop 0
    v_add_f32 v10, 1.0, v10
    v_rcp_f32 v10, v10
    s_nop 0
    v_mul_f32 v4, v4, v10
    v_cvt_pk_bf16_f32 v4, v4, v4
    v_lshlrev_b32 v4, 16, v4
    v_lshlrev_b32 v2, 2, v0
    ds_write_b32 v2, v4 offset:0
    v_lshlrev_b32 v5, 16, v5
    v_mul_f32 v10, 0xbfb8aa3b, v5
    v_exp_f32 v10, v10
    s_nop 0
    v_add_f32 v10, 1.0, v10
    v_rcp_f32 v10, v10
    s_nop 0
    v_mul_f32 v5, v5, v10
    v_cvt_pk_bf16_f32 v5, v5, v5
    v_lshlrev_b32 v5, 16, v5
    v_lshlrev_b32 v2, 2, v0
    ds_write_b32 v2, v5 offset:1024
    v_lshlrev_b32 v6, 16, v6
    v_mul_f32 v10, 0xbfb8aa3b, v6
    v_exp_f32 v10, v10
    s_nop 0
    v_add_f32 v10, 1.0, v10
    v_rcp_f32 v10, v10
    s_nop 0
    v_mul_f32 v6, v6, v10
    v_cvt_pk_bf16_f32 v6, v6, v6
    v_lshlrev_b32 v6, 16, v6
    v_lshlrev_b32 v2, 2, v0
    ds_write_b32 v2, v6 offset:2048
    v_lshlrev_b32 v7, 16, v7
    v_mul_f32 v10, 0xbfb8aa3b, v7
    v_exp_f32 v10, v10
    s_nop 0
    v_add_f32 v10, 1.0, v10
    v_rcp_f32 v10, v10
    s_nop 0
    v_mul_f32 v7, v7, v10
    v_cvt_pk_bf16_f32 v7, v7, v7
    v_lshlrev_b32 v7, 16, v7
    v_lshlrev_b32 v2, 2, v0
    ds_write_b32 v2, v7 offset:3072
    v_lshlrev_b32 v8, 16, v8
    v_mul_f32 v10, 0xbfb8aa3b, v8
    v_exp_f32 v10, v10
    s_nop 0
    v_add_f32 v10, 1.0, v10
    v_rcp_f32 v10, v10
    s_nop 0
    v_mul_f32 v8, v8, v10
    v_cvt_pk_bf16_f32 v8, v8, v8
    v_lshlrev_b32 v8, 16, v8
    v_lshlrev_b32 v2, 2, v0
    ds_write_b32 v2, v8 offset:4096
    v_lshlrev_b32 v9, 16, v9
    v_mul_f32 v10, 0xbfb8aa3b, v9
    v_exp_f32 v10, v10
    s_nop 0
    v_add_f32 v10, 1.0, v10
    v_rcp_f32 v10, v10
    s_nop 0
    v_mul_f32 v9, v9, v10
    v_cvt_pk_bf16_f32 v9, v9, v9
    v_lshlrev_b32 v9, 16, v9
    v_lshlrev_b32 v2, 2, v0
    ds_write_b32 v2, v9 offset:5120
    s_waitcnt lgkmcnt(0)
    s_barrier
    v_and_b32 v2, 7, v0
    v_lshrrev_b32 v3, 3, v0
    s_lshl_b32 s30, s2, 7
    s_mov_b32 s31, 9216
    v_mul_lo_u32 v4, s31, v3
    v_lshl_add_u32 v4, v2, 4, v4
    v_add_u32 v5, 0, v4
    buffer_load_dwordx4 v[32:35], v5, s[12:15], s30 offen
    v_add_u32 v5, 294912, v4
    buffer_load_dwordx4 v[36:39], v5, s[12:15], s30 offen
    v_add_u32 v5, 589824, v4
    buffer_load_dwordx4 v[40:43], v5, s[12:15], s30 offen
    v_add_u32 v5, 884736, v4
    buffer_load_dwordx4 v[44:47], v5, s[12:15], s30 offen
    v_add_u32 v5, 1179648, v4
    buffer_load_dwordx4 v[48:51], v5, s[12:15], s30 offen
    v_add_u32 v5, 1474560, v4
    buffer_load_dwordx4 v[52:55], v5, s[12:15], s30 offen
    v_add_u32 v5, 1769472, v4
    buffer_load_dwordx4 v[56:59], v5, s[12:15], s30 offen
    v_add_u32 v5, 2064384, v4
    buffer_load_dwordx4 v[60:63], v5, s[12:15], s30 offen
    v_add_u32 v5, 2359296, v4
    buffer_load_dwordx4 v[64:67], v5, s[12:15], s30 offen
    v_add_u32 v5, 2654208, v4
    buffer_load_dwordx4 v[68:71], v5, s[12:15], s30 offen
    v_add_u32 v5, 2949120, v4
    buffer_load_dwordx4 v[72:75], v5, s[12:15], s30 offen
    v_add_u32 v5, 3244032, v4
    buffer_load_dwordx4 v[76:79], v5, s[12:15], s30 offen
    v_add_u32 v5, 3538944, v4
    buffer_load_dwordx4 v[80:83], v5, s[12:15], s30 offen
    v_add_u32 v5, 3833856, v4
    buffer_load_dwordx4 v[84:87], v5, s[12:15], s30 offen
    v_add_u32 v5, 4128768, v4
    buffer_load_dwordx4 v[88:91], v5, s[12:15], s30 offen
    v_add_u32 v5, 4423680, v4
    buffer_load_dwordx4 v[92:95], v5, s[12:15], s30 offen
    v_add_u32 v5, 4718592, v4
    buffer_load_dwordx4 v[96:99], v5, s[12:15], s30 offen
    v_add_u32 v5, 5013504, v4
    buffer_load_dwordx4 v[100:103], v5, s[12:15], s30 offen
    v_add_u32 v5, 5308416, v4
    buffer_load_dwordx4 v[104:107], v5, s[12:15], s30 offen
    v_add_u32 v5, 5603328, v4
    buffer_load_dwordx4 v[108:111], v5, s[12:15], s30 offen
    v_add_u32 v5, 5898240, v4
    buffer_load_dwordx4 v[112:115], v5, s[12:15], s30 offen
    v_add_u32 v5, 6193152, v4
    buffer_load_dwordx4 v[116:119], v5, s[12:15], s30 offen
    v_add_u32 v5, 6488064, v4
    buffer_load_dwordx4 v[120:123], v5, s[12:15], s30 offen
    v_add_u32 v5, 6782976, v4
    buffer_load_dwordx4 v[124:127], v5, s[12:15], s30 offen
    v_lshlrev_b32 v6, 2, v3
    v_mov_b32 v8, 0
    v_mov_b32 v9, 0
    v_mov_b32 v10, 0
    v_mov_b32 v11, 0
    v_mov_b32 v12, 0
    v_mov_b32 v13, 0
    v_mov_b32 v14, 0
    v_mov_b32 v15, 0
    v_mov_b32 v16, 0
    v_mov_b32 v17, 0
    v_mov_b32 v18, 0
    v_mov_b32 v19, 0
    v_mov_b32 v20, 0
    v_mov_b32 v21, 0
    v_mov_b32 v22, 0
    v_mov_b32 v23, 0
    ds_read_b32 v24, v6 offset:0
    ds_read_b32 v25, v6 offset:3072
    s_waitcnt vmcnt(23) lgkmcnt(0)
    v_lshlrev_b32 v26, 16, v32
    v_and_b32 v27, 0xffff0000, v32
    v_fmac_f32 v8, v24, v26
    v_fmac_f32 v9, v24, v27
    v_fmac_f32 v16, v25, v26
    v_fmac_f32 v17, v25, v27
    v_lshlrev_b32 v26, 16, v33
    v_and_b32 v27, 0xffff0000, v33
    v_fmac_f32 v10, v24, v26
    v_fmac_f32 v11, v24, v27
    v_fmac_f32 v18, v25, v26
    v_fmac_f32 v19, v25, v27
    v_lshlrev_b32 v26, 16, v34
    v_and_b32 v27, 0xffff0000, v34
    v_fmac_f32 v12, v24, v26
    v_fmac_f32 v13, v24, v27
    v_fmac_f32 v20, v25, v26
    v_fmac_f32 v21, v25, v27
    v_lshlrev_b32 v26, 16, v35
    v_and_b32 v27, 0xffff0000, v35
    v_fmac_f32 v14, v24, v26
    v_fmac_f32 v15, v24, v27
    v_fmac_f32 v22, v25, v26
    v_fmac_f32 v23, v25, v27
    ds_read_b32 v24, v6 offset:128
    ds_read_b32 v25, v6 offset:3200
    s_waitcnt vmcnt(22) lgkmcnt(0)
    v_lshlrev_b32 v26, 16, v36
    v_and_b32 v27, 0xffff0000, v36
    v_fmac_f32 v8, v24, v26
    v_fmac_f32 v9, v24, v27
    v_fmac_f32 v16, v25, v26
    v_fmac_f32 v17, v25, v27
    v_lshlrev_b32 v26, 16, v37
    v_and_b32 v27, 0xffff0000, v37
    v_fmac_f32 v10, v24, v26
    v_fmac_f32 v11, v24, v27
    v_fmac_f32 v18, v25, v26
    v_fmac_f32 v19, v25, v27
    v_lshlrev_b32 v26, 16, v38
    v_and_b32 v27, 0xffff0000, v38
    v_fmac_f32 v12, v24, v26
    v_fmac_f32 v13, v24, v27
    v_fmac_f32 v20, v25, v26
    v_fmac_f32 v21, v25, v27
    v_lshlrev_b32 v26, 16, v39
    v_and_b32 v27, 0xffff0000, v39
    v_fmac_f32 v14, v24, v26
    v_fmac_f32 v15, v24, v27
    v_fmac_f32 v22, v25, v26
    v_fmac_f32 v23, v25, v27
    ds_read_b32 v24, v6 offset:256
    ds_read_b32 v25, v6 offset:3328
    s_waitcnt vmcnt(21) lgkmcnt(0)
    v_lshlrev_b32 v26, 16, v40
    v_and_b32 v27, 0xffff0000, v40
    v_fmac_f32 v8, v24, v26
    v_fmac_f32 v9, v24, v27
    v_fmac_f32 v16, v25, v26
    v_fmac_f32 v17, v25, v27
    v_lshlrev_b32 v26, 16, v41
    v_and_b32 v27, 0xffff0000, v41
    v_fmac_f32 v10, v24, v26
    v_fmac_f32 v11, v24, v27
    v_fmac_f32 v18, v25, v26
    v_fmac_f32 v19, v25, v27
    v_lshlrev_b32 v26, 16, v42
    v_and_b32 v27, 0xffff0000, v42
    v_fmac_f32 v12, v24, v26
    v_fmac_f32 v13, v24, v27
    v_fmac_f32 v20, v25, v26
    v_fmac_f32 v21, v25, v27
    v_lshlrev_b32 v26, 16, v43
    v_and_b32 v27, 0xffff0000, v43
    v_fmac_f32 v14, v24, v26
    v_fmac_f32 v15, v24, v27
    v_fmac_f32 v22, v25, v26
    v_fmac_f32 v23, v25, v27
    ds_read_b32 v24, v6 offset:384
    ds_read_b32 v25, v6 offset:3456
    s_waitcnt vmcnt(20) lgkmcnt(0)
    v_lshlrev_b32 v26, 16, v44
    v_and_b32 v27, 0xffff0000, v44
    v_fmac_f32 v8, v24, v26
    v_fmac_f32 v9, v24, v27
    v_fmac_f32 v16, v25, v26
    v_fmac_f32 v17, v25, v27
    v_lshlrev_b32 v26, 16, v45
    v_and_b32 v27, 0xffff0000, v45
    v_fmac_f32 v10, v24, v26
    v_fmac_f32 v11, v24, v27
    v_fmac_f32 v18, v25, v26
    v_fmac_f32 v19, v25, v27
    v_lshlrev_b32 v26, 16, v46
    v_and_b32 v27, 0xffff0000, v46
    v_fmac_f32 v12, v24, v26
    v_fmac_f32 v13, v24, v27
    v_fmac_f32 v20, v25, v26
    v_fmac_f32 v21, v25, v27
    v_lshlrev_b32 v26, 16, v47
    v_and_b32 v27, 0xffff0000, v47
    v_fmac_f32 v14, v24, v26
    v_fmac_f32 v15, v24, v27
    v_fmac_f32 v22, v25, v26
    v_fmac_f32 v23, v25, v27
    ds_read_b32 v24, v6 offset:512
    ds_read_b32 v25, v6 offset:3584
    s_waitcnt vmcnt(19) lgkmcnt(0)
    v_lshlrev_b32 v26, 16, v48
    v_and_b32 v27, 0xffff0000, v48
    v_fmac_f32 v8, v24, v26
    v_fmac_f32 v9, v24, v27
    v_fmac_f32 v16, v25, v26
    v_fmac_f32 v17, v25, v27
    v_lshlrev_b32 v26, 16, v49
    v_and_b32 v27, 0xffff0000, v49
    v_fmac_f32 v10, v24, v26
    v_fmac_f32 v11, v24, v27
    v_fmac_f32 v18, v25, v26
    v_fmac_f32 v19, v25, v27
    v_lshlrev_b32 v26, 16, v50
    v_and_b32 v27, 0xffff0000, v50
    v_fmac_f32 v12, v24, v26
    v_fmac_f32 v13, v24, v27
    v_fmac_f32 v20, v25, v26
    v_fmac_f32 v21, v25, v27
    v_lshlrev_b32 v26, 16, v51
    v_and_b32 v27, 0xffff0000, v51
    v_fmac_f32 v14, v24, v26
    v_fmac_f32 v15, v24, v27
    v_fmac_f32 v22, v25, v26
    v_fmac_f32 v23, v25, v27
    ds_read_b32 v24, v6 offset:640
    ds_read_b32 v25, v6 offset:3712
    s_waitcnt vmcnt(18) lgkmcnt(0)
    v_lshlrev_b32 v26, 16, v52
    v_and_b32 v27, 0xffff0000, v52
    v_fmac_f32 v8, v24, v26
    v_fmac_f32 v9, v24, v27
    v_fmac_f32 v16, v25, v26
    v_fmac_f32 v17, v25, v27
    v_lshlrev_b32 v26, 16, v53
    v_and_b32 v27, 0xffff0000, v53
    v_fmac_f32 v10, v24, v26
    v_fmac_f32 v11, v24, v27
    v_fmac_f32 v18, v25, v26
    v_fmac_f32 v19, v25, v27
    v_lshlrev_b32 v26, 16, v54
    v_and_b32 v27, 0xffff0000, v54
    v_fmac_f32 v12, v24, v26
    v_fmac_f32 v13, v24, v27
    v_fmac_f32 v20, v25, v26
    v_fmac_f32 v21, v25, v27
    v_lshlrev_b32 v26, 16, v55
    v_and_b32 v27, 0xffff0000, v55
    v_fmac_f32 v14, v24, v26
    v_fmac_f32 v15, v24, v27
    v_fmac_f32 v22, v25, v26
    v_fmac_f32 v23, v25, v27
    ds_read_b32 v24, v6 offset:768
    ds_read_b32 v25, v6 offset:3840
    s_waitcnt vmcnt(17) lgkmcnt(0)
    v_lshlrev_b32 v26, 16, v56
    v_and_b32 v27, 0xffff0000, v56
    v_fmac_f32 v8, v24, v26
    v_fmac_f32 v9, v24, v27
    v_fmac_f32 v16, v25, v26
    v_fmac_f32 v17, v25, v27
    v_lshlrev_b32 v26, 16, v57
    v_and_b32 v27, 0xffff0000, v57
    v_fmac_f32 v10, v24, v26
    v_fmac_f32 v11, v24, v27
    v_fmac_f32 v18, v25, v26
    v_fmac_f32 v19, v25, v27
    v_lshlrev_b32 v26, 16, v58
    v_and_b32 v27, 0xffff0000, v58
    v_fmac_f32 v12, v24, v26
    v_fmac_f32 v13, v24, v27
    v_fmac_f32 v20, v25, v26
    v_fmac_f32 v21, v25, v27
    v_lshlrev_b32 v26, 16, v59
    v_and_b32 v27, 0xffff0000, v59
    v_fmac_f32 v14, v24, v26
    v_fmac_f32 v15, v24, v27
    v_fmac_f32 v22, v25, v26
    v_fmac_f32 v23, v25, v27
    ds_read_b32 v24, v6 offset:896
    ds_read_b32 v25, v6 offset:3968
    s_waitcnt vmcnt(16) lgkmcnt(0)
    v_lshlrev_b32 v26, 16, v60
    v_and_b32 v27, 0xffff0000, v60
    v_fmac_f32 v8, v24, v26
    v_fmac_f32 v9, v24, v27
    v_fmac_f32 v16, v25, v26
    v_fmac_f32 v17, v25, v27
    v_lshlrev_b32 v26, 16, v61
    v_and_b32 v27, 0xffff0000, v61
    v_fmac_f32 v10, v24, v26
    v_fmac_f32 v11, v24, v27
    v_fmac_f32 v18, v25, v26
    v_fmac_f32 v19, v25, v27
    v_lshlrev_b32 v26, 16, v62
    v_and_b32 v27, 0xffff0000, v62
    v_fmac_f32 v12, v24, v26
    v_fmac_f32 v13, v24, v27
    v_fmac_f32 v20, v25, v26
    v_fmac_f32 v21, v25, v27
    v_lshlrev_b32 v26, 16, v63
    v_and_b32 v27, 0xffff0000, v63
    v_fmac_f32 v14, v24, v26
    v_fmac_f32 v15, v24, v27
    v_fmac_f32 v22, v25, v26
    v_fmac_f32 v23, v25, v27
    ds_read_b32 v24, v6 offset:1024
    ds_read_b32 v25, v6 offset:4096
    s_waitcnt vmcnt(15) lgkmcnt(0)
    v_lshlrev_b32 v26, 16, v64
    v_and_b32 v27, 0xffff0000, v64
    v_fmac_f32 v8, v24, v26
    v_fmac_f32 v9, v24, v27
    v_fmac_f32 v16, v25, v26
    v_fmac_f32 v17, v25, v27
    v_lshlrev_b32 v26, 16, v65
    v_and_b32 v27, 0xffff0000, v65
    v_fmac_f32 v10, v24, v26
    v_fmac_f32 v11, v24, v27
    v_fmac_f32 v18, v25, v26
    v_fmac_f32 v19, v25, v27
    v_lshlrev_b32 v26, 16, v66
    v_and_b32 v27, 0xffff0000, v66
    v_fmac_f32 v12, v24, v26
    v_fmac_f32 v13, v24, v27
    v_fmac_f32 v20, v25, v26
    v_fmac_f32 v21, v25, v27
    v_lshlrev_b32 v26, 16, v67
    v_and_b32 v27, 0xffff0000, v67
    v_fmac_f32 v14, v24, v26
    v_fmac_f32 v15, v24, v27
    v_fmac_f32 v22, v25, v26
    v_fmac_f32 v23, v25, v27
    ds_read_b32 v24, v6 offset:1152
    ds_read_b32 v25, v6 offset:4224
    s_waitcnt vmcnt(14) lgkmcnt(0)
    v_lshlrev_b32 v26, 16, v68
    v_and_b32 v27, 0xffff0000, v68
    v_fmac_f32 v8, v24, v26
    v_fmac_f32 v9, v24, v27
    v_fmac_f32 v16, v25, v26
    v_fmac_f32 v17, v25, v27
    v_lshlrev_b32 v26, 16, v69
    v_and_b32 v27, 0xffff0000, v69
    v_fmac_f32 v10, v24, v26
    v_fmac_f32 v11, v24, v27
    v_fmac_f32 v18, v25, v26
    v_fmac_f32 v19, v25, v27
    v_lshlrev_b32 v26, 16, v70
    v_and_b32 v27, 0xffff0000, v70
    v_fmac_f32 v12, v24, v26
    v_fmac_f32 v13, v24, v27
    v_fmac_f32 v20, v25, v26
    v_fmac_f32 v21, v25, v27
    v_lshlrev_b32 v26, 16, v71
    v_and_b32 v27, 0xffff0000, v71
    v_fmac_f32 v14, v24, v26
    v_fmac_f32 v15, v24, v27
    v_fmac_f32 v22, v25, v26
    v_fmac_f32 v23, v25, v27
    ds_read_b32 v24, v6 offset:1280
    ds_read_b32 v25, v6 offset:4352
    s_waitcnt vmcnt(13) lgkmcnt(0)
    v_lshlrev_b32 v26, 16, v72
    v_and_b32 v27, 0xffff0000, v72
    v_fmac_f32 v8, v24, v26
    v_fmac_f32 v9, v24, v27
    v_fmac_f32 v16, v25, v26
    v_fmac_f32 v17, v25, v27
    v_lshlrev_b32 v26, 16, v73
    v_and_b32 v27, 0xffff0000, v73
    v_fmac_f32 v10, v24, v26
    v_fmac_f32 v11, v24, v27
    v_fmac_f32 v18, v25, v26
    v_fmac_f32 v19, v25, v27
    v_lshlrev_b32 v26, 16, v74
    v_and_b32 v27, 0xffff0000, v74
    v_fmac_f32 v12, v24, v26
    v_fmac_f32 v13, v24, v27
    v_fmac_f32 v20, v25, v26
    v_fmac_f32 v21, v25, v27
    v_lshlrev_b32 v26, 16, v75
    v_and_b32 v27, 0xffff0000, v75
    v_fmac_f32 v14, v24, v26
    v_fmac_f32 v15, v24, v27
    v_fmac_f32 v22, v25, v26
    v_fmac_f32 v23, v25, v27
    ds_read_b32 v24, v6 offset:1408
    ds_read_b32 v25, v6 offset:4480
    s_waitcnt vmcnt(12) lgkmcnt(0)
    v_lshlrev_b32 v26, 16, v76
    v_and_b32 v27, 0xffff0000, v76
    v_fmac_f32 v8, v24, v26
    v_fmac_f32 v9, v24, v27
    v_fmac_f32 v16, v25, v26
    v_fmac_f32 v17, v25, v27
    v_lshlrev_b32 v26, 16, v77
    v_and_b32 v27, 0xffff0000, v77
    v_fmac_f32 v10, v24, v26
    v_fmac_f32 v11, v24, v27
    v_fmac_f32 v18, v25, v26
    v_fmac_f32 v19, v25, v27
    v_lshlrev_b32 v26, 16, v78
    v_and_b32 v27, 0xffff0000, v78
    v_fmac_f32 v12, v24, v26
    v_fmac_f32 v13, v24, v27
    v_fmac_f32 v20, v25, v26
    v_fmac_f32 v21, v25, v27
    v_lshlrev_b32 v26, 16, v79
    v_and_b32 v27, 0xffff0000, v79
    v_fmac_f32 v14, v24, v26
    v_fmac_f32 v15, v24, v27
    v_fmac_f32 v22, v25, v26
    v_fmac_f32 v23, v25, v27
    ds_read_b32 v24, v6 offset:1536
    ds_read_b32 v25, v6 offset:4608
    s_waitcnt vmcnt(11) lgkmcnt(0)
    v_lshlrev_b32 v26, 16, v80
    v_and_b32 v27, 0xffff0000, v80
    v_fmac_f32 v8, v24, v26
    v_fmac_f32 v9, v24, v27
    v_fmac_f32 v16, v25, v26
    v_fmac_f32 v17, v25, v27
    v_lshlrev_b32 v26, 16, v81
    v_and_b32 v27, 0xffff0000, v81
    v_fmac_f32 v10, v24, v26
    v_fmac_f32 v11, v24, v27
    v_fmac_f32 v18, v25, v26
    v_fmac_f32 v19, v25, v27
    v_lshlrev_b32 v26, 16, v82
    v_and_b32 v27, 0xffff0000, v82
    v_fmac_f32 v12, v24, v26
    v_fmac_f32 v13, v24, v27
    v_fmac_f32 v20, v25, v26
    v_fmac_f32 v21, v25, v27
    v_lshlrev_b32 v26, 16, v83
    v_and_b32 v27, 0xffff0000, v83
    v_fmac_f32 v14, v24, v26
    v_fmac_f32 v15, v24, v27
    v_fmac_f32 v22, v25, v26
    v_fmac_f32 v23, v25, v27
    ds_read_b32 v24, v6 offset:1664
    ds_read_b32 v25, v6 offset:4736
    s_waitcnt vmcnt(10) lgkmcnt(0)
    v_lshlrev_b32 v26, 16, v84
    v_and_b32 v27, 0xffff0000, v84
    v_fmac_f32 v8, v24, v26
    v_fmac_f32 v9, v24, v27
    v_fmac_f32 v16, v25, v26
    v_fmac_f32 v17, v25, v27
    v_lshlrev_b32 v26, 16, v85
    v_and_b32 v27, 0xffff0000, v85
    v_fmac_f32 v10, v24, v26
    v_fmac_f32 v11, v24, v27
    v_fmac_f32 v18, v25, v26
    v_fmac_f32 v19, v25, v27
    v_lshlrev_b32 v26, 16, v86
    v_and_b32 v27, 0xffff0000, v86
    v_fmac_f32 v12, v24, v26
    v_fmac_f32 v13, v24, v27
    v_fmac_f32 v20, v25, v26
    v_fmac_f32 v21, v25, v27
    v_lshlrev_b32 v26, 16, v87
    v_and_b32 v27, 0xffff0000, v87
    v_fmac_f32 v14, v24, v26
    v_fmac_f32 v15, v24, v27
    v_fmac_f32 v22, v25, v26
    v_fmac_f32 v23, v25, v27
    ds_read_b32 v24, v6 offset:1792
    ds_read_b32 v25, v6 offset:4864
    s_waitcnt vmcnt(9) lgkmcnt(0)
    v_lshlrev_b32 v26, 16, v88
    v_and_b32 v27, 0xffff0000, v88
    v_fmac_f32 v8, v24, v26
    v_fmac_f32 v9, v24, v27
    v_fmac_f32 v16, v25, v26
    v_fmac_f32 v17, v25, v27
    v_lshlrev_b32 v26, 16, v89
    v_and_b32 v27, 0xffff0000, v89
    v_fmac_f32 v10, v24, v26
    v_fmac_f32 v11, v24, v27
    v_fmac_f32 v18, v25, v26
    v_fmac_f32 v19, v25, v27
    v_lshlrev_b32 v26, 16, v90
    v_and_b32 v27, 0xffff0000, v90
    v_fmac_f32 v12, v24, v26
    v_fmac_f32 v13, v24, v27
    v_fmac_f32 v20, v25, v26
    v_fmac_f32 v21, v25, v27
    v_lshlrev_b32 v26, 16, v91
    v_and_b32 v27, 0xffff0000, v91
    v_fmac_f32 v14, v24, v26
    v_fmac_f32 v15, v24, v27
    v_fmac_f32 v22, v25, v26
    v_fmac_f32 v23, v25, v27
    ds_read_b32 v24, v6 offset:1920
    ds_read_b32 v25, v6 offset:4992
    s_waitcnt vmcnt(8) lgkmcnt(0)
    v_lshlrev_b32 v26, 16, v92
    v_and_b32 v27, 0xffff0000, v92
    v_fmac_f32 v8, v24, v26
    v_fmac_f32 v9, v24, v27
    v_fmac_f32 v16, v25, v26
    v_fmac_f32 v17, v25, v27
    v_lshlrev_b32 v26, 16, v93
    v_and_b32 v27, 0xffff0000, v93
    v_fmac_f32 v10, v24, v26
    v_fmac_f32 v11, v24, v27
    v_fmac_f32 v18, v25, v26
    v_fmac_f32 v19, v25, v27
    v_lshlrev_b32 v26, 16, v94
    v_and_b32 v27, 0xffff0000, v94
    v_fmac_f32 v12, v24, v26
    v_fmac_f32 v13, v24, v27
    v_fmac_f32 v20, v25, v26
    v_fmac_f32 v21, v25, v27
    v_lshlrev_b32 v26, 16, v95
    v_and_b32 v27, 0xffff0000, v95
    v_fmac_f32 v14, v24, v26
    v_fmac_f32 v15, v24, v27
    v_fmac_f32 v22, v25, v26
    v_fmac_f32 v23, v25, v27
    ds_read_b32 v24, v6 offset:2048
    ds_read_b32 v25, v6 offset:5120
    s_waitcnt vmcnt(7) lgkmcnt(0)
    v_lshlrev_b32 v26, 16, v96
    v_and_b32 v27, 0xffff0000, v96
    v_fmac_f32 v8, v24, v26
    v_fmac_f32 v9, v24, v27
    v_fmac_f32 v16, v25, v26
    v_fmac_f32 v17, v25, v27
    v_lshlrev_b32 v26, 16, v97
    v_and_b32 v27, 0xffff0000, v97
    v_fmac_f32 v10, v24, v26
    v_fmac_f32 v11, v24, v27
    v_fmac_f32 v18, v25, v26
    v_fmac_f32 v19, v25, v27
    v_lshlrev_b32 v26, 16, v98
    v_and_b32 v27, 0xffff0000, v98
    v_fmac_f32 v12, v24, v26
    v_fmac_f32 v13, v24, v27
    v_fmac_f32 v20, v25, v26
    v_fmac_f32 v21, v25, v27
    v_lshlrev_b32 v26, 16, v99
    v_and_b32 v27, 0xffff0000, v99
    v_fmac_f32 v14, v24, v26
    v_fmac_f32 v15, v24, v27
    v_fmac_f32 v22, v25, v26
    v_fmac_f32 v23, v25, v27
    ds_read_b32 v24, v6 offset:2176
    ds_read_b32 v25, v6 offset:5248
    s_waitcnt vmcnt(6) lgkmcnt(0)
    v_lshlrev_b32 v26, 16, v100
    v_and_b32 v27, 0xffff0000, v100
    v_fmac_f32 v8, v24, v26
    v_fmac_f32 v9, v24, v27
    v_fmac_f32 v16, v25, v26
    v_fmac_f32 v17, v25, v27
    v_lshlrev_b32 v26, 16, v101
    v_and_b32 v27, 0xffff0000, v101
    v_fmac_f32 v10, v24, v26
    v_fmac_f32 v11, v24, v27
    v_fmac_f32 v18, v25, v26
    v_fmac_f32 v19, v25, v27
    v_lshlrev_b32 v26, 16, v102
    v_and_b32 v27, 0xffff0000, v102
    v_fmac_f32 v12, v24, v26
    v_fmac_f32 v13, v24, v27
    v_fmac_f32 v20, v25, v26
    v_fmac_f32 v21, v25, v27
    v_lshlrev_b32 v26, 16, v103
    v_and_b32 v27, 0xffff0000, v103
    v_fmac_f32 v14, v24, v26
    v_fmac_f32 v15, v24, v27
    v_fmac_f32 v22, v25, v26
    v_fmac_f32 v23, v25, v27
    ds_read_b32 v24, v6 offset:2304
    ds_read_b32 v25, v6 offset:5376
    s_waitcnt vmcnt(5) lgkmcnt(0)
    v_lshlrev_b32 v26, 16, v104
    v_and_b32 v27, 0xffff0000, v104
    v_fmac_f32 v8, v24, v26
    v_fmac_f32 v9, v24, v27
    v_fmac_f32 v16, v25, v26
    v_fmac_f32 v17, v25, v27
    v_lshlrev_b32 v26, 16, v105
    v_and_b32 v27, 0xffff0000, v105
    v_fmac_f32 v10, v24, v26
    v_fmac_f32 v11, v24, v27
    v_fmac_f32 v18, v25, v26
    v_fmac_f32 v19, v25, v27
    v_lshlrev_b32 v26, 16, v106
    v_and_b32 v27, 0xffff0000, v106
    v_fmac_f32 v12, v24, v26
    v_fmac_f32 v13, v24, v27
    v_fmac_f32 v20, v25, v26
    v_fmac_f32 v21, v25, v27
    v_lshlrev_b32 v26, 16, v107
    v_and_b32 v27, 0xffff0000, v107
    v_fmac_f32 v14, v24, v26
    v_fmac_f32 v15, v24, v27
    v_fmac_f32 v22, v25, v26
    v_fmac_f32 v23, v25, v27
    ds_read_b32 v24, v6 offset:2432
    ds_read_b32 v25, v6 offset:5504
    s_waitcnt vmcnt(4) lgkmcnt(0)
    v_lshlrev_b32 v26, 16, v108
    v_and_b32 v27, 0xffff0000, v108
    v_fmac_f32 v8, v24, v26
    v_fmac_f32 v9, v24, v27
    v_fmac_f32 v16, v25, v26
    v_fmac_f32 v17, v25, v27
    v_lshlrev_b32 v26, 16, v109
    v_and_b32 v27, 0xffff0000, v109
    v_fmac_f32 v10, v24, v26
    v_fmac_f32 v11, v24, v27
    v_fmac_f32 v18, v25, v26
    v_fmac_f32 v19, v25, v27
    v_lshlrev_b32 v26, 16, v110
    v_and_b32 v27, 0xffff0000, v110
    v_fmac_f32 v12, v24, v26
    v_fmac_f32 v13, v24, v27
    v_fmac_f32 v20, v25, v26
    v_fmac_f32 v21, v25, v27
    v_lshlrev_b32 v26, 16, v111
    v_and_b32 v27, 0xffff0000, v111
    v_fmac_f32 v14, v24, v26
    v_fmac_f32 v15, v24, v27
    v_fmac_f32 v22, v25, v26
    v_fmac_f32 v23, v25, v27
    ds_read_b32 v24, v6 offset:2560
    ds_read_b32 v25, v6 offset:5632
    s_waitcnt vmcnt(3) lgkmcnt(0)
    v_lshlrev_b32 v26, 16, v112
    v_and_b32 v27, 0xffff0000, v112
    v_fmac_f32 v8, v24, v26
    v_fmac_f32 v9, v24, v27
    v_fmac_f32 v16, v25, v26
    v_fmac_f32 v17, v25, v27
    v_lshlrev_b32 v26, 16, v113
    v_and_b32 v27, 0xffff0000, v113
    v_fmac_f32 v10, v24, v26
    v_fmac_f32 v11, v24, v27
    v_fmac_f32 v18, v25, v26
    v_fmac_f32 v19, v25, v27
    v_lshlrev_b32 v26, 16, v114
    v_and_b32 v27, 0xffff0000, v114
    v_fmac_f32 v12, v24, v26
    v_fmac_f32 v13, v24, v27
    v_fmac_f32 v20, v25, v26
    v_fmac_f32 v21, v25, v27
    v_lshlrev_b32 v26, 16, v115
    v_and_b32 v27, 0xffff0000, v115
    v_fmac_f32 v14, v24, v26
    v_fmac_f32 v15, v24, v27
    v_fmac_f32 v22, v25, v26
    v_fmac_f32 v23, v25, v27
    ds_read_b32 v24, v6 offset:2688
    ds_read_b32 v25, v6 offset:5760
    s_waitcnt vmcnt(2) lgkmcnt(0)
    v_lshlrev_b32 v26, 16, v116
    v_and_b32 v27, 0xffff0000, v116
    v_fmac_f32 v8, v24, v26
    v_fmac_f32 v9, v24, v27
    v_fmac_f32 v16, v25, v26
    v_fmac_f32 v17, v25, v27
    v_lshlrev_b32 v26, 16, v117
    v_and_b32 v27, 0xffff0000, v117
    v_fmac_f32 v10, v24, v26
    v_fmac_f32 v11, v24, v27
    v_fmac_f32 v18, v25, v26
    v_fmac_f32 v19, v25, v27
    v_lshlrev_b32 v26, 16, v118
    v_and_b32 v27, 0xffff0000, v118
    v_fmac_f32 v12, v24, v26
    v_fmac_f32 v13, v24, v27
    v_fmac_f32 v20, v25, v26
    v_fmac_f32 v21, v25, v27
    v_lshlrev_b32 v26, 16, v119
    v_and_b32 v27, 0xffff0000, v119
    v_fmac_f32 v14, v24, v26
    v_fmac_f32 v15, v24, v27
    v_fmac_f32 v22, v25, v26
    v_fmac_f32 v23, v25, v27
    ds_read_b32 v24, v6 offset:2816
    ds_read_b32 v25, v6 offset:5888
    s_waitcnt vmcnt(1) lgkmcnt(0)
    v_lshlrev_b32 v26, 16, v120
    v_and_b32 v27, 0xffff0000, v120
    v_fmac_f32 v8, v24, v26
    v_fmac_f32 v9, v24, v27
    v_fmac_f32 v16, v25, v26
    v_fmac_f32 v17, v25, v27
    v_lshlrev_b32 v26, 16, v121
    v_and_b32 v27, 0xffff0000, v121
    v_fmac_f32 v10, v24, v26
    v_fmac_f32 v11, v24, v27
    v_fmac_f32 v18, v25, v26
    v_fmac_f32 v19, v25, v27
    v_lshlrev_b32 v26, 16, v122
    v_and_b32 v27, 0xffff0000, v122
    v_fmac_f32 v12, v24, v26
    v_fmac_f32 v13, v24, v27
    v_fmac_f32 v20, v25, v26
    v_fmac_f32 v21, v25, v27
    v_lshlrev_b32 v26, 16, v123
    v_and_b32 v27, 0xffff0000, v123
    v_fmac_f32 v14, v24, v26
    v_fmac_f32 v15, v24, v27
    v_fmac_f32 v22, v25, v26
    v_fmac_f32 v23, v25, v27
    ds_read_b32 v24, v6 offset:2944
    ds_read_b32 v25, v6 offset:6016
    s_waitcnt vmcnt(0) lgkmcnt(0)
    v_lshlrev_b32 v26, 16, v124
    v_and_b32 v27, 0xffff0000, v124
    v_fmac_f32 v8, v24, v26
    v_fmac_f32 v9, v24, v27
    v_fmac_f32 v16, v25, v26
    v_fmac_f32 v17, v25, v27
    v_lshlrev_b32 v26, 16, v125
    v_and_b32 v27, 0xffff0000, v125
    v_fmac_f32 v10, v24, v26
    v_fmac_f32 v11, v24, v27
    v_fmac_f32 v18, v25, v26
    v_fmac_f32 v19, v25, v27
    v_lshlrev_b32 v26, 16, v126
    v_and_b32 v27, 0xffff0000, v126
    v_fmac_f32 v12, v24, v26
    v_fmac_f32 v13, v24, v27
    v_fmac_f32 v20, v25, v26
    v_fmac_f32 v21, v25, v27
    v_lshlrev_b32 v26, 16, v127
    v_and_b32 v27, 0xffff0000, v127
    v_fmac_f32 v14, v24, v26
    v_fmac_f32 v15, v24, v27
    v_fmac_f32 v22, v25, v26
    v_fmac_f32 v23, v25, v27
    s_barrier
    v_lshlrev_b32 v6, 9, v3
    v_lshl_add_u32 v6, v2, 5, v6
    ds_write_b128 v6, v[8:11] offset:8192
    ds_write_b128 v6, v[12:15] offset:8208
    ds_write_b128 v6, v[16:19] offset:8448
    ds_write_b128 v6, v[20:23] offset:8464
    s_waitcnt lgkmcnt(0)
    s_barrier
    v_cmp_gt_u32 vcc, 128, v0
    s_and_saveexec_b64 s[32:33], vcc
    s_cbranch_execz mod_kernel_end
    v_lshlrev_b32 v6, 2, v0
    ds_read_b32 v32, v6 offset:8192
    ds_read_b32 v33, v6 offset:8704
    ds_read_b32 v34, v6 offset:9216
    ds_read_b32 v35, v6 offset:9728
    ds_read_b32 v36, v6 offset:10240
    ds_read_b32 v37, v6 offset:10752
    ds_read_b32 v38, v6 offset:11264
    ds_read_b32 v39, v6 offset:11776
    ds_read_b32 v40, v6 offset:12288
    ds_read_b32 v41, v6 offset:12800
    ds_read_b32 v42, v6 offset:13312
    ds_read_b32 v43, v6 offset:13824
    ds_read_b32 v44, v6 offset:14336
    ds_read_b32 v45, v6 offset:14848
    ds_read_b32 v46, v6 offset:15360
    ds_read_b32 v47, v6 offset:15872
    ds_read_b32 v48, v6 offset:16384
    ds_read_b32 v49, v6 offset:16896
    ds_read_b32 v50, v6 offset:17408
    ds_read_b32 v51, v6 offset:17920
    ds_read_b32 v52, v6 offset:18432
    ds_read_b32 v53, v6 offset:18944
    ds_read_b32 v54, v6 offset:19456
    ds_read_b32 v55, v6 offset:19968
    ds_read_b32 v56, v6 offset:20480
    ds_read_b32 v57, v6 offset:20992
    ds_read_b32 v58, v6 offset:21504
    ds_read_b32 v59, v6 offset:22016
    ds_read_b32 v60, v6 offset:22528
    ds_read_b32 v61, v6 offset:23040
    ds_read_b32 v62, v6 offset:23552
    ds_read_b32 v63, v6 offset:24064
    s_waitcnt lgkmcnt(0)
    v_add_f32 v32, v32, v33
    v_add_f32 v32, v32, v34
    v_add_f32 v32, v32, v35
    v_add_f32 v32, v32, v36
    v_add_f32 v32, v32, v37
    v_add_f32 v32, v32, v38
    v_add_f32 v32, v32, v39
    v_add_f32 v32, v32, v40
    v_add_f32 v32, v32, v41
    v_add_f32 v32, v32, v42
    v_add_f32 v32, v32, v43
    v_add_f32 v32, v32, v44
    v_add_f32 v32, v32, v45
    v_add_f32 v32, v32, v46
    v_add_f32 v32, v32, v47
    v_add_f32 v32, v32, v48
    v_add_f32 v32, v32, v49
    v_add_f32 v32, v32, v50
    v_add_f32 v32, v32, v51
    v_add_f32 v32, v32, v52
    v_add_f32 v32, v32, v53
    v_add_f32 v32, v32, v54
    v_add_f32 v32, v32, v55
    v_add_f32 v32, v32, v56
    v_add_f32 v32, v32, v57
    v_add_f32 v32, v32, v58
    v_add_f32 v32, v32, v59
    v_add_f32 v32, v32, v60
    v_add_f32 v32, v32, v61
    v_add_f32 v32, v32, v62
    v_add_f32 v32, v32, v63
    v_cvt_pk_bf16_f32 v32, v32, v32
    v_lshlrev_b32 v32, 16, v32
    v_lshrrev_b32 v7, 6, v0
    v_mul_u32_u24 v7, 4608, v7
    v_and_b32 v8, 63, v0
    v_add_u32 v7, v7, v8
    s_lshl_b32 s30, s2, 6
    v_add_u32 v7, s30, v7
    v_lshlrev_b32 v7, 2, v7
    buffer_store_dword v32, v7, s[16:19], 0 offen
mod_kernel_end:
    s_endpgm
.text
.globl ln1_kernel
.p2align 8
.type ln1_kernel,@function
ln1_kernel:
    s_cmp_ge_u32 s2, 512
    s_cbranch_scc1 ln1_kernel_end
    s_load_dwordx2 s[20:21], s[0:1], 0
    s_load_dwordx2 s[24:25], s[0:1], 72
    s_waitcnt lgkmcnt(0)
    s_mov_b32 s8, s20
    s_mov_b32 s9, s21
    s_mov_b32 s10, 3145728
    s_mov_b32 s11, 0x00020000
    s_mov_b32 s12, s24
    s_mov_b32 s13, s25
    s_mov_b32 s14, 36864
    s_mov_b32 s15, 0x00020000
    s_add_u32 s16, s24, 1048576
    s_addc_u32 s17, s25, 0
    s_mov_b32 s18, 3145728
    s_mov_b32 s19, 0x00020000
    v_lshrrev_b32 v2, 6, v0
    s_lshl_b32 s30, s2, 2
    v_add_u32 v2, s30, v2
    v_and_b32 v1, 63, v0
    s_movk_i32 s31, 1536
    v_mul_lo_u32 v3, s31, v2
    v_lshl_add_u32 v3, v1, 3, v3
    buffer_load_dwordx2 v[4:5], v3, s[8:11], 0 offen offset:0
    buffer_load_dwordx2 v[6:7], v3, s[8:11], 0 offen offset:512
    buffer_load_dwordx2 v[8:9], v3, s[8:11], 0 offen offset:1024
    v_lshrrev_b32 v10, 10, v2
    v_mul_u32_u24 v10, 18432, v10
    v_lshl_add_u32 v10, v1, 4, v10
    v_add_u32 v11, 0, v10
    buffer_load_dwordx4 v[40:43], v11, s[12:15], 0 offen offset:0
    buffer_load_dwordx4 v[44:47], v11, s[12:15], 0 offen offset:1024
    buffer_load_dwordx4 v[48:51], v11, s[12:15], 0 offen offset:2048
    v_add_u32 v11, 3072, v10
    buffer_load_dwordx4 v[56:59], v11, s[12:15], 0 offen offset:0
    buffer_load_dwordx4 v[60:63], v11, s[12:15], 0 offen offset:1024
    buffer_load_dwordx4 v[64:67], v11, s[12:15], 0 offen offset:2048
    s_waitcnt vmcnt(6)
    v_lshlrev_b32 v20, 16, v4
    v_and_b32 v21, 0xffff0000, v4
    v_lshlrev_b32 v22, 16, v5
    v_and_b32 v23, 0xffff0000, v5
    v_lshlrev_b32 v24, 16, v6
    v_and_b32 v25, 0xffff0000, v6
    v_lshlrev_b32 v26, 16, v7
    v_and_b32 v27, 0xffff0000, v7
    v_lshlrev_b32 v28, 16, v8
    v_and_b32 v29, 0xffff0000, v8
    v_lshlrev_b32 v30, 16, v9
    v_and_b32 v31, 0xffff0000, v9
    v_add_f32 v12, v20, v21
    v_add_f32 v12, v12, v22
    v_add_f32 v12, v12, v23
    v_add_f32 v12, v12, v24
    v_add_f32 v12, v12, v25
    v_add_f32 v12, v12, v26
    v_add_f32 v12, v12, v27
    v_add_f32 v12, v12, v28
    v_add_f32 v12, v12, v29
    v_add_f32 v12, v12, v30
    v_add_f32 v12, v12, v31
    ds_swizzle_b32 v13, v12 offset:0x41f
    s_waitcnt lgkmcnt(0)
    v_add_f32 v12, v12, v13
    ds_swizzle_b32 v13, v12 offset:0x81f
    s_waitcnt lgkmcnt(0)
    v_add_f32 v12, v12, v13
    ds_swizzle_b32 v13, v12 offset:0x101f
    s_waitcnt lgkmcnt(0)
    v_add_f32 v12, v12, v13
    ds_swizzle_b32 v13, v12 offset:0x201f
    s_waitcnt lgkmcnt(0)
    v_add_f32 v12, v12, v13
    ds_swizzle_b32 v13, v12 offset:0x401f
    s_waitcnt lgkmcnt(0)
    v_add_f32 v12, v12, v13
    s_nop 0
    v_readlane_b32 s58, v12, 32
    v_readlane_b32 s59, v12, 0
    s_nop 1
    v_mov_b32 v12, s58
    v_add_f32 v12, s59, v12
    v_mul_f32 v12, 0x3aaaaaab, v12
    v_sub_f32 v20, v20, v12
    v_sub_f32 v21, v21, v12
    v_sub_f32 v22, v22, v12
    v_sub_f32 v23, v23, v12
    v_sub_f32 v24, v24, v12
    v_sub_f32 v25, v25, v12
    v_sub_f32 v26, v26, v12
    v_sub_f32 v27, v27, v12
    v_sub_f32 v28, v28, v12
    v_sub_f32 v29, v29, v12
    v_sub_f32 v30, v30, v12
    v_sub_f32 v31, v31, v12
    v_mul_f32 v14, v20, v20
    v_fmac_f32 v14, v21, v21
    v_fmac_f32 v14, v22, v22
    v_fmac_f32 v14, v23, v23
    v_fmac_f32 v14, v24, v24
    v_fmac_f32 v14, v25, v25
    v_fmac_f32 v14, v26, v26
    v_fmac_f32 v14, v27, v27
    v_fmac_f32 v14, v28, v28
    v_fmac_f32 v14, v29, v29
    v_fmac_f32 v14, v30, v30
    v_fmac_f32 v14, v31, v31
    ds_swizzle_b32 v13, v14 offset:0x41f
    s_waitcnt lgkmcnt(0)
    v_add_f32 v14, v14, v13
    ds_swizzle_b32 v13, v14 offset:0x81f
    s_waitcnt lgkmcnt(0)
    v_add_f32 v14, v14, v13
    ds_swizzle_b32 v13, v14 offset:0x101f
    s_waitcnt lgkmcnt(0)
    v_add_f32 v14, v14, v13
    ds_swizzle_b32 v13, v14 offset:0x201f
    s_waitcnt lgkmcnt(0)
    v_add_f32 v14, v14, v13
    ds_swizzle_b32 v13, v14 offset:0x401f
    s_waitcnt lgkmcnt(0)
    v_add_f32 v14, v14, v13
    s_nop 0
    v_readlane_b32 s58, v14, 32
    v_readlane_b32 s59, v14, 0
    s_nop 1
    v_mov_b32 v14, s58
    v_add_f32 v14, s59, v14
    v_mov_b32 v15, 0x3727c5ac
    v_fmac_f32 v15, 0x3aaaaaab, v14
    v_rsq_f32 v15, v15
    s_waitcnt vmcnt(0)
    v_mul_f32 v20, v20, v15
    v_add_f32 v13, 1.0, v56
    v_fma_f32 v20, v20, v13, v40
    v_mul_f32 v21, v21, v15
    v_add_f32 v13, 1.0, v57
    v_fma_f32 v21, v21, v13, v41
    v_mul_f32 v22, v22, v15
    v_add_f32 v13, 1.0, v58
    v_fma_f32 v22, v22, v13, v42
    v_mul_f32 v23, v23, v15
    v_add_f32 v13, 1.0, v59
    v_fma_f32 v23, v23, v13, v43
    v_mul_f32 v24, v24, v15
    v_add_f32 v13, 1.0, v60
    v_fma_f32 v24, v24, v13, v44
    v_mul_f32 v25, v25, v15
    v_add_f32 v13, 1.0, v61
    v_fma_f32 v25, v25, v13, v45
    v_mul_f32 v26, v26, v15
    v_add_f32 v13, 1.0, v62
    v_fma_f32 v26, v26, v13, v46
    v_mul_f32 v27, v27, v15
    v_add_f32 v13, 1.0, v63
    v_fma_f32 v27, v27, v13, v47
    v_mul_f32 v28, v28, v15
    v_add_f32 v13, 1.0, v64
    v_fma_f32 v28, v28, v13, v48
    v_mul_f32 v29, v29, v15
    v_add_f32 v13, 1.0, v65
    v_fma_f32 v29, v29, v13, v49
    v_mul_f32 v30, v30, v15
    v_add_f32 v13, 1.0, v66
    v_fma_f32 v30, v30, v13, v50
    v_mul_f32 v31, v31, v15
    v_add_f32 v13, 1.0, v67
    v_fma_f32 v31, v31, v13, v51
    v_cvt_pk_bf16_f32 v4, v20, v21
    v_cvt_pk_bf16_f32 v5, v22, v23
    v_cvt_pk_bf16_f32 v6, v24, v25
    v_cvt_pk_bf16_f32 v7, v26, v27
    v_cvt_pk_bf16_f32 v8, v28, v29
    v_cvt_pk_bf16_f32 v9, v30, v31
    buffer_store_dwordx2 v[4:5], v3, s[16:19], 0 offen offset:0
    buffer_store_dwordx2 v[6:7], v3, s[16:19], 0 offen offset:512
    buffer_store_dwordx2 v[8:9], v3, s[16:19], 0 offen offset:1024
ln1_kernel_end:
    s_endpgm
.text
.globl qkv_kernel
.p2align 8
.type qkv_kernel,@function
qkv_kernel:
    s_cmp_ge_u32 s2, 256
    s_cbranch_scc1 qkv_kernel_end
    s_load_dwordx2 s[20:21], s[0:1], 72
    s_load_dwordx2 s[22:23], s[0:1], 16
    s_load_dwordx2 s[24:25], s[0:1], 72
    s_load_dwordx2 s[26:27], s[0:1], 72
    s_load_dwordx2 s[28:29], s[0:1], 0
    s_and_b32 s40, s2, 7
    s_mul_i32 s40, s40, 32
    s_lshr_b32 s2, s2, 3
    s_add_u32 s2, s2, s40
    s_lshr_b32 s30, s2, 8
    s_mul_i32 s31, s30, 256
    s_sub_u32 s31, s2, s31
    s_lshr_b32 s32, s31, 4
    s_mul_i32 s33, s32, 16
    s_sub_u32 s33, s31, s33
    s_lshr_b32 s34, s30, 1
    s_and_b32 s35, s30, 1
    v_lshrrev_b32 v203, 6, v0
    s_nop 0
    v_readfirstlane_b32 s36, v203
    v_and_b32 v1, 63, v0
    s_mul_i32 s37, s34, 0
    s_mul_i32 s40, s35, 0
    s_add_u32 s37, s37, s40
    s_mul_i32 s40, s32, 196608
    s_add_u32 s37, s37, s40
    s_mul_i32 s38, s34, 0
    s_mul_i32 s40, s35, 0
    s_add_u32 s38, s38, s40
    s_mul_i32 s40, s33, 288
    s_add_u32 s38, s38, s40
    s_mul_i32 s39, s34, 0
    s_mul_i32 s40, s35, 0
    s_add_u32 s39, s39, s40
    s_mul_i32 s40, s32, 589824
    s_add_u32 s39, s39, s40
    s_mul_i32 s40, s33, 288
    s_add_u32 s39, s39, s40
    s_waitcnt lgkmcnt(0)
    s_add_u32 s8, s20, 1048576
    s_addc_u32 s9, s21, 0
    s_add_u32 s8, s8, s37
    s_addc_u32 s9, s9, 0
    s_mov_b32 s11, 0x00020000
    s_add_u32 s12, s22, 0
    s_addc_u32 s13, s23, 0
    s_add_u32 s12, s12, s38
    s_addc_u32 s13, s13, 0
    s_mov_b32 s15, 0x00020000
    s_add_u32 s16, s24, 4194304
    s_addc_u32 s17, s25, 0
    s_add_u32 s16, s16, s39
    s_addc_u32 s17, s17, 0
    s_mov_b32 s19, 0x00020000
    s_mov_b32 s10, 196608
    s_mov_b32 s14, 3534624
    s_mov_b32 s18, 585504
    s_lshl_b32 s40, s36, 6
    v_add_u32 v175, s40, v1
    v_add_u32 v175, 0, v175
    v_lshrrev_b32 v176, 3, v175
    v_and_b32 v177, 7, v175
    v_and_b32 v178, 7, v176
    v_xor_b32 v177, v177, v178
    s_mov_b32 s40, 1536
    v_mul_lo_u32 v176, s40, v176
    v_lshl_add_u32 v164, v177, 4, v176
    s_lshl_b32 s40, s36, 6
    v_add_u32 v175, s40, v1
    v_add_u32 v175, 256, v175
    v_lshrrev_b32 v176, 3, v175
    v_and_b32 v177, 7, v175
    v_and_b32 v178, 7, v176
    v_xor_b32 v177, v177, v178
    s_mov_b32 s40, 1536
    v_mul_lo_u32 v176, s40, v176
    v_lshl_add_u32 v165, v177, 4, v176
    s_lshl_b32 s40, s36, 6
    v_add_u32 v175, s40, v1
    v_add_u32 v175, 512, v175
    v_lshrrev_b32 v176, 3, v175
    v_and_b32 v177, 7, v175
    v_and_b32 v178, 7, v176
    v_xor_b32 v177, v177, v178
    s_mov_b32 s40, 1536
    v_mul_lo_u32 v176, s40, v176
    v_lshl_add_u32 v166, v177, 4, v176
    s_lshl_b32 s40, s36, 6
    v_add_u32 v175, s40, v1
    v_add_u32 v175, 768, v175
    v_lshrrev_b32 v176, 3, v175
    v_and_b32 v177, 7, v175
    v_and_b32 v178, 7, v176
    v_xor_b32 v177, v177, v178
    s_mov_b32 s40, 1536
    v_mul_lo_u32 v176, s40, v176
    v_lshl_add_u32 v167, v177, 4, v176
    s_lshl_b32 s40, s36, 6
    v_add_u32 v175, s40, v1
    v_add_u32 v175, 0, v175
    s_mov_b32 s40, 238609295
    v_mul_hi_u32 v176, s40, v175
    v_mul_u32_u24 v177, 18, v176
    v_sub_u32 v177, v175, v177
    v_cmp_gt_u32 vcc, 18, v177
    s_nop 1
    v_cndmask_b32 v177, 0, v177, vcc
    v_min_u32 v176, 63, v176
    v_and_b32 v178, 0xfffffff3, v176
    v_lshlrev_b32 v179, 1, v176
    v_and_b32 v179, 8, v179
    v_or_b32 v178, v178, v179
    v_lshrrev_b32 v179, 1, v176
    v_and_b32 v179, 4, v179
    v_or_b32 v178, v178, v179
    s_mov_b32 s40, 4608
    v_mul_lo_u32 v178, s40, v178
    v_lshl_add_u32 v168, v177, 4, v178
    s_lshl_b32 s40, s36, 6
    v_add_u32 v175, s40, v1
    v_add_u32 v175, 256, v175
    s_mov_b32 s40, 238609295
    v_mul_hi_u32 v176, s40, v175
    v_mul_u32_u24 v177, 18, v176
    v_sub_u32 v177, v175, v177
    v_cmp_gt_u32 vcc, 18, v177
    s_nop 1
    v_cndmask_b32 v177, 0, v177, vcc
    v_min_u32 v176, 63, v176
    v_and_b32 v178, 0xfffffff3, v176
    v_lshlrev_b32 v179, 1, v176
    v_and_b32 v179, 8, v179
    v_or_b32 v178, v178, v179
    v_lshrrev_b32 v179, 1, v176
    v_and_b32 v179, 4, v179
    v_or_b32 v178, v178, v179
    s_mov_b32 s40, 4608
    v_mul_lo_u32 v178, s40, v178
    v_lshl_add_u32 v169, v177, 4, v178
    s_lshl_b32 s40, s36, 6
    v_add_u32 v175, s40, v1
    v_add_u32 v175, 512, v175
    s_mov_b32 s40, 238609295
    v_mul_hi_u32 v176, s40, v175
    v_mul_u32_u24 v177, 18, v176
    v_sub_u32 v177, v175, v177
    v_cmp_gt_u32 vcc, 18, v177
    s_nop 1
    v_cndmask_b32 v177, 0, v177, vcc
    v_min_u32 v176, 63, v176
    v_and_b32 v178, 0xfffffff3, v176
    v_lshlrev_b32 v179, 1, v176
    v_and_b32 v179, 8, v179
    v_or_b32 v178, v178, v179
    v_lshrrev_b32 v179, 1, v176
    v_and_b32 v179, 4, v179
    v_or_b32 v178, v178, v179
    s_mov_b32 s40, 4608
    v_mul_lo_u32 v178, s40, v178
    v_lshl_add_u32 v170, v177, 4, v178
    s_lshl_b32 s40, s36, 6
    v_add_u32 v175, s40, v1
    v_add_u32 v175, 768, v175
    s_mov_b32 s40, 238609295
    v_mul_hi_u32 v176, s40, v175
    v_mul_u32_u24 v177, 18, v176
    v_sub_u32 v177, v175, v177
    v_cmp_gt_u32 vcc, 18, v177
    s_nop 1
    v_cndmask_b32 v177, 0, v177, vcc
    v_min_u32 v176, 63, v176
    v_and_b32 v178, 0xfffffff3, v176
    v_lshlrev_b32 v179, 1, v176
    v_and_b32 v179, 8, v179
    v_or_b32 v178, v178, v179
    v_lshrrev_b32 v179, 1, v176
    v_and_b32 v179, 4, v179
    v_or_b32 v178, v178, v179
    s_mov_b32 s40, 4608
    v_mul_lo_u32 v178, s40, v178
    v_lshl_add_u32 v171, v177, 4, v178
    s_lshl_b32 s40, s36, 6
    v_add_u32 v175, s40, v1
    v_add_u32 v175, 1024, v175
    s_mov_b32 s40, 238609295
    v_mul_hi_u32 v176, s40, v175
    v_mul_u32_u24 v177, 18, v176
    v_sub_u32 v177, v175, v177
    v_cmp_gt_u32 vcc, 18, v177
    s_nop 1
    v_cndmask_b32 v177, 0, v177, vcc
    v_min_u32 v176, 63, v176
    v_and_b32 v178, 0xfffffff3, v176
    v_lshlrev_b32 v179, 1, v176
    v_and_b32 v179, 8, v179
    v_or_b32 v178, v178, v179
    v_lshrrev_b32 v179, 1, v176
    v_and_b32 v179, 4, v179
    v_or_b32 v178, v178, v179
    s_mov_b32 s40, 4608
    v_mul_lo_u32 v178, s40, v178
    v_lshl_add_u32 v172, v177, 4, v178
    s_lshr_b32 s41, s36, 0
    s_mul_i32 s42, s41, 1
    s_sub_u32 s42, s36, s42
    v_and_b32 v175, 15, v1
    v_lshrrev_b32 v176, 4, v1
    s_mul_i32 s40, s41, 32
    v_add_u32 v177, s40, v175
    v_and_b32 v178, 7, v177
    v_xor_b32 v178, v178, v176
    v_lshlrev_b32 v177, 7, v177
    v_lshl_add_u32 v173, v178, 4, v177
    v_lshrrev_b32 v177, 2, v1
    v_and_b32 v177, 3, v177
    v_and_b32 v178, 1, v176
    v_lshl_add_u32 v177, v178, 2, v177
    v_lshrrev_b32 v178, 1, v176
    v_lshl_add_u32 v177, v178, 4, v177
    v_mul_u32_u24 v177, 288, v177
    v_and_b32 v178, 3, v1
    v_lshl_add_u32 v177, v178, 3, v177
    s_mul_i32 s40, s42, 288
    v_add_u32 v174, s40, v177
    v_add_u32 v174, 16384, v174
    s_lshl_b32 s43, s36, 10
    s_mov_b32 s44, 0
    s_mov_b32 s45, 0
    v_xor_b32 v183, 64, v173
    v_xor_b32 v184, 64, v174
    v_add_u32 v187, 0, v173
    v_add_u32 v188, 0, v183
    v_add_u32 v189, 0, v174
    v_add_u32 v190, 0, v184
    v_add_u32 v191, 36864, v173
    v_add_u32 v192, 36864, v183
    v_add_u32 v193, 36864, v174
    v_add_u32 v194, 36864, v184
    v_add_u32 v195, 73728, v173
    v_add_u32 v196, 73728, v183
    v_add_u32 v197, 73728, v174
    v_add_u32 v198, 73728, v184
    s_add_u32 m0, s43, 0
    s_nop 0
    buffer_load_dwordx4 v164, s[8:11], s44 offen lds
    s_add_u32 m0, s43, 4096
    s_nop 0
    buffer_load_dwordx4 v165, s[8:11], s44 offen lds
    s_add_u32 m0, s43, 8192
    s_nop 0
    buffer_load_dwordx4 v166, s[8:11], s44 offen lds
    s_add_u32 m0, s43, 12288
    s_nop 0
    buffer_load_dwordx4 v167, s[8:11], s44 offen lds
    s_add_u32 m0, s43, 16384
    s_nop 0
    buffer_load_dwordx4 v168, s[12:15], s45 offen lds
    s_add_u32 m0, s43, 20480
    s_nop 0
    buffer_load_dwordx4 v169, s[12:15], s45 offen lds
    s_add_u32 m0, s43, 24576
    s_nop 0
    buffer_load_dwordx4 v170, s[12:15], s45 offen lds
    s_add_u32 m0, s43, 28672
    s_nop 0
    buffer_load_dwordx4 v171, s[12:15], s45 offen lds
    s_add_u32 m0, s43, 32768
    s_nop 0
    buffer_load_dwordx4 v172, s[12:15], s45 offen lds
    s_add_u32 s44, s44, 128
    s_add_u32 s45, s45, 294912
    s_add_u32 m0, s43, 36864
    s_nop 0
    buffer_load_dwordx4 v164, s[8:11], s44 offen lds
    s_add_u32 m0, s43, 40960
    s_nop 0
    buffer_load_dwordx4 v165, s[8:11], s44 offen lds
    s_add_u32 m0, s43, 45056
    s_nop 0
    buffer_load_dwordx4 v166, s[8:11], s44 offen lds
    s_add_u32 m0, s43, 49152
    s_nop 0
    buffer_load_dwordx4 v167, s[8:11], s44 offen lds
    s_add_u32 m0, s43, 53248
    s_nop 0
    buffer_load_dwordx4 v168, s[12:15], s45 offen lds
    s_add_u32 m0, s43, 57344
    s_nop 0
    buffer_load_dwordx4 v169, s[12:15], s45 offen lds
    s_add_u32 m0, s43, 61440
    s_nop 0
    buffer_load_dwordx4 v170, s[12:15], s45 offen lds
    s_add_u32 m0, s43, 65536
    s_nop 0
    buffer_load_dwordx4 v171, s[12:15], s45 offen lds
    s_add_u32 m0, s43, 69632
    s_nop 0
    buffer_load_dwordx4 v172, s[12:15], s45 offen lds
    s_add_u32 s44, s44, 128
    s_add_u32 s45, s45, 294912
    s_waitcnt vmcnt(9)
    s_barrier
    ds_read_b128 v[76:79], v187 offset:0
    ds_read_b128 v[80:83], v187 offset:2048
    ds_read_b64_tr_b16 v[92:93], v189 offset:0
    ds_read_b64_tr_b16 v[94:95], v189 offset:2304
    ds_read_b64_tr_b16 v[96:97], v189 offset:32
    ds_read_b64_tr_b16 v[98:99], v189 offset:2336
    ds_read_b64_tr_b16 v[100:101], v189 offset:64
    ds_read_b64_tr_b16 v[102:103], v189 offset:2368
    ds_read_b64_tr_b16 v[104:105], v189 offset:96
    ds_read_b64_tr_b16 v[106:107], v189 offset:2400
    ds_read_b64_tr_b16 v[108:109], v189 offset:128
    ds_read_b64_tr_b16 v[110:111], v189 offset:2432
    ds_read_b64_tr_b16 v[112:113], v189 offset:160
    ds_read_b64_tr_b16 v[114:115], v189 offset:2464
    ds_read_b64_tr_b16 v[116:117], v189 offset:192
    ds_read_b64_tr_b16 v[118:119], v189 offset:2496
    ds_read_b64_tr_b16 v[120:121], v189 offset:224
    ds_read_b64_tr_b16 v[122:123], v189 offset:2528
    ds_read_b64_tr_b16 v[124:125], v189 offset:256
    ds_read_b64_tr_b16 v[126:127], v189 offset:2560
    s_add_u32 m0, s43, 73728
    s_nop 0
    buffer_load_dwordx4 v164, s[8:11], s44 offen lds
    s_add_u32 m0, s43, 77824
    s_nop 0
    buffer_load_dwordx4 v165, s[8:11], s44 offen lds
    s_add_u32 m0, s43, 81920
    s_nop 0
    buffer_load_dwordx4 v166, s[8:11], s44 offen lds
    s_add_u32 m0, s43, 86016
    s_nop 0
    buffer_load_dwordx4 v167, s[8:11], s44 offen lds
    s_add_u32 m0, s43, 90112
    s_nop 0
    buffer_load_dwordx4 v168, s[12:15], s45 offen lds
    s_add_u32 m0, s43, 94208
    s_nop 0
    buffer_load_dwordx4 v169, s[12:15], s45 offen lds
    s_add_u32 m0, s43, 98304
    s_nop 0
    buffer_load_dwordx4 v170, s[12:15], s45 offen lds
    s_add_u32 m0, s43, 102400
    s_nop 0
    buffer_load_dwordx4 v171, s[12:15], s45 offen lds
    s_add_u32 m0, s43, 106496
    s_nop 0
    buffer_load_dwordx4 v172, s[12:15], s45 offen lds
    s_add_u32 s44, s44, 128
    s_add_u32 s45, s45, 294912
    ds_read_b128 v[84:87], v188 offset:0
    ds_read_b128 v[88:91], v188 offset:2048
    ds_read_b64_tr_b16 v[128:129], v189 offset:9216
    ds_read_b64_tr_b16 v[130:131], v189 offset:11520
    ds_read_b64_tr_b16 v[132:133], v189 offset:9248
    ds_read_b64_tr_b16 v[134:135], v189 offset:11552
    ds_read_b64_tr_b16 v[136:137], v189 offset:9280
    ds_read_b64_tr_b16 v[138:139], v189 offset:11584
    ds_read_b64_tr_b16 v[140:141], v189 offset:9312
    ds_read_b64_tr_b16 v[142:143], v189 offset:11616
    ds_read_b64_tr_b16 v[144:145], v189 offset:9344
    ds_read_b64_tr_b16 v[146:147], v189 offset:11648
    ds_read_b64_tr_b16 v[148:149], v189 offset:9376
    ds_read_b64_tr_b16 v[150:151], v189 offset:11680
    ds_read_b64_tr_b16 v[152:153], v189 offset:9408
    ds_read_b64_tr_b16 v[154:155], v189 offset:11712
    ds_read_b64_tr_b16 v[156:157], v189 offset:9440
    ds_read_b64_tr_b16 v[158:159], v189 offset:11744
    ds_read_b64_tr_b16 v[160:161], v189 offset:9472
    ds_read_b64_tr_b16 v[162:163], v189 offset:11776
    s_waitcnt lgkmcnt(15)
    v_mfma_f32_16x16x32_bf16 v[4:7], v[92:95], v[76:79], 0
    v_mfma_f32_16x16x32_bf16 v[8:11], v[92:95], v[80:83], 0
    v_mfma_f32_16x16x32_bf16 v[12:15], v[96:99], v[76:79], 0
    v_mfma_f32_16x16x32_bf16 v[16:19], v[96:99], v[80:83], 0
    v_mfma_f32_16x16x32_bf16 v[20:23], v[100:103], v[76:79], 0
    v_mfma_f32_16x16x32_bf16 v[24:27], v[100:103], v[80:83], 0
    v_mfma_f32_16x16x32_bf16 v[28:31], v[104:107], v[76:79], 0
    v_mfma_f32_16x16x32_bf16 v[32:35], v[104:107], v[80:83], 0
    v_mfma_f32_16x16x32_bf16 v[36:39], v[108:111], v[76:79], 0
    v_mfma_f32_16x16x32_bf16 v[40:43], v[108:111], v[80:83], 0
    v_mfma_f32_16x16x32_bf16 v[44:47], v[112:115], v[76:79], 0
    v_mfma_f32_16x16x32_bf16 v[48:51], v[112:115], v[80:83], 0
    v_mfma_f32_16x16x32_bf16 v[52:55], v[116:119], v[76:79], 0
    v_mfma_f32_16x16x32_bf16 v[56:59], v[116:119], v[80:83], 0
    v_mfma_f32_16x16x32_bf16 v[60:63], v[120:123], v[76:79], 0
    v_mfma_f32_16x16x32_bf16 v[64:67], v[120:123], v[80:83], 0
    v_mfma_f32_16x16x32_bf16 v[68:71], v[124:127], v[76:79], 0
    v_mfma_f32_16x16x32_bf16 v[72:75], v[124:127], v[80:83], 0
    s_waitcnt lgkmcnt(0)
    v_mfma_f32_16x16x32_bf16 v[4:7], v[128:131], v[84:87], v[4:7]
    v_mfma_f32_16x16x32_bf16 v[8:11], v[128:131], v[88:91], v[8:11]
    v_mfma_f32_16x16x32_bf16 v[12:15], v[132:135], v[84:87], v[12:15]
    v_mfma_f32_16x16x32_bf16 v[16:19], v[132:135], v[88:91], v[16:19]
    v_mfma_f32_16x16x32_bf16 v[20:23], v[136:139], v[84:87], v[20:23]
    v_mfma_f32_16x16x32_bf16 v[24:27], v[136:139], v[88:91], v[24:27]
    v_mfma_f32_16x16x32_bf16 v[28:31], v[140:143], v[84:87], v[28:31]
    v_mfma_f32_16x16x32_bf16 v[32:35], v[140:143], v[88:91], v[32:35]
    v_mfma_f32_16x16x32_bf16 v[36:39], v[144:147], v[84:87], v[36:39]
    v_mfma_f32_16x16x32_bf16 v[40:43], v[144:147], v[88:91], v[40:43]
    v_mfma_f32_16x16x32_bf16 v[44:47], v[148:151], v[84:87], v[44:47]
    v_mfma_f32_16x16x32_bf16 v[48:51], v[148:151], v[88:91], v[48:51]
    v_mfma_f32_16x16x32_bf16 v[52:55], v[152:155], v[84:87], v[52:55]
    v_mfma_f32_16x16x32_bf16 v[56:59], v[152:155], v[88:91], v[56:59]
    v_mfma_f32_16x16x32_bf16 v[60:63], v[156:159], v[84:87], v[60:63]
    v_mfma_f32_16x16x32_bf16 v[64:67], v[156:159], v[88:91], v[64:67]
    v_mfma_f32_16x16x32_bf16 v[68:71], v[160:163], v[84:87], v[68:71]
    v_mfma_f32_16x16x32_bf16 v[72:75], v[160:163], v[88:91], v[72:75]
    s_waitcnt vmcnt(9)
    s_barrier
    ds_read_b128 v[76:79], v191 offset:0
    ds_read_b128 v[80:83], v191 offset:2048
    ds_read_b64_tr_b16 v[92:93], v193 offset:0
    ds_read_b64_tr_b16 v[94:95], v193 offset:2304
    ds_read_b64_tr_b16 v[96:97], v193 offset:32
    ds_read_b64_tr_b16 v[98:99], v193 offset:2336
    ds_read_b64_tr_b16 v[100:101], v193 offset:64
    ds_read_b64_tr_b16 v[102:103], v193 offset:2368
    ds_read_b64_tr_b16 v[104:105], v193 offset:96
    ds_read_b64_tr_b16 v[106:107], v193 offset:2400
    ds_read_b64_tr_b16 v[108:109], v193 offset:128
    ds_read_b64_tr_b16 v[110:111], v193 offset:2432
    ds_read_b64_tr_b16 v[112:113], v193 offset:160
    ds_read_b64_tr_b16 v[114:115], v193 offset:2464
    ds_read_b64_tr_b16 v[116:117], v193 offset:192
    ds_read_b64_tr_b16 v[118:119], v193 offset:2496
    ds_read_b64_tr_b16 v[120:121], v193 offset:224
    ds_read_b64_tr_b16 v[122:123], v193 offset:2528
    ds_read_b64_tr_b16 v[124:125], v193 offset:256
    ds_read_b64_tr_b16 v[126:127], v193 offset:2560
    s_add_u32 m0, s43, 0
    s_nop 0
    buffer_load_dwordx4 v164, s[8:11], s44 offen lds
    s_add_u32 m0, s43, 4096
    s_nop 0
    buffer_load_dwordx4 v165, s[8:11], s44 offen lds
    s_add_u32 m0, s43, 8192
    s_nop 0
    buffer_load_dwordx4 v166, s[8:11], s44 offen lds
    s_add_u32 m0, s43, 12288
    s_nop 0
    buffer_load_dwordx4 v167, s[8:11], s44 offen lds
    s_add_u32 m0, s43, 16384
    s_nop 0
    buffer_load_dwordx4 v168, s[12:15], s45 offen lds
    s_add_u32 m0, s43, 20480
    s_nop 0
    buffer_load_dwordx4 v169, s[12:15], s45 offen lds
    s_add_u32 m0, s43, 24576
    s_nop 0
    buffer_load_dwordx4 v170, s[12:15], s45 offen lds
    s_add_u32 m0, s43, 28672
    s_nop 0
    buffer_load_dwordx4 v171, s[12:15], s45 offen lds
    s_add_u32 m0, s43, 32768
    s_nop 0
    buffer_load_dwordx4 v172, s[12:15], s45 offen lds
    s_add_u32 s44, s44, 128
    s_add_u32 s45, s45, 294912
    ds_read_b128 v[84:87], v192 offset:0
    ds_read_b128 v[88:91], v192 offset:2048
    ds_read_b64_tr_b16 v[128:129], v193 offset:9216
    ds_read_b64_tr_b16 v[130:131], v193 offset:11520
    ds_read_b64_tr_b16 v[132:133], v193 offset:9248
    ds_read_b64_tr_b16 v[134:135], v193 offset:11552
    ds_read_b64_tr_b16 v[136:137], v193 offset:9280
    ds_read_b64_tr_b16 v[138:139], v193 offset:11584
    ds_read_b64_tr_b16 v[140:141], v193 offset:9312
    ds_read_b64_tr_b16 v[142:143], v193 offset:11616
    ds_read_b64_tr_b16 v[144:145], v193 offset:9344
    ds_read_b64_tr_b16 v[146:147], v193 offset:11648
    ds_read_b64_tr_b16 v[148:149], v193 offset:9376
    ds_read_b64_tr_b16 v[150:151], v193 offset:11680
    ds_read_b64_tr_b16 v[152:153], v193 offset:9408
    ds_read_b64_tr_b16 v[154:155], v193 offset:11712
    ds_read_b64_tr_b16 v[156:157], v193 offset:9440
    ds_read_b64_tr_b16 v[158:159], v193 offset:11744
    ds_read_b64_tr_b16 v[160:161], v193 offset:9472
    ds_read_b64_tr_b16 v[162:163], v193 offset:11776
    s_waitcnt lgkmcnt(15)
    v_mfma_f32_16x16x32_bf16 v[4:7], v[92:95], v[76:79], v[4:7]
    v_mfma_f32_16x16x32_bf16 v[8:11], v[92:95], v[80:83], v[8:11]
    v_mfma_f32_16x16x32_bf16 v[12:15], v[96:99], v[76:79], v[12:15]
    v_mfma_f32_16x16x32_bf16 v[16:19], v[96:99], v[80:83], v[16:19]
    v_mfma_f32_16x16x32_bf16 v[20:23], v[100:103], v[76:79], v[20:23]
    v_mfma_f32_16x16x32_bf16 v[24:27], v[100:103], v[80:83], v[24:27]
    v_mfma_f32_16x16x32_bf16 v[28:31], v[104:107], v[76:79], v[28:31]
    v_mfma_f32_16x16x32_bf16 v[32:35], v[104:107], v[80:83], v[32:35]
    v_mfma_f32_16x16x32_bf16 v[36:39], v[108:111], v[76:79], v[36:39]
    v_mfma_f32_16x16x32_bf16 v[40:43], v[108:111], v[80:83], v[40:43]
    v_mfma_f32_16x16x32_bf16 v[44:47], v[112:115], v[76:79], v[44:47]
    v_mfma_f32_16x16x32_bf16 v[48:51], v[112:115], v[80:83], v[48:51]
    v_mfma_f32_16x16x32_bf16 v[52:55], v[116:119], v[76:79], v[52:55]
    v_mfma_f32_16x16x32_bf16 v[56:59], v[116:119], v[80:83], v[56:59]
    v_mfma_f32_16x16x32_bf16 v[60:63], v[120:123], v[76:79], v[60:63]
    v_mfma_f32_16x16x32_bf16 v[64:67], v[120:123], v[80:83], v[64:67]
    v_mfma_f32_16x16x32_bf16 v[68:71], v[124:127], v[76:79], v[68:71]
    v_mfma_f32_16x16x32_bf16 v[72:75], v[124:127], v[80:83], v[72:75]
    s_waitcnt lgkmcnt(0)
    v_mfma_f32_16x16x32_bf16 v[4:7], v[128:131], v[84:87], v[4:7]
    v_mfma_f32_16x16x32_bf16 v[8:11], v[128:131], v[88:91], v[8:11]
    v_mfma_f32_16x16x32_bf16 v[12:15], v[132:135], v[84:87], v[12:15]
    v_mfma_f32_16x16x32_bf16 v[16:19], v[132:135], v[88:91], v[16:19]
    v_mfma_f32_16x16x32_bf16 v[20:23], v[136:139], v[84:87], v[20:23]
    v_mfma_f32_16x16x32_bf16 v[24:27], v[136:139], v[88:91], v[24:27]
    v_mfma_f32_16x16x32_bf16 v[28:31], v[140:143], v[84:87], v[28:31]
    v_mfma_f32_16x16x32_bf16 v[32:35], v[140:143], v[88:91], v[32:35]
    v_mfma_f32_16x16x32_bf16 v[36:39], v[144:147], v[84:87], v[36:39]
    v_mfma_f32_16x16x32_bf16 v[40:43], v[144:147], v[88:91], v[40:43]
    v_mfma_f32_16x16x32_bf16 v[44:47], v[148:151], v[84:87], v[44:47]
    v_mfma_f32_16x16x32_bf16 v[48:51], v[148:151], v[88:91], v[48:51]
    v_mfma_f32_16x16x32_bf16 v[52:55], v[152:155], v[84:87], v[52:55]
    v_mfma_f32_16x16x32_bf16 v[56:59], v[152:155], v[88:91], v[56:59]
    v_mfma_f32_16x16x32_bf16 v[60:63], v[156:159], v[84:87], v[60:63]
    v_mfma_f32_16x16x32_bf16 v[64:67], v[156:159], v[88:91], v[64:67]
    v_mfma_f32_16x16x32_bf16 v[68:71], v[160:163], v[84:87], v[68:71]
    v_mfma_f32_16x16x32_bf16 v[72:75], v[160:163], v[88:91], v[72:75]
    s_waitcnt vmcnt(9)
    s_barrier
    ds_read_b128 v[76:79], v195 offset:0
    ds_read_b128 v[80:83], v195 offset:2048
    ds_read_b64_tr_b16 v[92:93], v197 offset:0
    ds_read_b64_tr_b16 v[94:95], v197 offset:2304
    ds_read_b64_tr_b16 v[96:97], v197 offset:32
    ds_read_b64_tr_b16 v[98:99], v197 offset:2336
    ds_read_b64_tr_b16 v[100:101], v197 offset:64
    ds_read_b64_tr_b16 v[102:103], v197 offset:2368
    ds_read_b64_tr_b16 v[104:105], v197 offset:96
    ds_read_b64_tr_b16 v[106:107], v197 offset:2400
    ds_read_b64_tr_b16 v[108:109], v197 offset:128
    ds_read_b64_tr_b16 v[110:111], v197 offset:2432
    ds_read_b64_tr_b16 v[112:113], v197 offset:160
    ds_read_b64_tr_b16 v[114:115], v197 offset:2464
    ds_read_b64_tr_b16 v[116:117], v197 offset:192
    ds_read_b64_tr_b16 v[118:119], v197 offset:2496
    ds_read_b64_tr_b16 v[120:121], v197 offset:224
    ds_read_b64_tr_b16 v[122:123], v197 offset:2528
    ds_read_b64_tr_b16 v[124:125], v197 offset:256
    ds_read_b64_tr_b16 v[126:127], v197 offset:2560
    s_add_u32 m0, s43, 36864
    s_nop 0
    buffer_load_dwordx4 v164, s[8:11], s44 offen lds
    s_add_u32 m0, s43, 40960
    s_nop 0
    buffer_load_dwordx4 v165, s[8:11], s44 offen lds
    s_add_u32 m0, s43, 45056
    s_nop 0
    buffer_load_dwordx4 v166, s[8:11], s44 offen lds
    s_add_u32 m0, s43, 49152
    s_nop 0
    buffer_load_dwordx4 v167, s[8:11], s44 offen lds
    s_add_u32 m0, s43, 53248
    s_nop 0
    buffer_load_dwordx4 v168, s[12:15], s45 offen lds
    s_add_u32 m0, s43, 57344
    s_nop 0
    buffer_load_dwordx4 v169, s[12:15], s45 offen lds
    s_add_u32 m0, s43, 61440
    s_nop 0
    buffer_load_dwordx4 v170, s[12:15], s45 offen lds
    s_add_u32 m0, s43, 65536
    s_nop 0
    buffer_load_dwordx4 v171, s[12:15], s45 offen lds
    s_add_u32 m0, s43, 69632
    s_nop 0
    buffer_load_dwordx4 v172, s[12:15], s45 offen lds
    s_add_u32 s44, s44, 128
    s_add_u32 s45, s45, 294912
    ds_read_b128 v[84:87], v196 offset:0
    ds_read_b128 v[88:91], v196 offset:2048
    ds_read_b64_tr_b16 v[128:129], v197 offset:9216
    ds_read_b64_tr_b16 v[130:131], v197 offset:11520
    ds_read_b64_tr_b16 v[132:133], v197 offset:9248
    ds_read_b64_tr_b16 v[134:135], v197 offset:11552
    ds_read_b64_tr_b16 v[136:137], v197 offset:9280
    ds_read_b64_tr_b16 v[138:139], v197 offset:11584
    ds_read_b64_tr_b16 v[140:141], v197 offset:9312
    ds_read_b64_tr_b16 v[142:143], v197 offset:11616
    ds_read_b64_tr_b16 v[144:145], v197 offset:9344
    ds_read_b64_tr_b16 v[146:147], v197 offset:11648
    ds_read_b64_tr_b16 v[148:149], v197 offset:9376
    ds_read_b64_tr_b16 v[150:151], v197 offset:11680
    ds_read_b64_tr_b16 v[152:153], v197 offset:9408
    ds_read_b64_tr_b16 v[154:155], v197 offset:11712
    ds_read_b64_tr_b16 v[156:157], v197 offset:9440
    ds_read_b64_tr_b16 v[158:159], v197 offset:11744
    ds_read_b64_tr_b16 v[160:161], v197 offset:9472
    ds_read_b64_tr_b16 v[162:163], v197 offset:11776
    s_waitcnt lgkmcnt(15)
    v_mfma_f32_16x16x32_bf16 v[4:7], v[92:95], v[76:79], v[4:7]
    v_mfma_f32_16x16x32_bf16 v[8:11], v[92:95], v[80:83], v[8:11]
    v_mfma_f32_16x16x32_bf16 v[12:15], v[96:99], v[76:79], v[12:15]
    v_mfma_f32_16x16x32_bf16 v[16:19], v[96:99], v[80:83], v[16:19]
    v_mfma_f32_16x16x32_bf16 v[20:23], v[100:103], v[76:79], v[20:23]
    v_mfma_f32_16x16x32_bf16 v[24:27], v[100:103], v[80:83], v[24:27]
    v_mfma_f32_16x16x32_bf16 v[28:31], v[104:107], v[76:79], v[28:31]
    v_mfma_f32_16x16x32_bf16 v[32:35], v[104:107], v[80:83], v[32:35]
    v_mfma_f32_16x16x32_bf16 v[36:39], v[108:111], v[76:79], v[36:39]
    v_mfma_f32_16x16x32_bf16 v[40:43], v[108:111], v[80:83], v[40:43]
    v_mfma_f32_16x16x32_bf16 v[44:47], v[112:115], v[76:79], v[44:47]
    v_mfma_f32_16x16x32_bf16 v[48:51], v[112:115], v[80:83], v[48:51]
    v_mfma_f32_16x16x32_bf16 v[52:55], v[116:119], v[76:79], v[52:55]
    v_mfma_f32_16x16x32_bf16 v[56:59], v[116:119], v[80:83], v[56:59]
    v_mfma_f32_16x16x32_bf16 v[60:63], v[120:123], v[76:79], v[60:63]
    v_mfma_f32_16x16x32_bf16 v[64:67], v[120:123], v[80:83], v[64:67]
    v_mfma_f32_16x16x32_bf16 v[68:71], v[124:127], v[76:79], v[68:71]
    v_mfma_f32_16x16x32_bf16 v[72:75], v[124:127], v[80:83], v[72:75]
    s_waitcnt lgkmcnt(0)
    v_mfma_f32_16x16x32_bf16 v[4:7], v[128:131], v[84:87], v[4:7]
    v_mfma_f32_16x16x32_bf16 v[8:11], v[128:131], v[88:91], v[8:11]
    v_mfma_f32_16x16x32_bf16 v[12:15], v[132:135], v[84:87], v[12:15]
    v_mfma_f32_16x16x32_bf16 v[16:19], v[132:135], v[88:91], v[16:19]
    v_mfma_f32_16x16x32_bf16 v[20:23], v[136:139], v[84:87], v[20:23]
    v_mfma_f32_16x16x32_bf16 v[24:27], v[136:139], v[88:91], v[24:27]
    v_mfma_f32_16x16x32_bf16 v[28:31], v[140:143], v[84:87], v[28:31]
    v_mfma_f32_16x16x32_bf16 v[32:35], v[140:143], v[88:91], v[32:35]
    v_mfma_f32_16x16x32_bf16 v[36:39], v[144:147], v[84:87], v[36:39]
    v_mfma_f32_16x16x32_bf16 v[40:43], v[144:147], v[88:91], v[40:43]
    v_mfma_f32_16x16x32_bf16 v[44:47], v[148:151], v[84:87], v[44:47]
    v_mfma_f32_16x16x32_bf16 v[48:51], v[148:151], v[88:91], v[48:51]
    v_mfma_f32_16x16x32_bf16 v[52:55], v[152:155], v[84:87], v[52:55]
    v_mfma_f32_16x16x32_bf16 v[56:59], v[152:155], v[88:91], v[56:59]
    v_mfma_f32_16x16x32_bf16 v[60:63], v[156:159], v[84:87], v[60:63]
    v_mfma_f32_16x16x32_bf16 v[64:67], v[156:159], v[88:91], v[64:67]
    v_mfma_f32_16x16x32_bf16 v[68:71], v[160:163], v[84:87], v[68:71]
    v_mfma_f32_16x16x32_bf16 v[72:75], v[160:163], v[88:91], v[72:75]
    s_waitcnt vmcnt(9)
    s_barrier
    ds_read_b128 v[76:79], v187 offset:0
    ds_read_b128 v[80:83], v187 offset:2048
    ds_read_b64_tr_b16 v[92:93], v189 offset:0
    ds_read_b64_tr_b16 v[94:95], v189 offset:2304
    ds_read_b64_tr_b16 v[96:97], v189 offset:32
    ds_read_b64_tr_b16 v[98:99], v189 offset:2336
    ds_read_b64_tr_b16 v[100:101], v189 offset:64
    ds_read_b64_tr_b16 v[102:103], v189 offset:2368
    ds_read_b64_tr_b16 v[104:105], v189 offset:96
    ds_read_b64_tr_b16 v[106:107], v189 offset:2400
    ds_read_b64_tr_b16 v[108:109], v189 offset:128
    ds_read_b64_tr_b16 v[110:111], v189 offset:2432
    ds_read_b64_tr_b16 v[112:113], v189 offset:160
    ds_read_b64_tr_b16 v[114:115], v189 offset:2464
    ds_read_b64_tr_b16 v[116:117], v189 offset:192
    ds_read_b64_tr_b16 v[118:119], v189 offset:2496
    ds_read_b64_tr_b16 v[120:121], v189 offset:224
    ds_read_b64_tr_b16 v[122:123], v189 offset:2528
    ds_read_b64_tr_b16 v[124:125], v189 offset:256
    ds_read_b64_tr_b16 v[126:127], v189 offset:2560
    s_add_u32 m0, s43, 73728
    s_nop 0
    buffer_load_dwordx4 v164, s[8:11], s44 offen lds
    s_add_u32 m0, s43, 77824
    s_nop 0
    buffer_load_dwordx4 v165, s[8:11], s44 offen lds
    s_add_u32 m0, s43, 81920
    s_nop 0
    buffer_load_dwordx4 v166, s[8:11], s44 offen lds
    s_add_u32 m0, s43, 86016
    s_nop 0
    buffer_load_dwordx4 v167, s[8:11], s44 offen lds
    s_add_u32 m0, s43, 90112
    s_nop 0
    buffer_load_dwordx4 v168, s[12:15], s45 offen lds
    s_add_u32 m0, s43, 94208
    s_nop 0
    buffer_load_dwordx4 v169, s[12:15], s45 offen lds
    s_add_u32 m0, s43, 98304
    s_nop 0
    buffer_load_dwordx4 v170, s[12:15], s45 offen lds
    s_add_u32 m0, s43, 102400
    s_nop 0
    buffer_load_dwordx4 v171, s[12:15], s45 offen lds
    s_add_u32 m0, s43, 106496
    s_nop 0
    buffer_load_dwordx4 v172, s[12:15], s45 offen lds
    s_add_u32 s44, s44, 128
    s_add_u32 s45, s45, 294912
    ds_read_b128 v[84:87], v188 offset:0
    ds_read_b128 v[88:91], v188 offset:2048
    ds_read_b64_tr_b16 v[128:129], v189 offset:9216
    ds_read_b64_tr_b16 v[130:131], v189 offset:11520
    ds_read_b64_tr_b16 v[132:133], v189 offset:9248
    ds_read_b64_tr_b16 v[134:135], v189 offset:11552
    ds_read_b64_tr_b16 v[136:137], v189 offset:9280
    ds_read_b64_tr_b16 v[138:139], v189 offset:11584
    ds_read_b64_tr_b16 v[140:141], v189 offset:9312
    ds_read_b64_tr_b16 v[142:143], v189 offset:11616
    ds_read_b64_tr_b16 v[144:145], v189 offset:9344
    ds_read_b64_tr_b16 v[146:147], v189 offset:11648
    ds_read_b64_tr_b16 v[148:149], v189 offset:9376
    ds_read_b64_tr_b16 v[150:151], v189 offset:11680
    ds_read_b64_tr_b16 v[152:153], v189 offset:9408
    ds_read_b64_tr_b16 v[154:155], v189 offset:11712
    ds_read_b64_tr_b16 v[156:157], v189 offset:9440
    ds_read_b64_tr_b16 v[158:159], v189 offset:11744
    ds_read_b64_tr_b16 v[160:161], v189 offset:9472
    ds_read_b64_tr_b16 v[162:163], v189 offset:11776
    s_waitcnt lgkmcnt(15)
    v_mfma_f32_16x16x32_bf16 v[4:7], v[92:95], v[76:79], v[4:7]
    v_mfma_f32_16x16x32_bf16 v[8:11], v[92:95], v[80:83], v[8:11]
    v_mfma_f32_16x16x32_bf16 v[12:15], v[96:99], v[76:79], v[12:15]
    v_mfma_f32_16x16x32_bf16 v[16:19], v[96:99], v[80:83], v[16:19]
    v_mfma_f32_16x16x32_bf16 v[20:23], v[100:103], v[76:79], v[20:23]
    v_mfma_f32_16x16x32_bf16 v[24:27], v[100:103], v[80:83], v[24:27]
    v_mfma_f32_16x16x32_bf16 v[28:31], v[104:107], v[76:79], v[28:31]
    v_mfma_f32_16x16x32_bf16 v[32:35], v[104:107], v[80:83], v[32:35]
    v_mfma_f32_16x16x32_bf16 v[36:39], v[108:111], v[76:79], v[36:39]
    v_mfma_f32_16x16x32_bf16 v[40:43], v[108:111], v[80:83], v[40:43]
    v_mfma_f32_16x16x32_bf16 v[44:47], v[112:115], v[76:79], v[44:47]
    v_mfma_f32_16x16x32_bf16 v[48:51], v[112:115], v[80:83], v[48:51]
    v_mfma_f32_16x16x32_bf16 v[52:55], v[116:119], v[76:79], v[52:55]
    v_mfma_f32_16x16x32_bf16 v[56:59], v[116:119], v[80:83], v[56:59]
    v_mfma_f32_16x16x32_bf16 v[60:63], v[120:123], v[76:79], v[60:63]
    v_mfma_f32_16x16x32_bf16 v[64:67], v[120:123], v[80:83], v[64:67]
    v_mfma_f32_16x16x32_bf16 v[68:71], v[124:127], v[76:79], v[68:71]
    v_mfma_f32_16x16x32_bf16 v[72:75], v[124:127], v[80:83], v[72:75]
    s_waitcnt lgkmcnt(0)
    v_mfma_f32_16x16x32_bf16 v[4:7], v[128:131], v[84:87], v[4:7]
    v_mfma_f32_16x16x32_bf16 v[8:11], v[128:131], v[88:91], v[8:11]
    v_mfma_f32_16x16x32_bf16 v[12:15], v[132:135], v[84:87], v[12:15]
    v_mfma_f32_16x16x32_bf16 v[16:19], v[132:135], v[88:91], v[16:19]
    v_mfma_f32_16x16x32_bf16 v[20:23], v[136:139], v[84:87], v[20:23]
    v_mfma_f32_16x16x32_bf16 v[24:27], v[136:139], v[88:91], v[24:27]
    v_mfma_f32_16x16x32_bf16 v[28:31], v[140:143], v[84:87], v[28:31]
    v_mfma_f32_16x16x32_bf16 v[32:35], v[140:143], v[88:91], v[32:35]
    v_mfma_f32_16x16x32_bf16 v[36:39], v[144:147], v[84:87], v[36:39]
    v_mfma_f32_16x16x32_bf16 v[40:43], v[144:147], v[88:91], v[40:43]
    v_mfma_f32_16x16x32_bf16 v[44:47], v[148:151], v[84:87], v[44:47]
    v_mfma_f32_16x16x32_bf16 v[48:51], v[148:151], v[88:91], v[48:51]
    v_mfma_f32_16x16x32_bf16 v[52:55], v[152:155], v[84:87], v[52:55]
    v_mfma_f32_16x16x32_bf16 v[56:59], v[152:155], v[88:91], v[56:59]
    v_mfma_f32_16x16x32_bf16 v[60:63], v[156:159], v[84:87], v[60:63]
    v_mfma_f32_16x16x32_bf16 v[64:67], v[156:159], v[88:91], v[64:67]
    v_mfma_f32_16x16x32_bf16 v[68:71], v[160:163], v[84:87], v[68:71]
    v_mfma_f32_16x16x32_bf16 v[72:75], v[160:163], v[88:91], v[72:75]
    s_waitcnt vmcnt(9)
    s_barrier
    ds_read_b128 v[76:79], v191 offset:0
    ds_read_b128 v[80:83], v191 offset:2048
    ds_read_b64_tr_b16 v[92:93], v193 offset:0
    ds_read_b64_tr_b16 v[94:95], v193 offset:2304
    ds_read_b64_tr_b16 v[96:97], v193 offset:32
    ds_read_b64_tr_b16 v[98:99], v193 offset:2336
    ds_read_b64_tr_b16 v[100:101], v193 offset:64
    ds_read_b64_tr_b16 v[102:103], v193 offset:2368
    ds_read_b64_tr_b16 v[104:105], v193 offset:96
    ds_read_b64_tr_b16 v[106:107], v193 offset:2400
    ds_read_b64_tr_b16 v[108:109], v193 offset:128
    ds_read_b64_tr_b16 v[110:111], v193 offset:2432
    ds_read_b64_tr_b16 v[112:113], v193 offset:160
    ds_read_b64_tr_b16 v[114:115], v193 offset:2464
    ds_read_b64_tr_b16 v[116:117], v193 offset:192
    ds_read_b64_tr_b16 v[118:119], v193 offset:2496
    ds_read_b64_tr_b16 v[120:121], v193 offset:224
    ds_read_b64_tr_b16 v[122:123], v193 offset:2528
    ds_read_b64_tr_b16 v[124:125], v193 offset:256
    ds_read_b64_tr_b16 v[126:127], v193 offset:2560
    s_add_u32 m0, s43, 0
    s_nop 0
    buffer_load_dwordx4 v164, s[8:11], s44 offen lds
    s_add_u32 m0, s43, 4096
    s_nop 0
    buffer_load_dwordx4 v165, s[8:11], s44 offen lds
    s_add_u32 m0, s43, 8192
    s_nop 0
    buffer_load_dwordx4 v166, s[8:11], s44 offen lds
    s_add_u32 m0, s43, 12288
    s_nop 0
    buffer_load_dwordx4 v167, s[8:11], s44 offen lds
    s_add_u32 m0, s43, 16384
    s_nop 0
    buffer_load_dwordx4 v168, s[12:15], s45 offen lds
    s_add_u32 m0, s43, 20480
    s_nop 0
    buffer_load_dwordx4 v169, s[12:15], s45 offen lds
    s_add_u32 m0, s43, 24576
    s_nop 0
    buffer_load_dwordx4 v170, s[12:15], s45 offen lds
    s_add_u32 m0, s43, 28672
    s_nop 0
    buffer_load_dwordx4 v171, s[12:15], s45 offen lds
    s_add_u32 m0, s43, 32768
    s_nop 0
    buffer_load_dwordx4 v172, s[12:15], s45 offen lds
    s_add_u32 s44, s44, 128
    s_add_u32 s45, s45, 294912
    ds_read_b128 v[84:87], v192 offset:0
    ds_read_b128 v[88:91], v192 offset:2048
    ds_read_b64_tr_b16 v[128:129], v193 offset:9216
    ds_read_b64_tr_b16 v[130:131], v193 offset:11520
    ds_read_b64_tr_b16 v[132:133], v193 offset:9248
    ds_read_b64_tr_b16 v[134:135], v193 offset:11552
    ds_read_b64_tr_b16 v[136:137], v193 offset:9280
    ds_read_b64_tr_b16 v[138:139], v193 offset:11584
    ds_read_b64_tr_b16 v[140:141], v193 offset:9312
    ds_read_b64_tr_b16 v[142:143], v193 offset:11616
    ds_read_b64_tr_b16 v[144:145], v193 offset:9344
    ds_read_b64_tr_b16 v[146:147], v193 offset:11648
    ds_read_b64_tr_b16 v[148:149], v193 offset:9376
    ds_read_b64_tr_b16 v[150:151], v193 offset:11680
    ds_read_b64_tr_b16 v[152:153], v193 offset:9408
    ds_read_b64_tr_b16 v[154:155], v193 offset:11712
    ds_read_b64_tr_b16 v[156:157], v193 offset:9440
    ds_read_b64_tr_b16 v[158:159], v193 offset:11744
    ds_read_b64_tr_b16 v[160:161], v193 offset:9472
    ds_read_b64_tr_b16 v[162:163], v193 offset:11776
    s_waitcnt lgkmcnt(15)
    v_mfma_f32_16x16x32_bf16 v[4:7], v[92:95], v[76:79], v[4:7]
    v_mfma_f32_16x16x32_bf16 v[8:11], v[92:95], v[80:83], v[8:11]
    v_mfma_f32_16x16x32_bf16 v[12:15], v[96:99], v[76:79], v[12:15]
    v_mfma_f32_16x16x32_bf16 v[16:19], v[96:99], v[80:83], v[16:19]
    v_mfma_f32_16x16x32_bf16 v[20:23], v[100:103], v[76:79], v[20:23]
    v_mfma_f32_16x16x32_bf16 v[24:27], v[100:103], v[80:83], v[24:27]
    v_mfma_f32_16x16x32_bf16 v[28:31], v[104:107], v[76:79], v[28:31]
    v_mfma_f32_16x16x32_bf16 v[32:35], v[104:107], v[80:83], v[32:35]
    v_mfma_f32_16x16x32_bf16 v[36:39], v[108:111], v[76:79], v[36:39]
    v_mfma_f32_16x16x32_bf16 v[40:43], v[108:111], v[80:83], v[40:43]
    v_mfma_f32_16x16x32_bf16 v[44:47], v[112:115], v[76:79], v[44:47]
    v_mfma_f32_16x16x32_bf16 v[48:51], v[112:115], v[80:83], v[48:51]
    v_mfma_f32_16x16x32_bf16 v[52:55], v[116:119], v[76:79], v[52:55]
    v_mfma_f32_16x16x32_bf16 v[56:59], v[116:119], v[80:83], v[56:59]
    v_mfma_f32_16x16x32_bf16 v[60:63], v[120:123], v[76:79], v[60:63]
    v_mfma_f32_16x16x32_bf16 v[64:67], v[120:123], v[80:83], v[64:67]
    v_mfma_f32_16x16x32_bf16 v[68:71], v[124:127], v[76:79], v[68:71]
    v_mfma_f32_16x16x32_bf16 v[72:75], v[124:127], v[80:83], v[72:75]
    s_waitcnt lgkmcnt(0)
    v_mfma_f32_16x16x32_bf16 v[4:7], v[128:131], v[84:87], v[4:7]
    v_mfma_f32_16x16x32_bf16 v[8:11], v[128:131], v[88:91], v[8:11]
    v_mfma_f32_16x16x32_bf16 v[12:15], v[132:135], v[84:87], v[12:15]
    v_mfma_f32_16x16x32_bf16 v[16:19], v[132:135], v[88:91], v[16:19]
    v_mfma_f32_16x16x32_bf16 v[20:23], v[136:139], v[84:87], v[20:23]
    v_mfma_f32_16x16x32_bf16 v[24:27], v[136:139], v[88:91], v[24:27]
    v_mfma_f32_16x16x32_bf16 v[28:31], v[140:143], v[84:87], v[28:31]
    v_mfma_f32_16x16x32_bf16 v[32:35], v[140:143], v[88:91], v[32:35]
    v_mfma_f32_16x16x32_bf16 v[36:39], v[144:147], v[84:87], v[36:39]
    v_mfma_f32_16x16x32_bf16 v[40:43], v[144:147], v[88:91], v[40:43]
    v_mfma_f32_16x16x32_bf16 v[44:47], v[148:151], v[84:87], v[44:47]
    v_mfma_f32_16x16x32_bf16 v[48:51], v[148:151], v[88:91], v[48:51]
    v_mfma_f32_16x16x32_bf16 v[52:55], v[152:155], v[84:87], v[52:55]
    v_mfma_f32_16x16x32_bf16 v[56:59], v[152:155], v[88:91], v[56:59]
    v_mfma_f32_16x16x32_bf16 v[60:63], v[156:159], v[84:87], v[60:63]
    v_mfma_f32_16x16x32_bf16 v[64:67], v[156:159], v[88:91], v[64:67]
    v_mfma_f32_16x16x32_bf16 v[68:71], v[160:163], v[84:87], v[68:71]
    v_mfma_f32_16x16x32_bf16 v[72:75], v[160:163], v[88:91], v[72:75]
    s_waitcnt vmcnt(9)
    s_barrier
    ds_read_b128 v[76:79], v195 offset:0
    ds_read_b128 v[80:83], v195 offset:2048
    ds_read_b64_tr_b16 v[92:93], v197 offset:0
    ds_read_b64_tr_b16 v[94:95], v197 offset:2304
    ds_read_b64_tr_b16 v[96:97], v197 offset:32
    ds_read_b64_tr_b16 v[98:99], v197 offset:2336
    ds_read_b64_tr_b16 v[100:101], v197 offset:64
    ds_read_b64_tr_b16 v[102:103], v197 offset:2368
    ds_read_b64_tr_b16 v[104:105], v197 offset:96
    ds_read_b64_tr_b16 v[106:107], v197 offset:2400
    ds_read_b64_tr_b16 v[108:109], v197 offset:128
    ds_read_b64_tr_b16 v[110:111], v197 offset:2432
    ds_read_b64_tr_b16 v[112:113], v197 offset:160
    ds_read_b64_tr_b16 v[114:115], v197 offset:2464
    ds_read_b64_tr_b16 v[116:117], v197 offset:192
    ds_read_b64_tr_b16 v[118:119], v197 offset:2496
    ds_read_b64_tr_b16 v[120:121], v197 offset:224
    ds_read_b64_tr_b16 v[122:123], v197 offset:2528
    ds_read_b64_tr_b16 v[124:125], v197 offset:256
    ds_read_b64_tr_b16 v[126:127], v197 offset:2560
    s_add_u32 m0, s43, 36864
    s_nop 0
    buffer_load_dwordx4 v164, s[8:11], s44 offen lds
    s_add_u32 m0, s43, 40960
    s_nop 0
    buffer_load_dwordx4 v165, s[8:11], s44 offen lds
    s_add_u32 m0, s43, 45056
    s_nop 0
    buffer_load_dwordx4 v166, s[8:11], s44 offen lds
    s_add_u32 m0, s43, 49152
    s_nop 0
    buffer_load_dwordx4 v167, s[8:11], s44 offen lds
    s_add_u32 m0, s43, 53248
    s_nop 0
    buffer_load_dwordx4 v168, s[12:15], s45 offen lds
    s_add_u32 m0, s43, 57344
    s_nop 0
    buffer_load_dwordx4 v169, s[12:15], s45 offen lds
    s_add_u32 m0, s43, 61440
    s_nop 0
    buffer_load_dwordx4 v170, s[12:15], s45 offen lds
    s_add_u32 m0, s43, 65536
    s_nop 0
    buffer_load_dwordx4 v171, s[12:15], s45 offen lds
    s_add_u32 m0, s43, 69632
    s_nop 0
    buffer_load_dwordx4 v172, s[12:15], s45 offen lds
    s_add_u32 s44, s44, 128
    s_add_u32 s45, s45, 294912
    ds_read_b128 v[84:87], v196 offset:0
    ds_read_b128 v[88:91], v196 offset:2048
    ds_read_b64_tr_b16 v[128:129], v197 offset:9216
    ds_read_b64_tr_b16 v[130:131], v197 offset:11520
    ds_read_b64_tr_b16 v[132:133], v197 offset:9248
    ds_read_b64_tr_b16 v[134:135], v197 offset:11552
    ds_read_b64_tr_b16 v[136:137], v197 offset:9280
    ds_read_b64_tr_b16 v[138:139], v197 offset:11584
    ds_read_b64_tr_b16 v[140:141], v197 offset:9312
    ds_read_b64_tr_b16 v[142:143], v197 offset:11616
    ds_read_b64_tr_b16 v[144:145], v197 offset:9344
    ds_read_b64_tr_b16 v[146:147], v197 offset:11648
    ds_read_b64_tr_b16 v[148:149], v197 offset:9376
    ds_read_b64_tr_b16 v[150:151], v197 offset:11680
    ds_read_b64_tr_b16 v[152:153], v197 offset:9408
    ds_read_b64_tr_b16 v[154:155], v197 offset:11712
    ds_read_b64_tr_b16 v[156:157], v197 offset:9440
    ds_read_b64_tr_b16 v[158:159], v197 offset:11744
    ds_read_b64_tr_b16 v[160:161], v197 offset:9472
    ds_read_b64_tr_b16 v[162:163], v197 offset:11776
    s_waitcnt lgkmcnt(15)
    v_mfma_f32_16x16x32_bf16 v[4:7], v[92:95], v[76:79], v[4:7]
    v_mfma_f32_16x16x32_bf16 v[8:11], v[92:95], v[80:83], v[8:11]
    v_mfma_f32_16x16x32_bf16 v[12:15], v[96:99], v[76:79], v[12:15]
    v_mfma_f32_16x16x32_bf16 v[16:19], v[96:99], v[80:83], v[16:19]
    v_mfma_f32_16x16x32_bf16 v[20:23], v[100:103], v[76:79], v[20:23]
    v_mfma_f32_16x16x32_bf16 v[24:27], v[100:103], v[80:83], v[24:27]
    v_mfma_f32_16x16x32_bf16 v[28:31], v[104:107], v[76:79], v[28:31]
    v_mfma_f32_16x16x32_bf16 v[32:35], v[104:107], v[80:83], v[32:35]
    v_mfma_f32_16x16x32_bf16 v[36:39], v[108:111], v[76:79], v[36:39]
    v_mfma_f32_16x16x32_bf16 v[40:43], v[108:111], v[80:83], v[40:43]
    v_mfma_f32_16x16x32_bf16 v[44:47], v[112:115], v[76:79], v[44:47]
    v_mfma_f32_16x16x32_bf16 v[48:51], v[112:115], v[80:83], v[48:51]
    v_mfma_f32_16x16x32_bf16 v[52:55], v[116:119], v[76:79], v[52:55]
    v_mfma_f32_16x16x32_bf16 v[56:59], v[116:119], v[80:83], v[56:59]
    v_mfma_f32_16x16x32_bf16 v[60:63], v[120:123], v[76:79], v[60:63]
    v_mfma_f32_16x16x32_bf16 v[64:67], v[120:123], v[80:83], v[64:67]
    v_mfma_f32_16x16x32_bf16 v[68:71], v[124:127], v[76:79], v[68:71]
    v_mfma_f32_16x16x32_bf16 v[72:75], v[124:127], v[80:83], v[72:75]
    s_waitcnt lgkmcnt(0)
    v_mfma_f32_16x16x32_bf16 v[4:7], v[128:131], v[84:87], v[4:7]
    v_mfma_f32_16x16x32_bf16 v[8:11], v[128:131], v[88:91], v[8:11]
    v_mfma_f32_16x16x32_bf16 v[12:15], v[132:135], v[84:87], v[12:15]
    v_mfma_f32_16x16x32_bf16 v[16:19], v[132:135], v[88:91], v[16:19]
    v_mfma_f32_16x16x32_bf16 v[20:23], v[136:139], v[84:87], v[20:23]
    v_mfma_f32_16x16x32_bf16 v[24:27], v[136:139], v[88:91], v[24:27]
    v_mfma_f32_16x16x32_bf16 v[28:31], v[140:143], v[84:87], v[28:31]
    v_mfma_f32_16x16x32_bf16 v[32:35], v[140:143], v[88:91], v[32:35]
    v_mfma_f32_16x16x32_bf16 v[36:39], v[144:147], v[84:87], v[36:39]
    v_mfma_f32_16x16x32_bf16 v[40:43], v[144:147], v[88:91], v[40:43]
    v_mfma_f32_16x16x32_bf16 v[44:47], v[148:151], v[84:87], v[44:47]
    v_mfma_f32_16x16x32_bf16 v[48:51], v[148:151], v[88:91], v[48:51]
    v_mfma_f32_16x16x32_bf16 v[52:55], v[152:155], v[84:87], v[52:55]
    v_mfma_f32_16x16x32_bf16 v[56:59], v[152:155], v[88:91], v[56:59]
    v_mfma_f32_16x16x32_bf16 v[60:63], v[156:159], v[84:87], v[60:63]
    v_mfma_f32_16x16x32_bf16 v[64:67], v[156:159], v[88:91], v[64:67]
    v_mfma_f32_16x16x32_bf16 v[68:71], v[160:163], v[84:87], v[68:71]
    v_mfma_f32_16x16x32_bf16 v[72:75], v[160:163], v[88:91], v[72:75]
    s_waitcnt vmcnt(9)
    s_barrier
    ds_read_b128 v[76:79], v187 offset:0
    ds_read_b128 v[80:83], v187 offset:2048
    ds_read_b64_tr_b16 v[92:93], v189 offset:0
    ds_read_b64_tr_b16 v[94:95], v189 offset:2304
    ds_read_b64_tr_b16 v[96:97], v189 offset:32
    ds_read_b64_tr_b16 v[98:99], v189 offset:2336
    ds_read_b64_tr_b16 v[100:101], v189 offset:64
    ds_read_b64_tr_b16 v[102:103], v189 offset:2368
    ds_read_b64_tr_b16 v[104:105], v189 offset:96
    ds_read_b64_tr_b16 v[106:107], v189 offset:2400
    ds_read_b64_tr_b16 v[108:109], v189 offset:128
    ds_read_b64_tr_b16 v[110:111], v189 offset:2432
    ds_read_b64_tr_b16 v[112:113], v189 offset:160
    ds_read_b64_tr_b16 v[114:115], v189 offset:2464
    ds_read_b64_tr_b16 v[116:117], v189 offset:192
    ds_read_b64_tr_b16 v[118:119], v189 offset:2496
    ds_read_b64_tr_b16 v[120:121], v189 offset:224
    ds_read_b64_tr_b16 v[122:123], v189 offset:2528
    ds_read_b64_tr_b16 v[124:125], v189 offset:256
    ds_read_b64_tr_b16 v[126:127], v189 offset:2560
    s_add_u32 m0, s43, 73728
    s_nop 0
    buffer_load_dwordx4 v164, s[8:11], s44 offen lds
    s_add_u32 m0, s43, 77824
    s_nop 0
    buffer_load_dwordx4 v165, s[8:11], s44 offen lds
    s_add_u32 m0, s43, 81920
    s_nop 0
    buffer_load_dwordx4 v166, s[8:11], s44 offen lds
    s_add_u32 m0, s43, 86016
    s_nop 0
    buffer_load_dwordx4 v167, s[8:11], s44 offen lds
    s_add_u32 m0, s43, 90112
    s_nop 0
    buffer_load_dwordx4 v168, s[12:15], s45 offen lds
    s_add_u32 m0, s43, 94208
    s_nop 0
    buffer_load_dwordx4 v169, s[12:15], s45 offen lds
    s_add_u32 m0, s43, 98304
    s_nop 0
    buffer_load_dwordx4 v170, s[12:15], s45 offen lds
    s_add_u32 m0, s43, 102400
    s_nop 0
    buffer_load_dwordx4 v171, s[12:15], s45 offen lds
    s_add_u32 m0, s43, 106496
    s_nop 0
    buffer_load_dwordx4 v172, s[12:15], s45 offen lds
    s_add_u32 s44, s44, 128
    s_add_u32 s45, s45, 294912
    ds_read_b128 v[84:87], v188 offset:0
    ds_read_b128 v[88:91], v188 offset:2048
    ds_read_b64_tr_b16 v[128:129], v189 offset:9216
    ds_read_b64_tr_b16 v[130:131], v189 offset:11520
    ds_read_b64_tr_b16 v[132:133], v189 offset:9248
    ds_read_b64_tr_b16 v[134:135], v189 offset:11552
    ds_read_b64_tr_b16 v[136:137], v189 offset:9280
    ds_read_b64_tr_b16 v[138:139], v189 offset:11584
    ds_read_b64_tr_b16 v[140:141], v189 offset:9312
    ds_read_b64_tr_b16 v[142:143], v189 offset:11616
    ds_read_b64_tr_b16 v[144:145], v189 offset:9344
    ds_read_b64_tr_b16 v[146:147], v189 offset:11648
    ds_read_b64_tr_b16 v[148:149], v189 offset:9376
    ds_read_b64_tr_b16 v[150:151], v189 offset:11680
    ds_read_b64_tr_b16 v[152:153], v189 offset:9408
    ds_read_b64_tr_b16 v[154:155], v189 offset:11712
    ds_read_b64_tr_b16 v[156:157], v189 offset:9440
    ds_read_b64_tr_b16 v[158:159], v189 offset:11744
    ds_read_b64_tr_b16 v[160:161], v189 offset:9472
    ds_read_b64_tr_b16 v[162:163], v189 offset:11776
    s_waitcnt lgkmcnt(15)
    v_mfma_f32_16x16x32_bf16 v[4:7], v[92:95], v[76:79], v[4:7]
    v_mfma_f32_16x16x32_bf16 v[8:11], v[92:95], v[80:83], v[8:11]
    v_mfma_f32_16x16x32_bf16 v[12:15], v[96:99], v[76:79], v[12:15]
    v_mfma_f32_16x16x32_bf16 v[16:19], v[96:99], v[80:83], v[16:19]
    v_mfma_f32_16x16x32_bf16 v[20:23], v[100:103], v[76:79], v[20:23]
    v_mfma_f32_16x16x32_bf16 v[24:27], v[100:103], v[80:83], v[24:27]
    v_mfma_f32_16x16x32_bf16 v[28:31], v[104:107], v[76:79], v[28:31]
    v_mfma_f32_16x16x32_bf16 v[32:35], v[104:107], v[80:83], v[32:35]
    v_mfma_f32_16x16x32_bf16 v[36:39], v[108:111], v[76:79], v[36:39]
    v_mfma_f32_16x16x32_bf16 v[40:43], v[108:111], v[80:83], v[40:43]
    v_mfma_f32_16x16x32_bf16 v[44:47], v[112:115], v[76:79], v[44:47]
    v_mfma_f32_16x16x32_bf16 v[48:51], v[112:115], v[80:83], v[48:51]
    v_mfma_f32_16x16x32_bf16 v[52:55], v[116:119], v[76:79], v[52:55]
    v_mfma_f32_16x16x32_bf16 v[56:59], v[116:119], v[80:83], v[56:59]
    v_mfma_f32_16x16x32_bf16 v[60:63], v[120:123], v[76:79], v[60:63]
    v_mfma_f32_16x16x32_bf16 v[64:67], v[120:123], v[80:83], v[64:67]
    v_mfma_f32_16x16x32_bf16 v[68:71], v[124:127], v[76:79], v[68:71]
    v_mfma_f32_16x16x32_bf16 v[72:75], v[124:127], v[80:83], v[72:75]
    s_waitcnt lgkmcnt(0)
    v_mfma_f32_16x16x32_bf16 v[4:7], v[128:131], v[84:87], v[4:7]
    v_mfma_f32_16x16x32_bf16 v[8:11], v[128:131], v[88:91], v[8:11]
    v_mfma_f32_16x16x32_bf16 v[12:15], v[132:135], v[84:87], v[12:15]
    v_mfma_f32_16x16x32_bf16 v[16:19], v[132:135], v[88:91], v[16:19]
    v_mfma_f32_16x16x32_bf16 v[20:23], v[136:139], v[84:87], v[20:23]
    v_mfma_f32_16x16x32_bf16 v[24:27], v[136:139], v[88:91], v[24:27]
    v_mfma_f32_16x16x32_bf16 v[28:31], v[140:143], v[84:87], v[28:31]
    v_mfma_f32_16x16x32_bf16 v[32:35], v[140:143], v[88:91], v[32:35]
    v_mfma_f32_16x16x32_bf16 v[36:39], v[144:147], v[84:87], v[36:39]
    v_mfma_f32_16x16x32_bf16 v[40:43], v[144:147], v[88:91], v[40:43]
    v_mfma_f32_16x16x32_bf16 v[44:47], v[148:151], v[84:87], v[44:47]
    v_mfma_f32_16x16x32_bf16 v[48:51], v[148:151], v[88:91], v[48:51]
    v_mfma_f32_16x16x32_bf16 v[52:55], v[152:155], v[84:87], v[52:55]
    v_mfma_f32_16x16x32_bf16 v[56:59], v[152:155], v[88:91], v[56:59]
    v_mfma_f32_16x16x32_bf16 v[60:63], v[156:159], v[84:87], v[60:63]
    v_mfma_f32_16x16x32_bf16 v[64:67], v[156:159], v[88:91], v[64:67]
    v_mfma_f32_16x16x32_bf16 v[68:71], v[160:163], v[84:87], v[68:71]
    v_mfma_f32_16x16x32_bf16 v[72:75], v[160:163], v[88:91], v[72:75]
    s_waitcnt vmcnt(9)
    s_barrier
    ds_read_b128 v[76:79], v191 offset:0
    ds_read_b128 v[80:83], v191 offset:2048
    ds_read_b64_tr_b16 v[92:93], v193 offset:0
    ds_read_b64_tr_b16 v[94:95], v193 offset:2304
    ds_read_b64_tr_b16 v[96:97], v193 offset:32
    ds_read_b64_tr_b16 v[98:99], v193 offset:2336
    ds_read_b64_tr_b16 v[100:101], v193 offset:64
    ds_read_b64_tr_b16 v[102:103], v193 offset:2368
    ds_read_b64_tr_b16 v[104:105], v193 offset:96
    ds_read_b64_tr_b16 v[106:107], v193 offset:2400
    ds_read_b64_tr_b16 v[108:109], v193 offset:128
    ds_read_b64_tr_b16 v[110:111], v193 offset:2432
    ds_read_b64_tr_b16 v[112:113], v193 offset:160
    ds_read_b64_tr_b16 v[114:115], v193 offset:2464
    ds_read_b64_tr_b16 v[116:117], v193 offset:192
    ds_read_b64_tr_b16 v[118:119], v193 offset:2496
    ds_read_b64_tr_b16 v[120:121], v193 offset:224
    ds_read_b64_tr_b16 v[122:123], v193 offset:2528
    ds_read_b64_tr_b16 v[124:125], v193 offset:256
    ds_read_b64_tr_b16 v[126:127], v193 offset:2560
    s_add_u32 m0, s43, 0
    s_nop 0
    buffer_load_dwordx4 v164, s[8:11], s44 offen lds
    s_add_u32 m0, s43, 4096
    s_nop 0
    buffer_load_dwordx4 v165, s[8:11], s44 offen lds
    s_add_u32 m0, s43, 8192
    s_nop 0
    buffer_load_dwordx4 v166, s[8:11], s44 offen lds
    s_add_u32 m0, s43, 12288
    s_nop 0
    buffer_load_dwordx4 v167, s[8:11], s44 offen lds
    s_add_u32 m0, s43, 16384
    s_nop 0
    buffer_load_dwordx4 v168, s[12:15], s45 offen lds
    s_add_u32 m0, s43, 20480
    s_nop 0
    buffer_load_dwordx4 v169, s[12:15], s45 offen lds
    s_add_u32 m0, s43, 24576
    s_nop 0
    buffer_load_dwordx4 v170, s[12:15], s45 offen lds
    s_add_u32 m0, s43, 28672
    s_nop 0
    buffer_load_dwordx4 v171, s[12:15], s45 offen lds
    s_add_u32 m0, s43, 32768
    s_nop 0
    buffer_load_dwordx4 v172, s[12:15], s45 offen lds
    s_add_u32 s44, s44, 128
    s_add_u32 s45, s45, 294912
    ds_read_b128 v[84:87], v192 offset:0
    ds_read_b128 v[88:91], v192 offset:2048
    ds_read_b64_tr_b16 v[128:129], v193 offset:9216
    ds_read_b64_tr_b16 v[130:131], v193 offset:11520
    ds_read_b64_tr_b16 v[132:133], v193 offset:9248
    ds_read_b64_tr_b16 v[134:135], v193 offset:11552
    ds_read_b64_tr_b16 v[136:137], v193 offset:9280
    ds_read_b64_tr_b16 v[138:139], v193 offset:11584
    ds_read_b64_tr_b16 v[140:141], v193 offset:9312
    ds_read_b64_tr_b16 v[142:143], v193 offset:11616
    ds_read_b64_tr_b16 v[144:145], v193 offset:9344
    ds_read_b64_tr_b16 v[146:147], v193 offset:11648
    ds_read_b64_tr_b16 v[148:149], v193 offset:9376
    ds_read_b64_tr_b16 v[150:151], v193 offset:11680
    ds_read_b64_tr_b16 v[152:153], v193 offset:9408
    ds_read_b64_tr_b16 v[154:155], v193 offset:11712
    ds_read_b64_tr_b16 v[156:157], v193 offset:9440
    ds_read_b64_tr_b16 v[158:159], v193 offset:11744
    ds_read_b64_tr_b16 v[160:161], v193 offset:9472
    ds_read_b64_tr_b16 v[162:163], v193 offset:11776
    s_waitcnt lgkmcnt(15)
    v_mfma_f32_16x16x32_bf16 v[4:7], v[92:95], v[76:79], v[4:7]
    v_mfma_f32_16x16x32_bf16 v[8:11], v[92:95], v[80:83], v[8:11]
    v_mfma_f32_16x16x32_bf16 v[12:15], v[96:99], v[76:79], v[12:15]
    v_mfma_f32_16x16x32_bf16 v[16:19], v[96:99], v[80:83], v[16:19]
    v_mfma_f32_16x16x32_bf16 v[20:23], v[100:103], v[76:79], v[20:23]
    v_mfma_f32_16x16x32_bf16 v[24:27], v[100:103], v[80:83], v[24:27]
    v_mfma_f32_16x16x32_bf16 v[28:31], v[104:107], v[76:79], v[28:31]
    v_mfma_f32_16x16x32_bf16 v[32:35], v[104:107], v[80:83], v[32:35]
    v_mfma_f32_16x16x32_bf16 v[36:39], v[108:111], v[76:79], v[36:39]
    v_mfma_f32_16x16x32_bf16 v[40:43], v[108:111], v[80:83], v[40:43]
    v_mfma_f32_16x16x32_bf16 v[44:47], v[112:115], v[76:79], v[44:47]
    v_mfma_f32_16x16x32_bf16 v[48:51], v[112:115], v[80:83], v[48:51]
    v_mfma_f32_16x16x32_bf16 v[52:55], v[116:119], v[76:79], v[52:55]
    v_mfma_f32_16x16x32_bf16 v[56:59], v[116:119], v[80:83], v[56:59]
    v_mfma_f32_16x16x32_bf16 v[60:63], v[120:123], v[76:79], v[60:63]
    v_mfma_f32_16x16x32_bf16 v[64:67], v[120:123], v[80:83], v[64:67]
    v_mfma_f32_16x16x32_bf16 v[68:71], v[124:127], v[76:79], v[68:71]
    v_mfma_f32_16x16x32_bf16 v[72:75], v[124:127], v[80:83], v[72:75]
    s_waitcnt lgkmcnt(0)
    v_mfma_f32_16x16x32_bf16 v[4:7], v[128:131], v[84:87], v[4:7]
    v_mfma_f32_16x16x32_bf16 v[8:11], v[128:131], v[88:91], v[8:11]
    v_mfma_f32_16x16x32_bf16 v[12:15], v[132:135], v[84:87], v[12:15]
    v_mfma_f32_16x16x32_bf16 v[16:19], v[132:135], v[88:91], v[16:19]
    v_mfma_f32_16x16x32_bf16 v[20:23], v[136:139], v[84:87], v[20:23]
    v_mfma_f32_16x16x32_bf16 v[24:27], v[136:139], v[88:91], v[24:27]
    v_mfma_f32_16x16x32_bf16 v[28:31], v[140:143], v[84:87], v[28:31]
    v_mfma_f32_16x16x32_bf16 v[32:35], v[140:143], v[88:91], v[32:35]
    v_mfma_f32_16x16x32_bf16 v[36:39], v[144:147], v[84:87], v[36:39]
    v_mfma_f32_16x16x32_bf16 v[40:43], v[144:147], v[88:91], v[40:43]
    v_mfma_f32_16x16x32_bf16 v[44:47], v[148:151], v[84:87], v[44:47]
    v_mfma_f32_16x16x32_bf16 v[48:51], v[148:151], v[88:91], v[48:51]
    v_mfma_f32_16x16x32_bf16 v[52:55], v[152:155], v[84:87], v[52:55]
    v_mfma_f32_16x16x32_bf16 v[56:59], v[152:155], v[88:91], v[56:59]
    v_mfma_f32_16x16x32_bf16 v[60:63], v[156:159], v[84:87], v[60:63]
    v_mfma_f32_16x16x32_bf16 v[64:67], v[156:159], v[88:91], v[64:67]
    v_mfma_f32_16x16x32_bf16 v[68:71], v[160:163], v[84:87], v[68:71]
    v_mfma_f32_16x16x32_bf16 v[72:75], v[160:163], v[88:91], v[72:75]
    s_waitcnt vmcnt(9)
    s_barrier
    ds_read_b128 v[76:79], v195 offset:0
    ds_read_b128 v[80:83], v195 offset:2048
    ds_read_b64_tr_b16 v[92:93], v197 offset:0
    ds_read_b64_tr_b16 v[94:95], v197 offset:2304
    ds_read_b64_tr_b16 v[96:97], v197 offset:32
    ds_read_b64_tr_b16 v[98:99], v197 offset:2336
    ds_read_b64_tr_b16 v[100:101], v197 offset:64
    ds_read_b64_tr_b16 v[102:103], v197 offset:2368
    ds_read_b64_tr_b16 v[104:105], v197 offset:96
    ds_read_b64_tr_b16 v[106:107], v197 offset:2400
    ds_read_b64_tr_b16 v[108:109], v197 offset:128
    ds_read_b64_tr_b16 v[110:111], v197 offset:2432
    ds_read_b64_tr_b16 v[112:113], v197 offset:160
    ds_read_b64_tr_b16 v[114:115], v197 offset:2464
    ds_read_b64_tr_b16 v[116:117], v197 offset:192
    ds_read_b64_tr_b16 v[118:119], v197 offset:2496
    ds_read_b64_tr_b16 v[120:121], v197 offset:224
    ds_read_b64_tr_b16 v[122:123], v197 offset:2528
    ds_read_b64_tr_b16 v[124:125], v197 offset:256
    ds_read_b64_tr_b16 v[126:127], v197 offset:2560
    s_add_u32 m0, s43, 36864
    s_nop 0
    buffer_load_dwordx4 v164, s[8:11], s44 offen lds
    s_add_u32 m0, s43, 40960
    s_nop 0
    buffer_load_dwordx4 v165, s[8:11], s44 offen lds
    s_add_u32 m0, s43, 45056
    s_nop 0
    buffer_load_dwordx4 v166, s[8:11], s44 offen lds
    s_add_u32 m0, s43, 49152
    s_nop 0
    buffer_load_dwordx4 v167, s[8:11], s44 offen lds
    s_add_u32 m0, s43, 53248
    s_nop 0
    buffer_load_dwordx4 v168, s[12:15], s45 offen lds
    s_add_u32 m0, s43, 57344
    s_nop 0
    buffer_load_dwordx4 v169, s[12:15], s45 offen lds
    s_add_u32 m0, s43, 61440
    s_nop 0
    buffer_load_dwordx4 v170, s[12:15], s45 offen lds
    s_add_u32 m0, s43, 65536
    s_nop 0
    buffer_load_dwordx4 v171, s[12:15], s45 offen lds
    s_add_u32 m0, s43, 69632
    s_nop 0
    buffer_load_dwordx4 v172, s[12:15], s45 offen lds
    s_add_u32 s44, s44, 128
    s_add_u32 s45, s45, 294912
    ds_read_b128 v[84:87], v196 offset:0
    ds_read_b128 v[88:91], v196 offset:2048
    ds_read_b64_tr_b16 v[128:129], v197 offset:9216
    ds_read_b64_tr_b16 v[130:131], v197 offset:11520
    ds_read_b64_tr_b16 v[132:133], v197 offset:9248
    ds_read_b64_tr_b16 v[134:135], v197 offset:11552
    ds_read_b64_tr_b16 v[136:137], v197 offset:9280
    ds_read_b64_tr_b16 v[138:139], v197 offset:11584
    ds_read_b64_tr_b16 v[140:141], v197 offset:9312
    ds_read_b64_tr_b16 v[142:143], v197 offset:11616
    ds_read_b64_tr_b16 v[144:145], v197 offset:9344
    ds_read_b64_tr_b16 v[146:147], v197 offset:11648
    ds_read_b64_tr_b16 v[148:149], v197 offset:9376
    ds_read_b64_tr_b16 v[150:151], v197 offset:11680
    ds_read_b64_tr_b16 v[152:153], v197 offset:9408
    ds_read_b64_tr_b16 v[154:155], v197 offset:11712
    ds_read_b64_tr_b16 v[156:157], v197 offset:9440
    ds_read_b64_tr_b16 v[158:159], v197 offset:11744
    ds_read_b64_tr_b16 v[160:161], v197 offset:9472
    ds_read_b64_tr_b16 v[162:163], v197 offset:11776
    s_waitcnt lgkmcnt(15)
    v_mfma_f32_16x16x32_bf16 v[4:7], v[92:95], v[76:79], v[4:7]
    v_mfma_f32_16x16x32_bf16 v[8:11], v[92:95], v[80:83], v[8:11]
    v_mfma_f32_16x16x32_bf16 v[12:15], v[96:99], v[76:79], v[12:15]
    v_mfma_f32_16x16x32_bf16 v[16:19], v[96:99], v[80:83], v[16:19]
    v_mfma_f32_16x16x32_bf16 v[20:23], v[100:103], v[76:79], v[20:23]
    v_mfma_f32_16x16x32_bf16 v[24:27], v[100:103], v[80:83], v[24:27]
    v_mfma_f32_16x16x32_bf16 v[28:31], v[104:107], v[76:79], v[28:31]
    v_mfma_f32_16x16x32_bf16 v[32:35], v[104:107], v[80:83], v[32:35]
    v_mfma_f32_16x16x32_bf16 v[36:39], v[108:111], v[76:79], v[36:39]
    v_mfma_f32_16x16x32_bf16 v[40:43], v[108:111], v[80:83], v[40:43]
    v_mfma_f32_16x16x32_bf16 v[44:47], v[112:115], v[76:79], v[44:47]
    v_mfma_f32_16x16x32_bf16 v[48:51], v[112:115], v[80:83], v[48:51]
    v_mfma_f32_16x16x32_bf16 v[52:55], v[116:119], v[76:79], v[52:55]
    v_mfma_f32_16x16x32_bf16 v[56:59], v[116:119], v[80:83], v[56:59]
    v_mfma_f32_16x16x32_bf16 v[60:63], v[120:123], v[76:79], v[60:63]
    v_mfma_f32_16x16x32_bf16 v[64:67], v[120:123], v[80:83], v[64:67]
    v_mfma_f32_16x16x32_bf16 v[68:71], v[124:127], v[76:79], v[68:71]
    v_mfma_f32_16x16x32_bf16 v[72:75], v[124:127], v[80:83], v[72:75]
    s_waitcnt lgkmcnt(0)
    v_mfma_f32_16x16x32_bf16 v[4:7], v[128:131], v[84:87], v[4:7]
    v_mfma_f32_16x16x32_bf16 v[8:11], v[128:131], v[88:91], v[8:11]
    v_mfma_f32_16x16x32_bf16 v[12:15], v[132:135], v[84:87], v[12:15]
    v_mfma_f32_16x16x32_bf16 v[16:19], v[132:135], v[88:91], v[16:19]
    v_mfma_f32_16x16x32_bf16 v[20:23], v[136:139], v[84:87], v[20:23]
    v_mfma_f32_16x16x32_bf16 v[24:27], v[136:139], v[88:91], v[24:27]
    v_mfma_f32_16x16x32_bf16 v[28:31], v[140:143], v[84:87], v[28:31]
    v_mfma_f32_16x16x32_bf16 v[32:35], v[140:143], v[88:91], v[32:35]
    v_mfma_f32_16x16x32_bf16 v[36:39], v[144:147], v[84:87], v[36:39]
    v_mfma_f32_16x16x32_bf16 v[40:43], v[144:147], v[88:91], v[40:43]
    v_mfma_f32_16x16x32_bf16 v[44:47], v[148:151], v[84:87], v[44:47]
    v_mfma_f32_16x16x32_bf16 v[48:51], v[148:151], v[88:91], v[48:51]
    v_mfma_f32_16x16x32_bf16 v[52:55], v[152:155], v[84:87], v[52:55]
    v_mfma_f32_16x16x32_bf16 v[56:59], v[152:155], v[88:91], v[56:59]
    v_mfma_f32_16x16x32_bf16 v[60:63], v[156:159], v[84:87], v[60:63]
    v_mfma_f32_16x16x32_bf16 v[64:67], v[156:159], v[88:91], v[64:67]
    v_mfma_f32_16x16x32_bf16 v[68:71], v[160:163], v[84:87], v[68:71]
    v_mfma_f32_16x16x32_bf16 v[72:75], v[160:163], v[88:91], v[72:75]
    s_waitcnt vmcnt(9)
    s_barrier
    ds_read_b128 v[76:79], v187 offset:0
    ds_read_b128 v[80:83], v187 offset:2048
    ds_read_b64_tr_b16 v[92:93], v189 offset:0
    ds_read_b64_tr_b16 v[94:95], v189 offset:2304
    ds_read_b64_tr_b16 v[96:97], v189 offset:32
    ds_read_b64_tr_b16 v[98:99], v189 offset:2336
    ds_read_b64_tr_b16 v[100:101], v189 offset:64
    ds_read_b64_tr_b16 v[102:103], v189 offset:2368
    ds_read_b64_tr_b16 v[104:105], v189 offset:96
    ds_read_b64_tr_b16 v[106:107], v189 offset:2400
    ds_read_b64_tr_b16 v[108:109], v189 offset:128
    ds_read_b64_tr_b16 v[110:111], v189 offset:2432
    ds_read_b64_tr_b16 v[112:113], v189 offset:160
    ds_read_b64_tr_b16 v[114:115], v189 offset:2464
    ds_read_b64_tr_b16 v[116:117], v189 offset:192
    ds_read_b64_tr_b16 v[118:119], v189 offset:2496
    ds_read_b64_tr_b16 v[120:121], v189 offset:224
    ds_read_b64_tr_b16 v[122:123], v189 offset:2528
    ds_read_b64_tr_b16 v[124:125], v189 offset:256
    ds_read_b64_tr_b16 v[126:127], v189 offset:2560
    s_add_u32 m0, s43, 73728
    s_nop 0
    buffer_load_dwordx4 v164, s[8:11], s44 offen lds
    s_add_u32 m0, s43, 77824
    s_nop 0
    buffer_load_dwordx4 v165, s[8:11], s44 offen lds
    s_add_u32 m0, s43, 81920
    s_nop 0
    buffer_load_dwordx4 v166, s[8:11], s44 offen lds
    s_add_u32 m0, s43, 86016
    s_nop 0
    buffer_load_dwordx4 v167, s[8:11], s44 offen lds
    s_add_u32 m0, s43, 90112
    s_nop 0
    buffer_load_dwordx4 v168, s[12:15], s45 offen lds
    s_add_u32 m0, s43, 94208
    s_nop 0
    buffer_load_dwordx4 v169, s[12:15], s45 offen lds
    s_add_u32 m0, s43, 98304
    s_nop 0
    buffer_load_dwordx4 v170, s[12:15], s45 offen lds
    s_add_u32 m0, s43, 102400
    s_nop 0
    buffer_load_dwordx4 v171, s[12:15], s45 offen lds
    s_add_u32 m0, s43, 106496
    s_nop 0
    buffer_load_dwordx4 v172, s[12:15], s45 offen lds
    s_add_u32 s44, s44, 128
    s_add_u32 s45, s45, 294912
    ds_read_b128 v[84:87], v188 offset:0
    ds_read_b128 v[88:91], v188 offset:2048
    ds_read_b64_tr_b16 v[128:129], v189 offset:9216
    ds_read_b64_tr_b16 v[130:131], v189 offset:11520
    ds_read_b64_tr_b16 v[132:133], v189 offset:9248
    ds_read_b64_tr_b16 v[134:135], v189 offset:11552
    ds_read_b64_tr_b16 v[136:137], v189 offset:9280
    ds_read_b64_tr_b16 v[138:139], v189 offset:11584
    ds_read_b64_tr_b16 v[140:141], v189 offset:9312
    ds_read_b64_tr_b16 v[142:143], v189 offset:11616
    ds_read_b64_tr_b16 v[144:145], v189 offset:9344
    ds_read_b64_tr_b16 v[146:147], v189 offset:11648
    ds_read_b64_tr_b16 v[148:149], v189 offset:9376
    ds_read_b64_tr_b16 v[150:151], v189 offset:11680
    ds_read_b64_tr_b16 v[152:153], v189 offset:9408
    ds_read_b64_tr_b16 v[154:155], v189 offset:11712
    ds_read_b64_tr_b16 v[156:157], v189 offset:9440
    ds_read_b64_tr_b16 v[158:159], v189 offset:11744
    ds_read_b64_tr_b16 v[160:161], v189 offset:9472
    ds_read_b64_tr_b16 v[162:163], v189 offset:11776
    s_waitcnt lgkmcnt(15)
    v_mfma_f32_16x16x32_bf16 v[4:7], v[92:95], v[76:79], v[4:7]
    v_mfma_f32_16x16x32_bf16 v[8:11], v[92:95], v[80:83], v[8:11]
    v_mfma_f32_16x16x32_bf16 v[12:15], v[96:99], v[76:79], v[12:15]
    v_mfma_f32_16x16x32_bf16 v[16:19], v[96:99], v[80:83], v[16:19]
    v_mfma_f32_16x16x32_bf16 v[20:23], v[100:103], v[76:79], v[20:23]
    v_mfma_f32_16x16x32_bf16 v[24:27], v[100:103], v[80:83], v[24:27]
    v_mfma_f32_16x16x32_bf16 v[28:31], v[104:107], v[76:79], v[28:31]
    v_mfma_f32_16x16x32_bf16 v[32:35], v[104:107], v[80:83], v[32:35]
    v_mfma_f32_16x16x32_bf16 v[36:39], v[108:111], v[76:79], v[36:39]
    v_mfma_f32_16x16x32_bf16 v[40:43], v[108:111], v[80:83], v[40:43]
    v_mfma_f32_16x16x32_bf16 v[44:47], v[112:115], v[76:79], v[44:47]
    v_mfma_f32_16x16x32_bf16 v[48:51], v[112:115], v[80:83], v[48:51]
    v_mfma_f32_16x16x32_bf16 v[52:55], v[116:119], v[76:79], v[52:55]
    v_mfma_f32_16x16x32_bf16 v[56:59], v[116:119], v[80:83], v[56:59]
    v_mfma_f32_16x16x32_bf16 v[60:63], v[120:123], v[76:79], v[60:63]
    v_mfma_f32_16x16x32_bf16 v[64:67], v[120:123], v[80:83], v[64:67]
    v_mfma_f32_16x16x32_bf16 v[68:71], v[124:127], v[76:79], v[68:71]
    v_mfma_f32_16x16x32_bf16 v[72:75], v[124:127], v[80:83], v[72:75]
    s_waitcnt lgkmcnt(0)
    v_mfma_f32_16x16x32_bf16 v[4:7], v[128:131], v[84:87], v[4:7]
    v_mfma_f32_16x16x32_bf16 v[8:11], v[128:131], v[88:91], v[8:11]
    v_mfma_f32_16x16x32_bf16 v[12:15], v[132:135], v[84:87], v[12:15]
    v_mfma_f32_16x16x32_bf16 v[16:19], v[132:135], v[88:91], v[16:19]
    v_mfma_f32_16x16x32_bf16 v[20:23], v[136:139], v[84:87], v[20:23]
    v_mfma_f32_16x16x32_bf16 v[24:27], v[136:139], v[88:91], v[24:27]
    v_mfma_f32_16x16x32_bf16 v[28:31], v[140:143], v[84:87], v[28:31]
    v_mfma_f32_16x16x32_bf16 v[32:35], v[140:143], v[88:91], v[32:35]
    v_mfma_f32_16x16x32_bf16 v[36:39], v[144:147], v[84:87], v[36:39]
    v_mfma_f32_16x16x32_bf16 v[40:43], v[144:147], v[88:91], v[40:43]
    v_mfma_f32_16x16x32_bf16 v[44:47], v[148:151], v[84:87], v[44:47]
    v_mfma_f32_16x16x32_bf16 v[48:51], v[148:151], v[88:91], v[48:51]
    v_mfma_f32_16x16x32_bf16 v[52:55], v[152:155], v[84:87], v[52:55]
    v_mfma_f32_16x16x32_bf16 v[56:59], v[152:155], v[88:91], v[56:59]
    v_mfma_f32_16x16x32_bf16 v[60:63], v[156:159], v[84:87], v[60:63]
    v_mfma_f32_16x16x32_bf16 v[64:67], v[156:159], v[88:91], v[64:67]
    v_mfma_f32_16x16x32_bf16 v[68:71], v[160:163], v[84:87], v[68:71]
    v_mfma_f32_16x16x32_bf16 v[72:75], v[160:163], v[88:91], v[72:75]
    s_waitcnt vmcnt(9)
    s_barrier
    ds_read_b128 v[76:79], v191 offset:0
    ds_read_b128 v[80:83], v191 offset:2048
    ds_read_b64_tr_b16 v[92:93], v193 offset:0
    ds_read_b64_tr_b16 v[94:95], v193 offset:2304
    ds_read_b64_tr_b16 v[96:97], v193 offset:32
    ds_read_b64_tr_b16 v[98:99], v193 offset:2336
    ds_read_b64_tr_b16 v[100:101], v193 offset:64
    ds_read_b64_tr_b16 v[102:103], v193 offset:2368
    ds_read_b64_tr_b16 v[104:105], v193 offset:96
    ds_read_b64_tr_b16 v[106:107], v193 offset:2400
    ds_read_b64_tr_b16 v[108:109], v193 offset:128
    ds_read_b64_tr_b16 v[110:111], v193 offset:2432
    ds_read_b64_tr_b16 v[112:113], v193 offset:160
    ds_read_b64_tr_b16 v[114:115], v193 offset:2464
    ds_read_b64_tr_b16 v[116:117], v193 offset:192
    ds_read_b64_tr_b16 v[118:119], v193 offset:2496
    ds_read_b64_tr_b16 v[120:121], v193 offset:224
    ds_read_b64_tr_b16 v[122:123], v193 offset:2528
    ds_read_b64_tr_b16 v[124:125], v193 offset:256
    ds_read_b64_tr_b16 v[126:127], v193 offset:2560
    ds_read_b128 v[84:87], v192 offset:0
    ds_read_b128 v[88:91], v192 offset:2048
    ds_read_b64_tr_b16 v[128:129], v193 offset:9216
    ds_read_b64_tr_b16 v[130:131], v193 offset:11520
    ds_read_b64_tr_b16 v[132:133], v193 offset:9248
    ds_read_b64_tr_b16 v[134:135], v193 offset:11552
    ds_read_b64_tr_b16 v[136:137], v193 offset:9280
    ds_read_b64_tr_b16 v[138:139], v193 offset:11584
    ds_read_b64_tr_b16 v[140:141], v193 offset:9312
    ds_read_b64_tr_b16 v[142:143], v193 offset:11616
    ds_read_b64_tr_b16 v[144:145], v193 offset:9344
    ds_read_b64_tr_b16 v[146:147], v193 offset:11648
    ds_read_b64_tr_b16 v[148:149], v193 offset:9376
    ds_read_b64_tr_b16 v[150:151], v193 offset:11680
    ds_read_b64_tr_b16 v[152:153], v193 offset:9408
    ds_read_b64_tr_b16 v[154:155], v193 offset:11712
    ds_read_b64_tr_b16 v[156:157], v193 offset:9440
    ds_read_b64_tr_b16 v[158:159], v193 offset:11744
    ds_read_b64_tr_b16 v[160:161], v193 offset:9472
    ds_read_b64_tr_b16 v[162:163], v193 offset:11776
    s_waitcnt lgkmcnt(15)
    v_mfma_f32_16x16x32_bf16 v[4:7], v[92:95], v[76:79], v[4:7]
    v_mfma_f32_16x16x32_bf16 v[8:11], v[92:95], v[80:83], v[8:11]
    v_mfma_f32_16x16x32_bf16 v[12:15], v[96:99], v[76:79], v[12:15]
    v_mfma_f32_16x16x32_bf16 v[16:19], v[96:99], v[80:83], v[16:19]
    v_mfma_f32_16x16x32_bf16 v[20:23], v[100:103], v[76:79], v[20:23]
    v_mfma_f32_16x16x32_bf16 v[24:27], v[100:103], v[80:83], v[24:27]
    v_mfma_f32_16x16x32_bf16 v[28:31], v[104:107], v[76:79], v[28:31]
    v_mfma_f32_16x16x32_bf16 v[32:35], v[104:107], v[80:83], v[32:35]
    v_mfma_f32_16x16x32_bf16 v[36:39], v[108:111], v[76:79], v[36:39]
    v_mfma_f32_16x16x32_bf16 v[40:43], v[108:111], v[80:83], v[40:43]
    v_mfma_f32_16x16x32_bf16 v[44:47], v[112:115], v[76:79], v[44:47]
    v_mfma_f32_16x16x32_bf16 v[48:51], v[112:115], v[80:83], v[48:51]
    v_mfma_f32_16x16x32_bf16 v[52:55], v[116:119], v[76:79], v[52:55]
    v_mfma_f32_16x16x32_bf16 v[56:59], v[116:119], v[80:83], v[56:59]
    v_mfma_f32_16x16x32_bf16 v[60:63], v[120:123], v[76:79], v[60:63]
    v_mfma_f32_16x16x32_bf16 v[64:67], v[120:123], v[80:83], v[64:67]
    v_mfma_f32_16x16x32_bf16 v[68:71], v[124:127], v[76:79], v[68:71]
    v_mfma_f32_16x16x32_bf16 v[72:75], v[124:127], v[80:83], v[72:75]
    s_waitcnt lgkmcnt(0)
    v_mfma_f32_16x16x32_bf16 v[4:7], v[128:131], v[84:87], v[4:7]
    v_mfma_f32_16x16x32_bf16 v[8:11], v[128:131], v[88:91], v[8:11]
    v_mfma_f32_16x16x32_bf16 v[12:15], v[132:135], v[84:87], v[12:15]
    v_mfma_f32_16x16x32_bf16 v[16:19], v[132:135], v[88:91], v[16:19]
    v_mfma_f32_16x16x32_bf16 v[20:23], v[136:139], v[84:87], v[20:23]
    v_mfma_f32_16x16x32_bf16 v[24:27], v[136:139], v[88:91], v[24:27]
    v_mfma_f32_16x16x32_bf16 v[28:31], v[140:143], v[84:87], v[28:31]
    v_mfma_f32_16x16x32_bf16 v[32:35], v[140:143], v[88:91], v[32:35]
    v_mfma_f32_16x16x32_bf16 v[36:39], v[144:147], v[84:87], v[36:39]
    v_mfma_f32_16x16x32_bf16 v[40:43], v[144:147], v[88:91], v[40:43]
    v_mfma_f32_16x16x32_bf16 v[44:47], v[148:151], v[84:87], v[44:47]
    v_mfma_f32_16x16x32_bf16 v[48:51], v[148:151], v[88:91], v[48:51]
    v_mfma_f32_16x16x32_bf16 v[52:55], v[152:155], v[84:87], v[52:55]
    v_mfma_f32_16x16x32_bf16 v[56:59], v[152:155], v[88:91], v[56:59]
    v_mfma_f32_16x16x32_bf16 v[60:63], v[156:159], v[84:87], v[60:63]
    v_mfma_f32_16x16x32_bf16 v[64:67], v[156:159], v[88:91], v[64:67]
    v_mfma_f32_16x16x32_bf16 v[68:71], v[160:163], v[84:87], v[68:71]
    v_mfma_f32_16x16x32_bf16 v[72:75], v[160:163], v[88:91], v[72:75]
    s_waitcnt vmcnt(0)
    s_barrier
    ds_read_b128 v[76:79], v195 offset:0
    ds_read_b128 v[80:83], v195 offset:2048
    ds_read_b64_tr_b16 v[92:93], v197 offset:0
    ds_read_b64_tr_b16 v[94:95], v197 offset:2304
    ds_read_b64_tr_b16 v[96:97], v197 offset:32
    ds_read_b64_tr_b16 v[98:99], v197 offset:2336
    ds_read_b64_tr_b16 v[100:101], v197 offset:64
    ds_read_b64_tr_b16 v[102:103], v197 offset:2368
    ds_read_b64_tr_b16 v[104:105], v197 offset:96
    ds_read_b64_tr_b16 v[106:107], v197 offset:2400
    ds_read_b64_tr_b16 v[108:109], v197 offset:128
    ds_read_b64_tr_b16 v[110:111], v197 offset:2432
    ds_read_b64_tr_b16 v[112:113], v197 offset:160
    ds_read_b64_tr_b16 v[114:115], v197 offset:2464
    ds_read_b64_tr_b16 v[116:117], v197 offset:192
    ds_read_b64_tr_b16 v[118:119], v197 offset:2496
    ds_read_b64_tr_b16 v[120:121], v197 offset:224
    ds_read_b64_tr_b16 v[122:123], v197 offset:2528
    ds_read_b64_tr_b16 v[124:125], v197 offset:256
    ds_read_b64_tr_b16 v[126:127], v197 offset:2560
    ds_read_b128 v[84:87], v196 offset:0
    ds_read_b128 v[88:91], v196 offset:2048
    ds_read_b64_tr_b16 v[128:129], v197 offset:9216
    ds_read_b64_tr_b16 v[130:131], v197 offset:11520
    ds_read_b64_tr_b16 v[132:133], v197 offset:9248
    ds_read_b64_tr_b16 v[134:135], v197 offset:11552
    ds_read_b64_tr_b16 v[136:137], v197 offset:9280
    ds_read_b64_tr_b16 v[138:139], v197 offset:11584
    ds_read_b64_tr_b16 v[140:141], v197 offset:9312
    ds_read_b64_tr_b16 v[142:143], v197 offset:11616
    ds_read_b64_tr_b16 v[144:145], v197 offset:9344
    ds_read_b64_tr_b16 v[146:147], v197 offset:11648
    ds_read_b64_tr_b16 v[148:149], v197 offset:9376
    ds_read_b64_tr_b16 v[150:151], v197 offset:11680
    ds_read_b64_tr_b16 v[152:153], v197 offset:9408
    ds_read_b64_tr_b16 v[154:155], v197 offset:11712
    ds_read_b64_tr_b16 v[156:157], v197 offset:9440
    ds_read_b64_tr_b16 v[158:159], v197 offset:11744
    ds_read_b64_tr_b16 v[160:161], v197 offset:9472
    ds_read_b64_tr_b16 v[162:163], v197 offset:11776
    s_waitcnt lgkmcnt(15)
    v_mfma_f32_16x16x32_bf16 v[4:7], v[92:95], v[76:79], v[4:7]
    v_mfma_f32_16x16x32_bf16 v[8:11], v[92:95], v[80:83], v[8:11]
    v_mfma_f32_16x16x32_bf16 v[12:15], v[96:99], v[76:79], v[12:15]
    v_mfma_f32_16x16x32_bf16 v[16:19], v[96:99], v[80:83], v[16:19]
    v_mfma_f32_16x16x32_bf16 v[20:23], v[100:103], v[76:79], v[20:23]
    v_mfma_f32_16x16x32_bf16 v[24:27], v[100:103], v[80:83], v[24:27]
    v_mfma_f32_16x16x32_bf16 v[28:31], v[104:107], v[76:79], v[28:31]
    v_mfma_f32_16x16x32_bf16 v[32:35], v[104:107], v[80:83], v[32:35]
    v_mfma_f32_16x16x32_bf16 v[36:39], v[108:111], v[76:79], v[36:39]
    v_mfma_f32_16x16x32_bf16 v[40:43], v[108:111], v[80:83], v[40:43]
    v_mfma_f32_16x16x32_bf16 v[44:47], v[112:115], v[76:79], v[44:47]
    v_mfma_f32_16x16x32_bf16 v[48:51], v[112:115], v[80:83], v[48:51]
    v_mfma_f32_16x16x32_bf16 v[52:55], v[116:119], v[76:79], v[52:55]
    v_mfma_f32_16x16x32_bf16 v[56:59], v[116:119], v[80:83], v[56:59]
    v_mfma_f32_16x16x32_bf16 v[60:63], v[120:123], v[76:79], v[60:63]
    v_mfma_f32_16x16x32_bf16 v[64:67], v[120:123], v[80:83], v[64:67]
    v_mfma_f32_16x16x32_bf16 v[68:71], v[124:127], v[76:79], v[68:71]
    v_mfma_f32_16x16x32_bf16 v[72:75], v[124:127], v[80:83], v[72:75]
    s_waitcnt lgkmcnt(0)
    v_mfma_f32_16x16x32_bf16 v[4:7], v[128:131], v[84:87], v[4:7]
    v_mfma_f32_16x16x32_bf16 v[8:11], v[128:131], v[88:91], v[8:11]
    v_mfma_f32_16x16x32_bf16 v[12:15], v[132:135], v[84:87], v[12:15]
    v_mfma_f32_16x16x32_bf16 v[16:19], v[132:135], v[88:91], v[16:19]
    v_mfma_f32_16x16x32_bf16 v[20:23], v[136:139], v[84:87], v[20:23]
    v_mfma_f32_16x16x32_bf16 v[24:27], v[136:139], v[88:91], v[24:27]
    v_mfma_f32_16x16x32_bf16 v[28:31], v[140:143], v[84:87], v[28:31]
    v_mfma_f32_16x16x32_bf16 v[32:35], v[140:143], v[88:91], v[32:35]
    v_mfma_f32_16x16x32_bf16 v[36:39], v[144:147], v[84:87], v[36:39]
    v_mfma_f32_16x16x32_bf16 v[40:43], v[144:147], v[88:91], v[40:43]
    v_mfma_f32_16x16x32_bf16 v[44:47], v[148:151], v[84:87], v[44:47]
    v_mfma_f32_16x16x32_bf16 v[48:51], v[148:151], v[88:91], v[48:51]
    v_mfma_f32_16x16x32_bf16 v[52:55], v[152:155], v[84:87], v[52:55]
    v_mfma_f32_16x16x32_bf16 v[56:59], v[152:155], v[88:91], v[56:59]
    v_mfma_f32_16x16x32_bf16 v[60:63], v[156:159], v[84:87], v[60:63]
    v_mfma_f32_16x16x32_bf16 v[64:67], v[156:159], v[88:91], v[64:67]
    v_mfma_f32_16x16x32_bf16 v[68:71], v[160:163], v[84:87], v[68:71]
    v_mfma_f32_16x16x32_bf16 v[72:75], v[160:163], v[88:91], v[72:75]
    v_and_b32 v175, 15, v1
    v_lshrrev_b32 v176, 4, v1
    s_mul_i32 s40, s41, 32
    v_add_u32 v175, s40, v175
    s_mul_i32 s40, s42, 144
    v_lshl_add_u32 v176, v176, 2, s40
    s_mov_b32 s40, 4608
    v_mul_lo_u32 v177, s40, v175
    v_lshl_add_u32 v177, v176, 1, v177
    s_nop 7
    s_nop 7
    v_cvt_pk_bf16_f32 v4, v4, v5
    v_cvt_pk_bf16_f32 v5, v6, v7
    buffer_store_dwordx2 v[4:5], v177, s[16:19], 0 offen offset:0
    v_cvt_pk_bf16_f32 v8, v8, v9
    v_cvt_pk_bf16_f32 v9, v10, v11
    v_add_u32 v179, 73728, v177
    buffer_store_dwordx2 v[8:9], v179, s[16:19], 0 offen
    v_cvt_pk_bf16_f32 v12, v12, v13
    v_cvt_pk_bf16_f32 v13, v14, v15
    buffer_store_dwordx2 v[12:13], v177, s[16:19], 0 offen offset:32
    v_cvt_pk_bf16_f32 v16, v16, v17
    v_cvt_pk_bf16_f32 v17, v18, v19
    v_add_u32 v179, 73760, v177
    buffer_store_dwordx2 v[16:17], v179, s[16:19], 0 offen
    v_cvt_pk_bf16_f32 v20, v20, v21
    v_cvt_pk_bf16_f32 v21, v22, v23
    buffer_store_dwordx2 v[20:21], v177, s[16:19], 0 offen offset:64
    v_cvt_pk_bf16_f32 v24, v24, v25
    v_cvt_pk_bf16_f32 v25, v26, v27
    v_add_u32 v179, 73792, v177
    buffer_store_dwordx2 v[24:25], v179, s[16:19], 0 offen
    v_cvt_pk_bf16_f32 v28, v28, v29
    v_cvt_pk_bf16_f32 v29, v30, v31
    buffer_store_dwordx2 v[28:29], v177, s[16:19], 0 offen offset:96
    v_cvt_pk_bf16_f32 v32, v32, v33
    v_cvt_pk_bf16_f32 v33, v34, v35
    v_add_u32 v179, 73824, v177
    buffer_store_dwordx2 v[32:33], v179, s[16:19], 0 offen
    v_cvt_pk_bf16_f32 v36, v36, v37
    v_cvt_pk_bf16_f32 v37, v38, v39
    buffer_store_dwordx2 v[36:37], v177, s[16:19], 0 offen offset:128
    v_cvt_pk_bf16_f32 v40, v40, v41
    v_cvt_pk_bf16_f32 v41, v42, v43
    v_add_u32 v179, 73856, v177
    buffer_store_dwordx2 v[40:41], v179, s[16:19], 0 offen
    v_cvt_pk_bf16_f32 v44, v44, v45
    v_cvt_pk_bf16_f32 v45, v46, v47
    buffer_store_dwordx2 v[44:45], v177, s[16:19], 0 offen offset:160
    v_cvt_pk_bf16_f32 v48, v48, v49
    v_cvt_pk_bf16_f32 v49, v50, v51
    v_add_u32 v179, 73888, v177
    buffer_store_dwordx2 v[48:49], v179, s[16:19], 0 offen
    v_cvt_pk_bf16_f32 v52, v52, v53
    v_cvt_pk_bf16_f32 v53, v54, v55
    buffer_store_dwordx2 v[52:53], v177, s[16:19], 0 offen offset:192
    v_cvt_pk_bf16_f32 v56, v56, v57
    v_cvt_pk_bf16_f32 v57, v58, v59
    v_add_u32 v179, 73920, v177
    buffer_store_dwordx2 v[56:57], v179, s[16:19], 0 offen
    v_cvt_pk_bf16_f32 v60, v60, v61
    v_cvt_pk_bf16_f32 v61, v62, v63
    buffer_store_dwordx2 v[60:61], v177, s[16:19], 0 offen offset:224
    v_cvt_pk_bf16_f32 v64, v64, v65
    v_cvt_pk_bf16_f32 v65, v66, v67
    v_add_u32 v179, 73952, v177
    buffer_store_dwordx2 v[64:65], v179, s[16:19], 0 offen
    v_cvt_pk_bf16_f32 v68, v68, v69
    v_cvt_pk_bf16_f32 v69, v70, v71
    buffer_store_dwordx2 v[68:69], v177, s[16:19], 0 offen offset:256
    v_cvt_pk_bf16_f32 v72, v72, v73
    v_cvt_pk_bf16_f32 v73, v74, v75
    v_add_u32 v179, 73984, v177
    buffer_store_dwordx2 v[72:73], v179, s[16:19], 0 offen
qkv_kernel_end:
    s_endpgm
.text
.globl s_kernel
.p2align 8
.type s_kernel,@function
s_kernel:
    s_cmp_ge_u32 s2, 256
    s_cbranch_scc1 s_kernel_end
    s_load_dwordx2 s[20:21], s[0:1], 72
    s_load_dwordx2 s[22:23], s[0:1], 72
    s_load_dwordx2 s[24:25], s[0:1], 72
    s_load_dwordx2 s[26:27], s[0:1], 72
    s_load_dwordx2 s[28:29], s[0:1], 0
    s_and_b32 s40, s2, 7
    s_mul_i32 s40, s40, 32
    s_lshr_b32 s2, s2, 3
    s_add_u32 s2, s2, s40
    s_lshr_b32 s30, s2, 6
    s_mul_i32 s31, s30, 64
    s_sub_u32 s31, s2, s31
    s_lshr_b32 s32, s31, 3
    s_mul_i32 s33, s32, 8
    s_sub_u32 s33, s31, s33
    s_lshr_b32 s34, s30, 1
    s_and_b32 s35, s30, 1
    v_lshrrev_b32 v200, 6, v0
    s_nop 0
    v_readfirstlane_b32 s36, v200
    v_and_b32 v1, 63, v0
    s_mul_i32 s37, s34, 4718592
    s_mul_i32 s40, s35, 768
    s_add_u32 s37, s37, s40
    s_mul_i32 s40, s32, 589824
    s_add_u32 s37, s37, s40
    s_mul_i32 s38, s34, 4718592
    s_mul_i32 s40, s35, 768
    s_add_u32 s38, s38, s40
    s_mul_i32 s40, s33, 589824
    s_add_u32 s38, s38, s40
    s_mul_i32 s39, s34, 4194304
    s_mul_i32 s40, s35, 2097152
    s_add_u32 s39, s39, s40
    s_mul_i32 s40, s32, 262144
    s_add_u32 s39, s39, s40
    s_mul_i32 s40, s33, 256
    s_add_u32 s39, s39, s40
    s_waitcnt lgkmcnt(0)
    s_add_u32 s8, s20, 4194304
    s_addc_u32 s9, s21, 0
    s_add_u32 s8, s8, s37
    s_addc_u32 s9, s9, 0
    s_mov_b32 s11, 0x00020000
    s_add_u32 s12, s22, 4195840
    s_addc_u32 s13, s23, 0
    s_add_u32 s12, s12, s38
    s_addc_u32 s13, s13, 0
    s_mov_b32 s15, 0x00020000
    s_add_u32 s16, s24, 16777216
    s_addc_u32 s17, s25, 0
    s_add_u32 s16, s16, s39
    s_addc_u32 s17, s17, 0
    s_mov_b32 s19, 0x00020000
    s_mov_b32 s10, 585984
    s_mov_b32 s14, 585984
    s_mov_b32 s18, 260352
    s_lshl_b32 s40, s36, 6
    v_add_u32 v142, s40, v1
    v_add_u32 v142, 0, v142
    v_lshrrev_b32 v143, 3, v142
    v_and_b32 v144, 7, v142
    v_and_b32 v145, 7, v143
    v_xor_b32 v144, v144, v145
    s_mov_b32 s40, 4608
    v_mul_lo_u32 v143, s40, v143
    v_lshl_add_u32 v132, v144, 4, v143
    s_lshl_b32 s40, s36, 6
    v_add_u32 v142, s40, v1
    v_add_u32 v142, 256, v142
    v_lshrrev_b32 v143, 3, v142
    v_and_b32 v144, 7, v142
    v_and_b32 v145, 7, v143
    v_xor_b32 v144, v144, v145
    s_mov_b32 s40, 4608
    v_mul_lo_u32 v143, s40, v143
    v_lshl_add_u32 v133, v144, 4, v143
    s_lshl_b32 s40, s36, 6
    v_add_u32 v142, s40, v1
    v_add_u32 v142, 512, v142
    v_lshrrev_b32 v143, 3, v142
    v_and_b32 v144, 7, v142
    v_and_b32 v145, 7, v143
    v_xor_b32 v144, v144, v145
    s_mov_b32 s40, 4608
    v_mul_lo_u32 v143, s40, v143
    v_lshl_add_u32 v134, v144, 4, v143
    s_lshl_b32 s40, s36, 6
    v_add_u32 v142, s40, v1
    v_add_u32 v142, 768, v142
    v_lshrrev_b32 v143, 3, v142
    v_and_b32 v144, 7, v142
    v_and_b32 v145, 7, v143
    v_xor_b32 v144, v144, v145
    s_mov_b32 s40, 4608
    v_mul_lo_u32 v143, s40, v143
    v_lshl_add_u32 v135, v144, 4, v143
    s_lshl_b32 s40, s36, 6
    v_add_u32 v142, s40, v1
    v_add_u32 v142, 0, v142
    v_lshrrev_b32 v143, 3, v142
    v_min_u32 v143, 127, v143
    v_and_b32 v144, 7, v142
    v_and_b32 v145, 7, v143
    v_xor_b32 v144, v144, v145
    s_mov_b32 s40, 4608
    v_mul_lo_u32 v143, s40, v143
    v_lshl_add_u32 v136, v144, 4, v143
    s_lshl_b32 s40, s36, 6
    v_add_u32 v142, s40, v1
    v_add_u32 v142, 256, v142
    v_lshrrev_b32 v143, 3, v142
    v_min_u32 v143, 127, v143
    v_and_b32 v144, 7, v142
    v_and_b32 v145, 7, v143
    v_xor_b32 v144, v144, v145
    s_mov_b32 s40, 4608
    v_mul_lo_u32 v143, s40, v143
    v_lshl_add_u32 v137, v144, 4, v143
    s_lshl_b32 s40, s36, 6
    v_add_u32 v142, s40, v1
    v_add_u32 v142, 512, v142
    v_lshrrev_b32 v143, 3, v142
    v_min_u32 v143, 127, v143
    v_and_b32 v144, 7, v142
    v_and_b32 v145, 7, v143
    v_xor_b32 v144, v144, v145
    s_mov_b32 s40, 4608
    v_mul_lo_u32 v143, s40, v143
    v_lshl_add_u32 v138, v144, 4, v143
    s_lshl_b32 s40, s36, 6
    v_add_u32 v142, s40, v1
    v_add_u32 v142, 768, v142
    v_lshrrev_b32 v143, 3, v142
    v_min_u32 v143, 127, v143
    v_and_b32 v144, 7, v142
    v_and_b32 v145, 7, v143
    v_xor_b32 v144, v144, v145
    s_mov_b32 s40, 4608
    v_mul_lo_u32 v143, s40, v143
    v_lshl_add_u32 v139, v144, 4, v143
    s_lshr_b32 s41, s36, 1
    s_mul_i32 s42, s41, 2
    s_sub_u32 s42, s36, s42
    v_and_b32 v142, 15, v1
    v_lshrrev_b32 v143, 4, v1
    s_mul_i32 s40, s41, 64
    v_add_u32 v144, s40, v142
    v_and_b32 v145, 7, v144
    v_xor_b32 v145, v145, v143
    v_lshlrev_b32 v144, 7, v144
    v_lshl_add_u32 v140, v145, 4, v144
    s_mul_i32 s40, s42, 64
    v_add_u32 v144, s40, v142
    v_and_b32 v145, 7, v144
    v_xor_b32 v145, v145, v143
    v_lshlrev_b32 v144, 7, v144
    v_lshl_add_u32 v141, v145, 4, v144
    v_add_u32 v141, 16384, v141
    s_lshl_b32 s43, s36, 10
    s_mov_b32 s44, 0
    s_mov_b32 s45, 0
    v_xor_b32 v150, 64, v140
    v_xor_b32 v151, 64, v141
    v_add_u32 v154, 0, v140
    v_add_u32 v155, 0, v150
    v_add_u32 v156, 0, v141
    v_add_u32 v157, 0, v151
    v_add_u32 v158, 32768, v140
    v_add_u32 v159, 32768, v150
    v_add_u32 v160, 32768, v141
    v_add_u32 v161, 32768, v151
    v_add_u32 v162, 65536, v140
    v_add_u32 v163, 65536, v150
    v_add_u32 v164, 65536, v141
    v_add_u32 v165, 65536, v151
    s_add_u32 m0, s43, 0
    s_nop 0
    buffer_load_dwordx4 v132, s[8:11], s44 offen lds
    s_add_u32 m0, s43, 4096
    s_nop 0
    buffer_load_dwordx4 v133, s[8:11], s44 offen lds
    s_add_u32 m0, s43, 8192
    s_nop 0
    buffer_load_dwordx4 v134, s[8:11], s44 offen lds
    s_add_u32 m0, s43, 12288
    s_nop 0
    buffer_load_dwordx4 v135, s[8:11], s44 offen lds
    s_add_u32 m0, s43, 16384
    s_nop 0
    buffer_load_dwordx4 v136, s[12:15], s45 offen lds
    s_add_u32 m0, s43, 20480
    s_nop 0
    buffer_load_dwordx4 v137, s[12:15], s45 offen lds
    s_add_u32 m0, s43, 24576
    s_nop 0
    buffer_load_dwordx4 v138, s[12:15], s45 offen lds
    s_add_u32 m0, s43, 28672
    s_nop 0
    buffer_load_dwordx4 v139, s[12:15], s45 offen lds
    s_add_u32 s44, s44, 128
    s_add_u32 s45, s45, 128
    s_add_u32 m0, s43, 32768
    s_nop 0
    buffer_load_dwordx4 v132, s[8:11], s44 offen lds
    s_add_u32 m0, s43, 36864
    s_nop 0
    buffer_load_dwordx4 v133, s[8:11], s44 offen lds
    s_add_u32 m0, s43, 40960
    s_nop 0
    buffer_load_dwordx4 v134, s[8:11], s44 offen lds
    s_add_u32 m0, s43, 45056
    s_nop 0
    buffer_load_dwordx4 v135, s[8:11], s44 offen lds
    s_add_u32 m0, s43, 49152
    s_nop 0
    buffer_load_dwordx4 v136, s[12:15], s45 offen lds
    s_add_u32 m0, s43, 53248
    s_nop 0
    buffer_load_dwordx4 v137, s[12:15], s45 offen lds
    s_add_u32 m0, s43, 57344
    s_nop 0
    buffer_load_dwordx4 v138, s[12:15], s45 offen lds
    s_add_u32 m0, s43, 61440
    s_nop 0
    buffer_load_dwordx4 v139, s[12:15], s45 offen lds
    s_add_u32 s44, s44, 128
    s_add_u32 s45, s45, 128
    s_waitcnt vmcnt(8)
    s_barrier
    ds_read_b128 v[68:71], v154 offset:0
    ds_read_b128 v[72:75], v154 offset:2048
    ds_read_b128 v[76:79], v154 offset:4096
    ds_read_b128 v[80:83], v154 offset:6144
    ds_read_b128 v[100:103], v156 offset:0
    ds_read_b128 v[104:107], v156 offset:2048
    ds_read_b128 v[108:111], v156 offset:4096
    ds_read_b128 v[112:115], v156 offset:6144
    s_add_u32 m0, s43, 65536
    s_nop 0
    buffer_load_dwordx4 v132, s[8:11], s44 offen lds
    s_add_u32 m0, s43, 69632
    s_nop 0
    buffer_load_dwordx4 v133, s[8:11], s44 offen lds
    s_add_u32 m0, s43, 73728
    s_nop 0
    buffer_load_dwordx4 v134, s[8:11], s44 offen lds
    s_add_u32 m0, s43, 77824
    s_nop 0
    buffer_load_dwordx4 v135, s[8:11], s44 offen lds
    s_add_u32 m0, s43, 81920
    s_nop 0
    buffer_load_dwordx4 v136, s[12:15], s45 offen lds
    s_add_u32 m0, s43, 86016
    s_nop 0
    buffer_load_dwordx4 v137, s[12:15], s45 offen lds
    s_add_u32 m0, s43, 90112
    s_nop 0
    buffer_load_dwordx4 v138, s[12:15], s45 offen lds
    s_add_u32 m0, s43, 94208
    s_nop 0
    buffer_load_dwordx4 v139, s[12:15], s45 offen lds
    s_add_u32 s44, s44, 128
    s_add_u32 s45, s45, 128
    ds_read_b128 v[84:87], v155 offset:0
    ds_read_b128 v[88:91], v155 offset:2048
    ds_read_b128 v[92:95], v155 offset:4096
    ds_read_b128 v[96:99], v155 offset:6144
    ds_read_b128 v[116:119], v157 offset:0
    ds_read_b128 v[120:123], v157 offset:2048
    ds_read_b128 v[124:127], v157 offset:4096
    ds_read_b128 v[128:131], v157 offset:6144
    s_waitcnt lgkmcnt(8)
    v_mfma_f32_16x16x32_bf16 v[4:7], v[100:103], v[68:71], 0
    v_mfma_f32_16x16x32_bf16 v[8:11], v[100:103], v[72:75], 0
    v_mfma_f32_16x16x32_bf16 v[12:15], v[100:103], v[76:79], 0
    v_mfma_f32_16x16x32_bf16 v[16:19], v[100:103], v[80:83], 0
    v_mfma_f32_16x16x32_bf16 v[20:23], v[104:107], v[68:71], 0
    v_mfma_f32_16x16x32_bf16 v[24:27], v[104:107], v[72:75], 0
    v_mfma_f32_16x16x32_bf16 v[28:31], v[104:107], v[76:79], 0
    v_mfma_f32_16x16x32_bf16 v[32:35], v[104:107], v[80:83], 0
    v_mfma_f32_16x16x32_bf16 v[36:39], v[108:111], v[68:71], 0
    v_mfma_f32_16x16x32_bf16 v[40:43], v[108:111], v[72:75], 0
    v_mfma_f32_16x16x32_bf16 v[44:47], v[108:111], v[76:79], 0
    v_mfma_f32_16x16x32_bf16 v[48:51], v[108:111], v[80:83], 0
    v_mfma_f32_16x16x32_bf16 v[52:55], v[112:115], v[68:71], 0
    v_mfma_f32_16x16x32_bf16 v[56:59], v[112:115], v[72:75], 0
    v_mfma_f32_16x16x32_bf16 v[60:63], v[112:115], v[76:79], 0
    v_mfma_f32_16x16x32_bf16 v[64:67], v[112:115], v[80:83], 0
    s_waitcnt lgkmcnt(0)
    v_mfma_f32_16x16x32_bf16 v[4:7], v[116:119], v[84:87], v[4:7]
    v_mfma_f32_16x16x32_bf16 v[8:11], v[116:119], v[88:91], v[8:11]
    v_mfma_f32_16x16x32_bf16 v[12:15], v[116:119], v[92:95], v[12:15]
    v_mfma_f32_16x16x32_bf16 v[16:19], v[116:119], v[96:99], v[16:19]
    v_mfma_f32_16x16x32_bf16 v[20:23], v[120:123], v[84:87], v[20:23]
    v_mfma_f32_16x16x32_bf16 v[24:27], v[120:123], v[88:91], v[24:27]
    v_mfma_f32_16x16x32_bf16 v[28:31], v[120:123], v[92:95], v[28:31]
    v_mfma_f32_16x16x32_bf16 v[32:35], v[120:123], v[96:99], v[32:35]
    v_mfma_f32_16x16x32_bf16 v[36:39], v[124:127], v[84:87], v[36:39]
    v_mfma_f32_16x16x32_bf16 v[40:43], v[124:127], v[88:91], v[40:43]
    v_mfma_f32_16x16x32_bf16 v[44:47], v[124:127], v[92:95], v[44:47]
    v_mfma_f32_16x16x32_bf16 v[48:51], v[124:127], v[96:99], v[48:51]
    v_mfma_f32_16x16x32_bf16 v[52:55], v[128:131], v[84:87], v[52:55]
    v_mfma_f32_16x16x32_bf16 v[56:59], v[128:131], v[88:91], v[56:59]
    v_mfma_f32_16x16x32_bf16 v[60:63], v[128:131], v[92:95], v[60:63]
    v_mfma_f32_16x16x32_bf16 v[64:67], v[128:131], v[96:99], v[64:67]
    s_waitcnt vmcnt(8)
    s_barrier
    ds_read_b128 v[68:71], v158 offset:0
    ds_read_b128 v[72:75], v158 offset:2048
    ds_read_b128 v[76:79], v158 offset:4096
    ds_read_b128 v[80:83], v158 offset:6144
    ds_read_b128 v[100:103], v160 offset:0
    ds_read_b128 v[104:107], v160 offset:2048
    ds_read_b128 v[108:111], v160 offset:4096
    ds_read_b128 v[112:115], v160 offset:6144
    s_add_u32 m0, s43, 0
    s_nop 0
    buffer_load_dwordx4 v132, s[8:11], s44 offen lds
    s_add_u32 m0, s43, 4096
    s_nop 0
    buffer_load_dwordx4 v133, s[8:11], s44 offen lds
    s_add_u32 m0, s43, 8192
    s_nop 0
    buffer_load_dwordx4 v134, s[8:11], s44 offen lds
    s_add_u32 m0, s43, 12288
    s_nop 0
    buffer_load_dwordx4 v135, s[8:11], s44 offen lds
    s_add_u32 m0, s43, 16384
    s_nop 0
    buffer_load_dwordx4 v136, s[12:15], s45 offen lds
    s_add_u32 m0, s43, 20480
    s_nop 0
    buffer_load_dwordx4 v137, s[12:15], s45 offen lds
    s_add_u32 m0, s43, 24576
    s_nop 0
    buffer_load_dwordx4 v138, s[12:15], s45 offen lds
    s_add_u32 m0, s43, 28672
    s_nop 0
    buffer_load_dwordx4 v139, s[12:15], s45 offen lds
    s_add_u32 s44, s44, 128
    s_add_u32 s45, s45, 128
    ds_read_b128 v[84:87], v159 offset:0
    ds_read_b128 v[88:91], v159 offset:2048
    ds_read_b128 v[92:95], v159 offset:4096
    ds_read_b128 v[96:99], v159 offset:6144
    ds_read_b128 v[116:119], v161 offset:0
    ds_read_b128 v[120:123], v161 offset:2048
    ds_read_b128 v[124:127], v161 offset:4096
    ds_read_b128 v[128:131], v161 offset:6144
    s_waitcnt lgkmcnt(8)
    v_mfma_f32_16x16x32_bf16 v[4:7], v[100:103], v[68:71], v[4:7]
    v_mfma_f32_16x16x32_bf16 v[8:11], v[100:103], v[72:75], v[8:11]
    v_mfma_f32_16x16x32_bf16 v[12:15], v[100:103], v[76:79], v[12:15]
    v_mfma_f32_16x16x32_bf16 v[16:19], v[100:103], v[80:83], v[16:19]
    v_mfma_f32_16x16x32_bf16 v[20:23], v[104:107], v[68:71], v[20:23]
    v_mfma_f32_16x16x32_bf16 v[24:27], v[104:107], v[72:75], v[24:27]
    v_mfma_f32_16x16x32_bf16 v[28:31], v[104:107], v[76:79], v[28:31]
    v_mfma_f32_16x16x32_bf16 v[32:35], v[104:107], v[80:83], v[32:35]
    v_mfma_f32_16x16x32_bf16 v[36:39], v[108:111], v[68:71], v[36:39]
    v_mfma_f32_16x16x32_bf16 v[40:43], v[108:111], v[72:75], v[40:43]
    v_mfma_f32_16x16x32_bf16 v[44:47], v[108:111], v[76:79], v[44:47]
    v_mfma_f32_16x16x32_bf16 v[48:51], v[108:111], v[80:83], v[48:51]
    v_mfma_f32_16x16x32_bf16 v[52:55], v[112:115], v[68:71], v[52:55]
    v_mfma_f32_16x16x32_bf16 v[56:59], v[112:115], v[72:75], v[56:59]
    v_mfma_f32_16x16x32_bf16 v[60:63], v[112:115], v[76:79], v[60:63]
    v_mfma_f32_16x16x32_bf16 v[64:67], v[112:115], v[80:83], v[64:67]
    s_waitcnt lgkmcnt(0)
    v_mfma_f32_16x16x32_bf16 v[4:7], v[116:119], v[84:87], v[4:7]
    v_mfma_f32_16x16x32_bf16 v[8:11], v[116:119], v[88:91], v[8:11]
    v_mfma_f32_16x16x32_bf16 v[12:15], v[116:119], v[92:95], v[12:15]
    v_mfma_f32_16x16x32_bf16 v[16:19], v[116:119], v[96:99], v[16:19]
    v_mfma_f32_16x16x32_bf16 v[20:23], v[120:123], v[84:87], v[20:23]
    v_mfma_f32_16x16x32_bf16 v[24:27], v[120:123], v[88:91], v[24:27]
    v_mfma_f32_16x16x32_bf16 v[28:31], v[120:123], v[92:95], v[28:31]
    v_mfma_f32_16x16x32_bf16 v[32:35], v[120:123], v[96:99], v[32:35]
    v_mfma_f32_16x16x32_bf16 v[36:39], v[124:127], v[84:87], v[36:39]
    v_mfma_f32_16x16x32_bf16 v[40:43], v[124:127], v[88:91], v[40:43]
    v_mfma_f32_16x16x32_bf16 v[44:47], v[124:127], v[92:95], v[44:47]
    v_mfma_f32_16x16x32_bf16 v[48:51], v[124:127], v[96:99], v[48:51]
    v_mfma_f32_16x16x32_bf16 v[52:55], v[128:131], v[84:87], v[52:55]
    v_mfma_f32_16x16x32_bf16 v[56:59], v[128:131], v[88:91], v[56:59]
    v_mfma_f32_16x16x32_bf16 v[60:63], v[128:131], v[92:95], v[60:63]
    v_mfma_f32_16x16x32_bf16 v[64:67], v[128:131], v[96:99], v[64:67]
    s_waitcnt vmcnt(8)
    s_barrier
    ds_read_b128 v[68:71], v162 offset:0
    ds_read_b128 v[72:75], v162 offset:2048
    ds_read_b128 v[76:79], v162 offset:4096
    ds_read_b128 v[80:83], v162 offset:6144
    ds_read_b128 v[100:103], v164 offset:0
    ds_read_b128 v[104:107], v164 offset:2048
    ds_read_b128 v[108:111], v164 offset:4096
    ds_read_b128 v[112:115], v164 offset:6144
    s_add_u32 m0, s43, 32768
    s_nop 0
    buffer_load_dwordx4 v132, s[8:11], s44 offen lds
    s_add_u32 m0, s43, 36864
    s_nop 0
    buffer_load_dwordx4 v133, s[8:11], s44 offen lds
    s_add_u32 m0, s43, 40960
    s_nop 0
    buffer_load_dwordx4 v134, s[8:11], s44 offen lds
    s_add_u32 m0, s43, 45056
    s_nop 0
    buffer_load_dwordx4 v135, s[8:11], s44 offen lds
    s_add_u32 m0, s43, 49152
    s_nop 0
    buffer_load_dwordx4 v136, s[12:15], s45 offen lds
    s_add_u32 m0, s43, 53248
    s_nop 0
    buffer_load_dwordx4 v137, s[12:15], s45 offen lds
    s_add_u32 m0, s43, 57344
    s_nop 0
    buffer_load_dwordx4 v138, s[12:15], s45 offen lds
    s_add_u32 m0, s43, 61440
    s_nop 0
    buffer_load_dwordx4 v139, s[12:15], s45 offen lds
    s_add_u32 s44, s44, 128
    s_add_u32 s45, s45, 128
    ds_read_b128 v[84:87], v163 offset:0
    ds_read_b128 v[88:91], v163 offset:2048
    ds_read_b128 v[92:95], v163 offset:4096
    ds_read_b128 v[96:99], v163 offset:6144
    ds_read_b128 v[116:119], v165 offset:0
    ds_read_b128 v[120:123], v165 offset:2048
    ds_read_b128 v[124:127], v165 offset:4096
    ds_read_b128 v[128:131], v165 offset:6144
    s_waitcnt lgkmcnt(8)
    v_mfma_f32_16x16x32_bf16 v[4:7], v[100:103], v[68:71], v[4:7]
    v_mfma_f32_16x16x32_bf16 v[8:11], v[100:103], v[72:75], v[8:11]
    v_mfma_f32_16x16x32_bf16 v[12:15], v[100:103], v[76:79], v[12:15]
    v_mfma_f32_16x16x32_bf16 v[16:19], v[100:103], v[80:83], v[16:19]
    v_mfma_f32_16x16x32_bf16 v[20:23], v[104:107], v[68:71], v[20:23]
    v_mfma_f32_16x16x32_bf16 v[24:27], v[104:107], v[72:75], v[24:27]
    v_mfma_f32_16x16x32_bf16 v[28:31], v[104:107], v[76:79], v[28:31]
    v_mfma_f32_16x16x32_bf16 v[32:35], v[104:107], v[80:83], v[32:35]
    v_mfma_f32_16x16x32_bf16 v[36:39], v[108:111], v[68:71], v[36:39]
    v_mfma_f32_16x16x32_bf16 v[40:43], v[108:111], v[72:75], v[40:43]
    v_mfma_f32_16x16x32_bf16 v[44:47], v[108:111], v[76:79], v[44:47]
    v_mfma_f32_16x16x32_bf16 v[48:51], v[108:111], v[80:83], v[48:51]
    v_mfma_f32_16x16x32_bf16 v[52:55], v[112:115], v[68:71], v[52:55]
    v_mfma_f32_16x16x32_bf16 v[56:59], v[112:115], v[72:75], v[56:59]
    v_mfma_f32_16x16x32_bf16 v[60:63], v[112:115], v[76:79], v[60:63]
    v_mfma_f32_16x16x32_bf16 v[64:67], v[112:115], v[80:83], v[64:67]
    s_waitcnt lgkmcnt(0)
    v_mfma_f32_16x16x32_bf16 v[4:7], v[116:119], v[84:87], v[4:7]
    v_mfma_f32_16x16x32_bf16 v[8:11], v[116:119], v[88:91], v[8:11]
    v_mfma_f32_16x16x32_bf16 v[12:15], v[116:119], v[92:95], v[12:15]
    v_mfma_f32_16x16x32_bf16 v[16:19], v[116:119], v[96:99], v[16:19]
    v_mfma_f32_16x16x32_bf16 v[20:23], v[120:123], v[84:87], v[20:23]
    v_mfma_f32_16x16x32_bf16 v[24:27], v[120:123], v[88:91], v[24:27]
    v_mfma_f32_16x16x32_bf16 v[28:31], v[120:123], v[92:95], v[28:31]
    v_mfma_f32_16x16x32_bf16 v[32:35], v[120:123], v[96:99], v[32:35]
    v_mfma_f32_16x16x32_bf16 v[36:39], v[124:127], v[84:87], v[36:39]
    v_mfma_f32_16x16x32_bf16 v[40:43], v[124:127], v[88:91], v[40:43]
    v_mfma_f32_16x16x32_bf16 v[44:47], v[124:127], v[92:95], v[44:47]
    v_mfma_f32_16x16x32_bf16 v[48:51], v[124:127], v[96:99], v[48:51]
    v_mfma_f32_16x16x32_bf16 v[52:55], v[128:131], v[84:87], v[52:55]
    v_mfma_f32_16x16x32_bf16 v[56:59], v[128:131], v[88:91], v[56:59]
    v_mfma_f32_16x16x32_bf16 v[60:63], v[128:131], v[92:95], v[60:63]
    v_mfma_f32_16x16x32_bf16 v[64:67], v[128:131], v[96:99], v[64:67]
    s_waitcnt vmcnt(8)
    s_barrier
    ds_read_b128 v[68:71], v154 offset:0
    ds_read_b128 v[72:75], v154 offset:2048
    ds_read_b128 v[76:79], v154 offset:4096
    ds_read_b128 v[80:83], v154 offset:6144
    ds_read_b128 v[100:103], v156 offset:0
    ds_read_b128 v[104:107], v156 offset:2048
    ds_read_b128 v[108:111], v156 offset:4096
    ds_read_b128 v[112:115], v156 offset:6144
    s_add_u32 m0, s43, 65536
    s_nop 0
    buffer_load_dwordx4 v132, s[8:11], s44 offen lds
    s_add_u32 m0, s43, 69632
    s_nop 0
    buffer_load_dwordx4 v133, s[8:11], s44 offen lds
    s_add_u32 m0, s43, 73728
    s_nop 0
    buffer_load_dwordx4 v134, s[8:11], s44 offen lds
    s_add_u32 m0, s43, 77824
    s_nop 0
    buffer_load_dwordx4 v135, s[8:11], s44 offen lds
    s_add_u32 m0, s43, 81920
    s_nop 0
    buffer_load_dwordx4 v136, s[12:15], s45 offen lds
    s_add_u32 m0, s43, 86016
    s_nop 0
    buffer_load_dwordx4 v137, s[12:15], s45 offen lds
    s_add_u32 m0, s43, 90112
    s_nop 0
    buffer_load_dwordx4 v138, s[12:15], s45 offen lds
    s_add_u32 m0, s43, 94208
    s_nop 0
    buffer_load_dwordx4 v139, s[12:15], s45 offen lds
    s_add_u32 s44, s44, 128
    s_add_u32 s45, s45, 128
    ds_read_b128 v[84:87], v155 offset:0
    ds_read_b128 v[88:91], v155 offset:2048
    ds_read_b128 v[92:95], v155 offset:4096
    ds_read_b128 v[96:99], v155 offset:6144
    ds_read_b128 v[116:119], v157 offset:0
    ds_read_b128 v[120:123], v157 offset:2048
    ds_read_b128 v[124:127], v157 offset:4096
    ds_read_b128 v[128:131], v157 offset:6144
    s_waitcnt lgkmcnt(8)
    v_mfma_f32_16x16x32_bf16 v[4:7], v[100:103], v[68:71], v[4:7]
    v_mfma_f32_16x16x32_bf16 v[8:11], v[100:103], v[72:75], v[8:11]
    v_mfma_f32_16x16x32_bf16 v[12:15], v[100:103], v[76:79], v[12:15]
    v_mfma_f32_16x16x32_bf16 v[16:19], v[100:103], v[80:83], v[16:19]
    v_mfma_f32_16x16x32_bf16 v[20:23], v[104:107], v[68:71], v[20:23]
    v_mfma_f32_16x16x32_bf16 v[24:27], v[104:107], v[72:75], v[24:27]
    v_mfma_f32_16x16x32_bf16 v[28:31], v[104:107], v[76:79], v[28:31]
    v_mfma_f32_16x16x32_bf16 v[32:35], v[104:107], v[80:83], v[32:35]
    v_mfma_f32_16x16x32_bf16 v[36:39], v[108:111], v[68:71], v[36:39]
    v_mfma_f32_16x16x32_bf16 v[40:43], v[108:111], v[72:75], v[40:43]
    v_mfma_f32_16x16x32_bf16 v[44:47], v[108:111], v[76:79], v[44:47]
    v_mfma_f32_16x16x32_bf16 v[48:51], v[108:111], v[80:83], v[48:51]
    v_mfma_f32_16x16x32_bf16 v[52:55], v[112:115], v[68:71], v[52:55]
    v_mfma_f32_16x16x32_bf16 v[56:59], v[112:115], v[72:75], v[56:59]
    v_mfma_f32_16x16x32_bf16 v[60:63], v[112:115], v[76:79], v[60:63]
    v_mfma_f32_16x16x32_bf16 v[64:67], v[112:115], v[80:83], v[64:67]
    s_waitcnt lgkmcnt(0)
    v_mfma_f32_16x16x32_bf16 v[4:7], v[116:119], v[84:87], v[4:7]
    v_mfma_f32_16x16x32_bf16 v[8:11], v[116:119], v[88:91], v[8:11]
    v_mfma_f32_16x16x32_bf16 v[12:15], v[116:119], v[92:95], v[12:15]
    v_mfma_f32_16x16x32_bf16 v[16:19], v[116:119], v[96:99], v[16:19]
    v_mfma_f32_16x16x32_bf16 v[20:23], v[120:123], v[84:87], v[20:23]
    v_mfma_f32_16x16x32_bf16 v[24:27], v[120:123], v[88:91], v[24:27]
    v_mfma_f32_16x16x32_bf16 v[28:31], v[120:123], v[92:95], v[28:31]
    v_mfma_f32_16x16x32_bf16 v[32:35], v[120:123], v[96:99], v[32:35]
    v_mfma_f32_16x16x32_bf16 v[36:39], v[124:127], v[84:87], v[36:39]
    v_mfma_f32_16x16x32_bf16 v[40:43], v[124:127], v[88:91], v[40:43]
    v_mfma_f32_16x16x32_bf16 v[44:47], v[124:127], v[92:95], v[44:47]
    v_mfma_f32_16x16x32_bf16 v[48:51], v[124:127], v[96:99], v[48:51]
    v_mfma_f32_16x16x32_bf16 v[52:55], v[128:131], v[84:87], v[52:55]
    v_mfma_f32_16x16x32_bf16 v[56:59], v[128:131], v[88:91], v[56:59]
    v_mfma_f32_16x16x32_bf16 v[60:63], v[128:131], v[92:95], v[60:63]
    v_mfma_f32_16x16x32_bf16 v[64:67], v[128:131], v[96:99], v[64:67]
    s_waitcnt vmcnt(8)
    s_barrier
    ds_read_b128 v[68:71], v158 offset:0
    ds_read_b128 v[72:75], v158 offset:2048
    ds_read_b128 v[76:79], v158 offset:4096
    ds_read_b128 v[80:83], v158 offset:6144
    ds_read_b128 v[100:103], v160 offset:0
    ds_read_b128 v[104:107], v160 offset:2048
    ds_read_b128 v[108:111], v160 offset:4096
    ds_read_b128 v[112:115], v160 offset:6144
    ds_read_b128 v[84:87], v159 offset:0
    ds_read_b128 v[88:91], v159 offset:2048
    ds_read_b128 v[92:95], v159 offset:4096
    ds_read_b128 v[96:99], v159 offset:6144
    ds_read_b128 v[116:119], v161 offset:0
    ds_read_b128 v[120:123], v161 offset:2048
    ds_read_b128 v[124:127], v161 offset:4096
    ds_read_b128 v[128:131], v161 offset:6144
    s_waitcnt lgkmcnt(8)
    v_mfma_f32_16x16x32_bf16 v[4:7], v[100:103], v[68:71], v[4:7]
    v_mfma_f32_16x16x32_bf16 v[8:11], v[100:103], v[72:75], v[8:11]
    v_mfma_f32_16x16x32_bf16 v[12:15], v[100:103], v[76:79], v[12:15]
    v_mfma_f32_16x16x32_bf16 v[16:19], v[100:103], v[80:83], v[16:19]
    v_mfma_f32_16x16x32_bf16 v[20:23], v[104:107], v[68:71], v[20:23]
    v_mfma_f32_16x16x32_bf16 v[24:27], v[104:107], v[72:75], v[24:27]
    v_mfma_f32_16x16x32_bf16 v[28:31], v[104:107], v[76:79], v[28:31]
    v_mfma_f32_16x16x32_bf16 v[32:35], v[104:107], v[80:83], v[32:35]
    v_mfma_f32_16x16x32_bf16 v[36:39], v[108:111], v[68:71], v[36:39]
    v_mfma_f32_16x16x32_bf16 v[40:43], v[108:111], v[72:75], v[40:43]
    v_mfma_f32_16x16x32_bf16 v[44:47], v[108:111], v[76:79], v[44:47]
    v_mfma_f32_16x16x32_bf16 v[48:51], v[108:111], v[80:83], v[48:51]
    v_mfma_f32_16x16x32_bf16 v[52:55], v[112:115], v[68:71], v[52:55]
    v_mfma_f32_16x16x32_bf16 v[56:59], v[112:115], v[72:75], v[56:59]
    v_mfma_f32_16x16x32_bf16 v[60:63], v[112:115], v[76:79], v[60:63]
    v_mfma_f32_16x16x32_bf16 v[64:67], v[112:115], v[80:83], v[64:67]
    s_waitcnt lgkmcnt(0)
    v_mfma_f32_16x16x32_bf16 v[4:7], v[116:119], v[84:87], v[4:7]
    v_mfma_f32_16x16x32_bf16 v[8:11], v[116:119], v[88:91], v[8:11]
    v_mfma_f32_16x16x32_bf16 v[12:15], v[116:119], v[92:95], v[12:15]
    v_mfma_f32_16x16x32_bf16 v[16:19], v[116:119], v[96:99], v[16:19]
    v_mfma_f32_16x16x32_bf16 v[20:23], v[120:123], v[84:87], v[20:23]
    v_mfma_f32_16x16x32_bf16 v[24:27], v[120:123], v[88:91], v[24:27]
    v_mfma_f32_16x16x32_bf16 v[28:31], v[120:123], v[92:95], v[28:31]
    v_mfma_f32_16x16x32_bf16 v[32:35], v[120:123], v[96:99], v[32:35]
    v_mfma_f32_16x16x32_bf16 v[36:39], v[124:127], v[84:87], v[36:39]
    v_mfma_f32_16x16x32_bf16 v[40:43], v[124:127], v[88:91], v[40:43]
    v_mfma_f32_16x16x32_bf16 v[44:47], v[124:127], v[92:95], v[44:47]
    v_mfma_f32_16x16x32_bf16 v[48:51], v[124:127], v[96:99], v[48:51]
    v_mfma_f32_16x16x32_bf16 v[52:55], v[128:131], v[84:87], v[52:55]
    v_mfma_f32_16x16x32_bf16 v[56:59], v[128:131], v[88:91], v[56:59]
    v_mfma_f32_16x16x32_bf16 v[60:63], v[128:131], v[92:95], v[60:63]
    v_mfma_f32_16x16x32_bf16 v[64:67], v[128:131], v[96:99], v[64:67]
    s_waitcnt vmcnt(0)
    s_barrier
    ds_read_b128 v[68:71], v162 offset:0
    ds_read_b128 v[72:75], v162 offset:2048
    ds_read_b128 v[76:79], v162 offset:4096
    ds_read_b128 v[80:83], v162 offset:6144
    ds_read_b128 v[100:103], v164 offset:0
    ds_read_b128 v[104:107], v164 offset:2048
    ds_read_b128 v[108:111], v164 offset:4096
    ds_read_b128 v[112:115], v164 offset:6144
    ds_read_b128 v[84:87], v163 offset:0
    ds_read_b128 v[88:91], v163 offset:2048
    ds_read_b128 v[92:95], v163 offset:4096
    ds_read_b128 v[96:99], v163 offset:6144
    ds_read_b128 v[116:119], v165 offset:0
    ds_read_b128 v[120:123], v165 offset:2048
    ds_read_b128 v[124:127], v165 offset:4096
    ds_read_b128 v[128:131], v165 offset:6144
    s_waitcnt lgkmcnt(8)
    v_mfma_f32_16x16x32_bf16 v[4:7], v[100:103], v[68:71], v[4:7]
    v_mfma_f32_16x16x32_bf16 v[8:11], v[100:103], v[72:75], v[8:11]
    v_mfma_f32_16x16x32_bf16 v[12:15], v[100:103], v[76:79], v[12:15]
    v_mfma_f32_16x16x32_bf16 v[16:19], v[100:103], v[80:83], v[16:19]
    v_mfma_f32_16x16x32_bf16 v[20:23], v[104:107], v[68:71], v[20:23]
    v_mfma_f32_16x16x32_bf16 v[24:27], v[104:107], v[72:75], v[24:27]
    v_mfma_f32_16x16x32_bf16 v[28:31], v[104:107], v[76:79], v[28:31]
    v_mfma_f32_16x16x32_bf16 v[32:35], v[104:107], v[80:83], v[32:35]
    v_mfma_f32_16x16x32_bf16 v[36:39], v[108:111], v[68:71], v[36:39]
    v_mfma_f32_16x16x32_bf16 v[40:43], v[108:111], v[72:75], v[40:43]
    v_mfma_f32_16x16x32_bf16 v[44:47], v[108:111], v[76:79], v[44:47]
    v_mfma_f32_16x16x32_bf16 v[48:51], v[108:111], v[80:83], v[48:51]
    v_mfma_f32_16x16x32_bf16 v[52:55], v[112:115], v[68:71], v[52:55]
    v_mfma_f32_16x16x32_bf16 v[56:59], v[112:115], v[72:75], v[56:59]
    v_mfma_f32_16x16x32_bf16 v[60:63], v[112:115], v[76:79], v[60:63]
    v_mfma_f32_16x16x32_bf16 v[64:67], v[112:115], v[80:83], v[64:67]
    s_waitcnt lgkmcnt(0)
    v_mfma_f32_16x16x32_bf16 v[4:7], v[116:119], v[84:87], v[4:7]
    v_mfma_f32_16x16x32_bf16 v[8:11], v[116:119], v[88:91], v[8:11]
    v_mfma_f32_16x16x32_bf16 v[12:15], v[116:119], v[92:95], v[12:15]
    v_mfma_f32_16x16x32_bf16 v[16:19], v[116:119], v[96:99], v[16:19]
    v_mfma_f32_16x16x32_bf16 v[20:23], v[120:123], v[84:87], v[20:23]
    v_mfma_f32_16x16x32_bf16 v[24:27], v[120:123], v[88:91], v[24:27]
    v_mfma_f32_16x16x32_bf16 v[28:31], v[120:123], v[92:95], v[28:31]
    v_mfma_f32_16x16x32_bf16 v[32:35], v[120:123], v[96:99], v[32:35]
    v_mfma_f32_16x16x32_bf16 v[36:39], v[124:127], v[84:87], v[36:39]
    v_mfma_f32_16x16x32_bf16 v[40:43], v[124:127], v[88:91], v[40:43]
    v_mfma_f32_16x16x32_bf16 v[44:47], v[124:127], v[92:95], v[44:47]
    v_mfma_f32_16x16x32_bf16 v[48:51], v[124:127], v[96:99], v[48:51]
    v_mfma_f32_16x16x32_bf16 v[52:55], v[128:131], v[84:87], v[52:55]
    v_mfma_f32_16x16x32_bf16 v[56:59], v[128:131], v[88:91], v[56:59]
    v_mfma_f32_16x16x32_bf16 v[60:63], v[128:131], v[92:95], v[60:63]
    v_mfma_f32_16x16x32_bf16 v[64:67], v[128:131], v[96:99], v[64:67]
    v_and_b32 v142, 15, v1
    v_lshrrev_b32 v143, 4, v1
    s_mul_i32 s40, s41, 64
    v_add_u32 v142, s40, v142
    s_mul_i32 s40, s42, 64
    v_lshl_add_u32 v143, v143, 2, s40
    s_mov_b32 s40, 2048
    v_mul_lo_u32 v144, s40, v142
    v_lshl_add_u32 v144, v143, 1, v144
    s_nop 7
    s_nop 7
    v_cvt_pk_bf16_f32 v4, v4, v5
    v_cvt_pk_bf16_f32 v6, v6, v7
    v_and_b32 v5, 0xffff0000, v4
    v_lshlrev_b32 v4, 16, v4
    v_and_b32 v7, 0xffff0000, v6
    v_lshlrev_b32 v6, 16, v6
    v_mul_f32 v4, 0x3d5105ec, v4
    v_mul_f32 v5, 0x3d5105ec, v5
    v_mul_f32 v6, 0x3d5105ec, v6
    v_mul_f32 v7, 0x3d5105ec, v7
    v_cvt_pk_bf16_f32 v4, v4, v5
    v_cvt_pk_bf16_f32 v5, v6, v7
    buffer_store_dwordx2 v[4:5], v144, s[16:19], 0 offen offset:0
    v_cvt_pk_bf16_f32 v8, v8, v9
    v_cvt_pk_bf16_f32 v10, v10, v11
    v_and_b32 v9, 0xffff0000, v8
    v_lshlrev_b32 v8, 16, v8
    v_and_b32 v11, 0xffff0000, v10
    v_lshlrev_b32 v10, 16, v10
    v_mul_f32 v8, 0x3d5105ec, v8
    v_mul_f32 v9, 0x3d5105ec, v9
    v_mul_f32 v10, 0x3d5105ec, v10
    v_mul_f32 v11, 0x3d5105ec, v11
    v_cvt_pk_bf16_f32 v8, v8, v9
    v_cvt_pk_bf16_f32 v9, v10, v11
    v_add_u32 v146, 32768, v144
    buffer_store_dwordx2 v[8:9], v146, s[16:19], 0 offen
    v_cvt_pk_bf16_f32 v12, v12, v13
    v_cvt_pk_bf16_f32 v14, v14, v15
    v_and_b32 v13, 0xffff0000, v12
    v_lshlrev_b32 v12, 16, v12
    v_and_b32 v15, 0xffff0000, v14
    v_lshlrev_b32 v14, 16, v14
    v_mul_f32 v12, 0x3d5105ec, v12
    v_mul_f32 v13, 0x3d5105ec, v13
    v_mul_f32 v14, 0x3d5105ec, v14
    v_mul_f32 v15, 0x3d5105ec, v15
    v_cvt_pk_bf16_f32 v12, v12, v13
    v_cvt_pk_bf16_f32 v13, v14, v15
    v_add_u32 v146, 65536, v144
    buffer_store_dwordx2 v[12:13], v146, s[16:19], 0 offen
    v_cvt_pk_bf16_f32 v16, v16, v17
    v_cvt_pk_bf16_f32 v18, v18, v19
    v_and_b32 v17, 0xffff0000, v16
    v_lshlrev_b32 v16, 16, v16
    v_and_b32 v19, 0xffff0000, v18
    v_lshlrev_b32 v18, 16, v18
    v_mul_f32 v16, 0x3d5105ec, v16
    v_mul_f32 v17, 0x3d5105ec, v17
    v_mul_f32 v18, 0x3d5105ec, v18
    v_mul_f32 v19, 0x3d5105ec, v19
    v_cvt_pk_bf16_f32 v16, v16, v17
    v_cvt_pk_bf16_f32 v17, v18, v19
    v_add_u32 v146, 98304, v144
    buffer_store_dwordx2 v[16:17], v146, s[16:19], 0 offen
    v_cvt_pk_bf16_f32 v20, v20, v21
    v_cvt_pk_bf16_f32 v22, v22, v23
    v_and_b32 v21, 0xffff0000, v20
    v_lshlrev_b32 v20, 16, v20
    v_and_b32 v23, 0xffff0000, v22
    v_lshlrev_b32 v22, 16, v22
    v_mul_f32 v20, 0x3d5105ec, v20
    v_mul_f32 v21, 0x3d5105ec, v21
    v_mul_f32 v22, 0x3d5105ec, v22
    v_mul_f32 v23, 0x3d5105ec, v23
    v_cvt_pk_bf16_f32 v20, v20, v21
    v_cvt_pk_bf16_f32 v21, v22, v23
    buffer_store_dwordx2 v[20:21], v144, s[16:19], 0 offen offset:32
    v_cvt_pk_bf16_f32 v24, v24, v25
    v_cvt_pk_bf16_f32 v26, v26, v27
    v_and_b32 v25, 0xffff0000, v24
    v_lshlrev_b32 v24, 16, v24
    v_and_b32 v27, 0xffff0000, v26
    v_lshlrev_b32 v26, 16, v26
    v_mul_f32 v24, 0x3d5105ec, v24
    v_mul_f32 v25, 0x3d5105ec, v25
    v_mul_f32 v26, 0x3d5105ec, v26
    v_mul_f32 v27, 0x3d5105ec, v27
    v_cvt_pk_bf16_f32 v24, v24, v25
    v_cvt_pk_bf16_f32 v25, v26, v27
    v_add_u32 v146, 32800, v144
    buffer_store_dwordx2 v[24:25], v146, s[16:19], 0 offen
    v_cvt_pk_bf16_f32 v28, v28, v29
    v_cvt_pk_bf16_f32 v30, v30, v31
    v_and_b32 v29, 0xffff0000, v28
    v_lshlrev_b32 v28, 16, v28
    v_and_b32 v31, 0xffff0000, v30
    v_lshlrev_b32 v30, 16, v30
    v_mul_f32 v28, 0x3d5105ec, v28
    v_mul_f32 v29, 0x3d5105ec, v29
    v_mul_f32 v30, 0x3d5105ec, v30
    v_mul_f32 v31, 0x3d5105ec, v31
    v_cvt_pk_bf16_f32 v28, v28, v29
    v_cvt_pk_bf16_f32 v29, v30, v31
    v_add_u32 v146, 65568, v144
    buffer_store_dwordx2 v[28:29], v146, s[16:19], 0 offen
    v_cvt_pk_bf16_f32 v32, v32, v33
    v_cvt_pk_bf16_f32 v34, v34, v35
    v_and_b32 v33, 0xffff0000, v32
    v_lshlrev_b32 v32, 16, v32
    v_and_b32 v35, 0xffff0000, v34
    v_lshlrev_b32 v34, 16, v34
    v_mul_f32 v32, 0x3d5105ec, v32
    v_mul_f32 v33, 0x3d5105ec, v33
    v_mul_f32 v34, 0x3d5105ec, v34
    v_mul_f32 v35, 0x3d5105ec, v35
    v_cvt_pk_bf16_f32 v32, v32, v33
    v_cvt_pk_bf16_f32 v33, v34, v35
    v_add_u32 v146, 98336, v144
    buffer_store_dwordx2 v[32:33], v146, s[16:19], 0 offen
    v_cvt_pk_bf16_f32 v36, v36, v37
    v_cvt_pk_bf16_f32 v38, v38, v39
    v_and_b32 v37, 0xffff0000, v36
    v_lshlrev_b32 v36, 16, v36
    v_and_b32 v39, 0xffff0000, v38
    v_lshlrev_b32 v38, 16, v38
    v_mul_f32 v36, 0x3d5105ec, v36
    v_mul_f32 v37, 0x3d5105ec, v37
    v_mul_f32 v38, 0x3d5105ec, v38
    v_mul_f32 v39, 0x3d5105ec, v39
    v_cvt_pk_bf16_f32 v36, v36, v37
    v_cvt_pk_bf16_f32 v37, v38, v39
    buffer_store_dwordx2 v[36:37], v144, s[16:19], 0 offen offset:64
    v_cvt_pk_bf16_f32 v40, v40, v41
    v_cvt_pk_bf16_f32 v42, v42, v43
    v_and_b32 v41, 0xffff0000, v40
    v_lshlrev_b32 v40, 16, v40
    v_and_b32 v43, 0xffff0000, v42
    v_lshlrev_b32 v42, 16, v42
    v_mul_f32 v40, 0x3d5105ec, v40
    v_mul_f32 v41, 0x3d5105ec, v41
    v_mul_f32 v42, 0x3d5105ec, v42
    v_mul_f32 v43, 0x3d5105ec, v43
    v_cvt_pk_bf16_f32 v40, v40, v41
    v_cvt_pk_bf16_f32 v41, v42, v43
    v_add_u32 v146, 32832, v144
    buffer_store_dwordx2 v[40:41], v146, s[16:19], 0 offen
    v_cvt_pk_bf16_f32 v44, v44, v45
    v_cvt_pk_bf16_f32 v46, v46, v47
    v_and_b32 v45, 0xffff0000, v44
    v_lshlrev_b32 v44, 16, v44
    v_and_b32 v47, 0xffff0000, v46
    v_lshlrev_b32 v46, 16, v46
    v_mul_f32 v44, 0x3d5105ec, v44
    v_mul_f32 v45, 0x3d5105ec, v45
    v_mul_f32 v46, 0x3d5105ec, v46
    v_mul_f32 v47, 0x3d5105ec, v47
    v_cvt_pk_bf16_f32 v44, v44, v45
    v_cvt_pk_bf16_f32 v45, v46, v47
    v_add_u32 v146, 65600, v144
    buffer_store_dwordx2 v[44:45], v146, s[16:19], 0 offen
    v_cvt_pk_bf16_f32 v48, v48, v49
    v_cvt_pk_bf16_f32 v50, v50, v51
    v_and_b32 v49, 0xffff0000, v48
    v_lshlrev_b32 v48, 16, v48
    v_and_b32 v51, 0xffff0000, v50
    v_lshlrev_b32 v50, 16, v50
    v_mul_f32 v48, 0x3d5105ec, v48
    v_mul_f32 v49, 0x3d5105ec, v49
    v_mul_f32 v50, 0x3d5105ec, v50
    v_mul_f32 v51, 0x3d5105ec, v51
    v_cvt_pk_bf16_f32 v48, v48, v49
    v_cvt_pk_bf16_f32 v49, v50, v51
    v_add_u32 v146, 98368, v144
    buffer_store_dwordx2 v[48:49], v146, s[16:19], 0 offen
    v_cvt_pk_bf16_f32 v52, v52, v53
    v_cvt_pk_bf16_f32 v54, v54, v55
    v_and_b32 v53, 0xffff0000, v52
    v_lshlrev_b32 v52, 16, v52
    v_and_b32 v55, 0xffff0000, v54
    v_lshlrev_b32 v54, 16, v54
    v_mul_f32 v52, 0x3d5105ec, v52
    v_mul_f32 v53, 0x3d5105ec, v53
    v_mul_f32 v54, 0x3d5105ec, v54
    v_mul_f32 v55, 0x3d5105ec, v55
    v_cvt_pk_bf16_f32 v52, v52, v53
    v_cvt_pk_bf16_f32 v53, v54, v55
    buffer_store_dwordx2 v[52:53], v144, s[16:19], 0 offen offset:96
    v_cvt_pk_bf16_f32 v56, v56, v57
    v_cvt_pk_bf16_f32 v58, v58, v59
    v_and_b32 v57, 0xffff0000, v56
    v_lshlrev_b32 v56, 16, v56
    v_and_b32 v59, 0xffff0000, v58
    v_lshlrev_b32 v58, 16, v58
    v_mul_f32 v56, 0x3d5105ec, v56
    v_mul_f32 v57, 0x3d5105ec, v57
    v_mul_f32 v58, 0x3d5105ec, v58
    v_mul_f32 v59, 0x3d5105ec, v59
    v_cvt_pk_bf16_f32 v56, v56, v57
    v_cvt_pk_bf16_f32 v57, v58, v59
    v_add_u32 v146, 32864, v144
    buffer_store_dwordx2 v[56:57], v146, s[16:19], 0 offen
    v_cvt_pk_bf16_f32 v60, v60, v61
    v_cvt_pk_bf16_f32 v62, v62, v63
    v_and_b32 v61, 0xffff0000, v60
    v_lshlrev_b32 v60, 16, v60
    v_and_b32 v63, 0xffff0000, v62
    v_lshlrev_b32 v62, 16, v62
    v_mul_f32 v60, 0x3d5105ec, v60
    v_mul_f32 v61, 0x3d5105ec, v61
    v_mul_f32 v62, 0x3d5105ec, v62
    v_mul_f32 v63, 0x3d5105ec, v63
    v_cvt_pk_bf16_f32 v60, v60, v61
    v_cvt_pk_bf16_f32 v61, v62, v63
    v_add_u32 v146, 65632, v144
    buffer_store_dwordx2 v[60:61], v146, s[16:19], 0 offen
    v_cvt_pk_bf16_f32 v64, v64, v65
    v_cvt_pk_bf16_f32 v66, v66, v67
    v_and_b32 v65, 0xffff0000, v64
    v_lshlrev_b32 v64, 16, v64
    v_and_b32 v67, 0xffff0000, v66
    v_lshlrev_b32 v66, 16, v66
    v_mul_f32 v64, 0x3d5105ec, v64
    v_mul_f32 v65, 0x3d5105ec, v65
    v_mul_f32 v66, 0x3d5105ec, v66
    v_mul_f32 v67, 0x3d5105ec, v67
    v_cvt_pk_bf16_f32 v64, v64, v65
    v_cvt_pk_bf16_f32 v65, v66, v67
    v_add_u32 v146, 98400, v144
    buffer_store_dwordx2 v[64:65], v146, s[16:19], 0 offen
s_kernel_end:
    s_endpgm
.text
.globl sm_kernel
.p2align 8
.type sm_kernel,@function
sm_kernel:
    s_cmp_ge_u32 s2, 1024
    s_cbranch_scc1 sm_kernel_end
    s_load_dwordx2 s[24:25], s[0:1], 72
    s_waitcnt lgkmcnt(0)
    s_add_u32 s8, s24, 16777216
    s_addc_u32 s9, s25, 0
    s_mov_b32 s10, 8388608
    s_mov_b32 s11, 0x00020000
    s_add_u32 s16, s24, 25165824
    s_addc_u32 s17, s25, 0
    s_mov_b32 s18, 8388608
    s_mov_b32 s19, 0x00020000
    v_lshrrev_b32 v2, 6, v0
    s_lshl_b32 s30, s2, 2
    v_add_u32 v2, s30, v2
    v_and_b32 v1, 63, v0
    v_lshlrev_b32 v3, 11, v2
    v_lshl_add_u32 v3, v1, 4, v3
    buffer_load_dwordx4 v[4:7], v3, s[8:11], 0 offen
    buffer_load_dwordx4 v[8:11], v3, s[8:11], 0 offen offset:1024
    s_waitcnt vmcnt(0)
    v_lshlrev_b32 v20, 16, v4
    v_and_b32 v21, 0xffff0000, v4
    v_lshlrev_b32 v22, 16, v5
    v_and_b32 v23, 0xffff0000, v5
    v_lshlrev_b32 v24, 16, v6
    v_and_b32 v25, 0xffff0000, v6
    v_lshlrev_b32 v26, 16, v7
    v_and_b32 v27, 0xffff0000, v7
    v_lshlrev_b32 v28, 16, v8
    v_and_b32 v29, 0xffff0000, v8
    v_lshlrev_b32 v30, 16, v9
    v_and_b32 v31, 0xffff0000, v9
    v_lshlrev_b32 v32, 16, v10
    v_and_b32 v33, 0xffff0000, v10
    v_lshlrev_b32 v34, 16, v11
    v_and_b32 v35, 0xffff0000, v11
    v_max_f32 v12, v20, v21
    v_max_f32 v12, v12, v22
    v_max_f32 v12, v12, v23
    v_max_f32 v12, v12, v24
    v_max_f32 v12, v12, v25
    v_max_f32 v12, v12, v26
    v_max_f32 v12, v12, v27
    v_max_f32 v12, v12, v28
    v_max_f32 v12, v12, v29
    v_max_f32 v12, v12, v30
    v_max_f32 v12, v12, v31
    v_max_f32 v12, v12, v32
    v_max_f32 v12, v12, v33
    v_max_f32 v12, v12, v34
    v_max_f32 v12, v12, v35
    ds_swizzle_b32 v13, v12 offset:0x41f
    s_waitcnt lgkmcnt(0)
    v_max_f32 v12, v12, v13
    ds_swizzle_b32 v13, v12 offset:0x81f
    s_waitcnt lgkmcnt(0)
    v_max_f32 v12, v12, v13
    ds_swizzle_b32 v13, v12 offset:0x101f
    s_waitcnt lgkmcnt(0)
    v_max_f32 v12, v12, v13
    ds_swizzle_b32 v13, v12 offset:0x201f
    s_waitcnt lgkmcnt(0)
    v_max_f32 v12, v12, v13
    ds_swizzle_b32 v13, v12 offset:0x401f
    s_waitcnt lgkmcnt(0)
    v_max_f32 v12, v12, v13
    s_nop 0
    v_readlane_b32 s58, v12, 32
    v_readlane_b32 s59, v12, 0
    s_nop 1
    v_mov_b32 v12, s58
    v_max_f32 v12, s59, v12
    v_mul_f32 v12, 0x3fb8aa3b, v12
    v_mov_b32 v14, 0
    v_mul_f32 v20, 0x3fb8aa3b, v20
    v_sub_f32 v20, v20, v12
    v_exp_f32 v20, v20
    s_nop 0
    v_add_f32 v14, v14, v20
    v_mul_f32 v21, 0x3fb8aa3b, v21
    v_sub_f32 v21, v21, v12
    v_exp_f32 v21, v21
    s_nop 0
    v_add_f32 v14, v14, v21
    v_mul_f32 v22, 0x3fb8aa3b, v22
    v_sub_f32 v22, v22, v12
    v_exp_f32 v22, v22
    s_nop 0
    v_add_f32 v14, v14, v22
    v_mul_f32 v23, 0x3fb8aa3b, v23
    v_sub_f32 v23, v23, v12
    v_exp_f32 v23, v23
    s_nop 0
    v_add_f32 v14, v14, v23
    v_mul_f32 v24, 0x3fb8aa3b, v24
    v_sub_f32 v24, v24, v12
    v_exp_f32 v24, v24
    s_nop 0
    v_add_f32 v14, v14, v24
    v_mul_f32 v25, 0x3fb8aa3b, v25
    v_sub_f32 v25, v25, v12
    v_exp_f32 v25, v25
    s_nop 0
    v_add_f32 v14, v14, v25
    v_mul_f32 v26, 0x3fb8aa3b, v26
    v_sub_f32 v26, v26, v12
    v_exp_f32 v26, v26
    s_nop 0
    v_add_f32 v14, v14, v26
    v_mul_f32 v27, 0x3fb8aa3b, v27
    v_sub_f32 v27, v27, v12
    v_exp_f32 v27, v27
    s_nop 0
    v_add_f32 v14, v14, v27
    v_mul_f32 v28, 0x3fb8aa3b, v28
    v_sub_f32 v28, v28, v12
    v_exp_f32 v28, v28
    s_nop 0
    v_add_f32 v14, v14, v28
    v_mul_f32 v29, 0x3fb8aa3b, v29
    v_sub_f32 v29, v29, v12
    v_exp_f32 v29, v29
    s_nop 0
    v_add_f32 v14, v14, v29
    v_mul_f32 v30, 0x3fb8aa3b, v30
    v_sub_f32 v30, v30, v12
    v_exp_f32 v30, v30
    s_nop 0
    v_add_f32 v14, v14, v30
    v_mul_f32 v31, 0x3fb8aa3b, v31
    v_sub_f32 v31, v31, v12
    v_exp_f32 v31, v31
    s_nop 0
    v_add_f32 v14, v14, v31
    v_mul_f32 v32, 0x3fb8aa3b, v32
    v_sub_f32 v32, v32, v12
    v_exp_f32 v32, v32
    s_nop 0
    v_add_f32 v14, v14, v32
    v_mul_f32 v33, 0x3fb8aa3b, v33
    v_sub_f32 v33, v33, v12
    v_exp_f32 v33, v33
    s_nop 0
    v_add_f32 v14, v14, v33
    v_mul_f32 v34, 0x3fb8aa3b, v34
    v_sub_f32 v34, v34, v12
    v_exp_f32 v34, v34
    s_nop 0
    v_add_f32 v14, v14, v34
    v_mul_f32 v35, 0x3fb8aa3b, v35
    v_sub_f32 v35, v35, v12
    v_exp_f32 v35, v35
    s_nop 0
    v_add_f32 v14, v14, v35
    ds_swizzle_b32 v13, v14 offset:0x41f
    s_waitcnt lgkmcnt(0)
    v_add_f32 v14, v14, v13
    ds_swizzle_b32 v13, v14 offset:0x81f
    s_waitcnt lgkmcnt(0)
    v_add_f32 v14, v14, v13
    ds_swizzle_b32 v13, v14 offset:0x101f
    s_waitcnt lgkmcnt(0)
    v_add_f32 v14, v14, v13
    ds_swizzle_b32 v13, v14 offset:0x201f
    s_waitcnt lgkmcnt(0)
    v_add_f32 v14, v14, v13
    ds_swizzle_b32 v13, v14 offset:0x401f
    s_waitcnt lgkmcnt(0)
    v_add_f32 v14, v14, v13
    s_nop 0
    v_readlane_b32 s58, v14, 32
    v_readlane_b32 s59, v14, 0
    s_nop 1
    v_mov_b32 v14, s58
    v_add_f32 v14, s59, v14
    v_rcp_f32 v14, v14
    s_nop 0
    v_mul_f32 v20, v20, v14
    v_mul_f32 v21, v21, v14
    v_mul_f32 v22, v22, v14
    v_mul_f32 v23, v23, v14
    v_mul_f32 v24, v24, v14
    v_mul_f32 v25, v25, v14
    v_mul_f32 v26, v26, v14
    v_mul_f32 v27, v27, v14
    v_mul_f32 v28, v28, v14
    v_mul_f32 v29, v29, v14
    v_mul_f32 v30, v30, v14
    v_mul_f32 v31, v31, v14
    v_mul_f32 v32, v32, v14
    v_mul_f32 v33, v33, v14
    v_mul_f32 v34, v34, v14
    v_mul_f32 v35, v35, v14
    v_cvt_pk_bf16_f32 v4, v20, v21
    v_cvt_pk_bf16_f32 v5, v22, v23
    v_cvt_pk_bf16_f32 v6, v24, v25
    v_cvt_pk_bf16_f32 v7, v26, v27
    v_cvt_pk_bf16_f32 v8, v28, v29
    v_cvt_pk_bf16_f32 v9, v30, v31
    v_cvt_pk_bf16_f32 v10, v32, v33
    v_cvt_pk_bf16_f32 v11, v34, v35
    buffer_store_dwordx4 v[4:7], v3, s[16:19], 0 offen
    buffer_store_dwordx4 v[8:11], v3, s[16:19], 0 offen offset:1024
sm_kernel_end:
    s_endpgm
.text
.globl pv_kernel
.p2align 8
.type pv_kernel,@function
pv_kernel:
    s_cmp_ge_u32 s2, 256
    s_cbranch_scc1 pv_kernel_end
    s_load_dwordx2 s[20:21], s[0:1], 72
    s_load_dwordx2 s[22:23], s[0:1], 72
    s_load_dwordx2 s[24:25], s[0:1], 72
    s_load_dwordx2 s[26:27], s[0:1], 72
    s_load_dwordx2 s[28:29], s[0:1], 0
    s_and_b32 s40, s2, 7
    s_mul_i32 s40, s40, 32
    s_lshr_b32 s2, s2, 3
    s_add_u32 s2, s2, s40
    s_lshr_b32 s30, s2, 6
    s_mul_i32 s31, s30, 64
    s_sub_u32 s31, s2, s31
    s_lshr_b32 s32, s31, 2
    s_mul_i32 s33, s32, 4
    s_sub_u32 s33, s31, s33
    s_lshr_b32 s34, s30, 1
    s_and_b32 s35, s30, 1
    v_lshrrev_b32 v200, 6, v0
    s_nop 0
    v_readfirstlane_b32 s36, v200
    v_and_b32 v1, 63, v0
    s_mul_i32 s37, s34, 4194304
    s_mul_i32 s40, s35, 2097152
    s_add_u32 s37, s37, s40
    s_mul_i32 s40, s32, 131072
    s_add_u32 s37, s37, s40
    s_mul_i32 s38, s34, 4718592
    s_mul_i32 s40, s35, 768
    s_add_u32 s38, s38, s40
    s_mul_i32 s40, s33, 192
    s_add_u32 s38, s38, s40
    s_mul_i32 s39, s34, 1572864
    s_mul_i32 s40, s35, 768
    s_add_u32 s39, s39, s40
    s_mul_i32 s40, s32, 98304
    s_add_u32 s39, s39, s40
    s_mul_i32 s40, s33, 192
    s_add_u32 s39, s39, s40
    s_waitcnt lgkmcnt(0)
    s_add_u32 s8, s20, 25165824
    s_addc_u32 s9, s21, 0
    s_add_u32 s8, s8, s37
    s_addc_u32 s9, s9, 0
    s_mov_b32 s11, 0x00020000
    s_add_u32 s12, s22, 4197376
    s_addc_u32 s13, s23, 0
    s_add_u32 s12, s12, s38
    s_addc_u32 s13, s13, 0
    s_mov_b32 s15, 0x00020000
    s_add_u32 s16, s24, 33554432
    s_addc_u32 s17, s25, 0
    s_add_u32 s16, s16, s39
    s_addc_u32 s17, s17, 0
    s_mov_b32 s19, 0x00020000
    s_mov_b32 s10, 131072
    s_mov_b32 s14, 4714176
    s_mov_b32 s18, 96960
    s_lshl_b32 s40, s36, 6
    v_add_u32 v76, s40, v1
    v_add_u32 v76, 0, v76
    v_lshrrev_b32 v77, 3, v76
    v_and_b32 v78, 7, v76
    v_and_b32 v79, 7, v77
    v_xor_b32 v78, v78, v79
    s_mov_b32 s40, 2048
    v_mul_lo_u32 v77, s40, v77
    v_lshl_add_u32 v68, v78, 4, v77
    s_lshl_b32 s40, s36, 6
    v_add_u32 v76, s40, v1
    v_add_u32 v76, 256, v76
    v_lshrrev_b32 v77, 3, v76
    v_and_b32 v78, 7, v76
    v_and_b32 v79, 7, v77
    v_xor_b32 v78, v78, v79
    s_mov_b32 s40, 2048
    v_mul_lo_u32 v77, s40, v77
    v_lshl_add_u32 v69, v78, 4, v77
    s_lshl_b32 s40, s36, 6
    v_add_u32 v76, s40, v1
    v_add_u32 v76, 0, v76
    s_mov_b32 s40, 306783379
    v_mul_hi_u32 v77, s40, v76
    v_mul_u32_u24 v78, 14, v77
    v_sub_u32 v78, v76, v78
    v_cmp_gt_u32 vcc, 12, v78
    s_nop 1
    v_cndmask_b32 v78, 0, v78, vcc
    v_min_u32 v77, 63, v77
    v_and_b32 v79, 0xfffffff3, v77
    v_lshlrev_b32 v80, 1, v77
    v_and_b32 v80, 8, v80
    v_or_b32 v79, v79, v80
    v_lshrrev_b32 v80, 1, v77
    v_and_b32 v80, 4, v80
    v_or_b32 v79, v79, v80
    s_mov_b32 s40, 4608
    v_mul_lo_u32 v79, s40, v79
    v_lshl_add_u32 v70, v78, 4, v79
    s_lshl_b32 s40, s36, 6
    v_add_u32 v76, s40, v1
    v_add_u32 v76, 256, v76
    s_mov_b32 s40, 306783379
    v_mul_hi_u32 v77, s40, v76
    v_mul_u32_u24 v78, 14, v77
    v_sub_u32 v78, v76, v78
    v_cmp_gt_u32 vcc, 12, v78
    s_nop 1
    v_cndmask_b32 v78, 0, v78, vcc
    v_min_u32 v77, 63, v77
    v_and_b32 v79, 0xfffffff3, v77
    v_lshlrev_b32 v80, 1, v77
    v_and_b32 v80, 8, v80
    v_or_b32 v79, v79, v80
    v_lshrrev_b32 v80, 1, v77
    v_and_b32 v80, 4, v80
    v_or_b32 v79, v79, v80
    s_mov_b32 s40, 4608
    v_mul_lo_u32 v79, s40, v79
    v_lshl_add_u32 v71, v78, 4, v79
    s_lshl_b32 s40, s36, 6
    v_add_u32 v76, s40, v1
    v_add_u32 v76, 512, v76
    s_mov_b32 s40, 306783379
    v_mul_hi_u32 v77, s40, v76
    v_mul_u32_u24 v78, 14, v77
    v_sub_u32 v78, v76, v78
    v_cmp_gt_u32 vcc, 12, v78
    s_nop 1
    v_cndmask_b32 v78, 0, v78, vcc
    v_min_u32 v77, 63, v77
    v_and_b32 v79, 0xfffffff3, v77
    v_lshlrev_b32 v80, 1, v77
    v_and_b32 v80, 8, v80
    v_or_b32 v79, v79, v80
    v_lshrrev_b32 v80, 1, v77
    v_and_b32 v80, 4, v80
    v_or_b32 v79, v79, v80
    s_mov_b32 s40, 4608
    v_mul_lo_u32 v79, s40, v79
    v_lshl_add_u32 v72, v78, 4, v79
    s_lshl_b32 s40, s36, 6
    v_add_u32 v76, s40, v1
    v_add_u32 v76, 768, v76
    s_mov_b32 s40, 306783379
    v_mul_hi_u32 v77, s40, v76
    v_mul_u32_u24 v78, 14, v77
    v_sub_u32 v78, v76, v78
    v_cmp_gt_u32 vcc, 12, v78
    s_nop 1
    v_cndmask_b32 v78, 0, v78, vcc
    v_min_u32 v77, 63, v77
    v_and_b32 v79, 0xfffffff3, v77
    v_lshlrev_b32 v80, 1, v77
    v_and_b32 v80, 8, v80
    v_or_b32 v79, v79, v80
    v_lshrrev_b32 v80, 1, v77
    v_and_b32 v80, 4, v80
    v_or_b32 v79, v79, v80
    s_mov_b32 s40, 4608
    v_mul_lo_u32 v79, s40, v79
    v_lshl_add_u32 v73, v78, 4, v79
    s_lshr_b32 s41, s36, 1
    s_mul_i32 s42, s41, 2
    s_sub_u32 s42, s36, s42
    v_and_b32 v76, 15, v1
    v_lshrrev_b32 v77, 4, v1
    s_mul_i32 s40, s41, 32
    v_add_u32 v78, s40, v76
    v_and_b32 v79, 7, v78
    v_xor_b32 v79, v79, v77
    v_lshlrev_b32 v78, 7, v78
    v_lshl_add_u32 v74, v79, 4, v78
    v_lshrrev_b32 v78, 2, v1
    v_and_b32 v78, 3, v78
    v_and_b32 v79, 1, v77
    v_lshl_add_u32 v78, v79, 2, v78
    v_lshrrev_b32 v79, 1, v77
    v_lshl_add_u32 v78, v79, 4, v78
    v_mul_u32_u24 v78, 224, v78
    v_and_b32 v79, 3, v1
    v_lshl_add_u32 v78, v79, 3, v78
    s_mul_i32 s40, s42, 96
    v_add_u32 v75, s40, v78
    v_add_u32 v75, 8192, v75
    s_lshl_b32 s43, s36, 10
    s_mov_b32 s44, 0
    s_mov_b32 s45, 0
    v_xor_b32 v84, 64, v74
    v_xor_b32 v85, 64, v75
    v_add_u32 v88, 0, v74
    v_add_u32 v89, 0, v84
    v_add_u32 v90, 0, v75
    v_add_u32 v91, 0, v85
    v_add_u32 v92, 24576, v74
    v_add_u32 v93, 24576, v84
    v_add_u32 v94, 24576, v75
    v_add_u32 v95, 24576, v85
    v_add_u32 v96, 49152, v74
    v_add_u32 v97, 49152, v84
    v_add_u32 v98, 49152, v75
    v_add_u32 v99, 49152, v85
    v_add_u32 v100, 73728, v74
    v_add_u32 v101, 73728, v84
    v_add_u32 v102, 73728, v75
    v_add_u32 v103, 73728, v85
    v_add_u32 v104, 98304, v74
    v_add_u32 v105, 98304, v84
    v_add_u32 v106, 98304, v75
    v_add_u32 v107, 98304, v85
    v_add_u32 v108, 122880, v74
    v_add_u32 v109, 122880, v84
    v_add_u32 v110, 122880, v75
    v_add_u32 v111, 122880, v85
    s_add_u32 m0, s43, 0
    s_nop 0
    buffer_load_dwordx4 v68, s[8:11], s44 offen lds
    s_add_u32 m0, s43, 4096
    s_nop 0
    buffer_load_dwordx4 v69, s[8:11], s44 offen lds
    s_add_u32 m0, s43, 8192
    s_nop 0
    buffer_load_dwordx4 v70, s[12:15], s45 offen lds
    s_add_u32 m0, s43, 12288
    s_nop 0
    buffer_load_dwordx4 v71, s[12:15], s45 offen lds
    s_add_u32 m0, s43, 16384
    s_nop 0
    buffer_load_dwordx4 v72, s[12:15], s45 offen lds
    s_add_u32 m0, s43, 20480
    s_nop 0
    buffer_load_dwordx4 v73, s[12:15], s45 offen lds
    s_add_u32 s44, s44, 128
    s_add_u32 s45, s45, 294912
    s_add_u32 m0, s43, 24576
    s_nop 0
    buffer_load_dwordx4 v68, s[8:11], s44 offen lds
    s_add_u32 m0, s43, 28672
    s_nop 0
    buffer_load_dwordx4 v69, s[8:11], s44 offen lds
    s_add_u32 m0, s43, 32768
    s_nop 0
    buffer_load_dwordx4 v70, s[12:15], s45 offen lds
    s_add_u32 m0, s43, 36864
    s_nop 0
    buffer_load_dwordx4 v71, s[12:15], s45 offen lds
    s_add_u32 m0, s43, 40960
    s_nop 0
    buffer_load_dwordx4 v72, s[12:15], s45 offen lds
    s_add_u32 m0, s43, 45056
    s_nop 0
    buffer_load_dwordx4 v73, s[12:15], s45 offen lds
    s_add_u32 s44, s44, 128
    s_add_u32 s45, s45, 294912
    s_add_u32 m0, s43, 49152
    s_nop 0
    buffer_load_dwordx4 v68, s[8:11], s44 offen lds
    s_add_u32 m0, s43, 53248
    s_nop 0
    buffer_load_dwordx4 v69, s[8:11], s44 offen lds
    s_add_u32 m0, s43, 57344
    s_nop 0
    buffer_load_dwordx4 v70, s[12:15], s45 offen lds
    s_add_u32 m0, s43, 61440
    s_nop 0
    buffer_load_dwordx4 v71, s[12:15], s45 offen lds
    s_add_u32 m0, s43, 65536
    s_nop 0
    buffer_load_dwordx4 v72, s[12:15], s45 offen lds
    s_add_u32 m0, s43, 69632
    s_nop 0
    buffer_load_dwordx4 v73, s[12:15], s45 offen lds
    s_add_u32 s44, s44, 128
    s_add_u32 s45, s45, 294912
    s_add_u32 m0, s43, 73728
    s_nop 0
    buffer_load_dwordx4 v68, s[8:11], s44 offen lds
    s_add_u32 m0, s43, 77824
    s_nop 0
    buffer_load_dwordx4 v69, s[8:11], s44 offen lds
    s_add_u32 m0, s43, 81920
    s_nop 0
    buffer_load_dwordx4 v70, s[12:15], s45 offen lds
    s_add_u32 m0, s43, 86016
    s_nop 0
    buffer_load_dwordx4 v71, s[12:15], s45 offen lds
    s_add_u32 m0, s43, 90112
    s_nop 0
    buffer_load_dwordx4 v72, s[12:15], s45 offen lds
    s_add_u32 m0, s43, 94208
    s_nop 0
    buffer_load_dwordx4 v73, s[12:15], s45 offen lds
    s_add_u32 s44, s44, 128
    s_add_u32 s45, s45, 294912
    s_waitcnt vmcnt(12)
    s_barrier
    ds_read_b128 v[28:31], v88 offset:0
    ds_read_b128 v[32:35], v88 offset:2048
    ds_read_b64_tr_b16 v[44:45], v90 offset:0
    ds_read_b64_tr_b16 v[46:47], v90 offset:1792
    ds_read_b64_tr_b16 v[48:49], v90 offset:32
    ds_read_b64_tr_b16 v[50:51], v90 offset:1824
    ds_read_b64_tr_b16 v[52:53], v90 offset:64
    ds_read_b64_tr_b16 v[54:55], v90 offset:1856
    s_add_u32 m0, s43, 98304
    s_nop 0
    buffer_load_dwordx4 v68, s[8:11], s44 offen lds
    s_add_u32 m0, s43, 102400
    s_nop 0
    buffer_load_dwordx4 v69, s[8:11], s44 offen lds
    s_add_u32 m0, s43, 106496
    s_nop 0
    buffer_load_dwordx4 v70, s[12:15], s45 offen lds
    s_add_u32 m0, s43, 110592
    s_nop 0
    buffer_load_dwordx4 v71, s[12:15], s45 offen lds
    s_add_u32 m0, s43, 114688
    s_nop 0
    buffer_load_dwordx4 v72, s[12:15], s45 offen lds
    s_add_u32 m0, s43, 118784
    s_nop 0
    buffer_load_dwordx4 v73, s[12:15], s45 offen lds
    s_add_u32 s44, s44, 128
    s_add_u32 s45, s45, 294912
    s_add_u32 m0, s43, 122880
    s_nop 0
    buffer_load_dwordx4 v68, s[8:11], s44 offen lds
    s_add_u32 m0, s43, 126976
    s_nop 0
    buffer_load_dwordx4 v69, s[8:11], s44 offen lds
    s_add_u32 m0, s43, 131072
    s_nop 0
    buffer_load_dwordx4 v70, s[12:15], s45 offen lds
    s_add_u32 m0, s43, 135168
    s_nop 0
    buffer_load_dwordx4 v71, s[12:15], s45 offen lds
    s_add_u32 m0, s43, 139264
    s_nop 0
    buffer_load_dwordx4 v72, s[12:15], s45 offen lds
    s_add_u32 m0, s43, 143360
    s_nop 0
    buffer_load_dwordx4 v73, s[12:15], s45 offen lds
    s_add_u32 s44, s44, 128
    s_add_u32 s45, s45, 294912
    ds_read_b128 v[36:39], v89 offset:0
    ds_read_b128 v[40:43], v89 offset:2048
    ds_read_b64_tr_b16 v[56:57], v90 offset:7168
    ds_read_b64_tr_b16 v[58:59], v90 offset:8960
    ds_read_b64_tr_b16 v[60:61], v90 offset:7200
    ds_read_b64_tr_b16 v[62:63], v90 offset:8992
    ds_read_b64_tr_b16 v[64:65], v90 offset:7232
    ds_read_b64_tr_b16 v[66:67], v90 offset:9024
    s_waitcnt lgkmcnt(8)
    v_mfma_f32_16x16x32_bf16 v[4:7], v[44:47], v[28:31], 0
    v_mfma_f32_16x16x32_bf16 v[8:11], v[44:47], v[32:35], 0
    v_mfma_f32_16x16x32_bf16 v[12:15], v[48:51], v[28:31], 0
    v_mfma_f32_16x16x32_bf16 v[16:19], v[48:51], v[32:35], 0
    v_mfma_f32_16x16x32_bf16 v[20:23], v[52:55], v[28:31], 0
    v_mfma_f32_16x16x32_bf16 v[24:27], v[52:55], v[32:35], 0
    ds_read_b128 v[28:31], v92 offset:0
    ds_read_b128 v[32:35], v92 offset:2048
    ds_read_b64_tr_b16 v[44:45], v94 offset:0
    ds_read_b64_tr_b16 v[46:47], v94 offset:1792
    ds_read_b64_tr_b16 v[48:49], v94 offset:32
    ds_read_b64_tr_b16 v[50:51], v94 offset:1824
    ds_read_b64_tr_b16 v[52:53], v94 offset:64
    ds_read_b64_tr_b16 v[54:55], v94 offset:1856
    s_waitcnt lgkmcnt(8)
    v_mfma_f32_16x16x32_bf16 v[4:7], v[56:59], v[36:39], v[4:7]
    v_mfma_f32_16x16x32_bf16 v[8:11], v[56:59], v[40:43], v[8:11]
    v_mfma_f32_16x16x32_bf16 v[12:15], v[60:63], v[36:39], v[12:15]
    v_mfma_f32_16x16x32_bf16 v[16:19], v[60:63], v[40:43], v[16:19]
    v_mfma_f32_16x16x32_bf16 v[20:23], v[64:67], v[36:39], v[20:23]
    v_mfma_f32_16x16x32_bf16 v[24:27], v[64:67], v[40:43], v[24:27]
    ds_read_b128 v[36:39], v93 offset:0
    ds_read_b128 v[40:43], v93 offset:2048
    ds_read_b64_tr_b16 v[56:57], v94 offset:7168
    ds_read_b64_tr_b16 v[58:59], v94 offset:8960
    ds_read_b64_tr_b16 v[60:61], v94 offset:7200
    ds_read_b64_tr_b16 v[62:63], v94 offset:8992
    ds_read_b64_tr_b16 v[64:65], v94 offset:7232
    ds_read_b64_tr_b16 v[66:67], v94 offset:9024
    s_waitcnt lgkmcnt(8)
    v_mfma_f32_16x16x32_bf16 v[4:7], v[44:47], v[28:31], v[4:7]
    v_mfma_f32_16x16x32_bf16 v[8:11], v[44:47], v[32:35], v[8:11]
    v_mfma_f32_16x16x32_bf16 v[12:15], v[48:51], v[28:31], v[12:15]
    v_mfma_f32_16x16x32_bf16 v[16:19], v[48:51], v[32:35], v[16:19]
    v_mfma_f32_16x16x32_bf16 v[20:23], v[52:55], v[28:31], v[20:23]
    v_mfma_f32_16x16x32_bf16 v[24:27], v[52:55], v[32:35], v[24:27]
    s_waitcnt lgkmcnt(0)
    v_mfma_f32_16x16x32_bf16 v[4:7], v[56:59], v[36:39], v[4:7]
    v_mfma_f32_16x16x32_bf16 v[8:11], v[56:59], v[40:43], v[8:11]
    v_mfma_f32_16x16x32_bf16 v[12:15], v[60:63], v[36:39], v[12:15]
    v_mfma_f32_16x16x32_bf16 v[16:19], v[60:63], v[40:43], v[16:19]
    v_mfma_f32_16x16x32_bf16 v[20:23], v[64:67], v[36:39], v[20:23]
    v_mfma_f32_16x16x32_bf16 v[24:27], v[64:67], v[40:43], v[24:27]
    s_waitcnt vmcnt(12)
    s_barrier
    ds_read_b128 v[28:31], v96 offset:0
    ds_read_b128 v[32:35], v96 offset:2048
    ds_read_b64_tr_b16 v[44:45], v98 offset:0
    ds_read_b64_tr_b16 v[46:47], v98 offset:1792
    ds_read_b64_tr_b16 v[48:49], v98 offset:32
    ds_read_b64_tr_b16 v[50:51], v98 offset:1824
    ds_read_b64_tr_b16 v[52:53], v98 offset:64
    ds_read_b64_tr_b16 v[54:55], v98 offset:1856
    s_add_u32 m0, s43, 0
    s_nop 0
    buffer_load_dwordx4 v68, s[8:11], s44 offen lds
    s_add_u32 m0, s43, 4096
    s_nop 0
    buffer_load_dwordx4 v69, s[8:11], s44 offen lds
    s_add_u32 m0, s43, 8192
    s_nop 0
    buffer_load_dwordx4 v70, s[12:15], s45 offen lds
    s_add_u32 m0, s43, 12288
    s_nop 0
    buffer_load_dwordx4 v71, s[12:15], s45 offen lds
    s_add_u32 m0, s43, 16384
    s_nop 0
    buffer_load_dwordx4 v72, s[12:15], s45 offen lds
    s_add_u32 m0, s43, 20480
    s_nop 0
    buffer_load_dwordx4 v73, s[12:15], s45 offen lds
    s_add_u32 s44, s44, 128
    s_add_u32 s45, s45, 294912
    s_add_u32 m0, s43, 24576
    s_nop 0
    buffer_load_dwordx4 v68, s[8:11], s44 offen lds
    s_add_u32 m0, s43, 28672
    s_nop 0
    buffer_load_dwordx4 v69, s[8:11], s44 offen lds
    s_add_u32 m0, s43, 32768
    s_nop 0
    buffer_load_dwordx4 v70, s[12:15], s45 offen lds
    s_add_u32 m0, s43, 36864
    s_nop 0
    buffer_load_dwordx4 v71, s[12:15], s45 offen lds
    s_add_u32 m0, s43, 40960
    s_nop 0
    buffer_load_dwordx4 v72, s[12:15], s45 offen lds
    s_add_u32 m0, s43, 45056
    s_nop 0
    buffer_load_dwordx4 v73, s[12:15], s45 offen lds
    s_add_u32 s44, s44, 128
    s_add_u32 s45, s45, 294912
    ds_read_b128 v[36:39], v97 offset:0
    ds_read_b128 v[40:43], v97 offset:2048
    ds_read_b64_tr_b16 v[56:57], v98 offset:7168
    ds_read_b64_tr_b16 v[58:59], v98 offset:8960
    ds_read_b64_tr_b16 v[60:61], v98 offset:7200
    ds_read_b64_tr_b16 v[62:63], v98 offset:8992
    ds_read_b64_tr_b16 v[64:65], v98 offset:7232
    ds_read_b64_tr_b16 v[66:67], v98 offset:9024
    s_waitcnt lgkmcnt(8)
    v_mfma_f32_16x16x32_bf16 v[4:7], v[44:47], v[28:31], v[4:7]
    v_mfma_f32_16x16x32_bf16 v[8:11], v[44:47], v[32:35], v[8:11]
    v_mfma_f32_16x16x32_bf16 v[12:15], v[48:51], v[28:31], v[12:15]
    v_mfma_f32_16x16x32_bf16 v[16:19], v[48:51], v[32:35], v[16:19]
    v_mfma_f32_16x16x32_bf16 v[20:23], v[52:55], v[28:31], v[20:23]
    v_mfma_f32_16x16x32_bf16 v[24:27], v[52:55], v[32:35], v[24:27]
    ds_read_b128 v[28:31], v100 offset:0
    ds_read_b128 v[32:35], v100 offset:2048
    ds_read_b64_tr_b16 v[44:45], v102 offset:0
    ds_read_b64_tr_b16 v[46:47], v102 offset:1792
    ds_read_b64_tr_b16 v[48:49], v102 offset:32
    ds_read_b64_tr_b16 v[50:51], v102 offset:1824
    ds_read_b64_tr_b16 v[52:53], v102 offset:64
    ds_read_b64_tr_b16 v[54:55], v102 offset:1856
    s_waitcnt lgkmcnt(8)
    v_mfma_f32_16x16x32_bf16 v[4:7], v[56:59], v[36:39], v[4:7]
    v_mfma_f32_16x16x32_bf16 v[8:11], v[56:59], v[40:43], v[8:11]
    v_mfma_f32_16x16x32_bf16 v[12:15], v[60:63], v[36:39], v[12:15]
    v_mfma_f32_16x16x32_bf16 v[16:19], v[60:63], v[40:43], v[16:19]
    v_mfma_f32_16x16x32_bf16 v[20:23], v[64:67], v[36:39], v[20:23]
    v_mfma_f32_16x16x32_bf16 v[24:27], v[64:67], v[40:43], v[24:27]
    ds_read_b128 v[36:39], v101 offset:0
    ds_read_b128 v[40:43], v101 offset:2048
    ds_read_b64_tr_b16 v[56:57], v102 offset:7168
    ds_read_b64_tr_b16 v[58:59], v102 offset:8960
    ds_read_b64_tr_b16 v[60:61], v102 offset:7200
    ds_read_b64_tr_b16 v[62:63], v102 offset:8992
    ds_read_b64_tr_b16 v[64:65], v102 offset:7232
    ds_read_b64_tr_b16 v[66:67], v102 offset:9024
    s_waitcnt lgkmcnt(8)
    v_mfma_f32_16x16x32_bf16 v[4:7], v[44:47], v[28:31], v[4:7]
    v_mfma_f32_16x16x32_bf16 v[8:11], v[44:47], v[32:35], v[8:11]
    v_mfma_f32_16x16x32_bf16 v[12:15], v[48:51], v[28:31], v[12:15]
    v_mfma_f32_16x16x32_bf16 v[16:19], v[48:51], v[32:35], v[16:19]
    v_mfma_f32_16x16x32_bf16 v[20:23], v[52:55], v[28:31], v[20:23]
    v_mfma_f32_16x16x32_bf16 v[24:27], v[52:55], v[32:35], v[24:27]
    s_waitcnt lgkmcnt(0)
    v_mfma_f32_16x16x32_bf16 v[4:7], v[56:59], v[36:39], v[4:7]
    v_mfma_f32_16x16x32_bf16 v[8:11], v[56:59], v[40:43], v[8:11]
    v_mfma_f32_16x16x32_bf16 v[12:15], v[60:63], v[36:39], v[12:15]
    v_mfma_f32_16x16x32_bf16 v[16:19], v[60:63], v[40:43], v[16:19]
    v_mfma_f32_16x16x32_bf16 v[20:23], v[64:67], v[36:39], v[20:23]
    v_mfma_f32_16x16x32_bf16 v[24:27], v[64:67], v[40:43], v[24:27]
    s_waitcnt vmcnt(12)
    s_barrier
    ds_read_b128 v[28:31], v104 offset:0
    ds_read_b128 v[32:35], v104 offset:2048
    ds_read_b64_tr_b16 v[44:45], v106 offset:0
    ds_read_b64_tr_b16 v[46:47], v106 offset:1792
    ds_read_b64_tr_b16 v[48:49], v106 offset:32
    ds_read_b64_tr_b16 v[50:51], v106 offset:1824
    ds_read_b64_tr_b16 v[52:53], v106 offset:64
    ds_read_b64_tr_b16 v[54:55], v106 offset:1856
    s_add_u32 m0, s43, 49152
    s_nop 0
    buffer_load_dwordx4 v68, s[8:11], s44 offen lds
    s_add_u32 m0, s43, 53248
    s_nop 0
    buffer_load_dwordx4 v69, s[8:11], s44 offen lds
    s_add_u32 m0, s43, 57344
    s_nop 0
    buffer_load_dwordx4 v70, s[12:15], s45 offen lds
    s_add_u32 m0, s43, 61440
    s_nop 0
    buffer_load_dwordx4 v71, s[12:15], s45 offen lds
    s_add_u32 m0, s43, 65536
    s_nop 0
    buffer_load_dwordx4 v72, s[12:15], s45 offen lds
    s_add_u32 m0, s43, 69632
    s_nop 0
    buffer_load_dwordx4 v73, s[12:15], s45 offen lds
    s_add_u32 s44, s44, 128
    s_add_u32 s45, s45, 294912
    s_add_u32 m0, s43, 73728
    s_nop 0
    buffer_load_dwordx4 v68, s[8:11], s44 offen lds
    s_add_u32 m0, s43, 77824
    s_nop 0
    buffer_load_dwordx4 v69, s[8:11], s44 offen lds
    s_add_u32 m0, s43, 81920
    s_nop 0
    buffer_load_dwordx4 v70, s[12:15], s45 offen lds
    s_add_u32 m0, s43, 86016
    s_nop 0
    buffer_load_dwordx4 v71, s[12:15], s45 offen lds
    s_add_u32 m0, s43, 90112
    s_nop 0
    buffer_load_dwordx4 v72, s[12:15], s45 offen lds
    s_add_u32 m0, s43, 94208
    s_nop 0
    buffer_load_dwordx4 v73, s[12:15], s45 offen lds
    s_add_u32 s44, s44, 128
    s_add_u32 s45, s45, 294912
    ds_read_b128 v[36:39], v105 offset:0
    ds_read_b128 v[40:43], v105 offset:2048
    ds_read_b64_tr_b16 v[56:57], v106 offset:7168
    ds_read_b64_tr_b16 v[58:59], v106 offset:8960
    ds_read_b64_tr_b16 v[60:61], v106 offset:7200
    ds_read_b64_tr_b16 v[62:63], v106 offset:8992
    ds_read_b64_tr_b16 v[64:65], v106 offset:7232
    ds_read_b64_tr_b16 v[66:67], v106 offset:9024
    s_waitcnt lgkmcnt(8)
    v_mfma_f32_16x16x32_bf16 v[4:7], v[44:47], v[28:31], v[4:7]
    v_mfma_f32_16x16x32_bf16 v[8:11], v[44:47], v[32:35], v[8:11]
    v_mfma_f32_16x16x32_bf16 v[12:15], v[48:51], v[28:31], v[12:15]
    v_mfma_f32_16x16x32_bf16 v[16:19], v[48:51], v[32:35], v[16:19]
    v_mfma_f32_16x16x32_bf16 v[20:23], v[52:55], v[28:31], v[20:23]
    v_mfma_f32_16x16x32_bf16 v[24:27], v[52:55], v[32:35], v[24:27]
    ds_read_b128 v[28:31], v108 offset:0
    ds_read_b128 v[32:35], v108 offset:2048
    ds_read_b64_tr_b16 v[44:45], v110 offset:0
    ds_read_b64_tr_b16 v[46:47], v110 offset:1792
    ds_read_b64_tr_b16 v[48:49], v110 offset:32
    ds_read_b64_tr_b16 v[50:51], v110 offset:1824
    ds_read_b64_tr_b16 v[52:53], v110 offset:64
    ds_read_b64_tr_b16 v[54:55], v110 offset:1856
    s_waitcnt lgkmcnt(8)
    v_mfma_f32_16x16x32_bf16 v[4:7], v[56:59], v[36:39], v[4:7]
    v_mfma_f32_16x16x32_bf16 v[8:11], v[56:59], v[40:43], v[8:11]
    v_mfma_f32_16x16x32_bf16 v[12:15], v[60:63], v[36:39], v[12:15]
    v_mfma_f32_16x16x32_bf16 v[16:19], v[60:63], v[40:43], v[16:19]
    v_mfma_f32_16x16x32_bf16 v[20:23], v[64:67], v[36:39], v[20:23]
    v_mfma_f32_16x16x32_bf16 v[24:27], v[64:67], v[40:43], v[24:27]
    ds_read_b128 v[36:39], v109 offset:0
    ds_read_b128 v[40:43], v109 offset:2048
    ds_read_b64_tr_b16 v[56:57], v110 offset:7168
    ds_read_b64_tr_b16 v[58:59], v110 offset:8960
    ds_read_b64_tr_b16 v[60:61], v110 offset:7200
    ds_read_b64_tr_b16 v[62:63], v110 offset:8992
    ds_read_b64_tr_b16 v[64:65], v110 offset:7232
    ds_read_b64_tr_b16 v[66:67], v110 offset:9024
    s_waitcnt lgkmcnt(8)
    v_mfma_f32_16x16x32_bf16 v[4:7], v[44:47], v[28:31], v[4:7]
    v_mfma_f32_16x16x32_bf16 v[8:11], v[44:47], v[32:35], v[8:11]
    v_mfma_f32_16x16x32_bf16 v[12:15], v[48:51], v[28:31], v[12:15]
    v_mfma_f32_16x16x32_bf16 v[16:19], v[48:51], v[32:35], v[16:19]
    v_mfma_f32_16x16x32_bf16 v[20:23], v[52:55], v[28:31], v[20:23]
    v_mfma_f32_16x16x32_bf16 v[24:27], v[52:55], v[32:35], v[24:27]
    s_waitcnt lgkmcnt(0)
    v_mfma_f32_16x16x32_bf16 v[4:7], v[56:59], v[36:39], v[4:7]
    v_mfma_f32_16x16x32_bf16 v[8:11], v[56:59], v[40:43], v[8:11]
    v_mfma_f32_16x16x32_bf16 v[12:15], v[60:63], v[36:39], v[12:15]
    v_mfma_f32_16x16x32_bf16 v[16:19], v[60:63], v[40:43], v[16:19]
    v_mfma_f32_16x16x32_bf16 v[20:23], v[64:67], v[36:39], v[20:23]
    v_mfma_f32_16x16x32_bf16 v[24:27], v[64:67], v[40:43], v[24:27]
    s_waitcnt vmcnt(12)
    s_barrier
    ds_read_b128 v[28:31], v88 offset:0
    ds_read_b128 v[32:35], v88 offset:2048
    ds_read_b64_tr_b16 v[44:45], v90 offset:0
    ds_read_b64_tr_b16 v[46:47], v90 offset:1792
    ds_read_b64_tr_b16 v[48:49], v90 offset:32
    ds_read_b64_tr_b16 v[50:51], v90 offset:1824
    ds_read_b64_tr_b16 v[52:53], v90 offset:64
    ds_read_b64_tr_b16 v[54:55], v90 offset:1856
    s_add_u32 m0, s43, 98304
    s_nop 0
    buffer_load_dwordx4 v68, s[8:11], s44 offen lds
    s_add_u32 m0, s43, 102400
    s_nop 0
    buffer_load_dwordx4 v69, s[8:11], s44 offen lds
    s_add_u32 m0, s43, 106496
    s_nop 0
    buffer_load_dwordx4 v70, s[12:15], s45 offen lds
    s_add_u32 m0, s43, 110592
    s_nop 0
    buffer_load_dwordx4 v71, s[12:15], s45 offen lds
    s_add_u32 m0, s43, 114688
    s_nop 0
    buffer_load_dwordx4 v72, s[12:15], s45 offen lds
    s_add_u32 m0, s43, 118784
    s_nop 0
    buffer_load_dwordx4 v73, s[12:15], s45 offen lds
    s_add_u32 s44, s44, 128
    s_add_u32 s45, s45, 294912
    s_add_u32 m0, s43, 122880
    s_nop 0
    buffer_load_dwordx4 v68, s[8:11], s44 offen lds
    s_add_u32 m0, s43, 126976
    s_nop 0
    buffer_load_dwordx4 v69, s[8:11], s44 offen lds
    s_add_u32 m0, s43, 131072
    s_nop 0
    buffer_load_dwordx4 v70, s[12:15], s45 offen lds
    s_add_u32 m0, s43, 135168
    s_nop 0
    buffer_load_dwordx4 v71, s[12:15], s45 offen lds
    s_add_u32 m0, s43, 139264
    s_nop 0
    buffer_load_dwordx4 v72, s[12:15], s45 offen lds
    s_add_u32 m0, s43, 143360
    s_nop 0
    buffer_load_dwordx4 v73, s[12:15], s45 offen lds
    s_add_u32 s44, s44, 128
    s_add_u32 s45, s45, 294912
    ds_read_b128 v[36:39], v89 offset:0
    ds_read_b128 v[40:43], v89 offset:2048
    ds_read_b64_tr_b16 v[56:57], v90 offset:7168
    ds_read_b64_tr_b16 v[58:59], v90 offset:8960
    ds_read_b64_tr_b16 v[60:61], v90 offset:7200
    ds_read_b64_tr_b16 v[62:63], v90 offset:8992
    ds_read_b64_tr_b16 v[64:65], v90 offset:7232
    ds_read_b64_tr_b16 v[66:67], v90 offset:9024
    s_waitcnt lgkmcnt(8)
    v_mfma_f32_16x16x32_bf16 v[4:7], v[44:47], v[28:31], v[4:7]
    v_mfma_f32_16x16x32_bf16 v[8:11], v[44:47], v[32:35], v[8:11]
    v_mfma_f32_16x16x32_bf16 v[12:15], v[48:51], v[28:31], v[12:15]
    v_mfma_f32_16x16x32_bf16 v[16:19], v[48:51], v[32:35], v[16:19]
    v_mfma_f32_16x16x32_bf16 v[20:23], v[52:55], v[28:31], v[20:23]
    v_mfma_f32_16x16x32_bf16 v[24:27], v[52:55], v[32:35], v[24:27]
    ds_read_b128 v[28:31], v92 offset:0
    ds_read_b128 v[32:35], v92 offset:2048
    ds_read_b64_tr_b16 v[44:45], v94 offset:0
    ds_read_b64_tr_b16 v[46:47], v94 offset:1792
    ds_read_b64_tr_b16 v[48:49], v94 offset:32
    ds_read_b64_tr_b16 v[50:51], v94 offset:1824
    ds_read_b64_tr_b16 v[52:53], v94 offset:64
    ds_read_b64_tr_b16 v[54:55], v94 offset:1856
    s_waitcnt lgkmcnt(8)
    v_mfma_f32_16x16x32_bf16 v[4:7], v[56:59], v[36:39], v[4:7]
    v_mfma_f32_16x16x32_bf16 v[8:11], v[56:59], v[40:43], v[8:11]
    v_mfma_f32_16x16x32_bf16 v[12:15], v[60:63], v[36:39], v[12:15]
    v_mfma_f32_16x16x32_bf16 v[16:19], v[60:63], v[40:43], v[16:19]
    v_mfma_f32_16x16x32_bf16 v[20:23], v[64:67], v[36:39], v[20:23]
    v_mfma_f32_16x16x32_bf16 v[24:27], v[64:67], v[40:43], v[24:27]
    ds_read_b128 v[36:39], v93 offset:0
    ds_read_b128 v[40:43], v93 offset:2048
    ds_read_b64_tr_b16 v[56:57], v94 offset:7168
    ds_read_b64_tr_b16 v[58:59], v94 offset:8960
    ds_read_b64_tr_b16 v[60:61], v94 offset:7200
    ds_read_b64_tr_b16 v[62:63], v94 offset:8992
    ds_read_b64_tr_b16 v[64:65], v94 offset:7232
    ds_read_b64_tr_b16 v[66:67], v94 offset:9024
    s_waitcnt lgkmcnt(8)
    v_mfma_f32_16x16x32_bf16 v[4:7], v[44:47], v[28:31], v[4:7]
    v_mfma_f32_16x16x32_bf16 v[8:11], v[44:47], v[32:35], v[8:11]
    v_mfma_f32_16x16x32_bf16 v[12:15], v[48:51], v[28:31], v[12:15]
    v_mfma_f32_16x16x32_bf16 v[16:19], v[48:51], v[32:35], v[16:19]
    v_mfma_f32_16x16x32_bf16 v[20:23], v[52:55], v[28:31], v[20:23]
    v_mfma_f32_16x16x32_bf16 v[24:27], v[52:55], v[32:35], v[24:27]
    s_waitcnt lgkmcnt(0)
    v_mfma_f32_16x16x32_bf16 v[4:7], v[56:59], v[36:39], v[4:7]
    v_mfma_f32_16x16x32_bf16 v[8:11], v[56:59], v[40:43], v[8:11]
    v_mfma_f32_16x16x32_bf16 v[12:15], v[60:63], v[36:39], v[12:15]
    v_mfma_f32_16x16x32_bf16 v[16:19], v[60:63], v[40:43], v[16:19]
    v_mfma_f32_16x16x32_bf16 v[20:23], v[64:67], v[36:39], v[20:23]
    v_mfma_f32_16x16x32_bf16 v[24:27], v[64:67], v[40:43], v[24:27]
    s_waitcnt vmcnt(12)
    s_barrier
    ds_read_b128 v[28:31], v96 offset:0
    ds_read_b128 v[32:35], v96 offset:2048
    ds_read_b64_tr_b16 v[44:45], v98 offset:0
    ds_read_b64_tr_b16 v[46:47], v98 offset:1792
    ds_read_b64_tr_b16 v[48:49], v98 offset:32
    ds_read_b64_tr_b16 v[50:51], v98 offset:1824
    ds_read_b64_tr_b16 v[52:53], v98 offset:64
    ds_read_b64_tr_b16 v[54:55], v98 offset:1856
    s_add_u32 m0, s43, 0
    s_nop 0
    buffer_load_dwordx4 v68, s[8:11], s44 offen lds
    s_add_u32 m0, s43, 4096
    s_nop 0
    buffer_load_dwordx4 v69, s[8:11], s44 offen lds
    s_add_u32 m0, s43, 8192
    s_nop 0
    buffer_load_dwordx4 v70, s[12:15], s45 offen lds
    s_add_u32 m0, s43, 12288
    s_nop 0
    buffer_load_dwordx4 v71, s[12:15], s45 offen lds
    s_add_u32 m0, s43, 16384
    s_nop 0
    buffer_load_dwordx4 v72, s[12:15], s45 offen lds
    s_add_u32 m0, s43, 20480
    s_nop 0
    buffer_load_dwordx4 v73, s[12:15], s45 offen lds
    s_add_u32 s44, s44, 128
    s_add_u32 s45, s45, 294912
    s_add_u32 m0, s43, 24576
    s_nop 0
    buffer_load_dwordx4 v68, s[8:11], s44 offen lds
    s_add_u32 m0, s43, 28672
    s_nop 0
    buffer_load_dwordx4 v69, s[8:11], s44 offen lds
    s_add_u32 m0, s43, 32768
    s_nop 0
    buffer_load_dwordx4 v70, s[12:15], s45 offen lds
    s_add_u32 m0, s43, 36864
    s_nop 0
    buffer_load_dwordx4 v71, s[12:15], s45 offen lds
    s_add_u32 m0, s43, 40960
    s_nop 0
    buffer_load_dwordx4 v72, s[12:15], s45 offen lds
    s_add_u32 m0, s43, 45056
    s_nop 0
    buffer_load_dwordx4 v73, s[12:15], s45 offen lds
    s_add_u32 s44, s44, 128
    s_add_u32 s45, s45, 294912
    ds_read_b128 v[36:39], v97 offset:0
    ds_read_b128 v[40:43], v97 offset:2048
    ds_read_b64_tr_b16 v[56:57], v98 offset:7168
    ds_read_b64_tr_b16 v[58:59], v98 offset:8960
    ds_read_b64_tr_b16 v[60:61], v98 offset:7200
    ds_read_b64_tr_b16 v[62:63], v98 offset:8992
    ds_read_b64_tr_b16 v[64:65], v98 offset:7232
    ds_read_b64_tr_b16 v[66:67], v98 offset:9024
    s_waitcnt lgkmcnt(8)
    v_mfma_f32_16x16x32_bf16 v[4:7], v[44:47], v[28:31], v[4:7]
    v_mfma_f32_16x16x32_bf16 v[8:11], v[44:47], v[32:35], v[8:11]
    v_mfma_f32_16x16x32_bf16 v[12:15], v[48:51], v[28:31], v[12:15]
    v_mfma_f32_16x16x32_bf16 v[16:19], v[48:51], v[32:35], v[16:19]
    v_mfma_f32_16x16x32_bf16 v[20:23], v[52:55], v[28:31], v[20:23]
    v_mfma_f32_16x16x32_bf16 v[24:27], v[52:55], v[32:35], v[24:27]
    ds_read_b128 v[28:31], v100 offset:0
    ds_read_b128 v[32:35], v100 offset:2048
    ds_read_b64_tr_b16 v[44:45], v102 offset:0
    ds_read_b64_tr_b16 v[46:47], v102 offset:1792
    ds_read_b64_tr_b16 v[48:49], v102 offset:32
    ds_read_b64_tr_b16 v[50:51], v102 offset:1824
    ds_read_b64_tr_b16 v[52:53], v102 offset:64
    ds_read_b64_tr_b16 v[54:55], v102 offset:1856
    s_waitcnt lgkmcnt(8)
    v_mfma_f32_16x16x32_bf16 v[4:7], v[56:59], v[36:39], v[4:7]
    v_mfma_f32_16x16x32_bf16 v[8:11], v[56:59], v[40:43], v[8:11]
    v_mfma_f32_16x16x32_bf16 v[12:15], v[60:63], v[36:39], v[12:15]
    v_mfma_f32_16x16x32_bf16 v[16:19], v[60:63], v[40:43], v[16:19]
    v_mfma_f32_16x16x32_bf16 v[20:23], v[64:67], v[36:39], v[20:23]
    v_mfma_f32_16x16x32_bf16 v[24:27], v[64:67], v[40:43], v[24:27]
    ds_read_b128 v[36:39], v101 offset:0
    ds_read_b128 v[40:43], v101 offset:2048
    ds_read_b64_tr_b16 v[56:57], v102 offset:7168
    ds_read_b64_tr_b16 v[58:59], v102 offset:8960
    ds_read_b64_tr_b16 v[60:61], v102 offset:7200
    ds_read_b64_tr_b16 v[62:63], v102 offset:8992
    ds_read_b64_tr_b16 v[64:65], v102 offset:7232
    ds_read_b64_tr_b16 v[66:67], v102 offset:9024
    s_waitcnt lgkmcnt(8)
    v_mfma_f32_16x16x32_bf16 v[4:7], v[44:47], v[28:31], v[4:7]
    v_mfma_f32_16x16x32_bf16 v[8:11], v[44:47], v[32:35], v[8:11]
    v_mfma_f32_16x16x32_bf16 v[12:15], v[48:51], v[28:31], v[12:15]
    v_mfma_f32_16x16x32_bf16 v[16:19], v[48:51], v[32:35], v[16:19]
    v_mfma_f32_16x16x32_bf16 v[20:23], v[52:55], v[28:31], v[20:23]
    v_mfma_f32_16x16x32_bf16 v[24:27], v[52:55], v[32:35], v[24:27]
    s_waitcnt lgkmcnt(0)
    v_mfma_f32_16x16x32_bf16 v[4:7], v[56:59], v[36:39], v[4:7]
    v_mfma_f32_16x16x32_bf16 v[8:11], v[56:59], v[40:43], v[8:11]
    v_mfma_f32_16x16x32_bf16 v[12:15], v[60:63], v[36:39], v[12:15]
    v_mfma_f32_16x16x32_bf16 v[16:19], v[60:63], v[40:43], v[16:19]
    v_mfma_f32_16x16x32_bf16 v[20:23], v[64:67], v[36:39], v[20:23]
    v_mfma_f32_16x16x32_bf16 v[24:27], v[64:67], v[40:43], v[24:27]
    s_waitcnt vmcnt(12)
    s_barrier
    ds_read_b128 v[28:31], v104 offset:0
    ds_read_b128 v[32:35], v104 offset:2048
    ds_read_b64_tr_b16 v[44:45], v106 offset:0
    ds_read_b64_tr_b16 v[46:47], v106 offset:1792
    ds_read_b64_tr_b16 v[48:49], v106 offset:32
    ds_read_b64_tr_b16 v[50:51], v106 offset:1824
    ds_read_b64_tr_b16 v[52:53], v106 offset:64
    ds_read_b64_tr_b16 v[54:55], v106 offset:1856
    s_add_u32 m0, s43, 49152
    s_nop 0
    buffer_load_dwordx4 v68, s[8:11], s44 offen lds
    s_add_u32 m0, s43, 53248
    s_nop 0
    buffer_load_dwordx4 v69, s[8:11], s44 offen lds
    s_add_u32 m0, s43, 57344
    s_nop 0
    buffer_load_dwordx4 v70, s[12:15], s45 offen lds
    s_add_u32 m0, s43, 61440
    s_nop 0
    buffer_load_dwordx4 v71, s[12:15], s45 offen lds
    s_add_u32 m0, s43, 65536
    s_nop 0
    buffer_load_dwordx4 v72, s[12:15], s45 offen lds
    s_add_u32 m0, s43, 69632
    s_nop 0
    buffer_load_dwordx4 v73, s[12:15], s45 offen lds
    s_add_u32 s44, s44, 128
    s_add_u32 s45, s45, 294912
    s_add_u32 m0, s43, 73728
    s_nop 0
    buffer_load_dwordx4 v68, s[8:11], s44 offen lds
    s_add_u32 m0, s43, 77824
    s_nop 0
    buffer_load_dwordx4 v69, s[8:11], s44 offen lds
    s_add_u32 m0, s43, 81920
    s_nop 0
    buffer_load_dwordx4 v70, s[12:15], s45 offen lds
    s_add_u32 m0, s43, 86016
    s_nop 0
    buffer_load_dwordx4 v71, s[12:15], s45 offen lds
    s_add_u32 m0, s43, 90112
    s_nop 0
    buffer_load_dwordx4 v72, s[12:15], s45 offen lds
    s_add_u32 m0, s43, 94208
    s_nop 0
    buffer_load_dwordx4 v73, s[12:15], s45 offen lds
    s_add_u32 s44, s44, 128
    s_add_u32 s45, s45, 294912
    ds_read_b128 v[36:39], v105 offset:0
    ds_read_b128 v[40:43], v105 offset:2048
    ds_read_b64_tr_b16 v[56:57], v106 offset:7168
    ds_read_b64_tr_b16 v[58:59], v106 offset:8960
    ds_read_b64_tr_b16 v[60:61], v106 offset:7200
    ds_read_b64_tr_b16 v[62:63], v106 offset:8992
    ds_read_b64_tr_b16 v[64:65], v106 offset:7232
    ds_read_b64_tr_b16 v[66:67], v106 offset:9024
    s_waitcnt lgkmcnt(8)
    v_mfma_f32_16x16x32_bf16 v[4:7], v[44:47], v[28:31], v[4:7]
    v_mfma_f32_16x16x32_bf16 v[8:11], v[44:47], v[32:35], v[8:11]
    v_mfma_f32_16x16x32_bf16 v[12:15], v[48:51], v[28:31], v[12:15]
    v_mfma_f32_16x16x32_bf16 v[16:19], v[48:51], v[32:35], v[16:19]
    v_mfma_f32_16x16x32_bf16 v[20:23], v[52:55], v[28:31], v[20:23]
    v_mfma_f32_16x16x32_bf16 v[24:27], v[52:55], v[32:35], v[24:27]
    ds_read_b128 v[28:31], v108 offset:0
    ds_read_b128 v[32:35], v108 offset:2048
    ds_read_b64_tr_b16 v[44:45], v110 offset:0
    ds_read_b64_tr_b16 v[46:47], v110 offset:1792
    ds_read_b64_tr_b16 v[48:49], v110 offset:32
    ds_read_b64_tr_b16 v[50:51], v110 offset:1824
    ds_read_b64_tr_b16 v[52:53], v110 offset:64
    ds_read_b64_tr_b16 v[54:55], v110 offset:1856
    s_waitcnt lgkmcnt(8)
    v_mfma_f32_16x16x32_bf16 v[4:7], v[56:59], v[36:39], v[4:7]
    v_mfma_f32_16x16x32_bf16 v[8:11], v[56:59], v[40:43], v[8:11]
    v_mfma_f32_16x16x32_bf16 v[12:15], v[60:63], v[36:39], v[12:15]
    v_mfma_f32_16x16x32_bf16 v[16:19], v[60:63], v[40:43], v[16:19]
    v_mfma_f32_16x16x32_bf16 v[20:23], v[64:67], v[36:39], v[20:23]
    v_mfma_f32_16x16x32_bf16 v[24:27], v[64:67], v[40:43], v[24:27]
    ds_read_b128 v[36:39], v109 offset:0
    ds_read_b128 v[40:43], v109 offset:2048
    ds_read_b64_tr_b16 v[56:57], v110 offset:7168
    ds_read_b64_tr_b16 v[58:59], v110 offset:8960
    ds_read_b64_tr_b16 v[60:61], v110 offset:7200
    ds_read_b64_tr_b16 v[62:63], v110 offset:8992
    ds_read_b64_tr_b16 v[64:65], v110 offset:7232
    ds_read_b64_tr_b16 v[66:67], v110 offset:9024
    s_waitcnt lgkmcnt(8)
    v_mfma_f32_16x16x32_bf16 v[4:7], v[44:47], v[28:31], v[4:7]
    v_mfma_f32_16x16x32_bf16 v[8:11], v[44:47], v[32:35], v[8:11]
    v_mfma_f32_16x16x32_bf16 v[12:15], v[48:51], v[28:31], v[12:15]
    v_mfma_f32_16x16x32_bf16 v[16:19], v[48:51], v[32:35], v[16:19]
    v_mfma_f32_16x16x32_bf16 v[20:23], v[52:55], v[28:31], v[20:23]
    v_mfma_f32_16x16x32_bf16 v[24:27], v[52:55], v[32:35], v[24:27]
    s_waitcnt lgkmcnt(0)
    v_mfma_f32_16x16x32_bf16 v[4:7], v[56:59], v[36:39], v[4:7]
    v_mfma_f32_16x16x32_bf16 v[8:11], v[56:59], v[40:43], v[8:11]
    v_mfma_f32_16x16x32_bf16 v[12:15], v[60:63], v[36:39], v[12:15]
    v_mfma_f32_16x16x32_bf16 v[16:19], v[60:63], v[40:43], v[16:19]
    v_mfma_f32_16x16x32_bf16 v[20:23], v[64:67], v[36:39], v[20:23]
    v_mfma_f32_16x16x32_bf16 v[24:27], v[64:67], v[40:43], v[24:27]
    s_waitcnt vmcnt(12)
    s_barrier
    ds_read_b128 v[28:31], v88 offset:0
    ds_read_b128 v[32:35], v88 offset:2048
    ds_read_b64_tr_b16 v[44:45], v90 offset:0
    ds_read_b64_tr_b16 v[46:47], v90 offset:1792
    ds_read_b64_tr_b16 v[48:49], v90 offset:32
    ds_read_b64_tr_b16 v[50:51], v90 offset:1824
    ds_read_b64_tr_b16 v[52:53], v90 offset:64
    ds_read_b64_tr_b16 v[54:55], v90 offset:1856
    ds_read_b128 v[36:39], v89 offset:0
    ds_read_b128 v[40:43], v89 offset:2048
    ds_read_b64_tr_b16 v[56:57], v90 offset:7168
    ds_read_b64_tr_b16 v[58:59], v90 offset:8960
    ds_read_b64_tr_b16 v[60:61], v90 offset:7200
    ds_read_b64_tr_b16 v[62:63], v90 offset:8992
    ds_read_b64_tr_b16 v[64:65], v90 offset:7232
    ds_read_b64_tr_b16 v[66:67], v90 offset:9024
    s_waitcnt lgkmcnt(8)
    v_mfma_f32_16x16x32_bf16 v[4:7], v[44:47], v[28:31], v[4:7]
    v_mfma_f32_16x16x32_bf16 v[8:11], v[44:47], v[32:35], v[8:11]
    v_mfma_f32_16x16x32_bf16 v[12:15], v[48:51], v[28:31], v[12:15]
    v_mfma_f32_16x16x32_bf16 v[16:19], v[48:51], v[32:35], v[16:19]
    v_mfma_f32_16x16x32_bf16 v[20:23], v[52:55], v[28:31], v[20:23]
    v_mfma_f32_16x16x32_bf16 v[24:27], v[52:55], v[32:35], v[24:27]
    ds_read_b128 v[28:31], v92 offset:0
    ds_read_b128 v[32:35], v92 offset:2048
    ds_read_b64_tr_b16 v[44:45], v94 offset:0
    ds_read_b64_tr_b16 v[46:47], v94 offset:1792
    ds_read_b64_tr_b16 v[48:49], v94 offset:32
    ds_read_b64_tr_b16 v[50:51], v94 offset:1824
    ds_read_b64_tr_b16 v[52:53], v94 offset:64
    ds_read_b64_tr_b16 v[54:55], v94 offset:1856
    s_waitcnt lgkmcnt(8)
    v_mfma_f32_16x16x32_bf16 v[4:7], v[56:59], v[36:39], v[4:7]
    v_mfma_f32_16x16x32_bf16 v[8:11], v[56:59], v[40:43], v[8:11]
    v_mfma_f32_16x16x32_bf16 v[12:15], v[60:63], v[36:39], v[12:15]
    v_mfma_f32_16x16x32_bf16 v[16:19], v[60:63], v[40:43], v[16:19]
    v_mfma_f32_16x16x32_bf16 v[20:23], v[64:67], v[36:39], v[20:23]
    v_mfma_f32_16x16x32_bf16 v[24:27], v[64:67], v[40:43], v[24:27]
    ds_read_b128 v[36:39], v93 offset:0
    ds_read_b128 v[40:43], v93 offset:2048
    ds_read_b64_tr_b16 v[56:57], v94 offset:7168
    ds_read_b64_tr_b16 v[58:59], v94 offset:8960
    ds_read_b64_tr_b16 v[60:61], v94 offset:7200
    ds_read_b64_tr_b16 v[62:63], v94 offset:8992
    ds_read_b64_tr_b16 v[64:65], v94 offset:7232
    ds_read_b64_tr_b16 v[66:67], v94 offset:9024
    s_waitcnt lgkmcnt(8)
    v_mfma_f32_16x16x32_bf16 v[4:7], v[44:47], v[28:31], v[4:7]
    v_mfma_f32_16x16x32_bf16 v[8:11], v[44:47], v[32:35], v[8:11]
    v_mfma_f32_16x16x32_bf16 v[12:15], v[48:51], v[28:31], v[12:15]
    v_mfma_f32_16x16x32_bf16 v[16:19], v[48:51], v[32:35], v[16:19]
    v_mfma_f32_16x16x32_bf16 v[20:23], v[52:55], v[28:31], v[20:23]
    v_mfma_f32_16x16x32_bf16 v[24:27], v[52:55], v[32:35], v[24:27]
    s_waitcnt lgkmcnt(0)
    v_mfma_f32_16x16x32_bf16 v[4:7], v[56:59], v[36:39], v[4:7]
    v_mfma_f32_16x16x32_bf16 v[8:11], v[56:59], v[40:43], v[8:11]
    v_mfma_f32_16x16x32_bf16 v[12:15], v[60:63], v[36:39], v[12:15]
    v_mfma_f32_16x16x32_bf16 v[16:19], v[60:63], v[40:43], v[16:19]
    v_mfma_f32_16x16x32_bf16 v[20:23], v[64:67], v[36:39], v[20:23]
    v_mfma_f32_16x16x32_bf16 v[24:27], v[64:67], v[40:43], v[24:27]
    s_waitcnt vmcnt(0)
    s_barrier
    ds_read_b128 v[28:31], v96 offset:0
    ds_read_b128 v[32:35], v96 offset:2048
    ds_read_b64_tr_b16 v[44:45], v98 offset:0
    ds_read_b64_tr_b16 v[46:47], v98 offset:1792
    ds_read_b64_tr_b16 v[48:49], v98 offset:32
    ds_read_b64_tr_b16 v[50:51], v98 offset:1824
    ds_read_b64_tr_b16 v[52:53], v98 offset:64
    ds_read_b64_tr_b16 v[54:55], v98 offset:1856
    ds_read_b128 v[36:39], v97 offset:0
    ds_read_b128 v[40:43], v97 offset:2048
    ds_read_b64_tr_b16 v[56:57], v98 offset:7168
    ds_read_b64_tr_b16 v[58:59], v98 offset:8960
    ds_read_b64_tr_b16 v[60:61], v98 offset:7200
    ds_read_b64_tr_b16 v[62:63], v98 offset:8992
    ds_read_b64_tr_b16 v[64:65], v98 offset:7232
    ds_read_b64_tr_b16 v[66:67], v98 offset:9024
    s_waitcnt lgkmcnt(8)
    v_mfma_f32_16x16x32_bf16 v[4:7], v[44:47], v[28:31], v[4:7]
    v_mfma_f32_16x16x32_bf16 v[8:11], v[44:47], v[32:35], v[8:11]
    v_mfma_f32_16x16x32_bf16 v[12:15], v[48:51], v[28:31], v[12:15]
    v_mfma_f32_16x16x32_bf16 v[16:19], v[48:51], v[32:35], v[16:19]
    v_mfma_f32_16x16x32_bf16 v[20:23], v[52:55], v[28:31], v[20:23]
    v_mfma_f32_16x16x32_bf16 v[24:27], v[52:55], v[32:35], v[24:27]
    ds_read_b128 v[28:31], v100 offset:0
    ds_read_b128 v[32:35], v100 offset:2048
    ds_read_b64_tr_b16 v[44:45], v102 offset:0
    ds_read_b64_tr_b16 v[46:47], v102 offset:1792
    ds_read_b64_tr_b16 v[48:49], v102 offset:32
    ds_read_b64_tr_b16 v[50:51], v102 offset:1824
    ds_read_b64_tr_b16 v[52:53], v102 offset:64
    ds_read_b64_tr_b16 v[54:55], v102 offset:1856
    s_waitcnt lgkmcnt(8)
    v_mfma_f32_16x16x32_bf16 v[4:7], v[56:59], v[36:39], v[4:7]
    v_mfma_f32_16x16x32_bf16 v[8:11], v[56:59], v[40:43], v[8:11]
    v_mfma_f32_16x16x32_bf16 v[12:15], v[60:63], v[36:39], v[12:15]
    v_mfma_f32_16x16x32_bf16 v[16:19], v[60:63], v[40:43], v[16:19]
    v_mfma_f32_16x16x32_bf16 v[20:23], v[64:67], v[36:39], v[20:23]
    v_mfma_f32_16x16x32_bf16 v[24:27], v[64:67], v[40:43], v[24:27]
    ds_read_b128 v[36:39], v101 offset:0
    ds_read_b128 v[40:43], v101 offset:2048
    ds_read_b64_tr_b16 v[56:57], v102 offset:7168
    ds_read_b64_tr_b16 v[58:59], v102 offset:8960
    ds_read_b64_tr_b16 v[60:61], v102 offset:7200
    ds_read_b64_tr_b16 v[62:63], v102 offset:8992
    ds_read_b64_tr_b16 v[64:65], v102 offset:7232
    ds_read_b64_tr_b16 v[66:67], v102 offset:9024
    s_waitcnt lgkmcnt(8)
    v_mfma_f32_16x16x32_bf16 v[4:7], v[44:47], v[28:31], v[4:7]
    v_mfma_f32_16x16x32_bf16 v[8:11], v[44:47], v[32:35], v[8:11]
    v_mfma_f32_16x16x32_bf16 v[12:15], v[48:51], v[28:31], v[12:15]
    v_mfma_f32_16x16x32_bf16 v[16:19], v[48:51], v[32:35], v[16:19]
    v_mfma_f32_16x16x32_bf16 v[20:23], v[52:55], v[28:31], v[20:23]
    v_mfma_f32_16x16x32_bf16 v[24:27], v[52:55], v[32:35], v[24:27]
    s_waitcnt lgkmcnt(0)
    v_mfma_f32_16x16x32_bf16 v[4:7], v[56:59], v[36:39], v[4:7]
    v_mfma_f32_16x16x32_bf16 v[8:11], v[56:59], v[40:43], v[8:11]
    v_mfma_f32_16x16x32_bf16 v[12:15], v[60:63], v[36:39], v[12:15]
    v_mfma_f32_16x16x32_bf16 v[16:19], v[60:63], v[40:43], v[16:19]
    v_mfma_f32_16x16x32_bf16 v[20:23], v[64:67], v[36:39], v[20:23]
    v_mfma_f32_16x16x32_bf16 v[24:27], v[64:67], v[40:43], v[24:27]
    v_and_b32 v76, 15, v1
    v_lshrrev_b32 v77, 4, v1
    s_mul_i32 s40, s41, 32
    v_add_u32 v76, s40, v76
    s_mul_i32 s40, s42, 48
    v_lshl_add_u32 v77, v77, 2, s40
    s_mov_b32 s40, 1536
    v_mul_lo_u32 v78, s40, v76
    v_lshl_add_u32 v78, v77, 1, v78
    s_nop 7
    s_nop 7
    v_cvt_pk_bf16_f32 v4, v4, v5
    v_cvt_pk_bf16_f32 v5, v6, v7
    buffer_store_dwordx2 v[4:5], v78, s[16:19], 0 offen offset:0
    v_cvt_pk_bf16_f32 v8, v8, v9
    v_cvt_pk_bf16_f32 v9, v10, v11
    v_add_u32 v80, 24576, v78
    buffer_store_dwordx2 v[8:9], v80, s[16:19], 0 offen
    v_cvt_pk_bf16_f32 v12, v12, v13
    v_cvt_pk_bf16_f32 v13, v14, v15
    buffer_store_dwordx2 v[12:13], v78, s[16:19], 0 offen offset:32
    v_cvt_pk_bf16_f32 v16, v16, v17
    v_cvt_pk_bf16_f32 v17, v18, v19
    v_add_u32 v80, 24608, v78
    buffer_store_dwordx2 v[16:17], v80, s[16:19], 0 offen
    v_cvt_pk_bf16_f32 v20, v20, v21
    v_cvt_pk_bf16_f32 v21, v22, v23
    buffer_store_dwordx2 v[20:21], v78, s[16:19], 0 offen offset:64
    v_cvt_pk_bf16_f32 v24, v24, v25
    v_cvt_pk_bf16_f32 v25, v26, v27
    v_add_u32 v80, 24640, v78
    buffer_store_dwordx2 v[24:25], v80, s[16:19], 0 offen
pv_kernel_end:
    s_endpgm
.text
.globl wo_kernel
.p2align 8
.type wo_kernel,@function
wo_kernel:
    s_cmp_ge_u32 s2, 256
    s_cbranch_scc1 wo_kernel_end
    s_load_dwordx2 s[20:21], s[0:1], 72
    s_load_dwordx2 s[22:23], s[0:1], 24
    s_load_dwordx2 s[24:25], s[0:1], 72
    s_load_dwordx2 s[26:27], s[0:1], 72
    s_load_dwordx2 s[28:29], s[0:1], 0
    s_and_b32 s40, s2, 7
    s_mul_i32 s40, s40, 32
    s_lshr_b32 s2, s2, 3
    s_add_u32 s2, s2, s40
    s_lshr_b32 s30, s2, 8
    s_mul_i32 s31, s30, 256
    s_sub_u32 s31, s2, s31
    s_lshr_b32 s32, s31, 3
    s_mul_i32 s33, s32, 8
    s_sub_u32 s33, s31, s33
    s_lshr_b32 s34, s30, 1
    s_and_b32 s35, s30, 1
    v_lshrrev_b32 v200, 6, v0
    s_nop 0
    v_readfirstlane_b32 s36, v200
    v_and_b32 v1, 63, v0
    s_mul_i32 s37, s34, 0
    s_mul_i32 s40, s35, 0
    s_add_u32 s37, s37, s40
    s_mul_i32 s40, s32, 98304
    s_add_u32 s37, s37, s40
    s_mul_i32 s38, s34, 0
    s_mul_i32 s40, s35, 0
    s_add_u32 s38, s38, s40
    s_mul_i32 s40, s33, 192
    s_add_u32 s38, s38, s40
    s_mul_i32 s39, s34, 0
    s_mul_i32 s40, s35, 0
    s_add_u32 s39, s39, s40
    s_mul_i32 s40, s32, 98304
    s_add_u32 s39, s39, s40
    s_mul_i32 s40, s33, 192
    s_add_u32 s39, s39, s40
    s_waitcnt lgkmcnt(0)
    s_add_u32 s8, s20, 33554432
    s_addc_u32 s9, s21, 0
    s_add_u32 s8, s8, s37
    s_addc_u32 s9, s9, 0
    s_mov_b32 s11, 0x00020000
    s_add_u32 s12, s22, 0
    s_addc_u32 s13, s23, 0
    s_add_u32 s12, s12, s38
    s_addc_u32 s13, s13, 0
    s_mov_b32 s15, 0x00020000
    s_add_u32 s16, s24, 37748736
    s_addc_u32 s17, s25, 0
    s_add_u32 s16, s16, s39
    s_addc_u32 s17, s17, 0
    s_mov_b32 s19, 0x00020000
    s_mov_b32 s10, 98304
    s_mov_b32 s14, 1178304
    s_mov_b32 s18, 96960
    s_lshl_b32 s40, s36, 6
    v_add_u32 v76, s40, v1
    v_add_u32 v76, 0, v76
    v_lshrrev_b32 v77, 3, v76
    v_and_b32 v78, 7, v76
    v_and_b32 v79, 7, v77
    v_xor_b32 v78, v78, v79
    s_mov_b32 s40, 1536
    v_mul_lo_u32 v77, s40, v77
    v_lshl_add_u32 v68, v78, 4, v77
    s_lshl_b32 s40, s36, 6
    v_add_u32 v76, s40, v1
    v_add_u32 v76, 256, v76
    v_lshrrev_b32 v77, 3, v76
    v_and_b32 v78, 7, v76
    v_and_b32 v79, 7, v77
    v_xor_b32 v78, v78, v79
    s_mov_b32 s40, 1536
    v_mul_lo_u32 v77, s40, v77
    v_lshl_add_u32 v69, v78, 4, v77
    s_lshl_b32 s40, s36, 6
    v_add_u32 v76, s40, v1
    v_add_u32 v76, 0, v76
    s_mov_b32 s40, 306783379
    v_mul_hi_u32 v77, s40, v76
    v_mul_u32_u24 v78, 14, v77
    v_sub_u32 v78, v76, v78
    v_cmp_gt_u32 vcc, 12, v78
    s_nop 1
    v_cndmask_b32 v78, 0, v78, vcc
    v_min_u32 v77, 63, v77
    v_and_b32 v79, 0xfffffff3, v77
    v_lshlrev_b32 v80, 1, v77
    v_and_b32 v80, 8, v80
    v_or_b32 v79, v79, v80
    v_lshrrev_b32 v80, 1, v77
    v_and_b32 v80, 4, v80
    v_or_b32 v79, v79, v80
    s_mov_b32 s40, 1536
    v_mul_lo_u32 v79, s40, v79
    v_lshl_add_u32 v70, v78, 4, v79
    s_lshl_b32 s40, s36, 6
    v_add_u32 v76, s40, v1
    v_add_u32 v76, 256, v76
    s_mov_b32 s40, 306783379
    v_mul_hi_u32 v77, s40, v76
    v_mul_u32_u24 v78, 14, v77
    v_sub_u32 v78, v76, v78
    v_cmp_gt_u32 vcc, 12, v78
    s_nop 1
    v_cndmask_b32 v78, 0, v78, vcc
    v_min_u32 v77, 63, v77
    v_and_b32 v79, 0xfffffff3, v77
    v_lshlrev_b32 v80, 1, v77
    v_and_b32 v80, 8, v80
    v_or_b32 v79, v79, v80
    v_lshrrev_b32 v80, 1, v77
    v_and_b32 v80, 4, v80
    v_or_b32 v79, v79, v80
    s_mov_b32 s40, 1536
    v_mul_lo_u32 v79, s40, v79
    v_lshl_add_u32 v71, v78, 4, v79
    s_lshl_b32 s40, s36, 6
    v_add_u32 v76, s40, v1
    v_add_u32 v76, 512, v76
    s_mov_b32 s40, 306783379
    v_mul_hi_u32 v77, s40, v76
    v_mul_u32_u24 v78, 14, v77
    v_sub_u32 v78, v76, v78
    v_cmp_gt_u32 vcc, 12, v78
    s_nop 1
    v_cndmask_b32 v78, 0, v78, vcc
    v_min_u32 v77, 63, v77
    v_and_b32 v79, 0xfffffff3, v77
    v_lshlrev_b32 v80, 1, v77
    v_and_b32 v80, 8, v80
    v_or_b32 v79, v79, v80
    v_lshrrev_b32 v80, 1, v77
    v_and_b32 v80, 4, v80
    v_or_b32 v79, v79, v80
    s_mov_b32 s40, 1536
    v_mul_lo_u32 v79, s40, v79
    v_lshl_add_u32 v72, v78, 4, v79
    s_lshl_b32 s40, s36, 6
    v_add_u32 v76, s40, v1
    v_add_u32 v76, 768, v76
    s_mov_b32 s40, 306783379
    v_mul_hi_u32 v77, s40, v76
    v_mul_u32_u24 v78, 14, v77
    v_sub_u32 v78, v76, v78
    v_cmp_gt_u32 vcc, 12, v78
    s_nop 1
    v_cndmask_b32 v78, 0, v78, vcc
    v_min_u32 v77, 63, v77
    v_and_b32 v79, 0xfffffff3, v77
    v_lshlrev_b32 v80, 1, v77
    v_and_b32 v80, 8, v80
    v_or_b32 v79, v79, v80
    v_lshrrev_b32 v80, 1, v77
    v_and_b32 v80, 4, v80
    v_or_b32 v79, v79, v80
    s_mov_b32 s40, 1536
    v_mul_lo_u32 v79, s40, v79
    v_lshl_add_u32 v73, v78, 4, v79
    s_lshr_b32 s41, s36, 1
    s_mul_i32 s42, s41, 2
    s_sub_u32 s42, s36, s42
    v_and_b32 v76, 15, v1
    v_lshrrev_b32 v77, 4, v1
    s_mul_i32 s40, s41, 32
    v_add_u32 v78, s40, v76
    v_and_b32 v79, 7, v78
    v_xor_b32 v79, v79, v77
    v_lshlrev_b32 v78, 7, v78
    v_lshl_add_u32 v74, v79, 4, v78
    v_lshrrev_b32 v78, 2, v1
    v_and_b32 v78, 3, v78
    v_and_b32 v79, 1, v77
    v_lshl_add_u32 v78, v79, 2, v78
    v_lshrrev_b32 v79, 1, v77
    v_lshl_add_u32 v78, v79, 4, v78
    v_mul_u32_u24 v78, 224, v78
    v_and_b32 v79, 3, v1
    v_lshl_add_u32 v78, v79, 3, v78
    s_mul_i32 s40, s42, 96
    v_add_u32 v75, s40, v78
    v_add_u32 v75, 8192, v75
    s_lshl_b32 s43, s36, 10
    s_mov_b32 s44, 0
    s_mov_b32 s45, 0
    v_xor_b32 v84, 64, v74
    v_xor_b32 v85, 64, v75
    v_add_u32 v88, 0, v74
    v_add_u32 v89, 0, v84
    v_add_u32 v90, 0, v75
    v_add_u32 v91, 0, v85
    v_add_u32 v92, 24576, v74
    v_add_u32 v93, 24576, v84
    v_add_u32 v94, 24576, v75
    v_add_u32 v95, 24576, v85
    v_add_u32 v96, 49152, v74
    v_add_u32 v97, 49152, v84
    v_add_u32 v98, 49152, v75
    v_add_u32 v99, 49152, v85
    v_add_u32 v100, 73728, v74
    v_add_u32 v101, 73728, v84
    v_add_u32 v102, 73728, v75
    v_add_u32 v103, 73728, v85
    v_add_u32 v104, 98304, v74
    v_add_u32 v105, 98304, v84
    v_add_u32 v106, 98304, v75
    v_add_u32 v107, 98304, v85
    v_add_u32 v108, 122880, v74
    v_add_u32 v109, 122880, v84
    v_add_u32 v110, 122880, v75
    v_add_u32 v111, 122880, v85
    s_add_u32 m0, s43, 0
    s_nop 0
    buffer_load_dwordx4 v68, s[8:11], s44 offen lds
    s_add_u32 m0, s43, 4096
    s_nop 0
    buffer_load_dwordx4 v69, s[8:11], s44 offen lds
    s_add_u32 m0, s43, 8192
    s_nop 0
    buffer_load_dwordx4 v70, s[12:15], s45 offen lds
    s_add_u32 m0, s43, 12288
    s_nop 0
    buffer_load_dwordx4 v71, s[12:15], s45 offen lds
    s_add_u32 m0, s43, 16384
    s_nop 0
    buffer_load_dwordx4 v72, s[12:15], s45 offen lds
    s_add_u32 m0, s43, 20480
    s_nop 0
    buffer_load_dwordx4 v73, s[12:15], s45 offen lds
    s_add_u32 s44, s44, 128
    s_add_u32 s45, s45, 98304
    s_add_u32 m0, s43, 24576
    s_nop 0
    buffer_load_dwordx4 v68, s[8:11], s44 offen lds
    s_add_u32 m0, s43, 28672
    s_nop 0
    buffer_load_dwordx4 v69, s[8:11], s44 offen lds
    s_add_u32 m0, s43, 32768
    s_nop 0
    buffer_load_dwordx4 v70, s[12:15], s45 offen lds
    s_add_u32 m0, s43, 36864
    s_nop 0
    buffer_load_dwordx4 v71, s[12:15], s45 offen lds
    s_add_u32 m0, s43, 40960
    s_nop 0
    buffer_load_dwordx4 v72, s[12:15], s45 offen lds
    s_add_u32 m0, s43, 45056
    s_nop 0
    buffer_load_dwordx4 v73, s[12:15], s45 offen lds
    s_add_u32 s44, s44, 128
    s_add_u32 s45, s45, 98304
    s_add_u32 m0, s43, 49152
    s_nop 0
    buffer_load_dwordx4 v68, s[8:11], s44 offen lds
    s_add_u32 m0, s43, 53248
    s_nop 0
    buffer_load_dwordx4 v69, s[8:11], s44 offen lds
    s_add_u32 m0, s43, 57344
    s_nop 0
    buffer_load_dwordx4 v70, s[12:15], s45 offen lds
    s_add_u32 m0, s43, 61440
    s_nop 0
    buffer_load_dwordx4 v71, s[12:15], s45 offen lds
    s_add_u32 m0, s43, 65536
    s_nop 0
    buffer_load_dwordx4 v72, s[12:15], s45 offen lds
    s_add_u32 m0, s43, 69632
    s_nop 0
    buffer_load_dwordx4 v73, s[12:15], s45 offen lds
    s_add_u32 s44, s44, 128
    s_add_u32 s45, s45, 98304
    s_add_u32 m0, s43, 73728
    s_nop 0
    buffer_load_dwordx4 v68, s[8:11], s44 offen lds
    s_add_u32 m0, s43, 77824
    s_nop 0
    buffer_load_dwordx4 v69, s[8:11], s44 offen lds
    s_add_u32 m0, s43, 81920
    s_nop 0
    buffer_load_dwordx4 v70, s[12:15], s45 offen lds
    s_add_u32 m0, s43, 86016
    s_nop 0
    buffer_load_dwordx4 v71, s[12:15], s45 offen lds
    s_add_u32 m0, s43, 90112
    s_nop 0
    buffer_load_dwordx4 v72, s[12:15], s45 offen lds
    s_add_u32 m0, s43, 94208
    s_nop 0
    buffer_load_dwordx4 v73, s[12:15], s45 offen lds
    s_add_u32 s44, s44, 128
    s_add_u32 s45, s45, 98304
    s_waitcnt vmcnt(12)
    s_barrier
    ds_read_b128 v[28:31], v88 offset:0
    ds_read_b128 v[32:35], v88 offset:2048
    ds_read_b64_tr_b16 v[44:45], v90 offset:0
    ds_read_b64_tr_b16 v[46:47], v90 offset:1792
    ds_read_b64_tr_b16 v[48:49], v90 offset:32
    ds_read_b64_tr_b16 v[50:51], v90 offset:1824
    ds_read_b64_tr_b16 v[52:53], v90 offset:64
    ds_read_b64_tr_b16 v[54:55], v90 offset:1856
    s_add_u32 m0, s43, 98304
    s_nop 0
    buffer_load_dwordx4 v68, s[8:11], s44 offen lds
    s_add_u32 m0, s43, 102400
    s_nop 0
    buffer_load_dwordx4 v69, s[8:11], s44 offen lds
    s_add_u32 m0, s43, 106496
    s_nop 0
    buffer_load_dwordx4 v70, s[12:15], s45 offen lds
    s_add_u32 m0, s43, 110592
    s_nop 0
    buffer_load_dwordx4 v71, s[12:15], s45 offen lds
    s_add_u32 m0, s43, 114688
    s_nop 0
    buffer_load_dwordx4 v72, s[12:15], s45 offen lds
    s_add_u32 m0, s43, 118784
    s_nop 0
    buffer_load_dwordx4 v73, s[12:15], s45 offen lds
    s_add_u32 s44, s44, 128
    s_add_u32 s45, s45, 98304
    s_add_u32 m0, s43, 122880
    s_nop 0
    buffer_load_dwordx4 v68, s[8:11], s44 offen lds
    s_add_u32 m0, s43, 126976
    s_nop 0
    buffer_load_dwordx4 v69, s[8:11], s44 offen lds
    s_add_u32 m0, s43, 131072
    s_nop 0
    buffer_load_dwordx4 v70, s[12:15], s45 offen lds
    s_add_u32 m0, s43, 135168
    s_nop 0
    buffer_load_dwordx4 v71, s[12:15], s45 offen lds
    s_add_u32 m0, s43, 139264
    s_nop 0
    buffer_load_dwordx4 v72, s[12:15], s45 offen lds
    s_add_u32 m0, s43, 143360
    s_nop 0
    buffer_load_dwordx4 v73, s[12:15], s45 offen lds
    s_add_u32 s44, s44, 128
    s_add_u32 s45, s45, 98304
    ds_read_b128 v[36:39], v89 offset:0
    ds_read_b128 v[40:43], v89 offset:2048
    ds_read_b64_tr_b16 v[56:57], v90 offset:7168
    ds_read_b64_tr_b16 v[58:59], v90 offset:8960
    ds_read_b64_tr_b16 v[60:61], v90 offset:7200
    ds_read_b64_tr_b16 v[62:63], v90 offset:8992
    ds_read_b64_tr_b16 v[64:65], v90 offset:7232
    ds_read_b64_tr_b16 v[66:67], v90 offset:9024
    s_waitcnt lgkmcnt(8)
    v_mfma_f32_16x16x32_bf16 v[4:7], v[44:47], v[28:31], 0
    v_mfma_f32_16x16x32_bf16 v[8:11], v[44:47], v[32:35], 0
    v_mfma_f32_16x16x32_bf16 v[12:15], v[48:51], v[28:31], 0
    v_mfma_f32_16x16x32_bf16 v[16:19], v[48:51], v[32:35], 0
    v_mfma_f32_16x16x32_bf16 v[20:23], v[52:55], v[28:31], 0
    v_mfma_f32_16x16x32_bf16 v[24:27], v[52:55], v[32:35], 0
    ds_read_b128 v[28:31], v92 offset:0
    ds_read_b128 v[32:35], v92 offset:2048
    ds_read_b64_tr_b16 v[44:45], v94 offset:0
    ds_read_b64_tr_b16 v[46:47], v94 offset:1792
    ds_read_b64_tr_b16 v[48:49], v94 offset:32
    ds_read_b64_tr_b16 v[50:51], v94 offset:1824
    ds_read_b64_tr_b16 v[52:53], v94 offset:64
    ds_read_b64_tr_b16 v[54:55], v94 offset:1856
    s_waitcnt lgkmcnt(8)
    v_mfma_f32_16x16x32_bf16 v[4:7], v[56:59], v[36:39], v[4:7]
    v_mfma_f32_16x16x32_bf16 v[8:11], v[56:59], v[40:43], v[8:11]
    v_mfma_f32_16x16x32_bf16 v[12:15], v[60:63], v[36:39], v[12:15]
    v_mfma_f32_16x16x32_bf16 v[16:19], v[60:63], v[40:43], v[16:19]
    v_mfma_f32_16x16x32_bf16 v[20:23], v[64:67], v[36:39], v[20:23]
    v_mfma_f32_16x16x32_bf16 v[24:27], v[64:67], v[40:43], v[24:27]
    ds_read_b128 v[36:39], v93 offset:0
    ds_read_b128 v[40:43], v93 offset:2048
    ds_read_b64_tr_b16 v[56:57], v94 offset:7168
    ds_read_b64_tr_b16 v[58:59], v94 offset:8960
    ds_read_b64_tr_b16 v[60:61], v94 offset:7200
    ds_read_b64_tr_b16 v[62:63], v94 offset:8992
    ds_read_b64_tr_b16 v[64:65], v94 offset:7232
    ds_read_b64_tr_b16 v[66:67], v94 offset:9024
    s_waitcnt lgkmcnt(8)
    v_mfma_f32_16x16x32_bf16 v[4:7], v[44:47], v[28:31], v[4:7]
    v_mfma_f32_16x16x32_bf16 v[8:11], v[44:47], v[32:35], v[8:11]
    v_mfma_f32_16x16x32_bf16 v[12:15], v[48:51], v[28:31], v[12:15]
    v_mfma_f32_16x16x32_bf16 v[16:19], v[48:51], v[32:35], v[16:19]
    v_mfma_f32_16x16x32_bf16 v[20:23], v[52:55], v[28:31], v[20:23]
    v_mfma_f32_16x16x32_bf16 v[24:27], v[52:55], v[32:35], v[24:27]
    s_waitcnt lgkmcnt(0)
    v_mfma_f32_16x16x32_bf16 v[4:7], v[56:59], v[36:39], v[4:7]
    v_mfma_f32_16x16x32_bf16 v[8:11], v[56:59], v[40:43], v[8:11]
    v_mfma_f32_16x16x32_bf16 v[12:15], v[60:63], v[36:39], v[12:15]
    v_mfma_f32_16x16x32_bf16 v[16:19], v[60:63], v[40:43], v[16:19]
    v_mfma_f32_16x16x32_bf16 v[20:23], v[64:67], v[36:39], v[20:23]
    v_mfma_f32_16x16x32_bf16 v[24:27], v[64:67], v[40:43], v[24:27]
    s_waitcnt vmcnt(12)
    s_barrier
    ds_read_b128 v[28:31], v96 offset:0
    ds_read_b128 v[32:35], v96 offset:2048
    ds_read_b64_tr_b16 v[44:45], v98 offset:0
    ds_read_b64_tr_b16 v[46:47], v98 offset:1792
    ds_read_b64_tr_b16 v[48:49], v98 offset:32
    ds_read_b64_tr_b16 v[50:51], v98 offset:1824
    ds_read_b64_tr_b16 v[52:53], v98 offset:64
    ds_read_b64_tr_b16 v[54:55], v98 offset:1856
    s_add_u32 m0, s43, 0
    s_nop 0
    buffer_load_dwordx4 v68, s[8:11], s44 offen lds
    s_add_u32 m0, s43, 4096
    s_nop 0
    buffer_load_dwordx4 v69, s[8:11], s44 offen lds
    s_add_u32 m0, s43, 8192
    s_nop 0
    buffer_load_dwordx4 v70, s[12:15], s45 offen lds
    s_add_u32 m0, s43, 12288
    s_nop 0
    buffer_load_dwordx4 v71, s[12:15], s45 offen lds
    s_add_u32 m0, s43, 16384
    s_nop 0
    buffer_load_dwordx4 v72, s[12:15], s45 offen lds
    s_add_u32 m0, s43, 20480
    s_nop 0
    buffer_load_dwordx4 v73, s[12:15], s45 offen lds
    s_add_u32 s44, s44, 128
    s_add_u32 s45, s45, 98304
    s_add_u32 m0, s43, 24576
    s_nop 0
    buffer_load_dwordx4 v68, s[8:11], s44 offen lds
    s_add_u32 m0, s43, 28672
    s_nop 0
    buffer_load_dwordx4 v69, s[8:11], s44 offen lds
    s_add_u32 m0, s43, 32768
    s_nop 0
    buffer_load_dwordx4 v70, s[12:15], s45 offen lds
    s_add_u32 m0, s43, 36864
    s_nop 0
    buffer_load_dwordx4 v71, s[12:15], s45 offen lds
    s_add_u32 m0, s43, 40960
    s_nop 0
    buffer_load_dwordx4 v72, s[12:15], s45 offen lds
    s_add_u32 m0, s43, 45056
    s_nop 0
    buffer_load_dwordx4 v73, s[12:15], s45 offen lds
    s_add_u32 s44, s44, 128
    s_add_u32 s45, s45, 98304
    ds_read_b128 v[36:39], v97 offset:0
    ds_read_b128 v[40:43], v97 offset:2048
    ds_read_b64_tr_b16 v[56:57], v98 offset:7168
    ds_read_b64_tr_b16 v[58:59], v98 offset:8960
    ds_read_b64_tr_b16 v[60:61], v98 offset:7200
    ds_read_b64_tr_b16 v[62:63], v98 offset:8992
    ds_read_b64_tr_b16 v[64:65], v98 offset:7232
    ds_read_b64_tr_b16 v[66:67], v98 offset:9024
    s_waitcnt lgkmcnt(8)
    v_mfma_f32_16x16x32_bf16 v[4:7], v[44:47], v[28:31], v[4:7]
    v_mfma_f32_16x16x32_bf16 v[8:11], v[44:47], v[32:35], v[8:11]
    v_mfma_f32_16x16x32_bf16 v[12:15], v[48:51], v[28:31], v[12:15]
    v_mfma_f32_16x16x32_bf16 v[16:19], v[48:51], v[32:35], v[16:19]
    v_mfma_f32_16x16x32_bf16 v[20:23], v[52:55], v[28:31], v[20:23]
    v_mfma_f32_16x16x32_bf16 v[24:27], v[52:55], v[32:35], v[24:27]
    ds_read_b128 v[28:31], v100 offset:0
    ds_read_b128 v[32:35], v100 offset:2048
    ds_read_b64_tr_b16 v[44:45], v102 offset:0
    ds_read_b64_tr_b16 v[46:47], v102 offset:1792
    ds_read_b64_tr_b16 v[48:49], v102 offset:32
    ds_read_b64_tr_b16 v[50:51], v102 offset:1824
    ds_read_b64_tr_b16 v[52:53], v102 offset:64
    ds_read_b64_tr_b16 v[54:55], v102 offset:1856
    s_waitcnt lgkmcnt(8)
    v_mfma_f32_16x16x32_bf16 v[4:7], v[56:59], v[36:39], v[4:7]
    v_mfma_f32_16x16x32_bf16 v[8:11], v[56:59], v[40:43], v[8:11]
    v_mfma_f32_16x16x32_bf16 v[12:15], v[60:63], v[36:39], v[12:15]
    v_mfma_f32_16x16x32_bf16 v[16:19], v[60:63], v[40:43], v[16:19]
    v_mfma_f32_16x16x32_bf16 v[20:23], v[64:67], v[36:39], v[20:23]
    v_mfma_f32_16x16x32_bf16 v[24:27], v[64:67], v[40:43], v[24:27]
    ds_read_b128 v[36:39], v101 offset:0
    ds_read_b128 v[40:43], v101 offset:2048
    ds_read_b64_tr_b16 v[56:57], v102 offset:7168
    ds_read_b64_tr_b16 v[58:59], v102 offset:8960
    ds_read_b64_tr_b16 v[60:61], v102 offset:7200
    ds_read_b64_tr_b16 v[62:63], v102 offset:8992
    ds_read_b64_tr_b16 v[64:65], v102 offset:7232
    ds_read_b64_tr_b16 v[66:67], v102 offset:9024
    s_waitcnt lgkmcnt(8)
    v_mfma_f32_16x16x32_bf16 v[4:7], v[44:47], v[28:31], v[4:7]
    v_mfma_f32_16x16x32_bf16 v[8:11], v[44:47], v[32:35], v[8:11]
    v_mfma_f32_16x16x32_bf16 v[12:15], v[48:51], v[28:31], v[12:15]
    v_mfma_f32_16x16x32_bf16 v[16:19], v[48:51], v[32:35], v[16:19]
    v_mfma_f32_16x16x32_bf16 v[20:23], v[52:55], v[28:31], v[20:23]
    v_mfma_f32_16x16x32_bf16 v[24:27], v[52:55], v[32:35], v[24:27]
    s_waitcnt lgkmcnt(0)
    v_mfma_f32_16x16x32_bf16 v[4:7], v[56:59], v[36:39], v[4:7]
    v_mfma_f32_16x16x32_bf16 v[8:11], v[56:59], v[40:43], v[8:11]
    v_mfma_f32_16x16x32_bf16 v[12:15], v[60:63], v[36:39], v[12:15]
    v_mfma_f32_16x16x32_bf16 v[16:19], v[60:63], v[40:43], v[16:19]
    v_mfma_f32_16x16x32_bf16 v[20:23], v[64:67], v[36:39], v[20:23]
    v_mfma_f32_16x16x32_bf16 v[24:27], v[64:67], v[40:43], v[24:27]
    s_waitcnt vmcnt(12)
    s_barrier
    ds_read_b128 v[28:31], v104 offset:0
    ds_read_b128 v[32:35], v104 offset:2048
    ds_read_b64_tr_b16 v[44:45], v106 offset:0
    ds_read_b64_tr_b16 v[46:47], v106 offset:1792
    ds_read_b64_tr_b16 v[48:49], v106 offset:32
    ds_read_b64_tr_b16 v[50:51], v106 offset:1824
    ds_read_b64_tr_b16 v[52:53], v106 offset:64
    ds_read_b64_tr_b16 v[54:55], v106 offset:1856
    s_add_u32 m0, s43, 49152
    s_nop 0
    buffer_load_dwordx4 v68, s[8:11], s44 offen lds
    s_add_u32 m0, s43, 53248
    s_nop 0
    buffer_load_dwordx4 v69, s[8:11], s44 offen lds
    s_add_u32 m0, s43, 57344
    s_nop 0
    buffer_load_dwordx4 v70, s[12:15], s45 offen lds
    s_add_u32 m0, s43, 61440
    s_nop 0
    buffer_load_dwordx4 v71, s[12:15], s45 offen lds
    s_add_u32 m0, s43, 65536
    s_nop 0
    buffer_load_dwordx4 v72, s[12:15], s45 offen lds
    s_add_u32 m0, s43, 69632
    s_nop 0
    buffer_load_dwordx4 v73, s[12:15], s45 offen lds
    s_add_u32 s44, s44, 128
    s_add_u32 s45, s45, 98304
    s_add_u32 m0, s43, 73728
    s_nop 0
    buffer_load_dwordx4 v68, s[8:11], s44 offen lds
    s_add_u32 m0, s43, 77824
    s_nop 0
    buffer_load_dwordx4 v69, s[8:11], s44 offen lds
    s_add_u32 m0, s43, 81920
    s_nop 0
    buffer_load_dwordx4 v70, s[12:15], s45 offen lds
    s_add_u32 m0, s43, 86016
    s_nop 0
    buffer_load_dwordx4 v71, s[12:15], s45 offen lds
    s_add_u32 m0, s43, 90112
    s_nop 0
    buffer_load_dwordx4 v72, s[12:15], s45 offen lds
    s_add_u32 m0, s43, 94208
    s_nop 0
    buffer_load_dwordx4 v73, s[12:15], s45 offen lds
    s_add_u32 s44, s44, 128
    s_add_u32 s45, s45, 98304
    ds_read_b128 v[36:39], v105 offset:0
    ds_read_b128 v[40:43], v105 offset:2048
    ds_read_b64_tr_b16 v[56:57], v106 offset:7168
    ds_read_b64_tr_b16 v[58:59], v106 offset:8960
    ds_read_b64_tr_b16 v[60:61], v106 offset:7200
    ds_read_b64_tr_b16 v[62:63], v106 offset:8992
    ds_read_b64_tr_b16 v[64:65], v106 offset:7232
    ds_read_b64_tr_b16 v[66:67], v106 offset:9024
    s_waitcnt lgkmcnt(8)
    v_mfma_f32_16x16x32_bf16 v[4:7], v[44:47], v[28:31], v[4:7]
    v_mfma_f32_16x16x32_bf16 v[8:11], v[44:47], v[32:35], v[8:11]
    v_mfma_f32_16x16x32_bf16 v[12:15], v[48:51], v[28:31], v[12:15]
    v_mfma_f32_16x16x32_bf16 v[16:19], v[48:51], v[32:35], v[16:19]
    v_mfma_f32_16x16x32_bf16 v[20:23], v[52:55], v[28:31], v[20:23]
    v_mfma_f32_16x16x32_bf16 v[24:27], v[52:55], v[32:35], v[24:27]
    ds_read_b128 v[28:31], v108 offset:0
    ds_read_b128 v[32:35], v108 offset:2048
    ds_read_b64_tr_b16 v[44:45], v110 offset:0
    ds_read_b64_tr_b16 v[46:47], v110 offset:1792
    ds_read_b64_tr_b16 v[48:49], v110 offset:32
    ds_read_b64_tr_b16 v[50:51], v110 offset:1824
    ds_read_b64_tr_b16 v[52:53], v110 offset:64
    ds_read_b64_tr_b16 v[54:55], v110 offset:1856
    s_waitcnt lgkmcnt(8)
    v_mfma_f32_16x16x32_bf16 v[4:7], v[56:59], v[36:39], v[4:7]
    v_mfma_f32_16x16x32_bf16 v[8:11], v[56:59], v[40:43], v[8:11]
    v_mfma_f32_16x16x32_bf16 v[12:15], v[60:63], v[36:39], v[12:15]
    v_mfma_f32_16x16x32_bf16 v[16:19], v[60:63], v[40:43], v[16:19]
    v_mfma_f32_16x16x32_bf16 v[20:23], v[64:67], v[36:39], v[20:23]
    v_mfma_f32_16x16x32_bf16 v[24:27], v[64:67], v[40:43], v[24:27]
    ds_read_b128 v[36:39], v109 offset:0
    ds_read_b128 v[40:43], v109 offset:2048
    ds_read_b64_tr_b16 v[56:57], v110 offset:7168
    ds_read_b64_tr_b16 v[58:59], v110 offset:8960
    ds_read_b64_tr_b16 v[60:61], v110 offset:7200
    ds_read_b64_tr_b16 v[62:63], v110 offset:8992
    ds_read_b64_tr_b16 v[64:65], v110 offset:7232
    ds_read_b64_tr_b16 v[66:67], v110 offset:9024
    s_waitcnt lgkmcnt(8)
    v_mfma_f32_16x16x32_bf16 v[4:7], v[44:47], v[28:31], v[4:7]
    v_mfma_f32_16x16x32_bf16 v[8:11], v[44:47], v[32:35], v[8:11]
    v_mfma_f32_16x16x32_bf16 v[12:15], v[48:51], v[28:31], v[12:15]
    v_mfma_f32_16x16x32_bf16 v[16:19], v[48:51], v[32:35], v[16:19]
    v_mfma_f32_16x16x32_bf16 v[20:23], v[52:55], v[28:31], v[20:23]
    v_mfma_f32_16x16x32_bf16 v[24:27], v[52:55], v[32:35], v[24:27]
    s_waitcnt lgkmcnt(0)
    v_mfma_f32_16x16x32_bf16 v[4:7], v[56:59], v[36:39], v[4:7]
    v_mfma_f32_16x16x32_bf16 v[8:11], v[56:59], v[40:43], v[8:11]
    v_mfma_f32_16x16x32_bf16 v[12:15], v[60:63], v[36:39], v[12:15]
    v_mfma_f32_16x16x32_bf16 v[16:19], v[60:63], v[40:43], v[16:19]
    v_mfma_f32_16x16x32_bf16 v[20:23], v[64:67], v[36:39], v[20:23]
    v_mfma_f32_16x16x32_bf16 v[24:27], v[64:67], v[40:43], v[24:27]
    s_waitcnt vmcnt(12)
    s_barrier
    ds_read_b128 v[28:31], v88 offset:0
    ds_read_b128 v[32:35], v88 offset:2048
    ds_read_b64_tr_b16 v[44:45], v90 offset:0
    ds_read_b64_tr_b16 v[46:47], v90 offset:1792
    ds_read_b64_tr_b16 v[48:49], v90 offset:32
    ds_read_b64_tr_b16 v[50:51], v90 offset:1824
    ds_read_b64_tr_b16 v[52:53], v90 offset:64
    ds_read_b64_tr_b16 v[54:55], v90 offset:1856
    s_add_u32 m0, s43, 98304
    s_nop 0
    buffer_load_dwordx4 v68, s[8:11], s44 offen lds
    s_add_u32 m0, s43, 102400
    s_nop 0
    buffer_load_dwordx4 v69, s[8:11], s44 offen lds
    s_add_u32 m0, s43, 106496
    s_nop 0
    buffer_load_dwordx4 v70, s[12:15], s45 offen lds
    s_add_u32 m0, s43, 110592
    s_nop 0
    buffer_load_dwordx4 v71, s[12:15], s45 offen lds
    s_add_u32 m0, s43, 114688
    s_nop 0
    buffer_load_dwordx4 v72, s[12:15], s45 offen lds
    s_add_u32 m0, s43, 118784
    s_nop 0
    buffer_load_dwordx4 v73, s[12:15], s45 offen lds
    s_add_u32 s44, s44, 128
    s_add_u32 s45, s45, 98304
    s_add_u32 m0, s43, 122880
    s_nop 0
    buffer_load_dwordx4 v68, s[8:11], s44 offen lds
    s_add_u32 m0, s43, 126976
    s_nop 0
    buffer_load_dwordx4 v69, s[8:11], s44 offen lds
    s_add_u32 m0, s43, 131072
    s_nop 0
    buffer_load_dwordx4 v70, s[12:15], s45 offen lds
    s_add_u32 m0, s43, 135168
    s_nop 0
    buffer_load_dwordx4 v71, s[12:15], s45 offen lds
    s_add_u32 m0, s43, 139264
    s_nop 0
    buffer_load_dwordx4 v72, s[12:15], s45 offen lds
    s_add_u32 m0, s43, 143360
    s_nop 0
    buffer_load_dwordx4 v73, s[12:15], s45 offen lds
    s_add_u32 s44, s44, 128
    s_add_u32 s45, s45, 98304
    ds_read_b128 v[36:39], v89 offset:0
    ds_read_b128 v[40:43], v89 offset:2048
    ds_read_b64_tr_b16 v[56:57], v90 offset:7168
    ds_read_b64_tr_b16 v[58:59], v90 offset:8960
    ds_read_b64_tr_b16 v[60:61], v90 offset:7200
    ds_read_b64_tr_b16 v[62:63], v90 offset:8992
    ds_read_b64_tr_b16 v[64:65], v90 offset:7232
    ds_read_b64_tr_b16 v[66:67], v90 offset:9024
    s_waitcnt lgkmcnt(8)
    v_mfma_f32_16x16x32_bf16 v[4:7], v[44:47], v[28:31], v[4:7]
    v_mfma_f32_16x16x32_bf16 v[8:11], v[44:47], v[32:35], v[8:11]
    v_mfma_f32_16x16x32_bf16 v[12:15], v[48:51], v[28:31], v[12:15]
    v_mfma_f32_16x16x32_bf16 v[16:19], v[48:51], v[32:35], v[16:19]
    v_mfma_f32_16x16x32_bf16 v[20:23], v[52:55], v[28:31], v[20:23]
    v_mfma_f32_16x16x32_bf16 v[24:27], v[52:55], v[32:35], v[24:27]
    ds_read_b128 v[28:31], v92 offset:0
    ds_read_b128 v[32:35], v92 offset:2048
    ds_read_b64_tr_b16 v[44:45], v94 offset:0
    ds_read_b64_tr_b16 v[46:47], v94 offset:1792
    ds_read_b64_tr_b16 v[48:49], v94 offset:32
    ds_read_b64_tr_b16 v[50:51], v94 offset:1824
    ds_read_b64_tr_b16 v[52:53], v94 offset:64
    ds_read_b64_tr_b16 v[54:55], v94 offset:1856
    s_waitcnt lgkmcnt(8)
    v_mfma_f32_16x16x32_bf16 v[4:7], v[56:59], v[36:39], v[4:7]
    v_mfma_f32_16x16x32_bf16 v[8:11], v[56:59], v[40:43], v[8:11]
    v_mfma_f32_16x16x32_bf16 v[12:15], v[60:63], v[36:39], v[12:15]
    v_mfma_f32_16x16x32_bf16 v[16:19], v[60:63], v[40:43], v[16:19]
    v_mfma_f32_16x16x32_bf16 v[20:23], v[64:67], v[36:39], v[20:23]
    v_mfma_f32_16x16x32_bf16 v[24:27], v[64:67], v[40:43], v[24:27]
    ds_read_b128 v[36:39], v93 offset:0
    ds_read_b128 v[40:43], v93 offset:2048
    ds_read_b64_tr_b16 v[56:57], v94 offset:7168
    ds_read_b64_tr_b16 v[58:59], v94 offset:8960
    ds_read_b64_tr_b16 v[60:61], v94 offset:7200
    ds_read_b64_tr_b16 v[62:63], v94 offset:8992
    ds_read_b64_tr_b16 v[64:65], v94 offset:7232
    ds_read_b64_tr_b16 v[66:67], v94 offset:9024
    s_waitcnt lgkmcnt(8)
    v_mfma_f32_16x16x32_bf16 v[4:7], v[44:47], v[28:31], v[4:7]
    v_mfma_f32_16x16x32_bf16 v[8:11], v[44:47], v[32:35], v[8:11]
    v_mfma_f32_16x16x32_bf16 v[12:15], v[48:51], v[28:31], v[12:15]
    v_mfma_f32_16x16x32_bf16 v[16:19], v[48:51], v[32:35], v[16:19]
    v_mfma_f32_16x16x32_bf16 v[20:23], v[52:55], v[28:31], v[20:23]
    v_mfma_f32_16x16x32_bf16 v[24:27], v[52:55], v[32:35], v[24:27]
    s_waitcnt lgkmcnt(0)
    v_mfma_f32_16x16x32_bf16 v[4:7], v[56:59], v[36:39], v[4:7]
    v_mfma_f32_16x16x32_bf16 v[8:11], v[56:59], v[40:43], v[8:11]
    v_mfma_f32_16x16x32_bf16 v[12:15], v[60:63], v[36:39], v[12:15]
    v_mfma_f32_16x16x32_bf16 v[16:19], v[60:63], v[40:43], v[16:19]
    v_mfma_f32_16x16x32_bf16 v[20:23], v[64:67], v[36:39], v[20:23]
    v_mfma_f32_16x16x32_bf16 v[24:27], v[64:67], v[40:43], v[24:27]
    s_waitcnt vmcnt(12)
    s_barrier
    ds_read_b128 v[28:31], v96 offset:0
    ds_read_b128 v[32:35], v96 offset:2048
    ds_read_b64_tr_b16 v[44:45], v98 offset:0
    ds_read_b64_tr_b16 v[46:47], v98 offset:1792
    ds_read_b64_tr_b16 v[48:49], v98 offset:32
    ds_read_b64_tr_b16 v[50:51], v98 offset:1824
    ds_read_b64_tr_b16 v[52:53], v98 offset:64
    ds_read_b64_tr_b16 v[54:55], v98 offset:1856
    ds_read_b128 v[36:39], v97 offset:0
    ds_read_b128 v[40:43], v97 offset:2048
    ds_read_b64_tr_b16 v[56:57], v98 offset:7168
    ds_read_b64_tr_b16 v[58:59], v98 offset:8960
    ds_read_b64_tr_b16 v[60:61], v98 offset:7200
    ds_read_b64_tr_b16 v[62:63], v98 offset:8992
    ds_read_b64_tr_b16 v[64:65], v98 offset:7232
    ds_read_b64_tr_b16 v[66:67], v98 offset:9024
    s_waitcnt lgkmcnt(8)
    v_mfma_f32_16x16x32_bf16 v[4:7], v[44:47], v[28:31], v[4:7]
    v_mfma_f32_16x16x32_bf16 v[8:11], v[44:47], v[32:35], v[8:11]
    v_mfma_f32_16x16x32_bf16 v[12:15], v[48:51], v[28:31], v[12:15]
    v_mfma_f32_16x16x32_bf16 v[16:19], v[48:51], v[32:35], v[16:19]
    v_mfma_f32_16x16x32_bf16 v[20:23], v[52:55], v[28:31], v[20:23]
    v_mfma_f32_16x16x32_bf16 v[24:27], v[52:55], v[32:35], v[24:27]
    ds_read_b128 v[28:31], v100 offset:0
    ds_read_b128 v[32:35], v100 offset:2048
    ds_read_b64_tr_b16 v[44:45], v102 offset:0
    ds_read_b64_tr_b16 v[46:47], v102 offset:1792
    ds_read_b64_tr_b16 v[48:49], v102 offset:32
    ds_read_b64_tr_b16 v[50:51], v102 offset:1824
    ds_read_b64_tr_b16 v[52:53], v102 offset:64
    ds_read_b64_tr_b16 v[54:55], v102 offset:1856
    s_waitcnt lgkmcnt(8)
    v_mfma_f32_16x16x32_bf16 v[4:7], v[56:59], v[36:39], v[4:7]
    v_mfma_f32_16x16x32_bf16 v[8:11], v[56:59], v[40:43], v[8:11]
    v_mfma_f32_16x16x32_bf16 v[12:15], v[60:63], v[36:39], v[12:15]
    v_mfma_f32_16x16x32_bf16 v[16:19], v[60:63], v[40:43], v[16:19]
    v_mfma_f32_16x16x32_bf16 v[20:23], v[64:67], v[36:39], v[20:23]
    v_mfma_f32_16x16x32_bf16 v[24:27], v[64:67], v[40:43], v[24:27]
    ds_read_b128 v[36:39], v101 offset:0
    ds_read_b128 v[40:43], v101 offset:2048
    ds_read_b64_tr_b16 v[56:57], v102 offset:7168
    ds_read_b64_tr_b16 v[58:59], v102 offset:8960
    ds_read_b64_tr_b16 v[60:61], v102 offset:7200
    ds_read_b64_tr_b16 v[62:63], v102 offset:8992
    ds_read_b64_tr_b16 v[64:65], v102 offset:7232
    ds_read_b64_tr_b16 v[66:67], v102 offset:9024
    s_waitcnt lgkmcnt(8)
    v_mfma_f32_16x16x32_bf16 v[4:7], v[44:47], v[28:31], v[4:7]
    v_mfma_f32_16x16x32_bf16 v[8:11], v[44:47], v[32:35], v[8:11]
    v_mfma_f32_16x16x32_bf16 v[12:15], v[48:51], v[28:31], v[12:15]
    v_mfma_f32_16x16x32_bf16 v[16:19], v[48:51], v[32:35], v[16:19]
    v_mfma_f32_16x16x32_bf16 v[20:23], v[52:55], v[28:31], v[20:23]
    v_mfma_f32_16x16x32_bf16 v[24:27], v[52:55], v[32:35], v[24:27]
    s_waitcnt lgkmcnt(0)
    v_mfma_f32_16x16x32_bf16 v[4:7], v[56:59], v[36:39], v[4:7]
    v_mfma_f32_16x16x32_bf16 v[8:11], v[56:59], v[40:43], v[8:11]
    v_mfma_f32_16x16x32_bf16 v[12:15], v[60:63], v[36:39], v[12:15]
    v_mfma_f32_16x16x32_bf16 v[16:19], v[60:63], v[40:43], v[16:19]
    v_mfma_f32_16x16x32_bf16 v[20:23], v[64:67], v[36:39], v[20:23]
    v_mfma_f32_16x16x32_bf16 v[24:27], v[64:67], v[40:43], v[24:27]
    s_waitcnt vmcnt(0)
    s_barrier
    ds_read_b128 v[28:31], v104 offset:0
    ds_read_b128 v[32:35], v104 offset:2048
    ds_read_b64_tr_b16 v[44:45], v106 offset:0
    ds_read_b64_tr_b16 v[46:47], v106 offset:1792
    ds_read_b64_tr_b16 v[48:49], v106 offset:32
    ds_read_b64_tr_b16 v[50:51], v106 offset:1824
    ds_read_b64_tr_b16 v[52:53], v106 offset:64
    ds_read_b64_tr_b16 v[54:55], v106 offset:1856
    ds_read_b128 v[36:39], v105 offset:0
    ds_read_b128 v[40:43], v105 offset:2048
    ds_read_b64_tr_b16 v[56:57], v106 offset:7168
    ds_read_b64_tr_b16 v[58:59], v106 offset:8960
    ds_read_b64_tr_b16 v[60:61], v106 offset:7200
    ds_read_b64_tr_b16 v[62:63], v106 offset:8992
    ds_read_b64_tr_b16 v[64:65], v106 offset:7232
    ds_read_b64_tr_b16 v[66:67], v106 offset:9024
    s_waitcnt lgkmcnt(8)
    v_mfma_f32_16x16x32_bf16 v[4:7], v[44:47], v[28:31], v[4:7]
    v_mfma_f32_16x16x32_bf16 v[8:11], v[44:47], v[32:35], v[8:11]
    v_mfma_f32_16x16x32_bf16 v[12:15], v[48:51], v[28:31], v[12:15]
    v_mfma_f32_16x16x32_bf16 v[16:19], v[48:51], v[32:35], v[16:19]
    v_mfma_f32_16x16x32_bf16 v[20:23], v[52:55], v[28:31], v[20:23]
    v_mfma_f32_16x16x32_bf16 v[24:27], v[52:55], v[32:35], v[24:27]
    ds_read_b128 v[28:31], v108 offset:0
    ds_read_b128 v[32:35], v108 offset:2048
    ds_read_b64_tr_b16 v[44:45], v110 offset:0
    ds_read_b64_tr_b16 v[46:47], v110 offset:1792
    ds_read_b64_tr_b16 v[48:49], v110 offset:32
    ds_read_b64_tr_b16 v[50:51], v110 offset:1824
    ds_read_b64_tr_b16 v[52:53], v110 offset:64
    ds_read_b64_tr_b16 v[54:55], v110 offset:1856
    s_waitcnt lgkmcnt(8)
    v_mfma_f32_16x16x32_bf16 v[4:7], v[56:59], v[36:39], v[4:7]
    v_mfma_f32_16x16x32_bf16 v[8:11], v[56:59], v[40:43], v[8:11]
    v_mfma_f32_16x16x32_bf16 v[12:15], v[60:63], v[36:39], v[12:15]
    v_mfma_f32_16x16x32_bf16 v[16:19], v[60:63], v[40:43], v[16:19]
    v_mfma_f32_16x16x32_bf16 v[20:23], v[64:67], v[36:39], v[20:23]
    v_mfma_f32_16x16x32_bf16 v[24:27], v[64:67], v[40:43], v[24:27]
    ds_read_b128 v[36:39], v109 offset:0
    ds_read_b128 v[40:43], v109 offset:2048
    ds_read_b64_tr_b16 v[56:57], v110 offset:7168
    ds_read_b64_tr_b16 v[58:59], v110 offset:8960
    ds_read_b64_tr_b16 v[60:61], v110 offset:7200
    ds_read_b64_tr_b16 v[62:63], v110 offset:8992
    ds_read_b64_tr_b16 v[64:65], v110 offset:7232
    ds_read_b64_tr_b16 v[66:67], v110 offset:9024
    s_waitcnt lgkmcnt(8)
    v_mfma_f32_16x16x32_bf16 v[4:7], v[44:47], v[28:31], v[4:7]
    v_mfma_f32_16x16x32_bf16 v[8:11], v[44:47], v[32:35], v[8:11]
    v_mfma_f32_16x16x32_bf16 v[12:15], v[48:51], v[28:31], v[12:15]
    v_mfma_f32_16x16x32_bf16 v[16:19], v[48:51], v[32:35], v[16:19]
    v_mfma_f32_16x16x32_bf16 v[20:23], v[52:55], v[28:31], v[20:23]
    v_mfma_f32_16x16x32_bf16 v[24:27], v[52:55], v[32:35], v[24:27]
    s_waitcnt lgkmcnt(0)
    v_mfma_f32_16x16x32_bf16 v[4:7], v[56:59], v[36:39], v[4:7]
    v_mfma_f32_16x16x32_bf16 v[8:11], v[56:59], v[40:43], v[8:11]
    v_mfma_f32_16x16x32_bf16 v[12:15], v[60:63], v[36:39], v[12:15]
    v_mfma_f32_16x16x32_bf16 v[16:19], v[60:63], v[40:43], v[16:19]
    v_mfma_f32_16x16x32_bf16 v[20:23], v[64:67], v[36:39], v[20:23]
    v_mfma_f32_16x16x32_bf16 v[24:27], v[64:67], v[40:43], v[24:27]
    v_and_b32 v76, 15, v1
    v_lshrrev_b32 v77, 4, v1
    s_mul_i32 s40, s41, 32
    v_add_u32 v76, s40, v76
    s_mul_i32 s40, s42, 48
    v_lshl_add_u32 v77, v77, 2, s40
    s_mov_b32 s40, 1536
    v_mul_lo_u32 v78, s40, v76
    v_lshl_add_u32 v78, v77, 1, v78
    s_mul_i32 s46, s32, 64
    s_lshr_b32 s46, s46, 10
    s_mul_i32 s46, s46, 18432
    s_mul_i32 s40, s33, 384
    s_add_u32 s46, s46, s40
    s_add_u32 s46, s46, 6144
    s_mov_b32 s48, s26
    s_mov_b32 s49, s27
    s_mov_b32 s50, 36864
    s_mov_b32 s51, 0x00020000
    s_add_u32 s52, s28, s39
    s_addc_u32 s53, s29, 0
    s_mov_b32 s54, 96960
    s_mov_b32 s55, 0x00020000
    v_lshlrev_b32 v79, 2, v77
    s_nop 7
    s_nop 7
    buffer_load_dwordx4 v[28:31], v79, s[48:51], s46 offen offset:0
    buffer_load_dwordx2 v[32:33], v78, s[52:55], 0 offen offset:0
    v_add_u32 v80, 24576, v78
    buffer_load_dwordx2 v[34:35], v80, s[52:55], 0 offen
    s_waitcnt vmcnt(0)
    v_lshlrev_b32 v86, 16, v32
    v_fma_f32 v4, v4, v28, v86
    v_and_b32 v86, 0xffff0000, v32
    v_fma_f32 v5, v5, v29, v86
    v_lshlrev_b32 v86, 16, v33
    v_fma_f32 v6, v6, v30, v86
    v_and_b32 v86, 0xffff0000, v33
    v_fma_f32 v7, v7, v31, v86
    v_cvt_pk_bf16_f32 v4, v4, v5
    v_cvt_pk_bf16_f32 v5, v6, v7
    buffer_store_dwordx2 v[4:5], v78, s[16:19], 0 offen offset:0
    v_lshlrev_b32 v86, 16, v34
    v_fma_f32 v8, v8, v28, v86
    v_and_b32 v86, 0xffff0000, v34
    v_fma_f32 v9, v9, v29, v86
    v_lshlrev_b32 v86, 16, v35
    v_fma_f32 v10, v10, v30, v86
    v_and_b32 v86, 0xffff0000, v35
    v_fma_f32 v11, v11, v31, v86
    v_cvt_pk_bf16_f32 v8, v8, v9
    v_cvt_pk_bf16_f32 v9, v10, v11
    v_add_u32 v80, 24576, v78
    buffer_store_dwordx2 v[8:9], v80, s[16:19], 0 offen
    buffer_load_dwordx4 v[28:31], v79, s[48:51], s46 offen offset:64
    buffer_load_dwordx2 v[32:33], v78, s[52:55], 0 offen offset:32
    v_add_u32 v80, 24608, v78
    buffer_load_dwordx2 v[34:35], v80, s[52:55], 0 offen
    s_waitcnt vmcnt(0)
    v_lshlrev_b32 v86, 16, v32
    v_fma_f32 v12, v12, v28, v86
    v_and_b32 v86, 0xffff0000, v32
    v_fma_f32 v13, v13, v29, v86
    v_lshlrev_b32 v86, 16, v33
    v_fma_f32 v14, v14, v30, v86
    v_and_b32 v86, 0xffff0000, v33
    v_fma_f32 v15, v15, v31, v86
    v_cvt_pk_bf16_f32 v12, v12, v13
    v_cvt_pk_bf16_f32 v13, v14, v15
    buffer_store_dwordx2 v[12:13], v78, s[16:19], 0 offen offset:32
    v_lshlrev_b32 v86, 16, v34
    v_fma_f32 v16, v16, v28, v86
    v_and_b32 v86, 0xffff0000, v34
    v_fma_f32 v17, v17, v29, v86
    v_lshlrev_b32 v86, 16, v35
    v_fma_f32 v18, v18, v30, v86
    v_and_b32 v86, 0xffff0000, v35
    v_fma_f32 v19, v19, v31, v86
    v_cvt_pk_bf16_f32 v16, v16, v17
    v_cvt_pk_bf16_f32 v17, v18, v19
    v_add_u32 v80, 24608, v78
    buffer_store_dwordx2 v[16:17], v80, s[16:19], 0 offen
    buffer_load_dwordx4 v[28:31], v79, s[48:51], s46 offen offset:128
    buffer_load_dwordx2 v[32:33], v78, s[52:55], 0 offen offset:64
    v_add_u32 v80, 24640, v78
    buffer_load_dwordx2 v[34:35], v80, s[52:55], 0 offen
    s_waitcnt vmcnt(0)
    v_lshlrev_b32 v86, 16, v32
    v_fma_f32 v20, v20, v28, v86
    v_and_b32 v86, 0xffff0000, v32
    v_fma_f32 v21, v21, v29, v86
    v_lshlrev_b32 v86, 16, v33
    v_fma_f32 v22, v22, v30, v86
    v_and_b32 v86, 0xffff0000, v33
    v_fma_f32 v23, v23, v31, v86
    v_cvt_pk_bf16_f32 v20, v20, v21
    v_cvt_pk_bf16_f32 v21, v22, v23
    buffer_store_dwordx2 v[20:21], v78, s[16:19], 0 offen offset:64
    v_lshlrev_b32 v86, 16, v34
    v_fma_f32 v24, v24, v28, v86
    v_and_b32 v86, 0xffff0000, v34
    v_fma_f32 v25, v25, v29, v86
    v_lshlrev_b32 v86, 16, v35
    v_fma_f32 v26, v26, v30, v86
    v_and_b32 v86, 0xffff0000, v35
    v_fma_f32 v27, v27, v31, v86
    v_cvt_pk_bf16_f32 v24, v24, v25
    v_cvt_pk_bf16_f32 v25, v26, v27
    v_add_u32 v80, 24640, v78
    buffer_store_dwordx2 v[24:25], v80, s[16:19], 0 offen
wo_kernel_end:
    s_endpgm
.text
.globl ln2_kernel
.p2align 8
.type ln2_kernel,@function
ln2_kernel:
    s_cmp_ge_u32 s2, 512
    s_cbranch_scc1 ln2_kernel_end
    s_load_dwordx2 s[20:21], s[0:1], 72
    s_load_dwordx2 s[24:25], s[0:1], 72
    s_waitcnt lgkmcnt(0)
    s_add_u32 s8, s20, 37748736
    s_addc_u32 s9, s21, 0
    s_mov_b32 s10, 3145728
    s_mov_b32 s11, 0x00020000
    s_mov_b32 s12, s24
    s_mov_b32 s13, s25
    s_mov_b32 s14, 36864
    s_mov_b32 s15, 0x00020000
    s_add_u32 s16, s24, 41943040
    s_addc_u32 s17, s25, 0
    s_mov_b32 s18, 3145728
    s_mov_b32 s19, 0x00020000
    v_lshrrev_b32 v2, 6, v0
    s_lshl_b32 s30, s2, 2
    v_add_u32 v2, s30, v2
    v_and_b32 v1, 63, v0
    s_movk_i32 s31, 1536
    v_mul_lo_u32 v3, s31, v2
    v_lshl_add_u32 v3, v1, 3, v3
    buffer_load_dwordx2 v[4:5], v3, s[8:11], 0 offen offset:0
    buffer_load_dwordx2 v[6:7], v3, s[8:11], 0 offen offset:512
    buffer_load_dwordx2 v[8:9], v3, s[8:11], 0 offen offset:1024
    v_lshrrev_b32 v10, 10, v2
    v_mul_u32_u24 v10, 18432, v10
    v_lshl_add_u32 v10, v1, 4, v10
    v_add_u32 v11, 9216, v10
    buffer_load_dwordx4 v[40:43], v11, s[12:15], 0 offen offset:0
    buffer_load_dwordx4 v[44:47], v11, s[12:15], 0 offen offset:1024
    buffer_load_dwordx4 v[48:51], v11, s[12:15], 0 offen offset:2048
    v_add_u32 v11, 12288, v10
    buffer_load_dwordx4 v[56:59], v11, s[12:15], 0 offen offset:0
    buffer_load_dwordx4 v[60:63], v11, s[12:15], 0 offen offset:1024
    buffer_load_dwordx4 v[64:67], v11, s[12:15], 0 offen offset:2048
    s_waitcnt vmcnt(6)
    v_lshlrev_b32 v20, 16, v4
    v_and_b32 v21, 0xffff0000, v4
    v_lshlrev_b32 v22, 16, v5
    v_and_b32 v23, 0xffff0000, v5
    v_lshlrev_b32 v24, 16, v6
    v_and_b32 v25, 0xffff0000, v6
    v_lshlrev_b32 v26, 16, v7
    v_and_b32 v27, 0xffff0000, v7
    v_lshlrev_b32 v28, 16, v8
    v_and_b32 v29, 0xffff0000, v8
    v_lshlrev_b32 v30, 16, v9
    v_and_b32 v31, 0xffff0000, v9
    v_add_f32 v12, v20, v21
    v_add_f32 v12, v12, v22
    v_add_f32 v12, v12, v23
    v_add_f32 v12, v12, v24
    v_add_f32 v12, v12, v25
    v_add_f32 v12, v12, v26
    v_add_f32 v12, v12, v27
    v_add_f32 v12, v12, v28
    v_add_f32 v12, v12, v29
    v_add_f32 v12, v12, v30
    v_add_f32 v12, v12, v31
    ds_swizzle_b32 v13, v12 offset:0x41f
    s_waitcnt lgkmcnt(0)
    v_add_f32 v12, v12, v13
    ds_swizzle_b32 v13, v12 offset:0x81f
    s_waitcnt lgkmcnt(0)
    v_add_f32 v12, v12, v13
    ds_swizzle_b32 v13, v12 offset:0x101f
    s_waitcnt lgkmcnt(0)
    v_add_f32 v12, v12, v13
    ds_swizzle_b32 v13, v12 offset:0x201f
    s_waitcnt lgkmcnt(0)
    v_add_f32 v12, v12, v13
    ds_swizzle_b32 v13, v12 offset:0x401f
    s_waitcnt lgkmcnt(0)
    v_add_f32 v12, v12, v13
    s_nop 0
    v_readlane_b32 s58, v12, 32
    v_readlane_b32 s59, v12, 0
    s_nop 1
    v_mov_b32 v12, s58
    v_add_f32 v12, s59, v12
    v_mul_f32 v12, 0x3aaaaaab, v12
    v_sub_f32 v20, v20, v12
    v_sub_f32 v21, v21, v12
    v_sub_f32 v22, v22, v12
    v_sub_f32 v23, v23, v12
    v_sub_f32 v24, v24, v12
    v_sub_f32 v25, v25, v12
    v_sub_f32 v26, v26, v12
    v_sub_f32 v27, v27, v12
    v_sub_f32 v28, v28, v12
    v_sub_f32 v29, v29, v12
    v_sub_f32 v30, v30, v12
    v_sub_f32 v31, v31, v12
    v_mul_f32 v14, v20, v20
    v_fmac_f32 v14, v21, v21
    v_fmac_f32 v14, v22, v22
    v_fmac_f32 v14, v23, v23
    v_fmac_f32 v14, v24, v24
    v_fmac_f32 v14, v25, v25
    v_fmac_f32 v14, v26, v26
    v_fmac_f32 v14, v27, v27
    v_fmac_f32 v14, v28, v28
    v_fmac_f32 v14, v29, v29
    v_fmac_f32 v14, v30, v30
    v_fmac_f32 v14, v31, v31
    ds_swizzle_b32 v13, v14 offset:0x41f
    s_waitcnt lgkmcnt(0)
    v_add_f32 v14, v14, v13
    ds_swizzle_b32 v13, v14 offset:0x81f
    s_waitcnt lgkmcnt(0)
    v_add_f32 v14, v14, v13
    ds_swizzle_b32 v13, v14 offset:0x101f
    s_waitcnt lgkmcnt(0)
    v_add_f32 v14, v14, v13
    ds_swizzle_b32 v13, v14 offset:0x201f
    s_waitcnt lgkmcnt(0)
    v_add_f32 v14, v14, v13
    ds_swizzle_b32 v13, v14 offset:0x401f
    s_waitcnt lgkmcnt(0)
    v_add_f32 v14, v14, v13
    s_nop 0
    v_readlane_b32 s58, v14, 32
    v_readlane_b32 s59, v14, 0
    s_nop 1
    v_mov_b32 v14, s58
    v_add_f32 v14, s59, v14
    v_mov_b32 v15, 0x3727c5ac
    v_fmac_f32 v15, 0x3aaaaaab, v14
    v_rsq_f32 v15, v15
    s_waitcnt vmcnt(0)
    v_mul_f32 v20, v20, v15
    v_add_f32 v13, 1.0, v56
    v_fma_f32 v20, v20, v13, v40
    v_mul_f32 v21, v21, v15
    v_add_f32 v13, 1.0, v57
    v_fma_f32 v21, v21, v13, v41
    v_mul_f32 v22, v22, v15
    v_add_f32 v13, 1.0, v58
    v_fma_f32 v22, v22, v13, v42
    v_mul_f32 v23, v23, v15
    v_add_f32 v13, 1.0, v59
    v_fma_f32 v23, v23, v13, v43
    v_mul_f32 v24, v24, v15
    v_add_f32 v13, 1.0, v60
    v_fma_f32 v24, v24, v13, v44
    v_mul_f32 v25, v25, v15
    v_add_f32 v13, 1.0, v61
    v_fma_f32 v25, v25, v13, v45
    v_mul_f32 v26, v26, v15
    v_add_f32 v13, 1.0, v62
    v_fma_f32 v26, v26, v13, v46
    v_mul_f32 v27, v27, v15
    v_add_f32 v13, 1.0, v63
    v_fma_f32 v27, v27, v13, v47
    v_mul_f32 v28, v28, v15
    v_add_f32 v13, 1.0, v64
    v_fma_f32 v28, v28, v13, v48
    v_mul_f32 v29, v29, v15
    v_add_f32 v13, 1.0, v65
    v_fma_f32 v29, v29, v13, v49
    v_mul_f32 v30, v30, v15
    v_add_f32 v13, 1.0, v66
    v_fma_f32 v30, v30, v13, v50
    v_mul_f32 v31, v31, v15
    v_add_f32 v13, 1.0, v67
    v_fma_f32 v31, v31, v13, v51
    v_cvt_pk_bf16_f32 v4, v20, v21
    v_cvt_pk_bf16_f32 v5, v22, v23
    v_cvt_pk_bf16_f32 v6, v24, v25
    v_cvt_pk_bf16_f32 v7, v26, v27
    v_cvt_pk_bf16_f32 v8, v28, v29
    v_cvt_pk_bf16_f32 v9, v30, v31
    buffer_store_dwordx2 v[4:5], v3, s[16:19], 0 offen offset:0
    buffer_store_dwordx2 v[6:7], v3, s[16:19], 0 offen offset:512
    buffer_store_dwordx2 v[8:9], v3, s[16:19], 0 offen offset:1024
ln2_kernel_end:
    s_endpgm
.text
.globl fc1_kernel
.p2align 8
.type fc1_kernel,@function
fc1_kernel:
    s_cmp_ge_u32 s2, 256
    s_cbranch_scc1 fc1_kernel_end
    s_load_dwordx2 s[20:21], s[0:1], 72
    s_load_dwordx2 s[22:23], s[0:1], 40
    s_load_dwordx2 s[24:25], s[0:1], 72
    s_load_dwordx2 s[26:27], s[0:1], 72
    s_load_dwordx2 s[28:29], s[0:1], 0
    s_and_b32 s40, s2, 7
    s_mul_i32 s40, s40, 32
    s_lshr_b32 s2, s2, 3
    s_add_u32 s2, s2, s40
    s_lshr_b32 s30, s2, 8
    s_mul_i32 s31, s30, 256
    s_sub_u32 s31, s2, s31
    s_lshr_b32 s32, s31, 4
    s_mul_i32 s33, s32, 16
    s_sub_u32 s33, s31, s33
    s_lshr_b32 s34, s30, 1
    s_and_b32 s35, s30, 1
    v_lshrrev_b32 v221, 6, v0
    s_nop 0
    v_readfirstlane_b32 s36, v221
    v_and_b32 v1, 63, v0
    s_mul_i32 s37, s34, 0
    s_mul_i32 s40, s35, 0
    s_add_u32 s37, s37, s40
    s_mul_i32 s40, s32, 196608
    s_add_u32 s37, s37, s40
    s_mul_i32 s38, s34, 0
    s_mul_i32 s40, s35, 0
    s_add_u32 s38, s38, s40
    s_mul_i32 s40, s33, 384
    s_add_u32 s38, s38, s40
    s_mul_i32 s39, s34, 0
    s_mul_i32 s40, s35, 0
    s_add_u32 s39, s39, s40
    s_mul_i32 s40, s32, 786432
    s_add_u32 s39, s39, s40
    s_mul_i32 s40, s33, 384
    s_add_u32 s39, s39, s40
    s_waitcnt lgkmcnt(0)
    s_add_u32 s8, s20, 41943040
    s_addc_u32 s9, s21, 0
    s_add_u32 s8, s8, s37
    s_addc_u32 s9, s9, 0
    s_mov_b32 s11, 0x00020000
    s_add_u32 s12, s22, 0
    s_addc_u32 s13, s23, 0
    s_add_u32 s12, s12, s38
    s_addc_u32 s13, s13, 0
    s_mov_b32 s15, 0x00020000
    s_add_u32 s16, s24, 46137344
    s_addc_u32 s17, s25, 0
    s_add_u32 s16, s16, s39
    s_addc_u32 s17, s17, 0
    s_mov_b32 s19, 0x00020000
    s_mov_b32 s10, 196608
    s_mov_b32 s14, 4712832
    s_mov_b32 s18, 780672
    s_lshl_b32 s40, s36, 6
    v_add_u32 v193, s40, v1
    v_add_u32 v193, 0, v193
    v_lshrrev_b32 v194, 3, v193
    v_and_b32 v195, 7, v193
    v_and_b32 v196, 7, v194
    v_xor_b32 v195, v195, v196
    s_mov_b32 s40, 1536
    v_mul_lo_u32 v194, s40, v194
    v_lshl_add_u32 v180, v195, 4, v194
    s_lshl_b32 s40, s36, 6
    v_add_u32 v193, s40, v1
    v_add_u32 v193, 256, v193
    v_lshrrev_b32 v194, 3, v193
    v_and_b32 v195, 7, v193
    v_and_b32 v196, 7, v194
    v_xor_b32 v195, v195, v196
    s_mov_b32 s40, 1536
    v_mul_lo_u32 v194, s40, v194
    v_lshl_add_u32 v181, v195, 4, v194
    s_lshl_b32 s40, s36, 6
    v_add_u32 v193, s40, v1
    v_add_u32 v193, 512, v193
    v_lshrrev_b32 v194, 3, v193
    v_and_b32 v195, 7, v193
    v_and_b32 v196, 7, v194
    v_xor_b32 v195, v195, v196
    s_mov_b32 s40, 1536
    v_mul_lo_u32 v194, s40, v194
    v_lshl_add_u32 v182, v195, 4, v194
    s_lshl_b32 s40, s36, 6
    v_add_u32 v193, s40, v1
    v_add_u32 v193, 768, v193
    v_lshrrev_b32 v194, 3, v193
    v_and_b32 v195, 7, v193
    v_and_b32 v196, 7, v194
    v_xor_b32 v195, v195, v196
    s_mov_b32 s40, 1536
    v_mul_lo_u32 v194, s40, v194
    v_lshl_add_u32 v183, v195, 4, v194
    s_lshl_b32 s40, s36, 6
    v_add_u32 v193, s40, v1
    v_add_u32 v193, 0, v193
    s_mov_b32 s40, 165191050
    v_mul_hi_u32 v194, s40, v193
    v_mul_u32_u24 v195, 26, v194
    v_sub_u32 v195, v193, v195
    v_cmp_gt_u32 vcc, 24, v195
    s_nop 1
    v_cndmask_b32 v195, 0, v195, vcc
    v_min_u32 v194, 63, v194
    v_and_b32 v196, 0xfffffff3, v194
    v_lshlrev_b32 v197, 1, v194
    v_and_b32 v197, 8, v197
    v_or_b32 v196, v196, v197
    v_lshrrev_b32 v197, 1, v194
    v_and_b32 v197, 4, v197
    v_or_b32 v196, v196, v197
    s_mov_b32 s40, 6144
    v_mul_lo_u32 v196, s40, v196
    v_lshl_add_u32 v184, v195, 4, v196
    s_lshl_b32 s40, s36, 6
    v_add_u32 v193, s40, v1
    v_add_u32 v193, 256, v193
    s_mov_b32 s40, 165191050
    v_mul_hi_u32 v194, s40, v193
    v_mul_u32_u24 v195, 26, v194
    v_sub_u32 v195, v193, v195
    v_cmp_gt_u32 vcc, 24, v195
    s_nop 1
    v_cndmask_b32 v195, 0, v195, vcc
    v_min_u32 v194, 63, v194
    v_and_b32 v196, 0xfffffff3, v194
    v_lshlrev_b32 v197, 1, v194
    v_and_b32 v197, 8, v197
    v_or_b32 v196, v196, v197
    v_lshrrev_b32 v197, 1, v194
    v_and_b32 v197, 4, v197
    v_or_b32 v196, v196, v197
    s_mov_b32 s40, 6144
    v_mul_lo_u32 v196, s40, v196
    v_lshl_add_u32 v185, v195, 4, v196
    s_lshl_b32 s40, s36, 6
    v_add_u32 v193, s40, v1
    v_add_u32 v193, 512, v193
    s_mov_b32 s40, 165191050
    v_mul_hi_u32 v194, s40, v193
    v_mul_u32_u24 v195, 26, v194
    v_sub_u32 v195, v193, v195
    v_cmp_gt_u32 vcc, 24, v195
    s_nop 1
    v_cndmask_b32 v195, 0, v195, vcc
    v_min_u32 v194, 63, v194
    v_and_b32 v196, 0xfffffff3, v194
    v_lshlrev_b32 v197, 1, v194
    v_and_b32 v197, 8, v197
    v_or_b32 v196, v196, v197
    v_lshrrev_b32 v197, 1, v194
    v_and_b32 v197, 4, v197
    v_or_b32 v196, v196, v197
    s_mov_b32 s40, 6144
    v_mul_lo_u32 v196, s40, v196
    v_lshl_add_u32 v186, v195, 4, v196
    s_lshl_b32 s40, s36, 6
    v_add_u32 v193, s40, v1
    v_add_u32 v193, 768, v193
    s_mov_b32 s40, 165191050
    v_mul_hi_u32 v194, s40, v193
    v_mul_u32_u24 v195, 26, v194
    v_sub_u32 v195, v193, v195
    v_cmp_gt_u32 vcc, 24, v195
    s_nop 1
    v_cndmask_b32 v195, 0, v195, vcc
    v_min_u32 v194, 63, v194
    v_and_b32 v196, 0xfffffff3, v194
    v_lshlrev_b32 v197, 1, v194
    v_and_b32 v197, 8, v197
    v_or_b32 v196, v196, v197
    v_lshrrev_b32 v197, 1, v194
    v_and_b32 v197, 4, v197
    v_or_b32 v196, v196, v197
    s_mov_b32 s40, 6144
    v_mul_lo_u32 v196, s40, v196
    v_lshl_add_u32 v187, v195, 4, v196
    s_lshl_b32 s40, s36, 6
    v_add_u32 v193, s40, v1
    v_add_u32 v193, 1024, v193
    s_mov_b32 s40, 165191050
    v_mul_hi_u32 v194, s40, v193
    v_mul_u32_u24 v195, 26, v194
    v_sub_u32 v195, v193, v195
    v_cmp_gt_u32 vcc, 24, v195
    s_nop 1
    v_cndmask_b32 v195, 0, v195, vcc
    v_min_u32 v194, 63, v194
    v_and_b32 v196, 0xfffffff3, v194
    v_lshlrev_b32 v197, 1, v194
    v_and_b32 v197, 8, v197
    v_or_b32 v196, v196, v197
    v_lshrrev_b32 v197, 1, v194
    v_and_b32 v197, 4, v197
    v_or_b32 v196, v196, v197
    s_mov_b32 s40, 6144
    v_mul_lo_u32 v196, s40, v196
    v_lshl_add_u32 v188, v195, 4, v196
    s_lshl_b32 s40, s36, 6
    v_add_u32 v193, s40, v1
    v_add_u32 v193, 1280, v193
    s_mov_b32 s40, 165191050
    v_mul_hi_u32 v194, s40, v193
    v_mul_u32_u24 v195, 26, v194
    v_sub_u32 v195, v193, v195
    v_cmp_gt_u32 vcc, 24, v195
    s_nop 1
    v_cndmask_b32 v195, 0, v195, vcc
    v_min_u32 v194, 63, v194
    v_and_b32 v196, 0xfffffff3, v194
    v_lshlrev_b32 v197, 1, v194
    v_and_b32 v197, 8, v197
    v_or_b32 v196, v196, v197
    v_lshrrev_b32 v197, 1, v194
    v_and_b32 v197, 4, v197
    v_or_b32 v196, v196, v197
    s_mov_b32 s40, 6144
    v_mul_lo_u32 v196, s40, v196
    v_lshl_add_u32 v189, v195, 4, v196
    s_lshl_b32 s40, s36, 6
    v_add_u32 v193, s40, v1
    v_add_u32 v193, 1536, v193
    s_mov_b32 s40, 165191050
    v_mul_hi_u32 v194, s40, v193
    v_mul_u32_u24 v195, 26, v194
    v_sub_u32 v195, v193, v195
    v_cmp_gt_u32 vcc, 24, v195
    s_nop 1
    v_cndmask_b32 v195, 0, v195, vcc
    v_min_u32 v194, 63, v194
    v_and_b32 v196, 0xfffffff3, v194
    v_lshlrev_b32 v197, 1, v194
    v_and_b32 v197, 8, v197
    v_or_b32 v196, v196, v197
    v_lshrrev_b32 v197, 1, v194
    v_and_b32 v197, 4, v197
    v_or_b32 v196, v196, v197
    s_mov_b32 s40, 6144
    v_mul_lo_u32 v196, s40, v196
    v_lshl_add_u32 v190, v195, 4, v196
    s_lshr_b32 s41, s36, 1
    s_mul_i32 s42, s41, 2
    s_sub_u32 s42, s36, s42
    v_and_b32 v193, 15, v1
    v_lshrrev_b32 v194, 4, v1
    s_mul_i32 s40, s41, 64
    v_add_u32 v195, s40, v193
    v_and_b32 v196, 7, v195
    v_xor_b32 v196, v196, v194
    v_lshlrev_b32 v195, 7, v195
    v_lshl_add_u32 v191, v196, 4, v195
    v_lshrrev_b32 v195, 2, v1
    v_and_b32 v195, 3, v195
    v_and_b32 v196, 1, v194
    v_lshl_add_u32 v195, v196, 2, v195
    v_lshrrev_b32 v196, 1, v194
    v_lshl_add_u32 v195, v196, 4, v195
    v_mul_u32_u24 v195, 416, v195
    v_and_b32 v196, 3, v1
    v_lshl_add_u32 v195, v196, 3, v195
    s_mul_i32 s40, s42, 192
    v_add_u32 v192, s40, v195
    v_add_u32 v192, 16384, v192
    s_lshl_b32 s43, s36, 10
    s_mov_b32 s44, 0
    s_mov_b32 s45, 0
    v_xor_b32 v201, 64, v191
    v_xor_b32 v202, 64, v192
    v_add_u32 v205, 0, v191
    v_add_u32 v206, 0, v201
    v_add_u32 v207, 0, v192
    v_add_u32 v208, 0, v202
    v_add_u32 v209, 45056, v191
    v_add_u32 v210, 45056, v201
    v_add_u32 v211, 45056, v192
    v_add_u32 v212, 45056, v202
    v_add_u32 v213, 90112, v191
    v_add_u32 v214, 90112, v201
    v_add_u32 v215, 90112, v192
    v_add_u32 v216, 90112, v202
    s_add_u32 m0, s43, 0
    s_nop 0
    buffer_load_dwordx4 v180, s[8:11], s44 offen lds
    s_add_u32 m0, s43, 4096
    s_nop 0
    buffer_load_dwordx4 v181, s[8:11], s44 offen lds
    s_add_u32 m0, s43, 8192
    s_nop 0
    buffer_load_dwordx4 v182, s[8:11], s44 offen lds
    s_add_u32 m0, s43, 12288
    s_nop 0
    buffer_load_dwordx4 v183, s[8:11], s44 offen lds
    s_add_u32 m0, s43, 16384
    s_nop 0
    buffer_load_dwordx4 v184, s[12:15], s45 offen lds
    s_add_u32 m0, s43, 20480
    s_nop 0
    buffer_load_dwordx4 v185, s[12:15], s45 offen lds
    s_add_u32 m0, s43, 24576
    s_nop 0
    buffer_load_dwordx4 v186, s[12:15], s45 offen lds
    s_add_u32 m0, s43, 28672
    s_nop 0
    buffer_load_dwordx4 v187, s[12:15], s45 offen lds
    s_add_u32 m0, s43, 32768
    s_nop 0
    buffer_load_dwordx4 v188, s[12:15], s45 offen lds
    s_add_u32 m0, s43, 36864
    s_nop 0
    buffer_load_dwordx4 v189, s[12:15], s45 offen lds
    s_add_u32 m0, s43, 40960
    s_nop 0
    buffer_load_dwordx4 v190, s[12:15], s45 offen lds
    s_add_u32 s44, s44, 128
    s_add_u32 s45, s45, 393216
    s_add_u32 m0, s43, 45056
    s_nop 0
    buffer_load_dwordx4 v180, s[8:11], s44 offen lds
    s_add_u32 m0, s43, 49152
    s_nop 0
    buffer_load_dwordx4 v181, s[8:11], s44 offen lds
    s_add_u32 m0, s43, 53248
    s_nop 0
    buffer_load_dwordx4 v182, s[8:11], s44 offen lds
    s_add_u32 m0, s43, 57344
    s_nop 0
    buffer_load_dwordx4 v183, s[8:11], s44 offen lds
    s_add_u32 m0, s43, 61440
    s_nop 0
    buffer_load_dwordx4 v184, s[12:15], s45 offen lds
    s_add_u32 m0, s43, 65536
    s_nop 0
    buffer_load_dwordx4 v185, s[12:15], s45 offen lds
    s_add_u32 m0, s43, 69632
    s_nop 0
    buffer_load_dwordx4 v186, s[12:15], s45 offen lds
    s_add_u32 m0, s43, 73728
    s_nop 0
    buffer_load_dwordx4 v187, s[12:15], s45 offen lds
    s_add_u32 m0, s43, 77824
    s_nop 0
    buffer_load_dwordx4 v188, s[12:15], s45 offen lds
    s_add_u32 m0, s43, 81920
    s_nop 0
    buffer_load_dwordx4 v189, s[12:15], s45 offen lds
    s_add_u32 m0, s43, 86016
    s_nop 0
    buffer_load_dwordx4 v190, s[12:15], s45 offen lds
    s_add_u32 s44, s44, 128
    s_add_u32 s45, s45, 393216
    s_waitcnt vmcnt(11)
    s_barrier
    ds_read_b128 v[100:103], v205 offset:0
    ds_read_b128 v[104:107], v205 offset:2048
    ds_read_b128 v[108:111], v205 offset:4096
    ds_read_b128 v[112:115], v205 offset:6144
    ds_read_b64_tr_b16 v[132:133], v207 offset:0
    ds_read_b64_tr_b16 v[134:135], v207 offset:3328
    ds_read_b64_tr_b16 v[136:137], v207 offset:32
    ds_read_b64_tr_b16 v[138:139], v207 offset:3360
    ds_read_b64_tr_b16 v[140:141], v207 offset:64
    ds_read_b64_tr_b16 v[142:143], v207 offset:3392
    ds_read_b64_tr_b16 v[144:145], v207 offset:96
    ds_read_b64_tr_b16 v[146:147], v207 offset:3424
    ds_read_b64_tr_b16 v[148:149], v207 offset:128
    ds_read_b64_tr_b16 v[150:151], v207 offset:3456
    ds_read_b64_tr_b16 v[152:153], v207 offset:160
    ds_read_b64_tr_b16 v[154:155], v207 offset:3488
    s_add_u32 m0, s43, 90112
    s_nop 0
    buffer_load_dwordx4 v180, s[8:11], s44 offen lds
    s_add_u32 m0, s43, 94208
    s_nop 0
    buffer_load_dwordx4 v181, s[8:11], s44 offen lds
    s_add_u32 m0, s43, 98304
    s_nop 0
    buffer_load_dwordx4 v182, s[8:11], s44 offen lds
    s_add_u32 m0, s43, 102400
    s_nop 0
    buffer_load_dwordx4 v183, s[8:11], s44 offen lds
    s_add_u32 m0, s43, 106496
    s_nop 0
    buffer_load_dwordx4 v184, s[12:15], s45 offen lds
    s_add_u32 m0, s43, 110592
    s_nop 0
    buffer_load_dwordx4 v185, s[12:15], s45 offen lds
    s_add_u32 m0, s43, 114688
    s_nop 0
    buffer_load_dwordx4 v186, s[12:15], s45 offen lds
    s_add_u32 m0, s43, 118784
    s_nop 0
    buffer_load_dwordx4 v187, s[12:15], s45 offen lds
    s_add_u32 m0, s43, 122880
    s_nop 0
    buffer_load_dwordx4 v188, s[12:15], s45 offen lds
    s_add_u32 m0, s43, 126976
    s_nop 0
    buffer_load_dwordx4 v189, s[12:15], s45 offen lds
    s_add_u32 m0, s43, 131072
    s_nop 0
    buffer_load_dwordx4 v190, s[12:15], s45 offen lds
    s_add_u32 s44, s44, 128
    s_add_u32 s45, s45, 393216
    ds_read_b128 v[116:119], v206 offset:0
    ds_read_b128 v[120:123], v206 offset:2048
    ds_read_b128 v[124:127], v206 offset:4096
    ds_read_b128 v[128:131], v206 offset:6144
    ds_read_b64_tr_b16 v[156:157], v207 offset:13312
    ds_read_b64_tr_b16 v[158:159], v207 offset:16640
    ds_read_b64_tr_b16 v[160:161], v207 offset:13344
    ds_read_b64_tr_b16 v[162:163], v207 offset:16672
    ds_read_b64_tr_b16 v[164:165], v207 offset:13376
    ds_read_b64_tr_b16 v[166:167], v207 offset:16704
    ds_read_b64_tr_b16 v[168:169], v207 offset:13408
    ds_read_b64_tr_b16 v[170:171], v207 offset:16736
    ds_read_b64_tr_b16 v[172:173], v207 offset:13440
    ds_read_b64_tr_b16 v[174:175], v207 offset:16768
    ds_read_b64_tr_b16 v[176:177], v207 offset:13472
    ds_read_b64_tr_b16 v[178:179], v207 offset:16800
    s_waitcnt lgkmcnt(15)
    v_mfma_f32_16x16x32_bf16 v[4:7], v[132:135], v[100:103], 0
    v_mfma_f32_16x16x32_bf16 v[8:11], v[132:135], v[104:107], 0
    v_mfma_f32_16x16x32_bf16 v[12:15], v[132:135], v[108:111], 0
    v_mfma_f32_16x16x32_bf16 v[16:19], v[132:135], v[112:115], 0
    v_mfma_f32_16x16x32_bf16 v[20:23], v[136:139], v[100:103], 0
    v_mfma_f32_16x16x32_bf16 v[24:27], v[136:139], v[104:107], 0
    v_mfma_f32_16x16x32_bf16 v[28:31], v[136:139], v[108:111], 0
    v_mfma_f32_16x16x32_bf16 v[32:35], v[136:139], v[112:115], 0
    v_mfma_f32_16x16x32_bf16 v[36:39], v[140:143], v[100:103], 0
    v_mfma_f32_16x16x32_bf16 v[40:43], v[140:143], v[104:107], 0
    v_mfma_f32_16x16x32_bf16 v[44:47], v[140:143], v[108:111], 0
    v_mfma_f32_16x16x32_bf16 v[48:51], v[140:143], v[112:115], 0
    v_mfma_f32_16x16x32_bf16 v[52:55], v[144:147], v[100:103], 0
    v_mfma_f32_16x16x32_bf16 v[56:59], v[144:147], v[104:107], 0
    v_mfma_f32_16x16x32_bf16 v[60:63], v[144:147], v[108:111], 0
    v_mfma_f32_16x16x32_bf16 v[64:67], v[144:147], v[112:115], 0
    v_mfma_f32_16x16x32_bf16 v[68:71], v[148:151], v[100:103], 0
    v_mfma_f32_16x16x32_bf16 v[72:75], v[148:151], v[104:107], 0
    v_mfma_f32_16x16x32_bf16 v[76:79], v[148:151], v[108:111], 0
    v_mfma_f32_16x16x32_bf16 v[80:83], v[148:151], v[112:115], 0
    v_mfma_f32_16x16x32_bf16 v[84:87], v[152:155], v[100:103], 0
    v_mfma_f32_16x16x32_bf16 v[88:91], v[152:155], v[104:107], 0
    v_mfma_f32_16x16x32_bf16 v[92:95], v[152:155], v[108:111], 0
    v_mfma_f32_16x16x32_bf16 v[96:99], v[152:155], v[112:115], 0
    s_waitcnt lgkmcnt(0)
    v_mfma_f32_16x16x32_bf16 v[4:7], v[156:159], v[116:119], v[4:7]
    v_mfma_f32_16x16x32_bf16 v[8:11], v[156:159], v[120:123], v[8:11]
    v_mfma_f32_16x16x32_bf16 v[12:15], v[156:159], v[124:127], v[12:15]
    v_mfma_f32_16x16x32_bf16 v[16:19], v[156:159], v[128:131], v[16:19]
    v_mfma_f32_16x16x32_bf16 v[20:23], v[160:163], v[116:119], v[20:23]
    v_mfma_f32_16x16x32_bf16 v[24:27], v[160:163], v[120:123], v[24:27]
    v_mfma_f32_16x16x32_bf16 v[28:31], v[160:163], v[124:127], v[28:31]
    v_mfma_f32_16x16x32_bf16 v[32:35], v[160:163], v[128:131], v[32:35]
    v_mfma_f32_16x16x32_bf16 v[36:39], v[164:167], v[116:119], v[36:39]
    v_mfma_f32_16x16x32_bf16 v[40:43], v[164:167], v[120:123], v[40:43]
    v_mfma_f32_16x16x32_bf16 v[44:47], v[164:167], v[124:127], v[44:47]
    v_mfma_f32_16x16x32_bf16 v[48:51], v[164:167], v[128:131], v[48:51]
    v_mfma_f32_16x16x32_bf16 v[52:55], v[168:171], v[116:119], v[52:55]
    v_mfma_f32_16x16x32_bf16 v[56:59], v[168:171], v[120:123], v[56:59]
    v_mfma_f32_16x16x32_bf16 v[60:63], v[168:171], v[124:127], v[60:63]
    v_mfma_f32_16x16x32_bf16 v[64:67], v[168:171], v[128:131], v[64:67]
    v_mfma_f32_16x16x32_bf16 v[68:71], v[172:175], v[116:119], v[68:71]
    v_mfma_f32_16x16x32_bf16 v[72:75], v[172:175], v[120:123], v[72:75]
    v_mfma_f32_16x16x32_bf16 v[76:79], v[172:175], v[124:127], v[76:79]
    v_mfma_f32_16x16x32_bf16 v[80:83], v[172:175], v[128:131], v[80:83]
    v_mfma_f32_16x16x32_bf16 v[84:87], v[176:179], v[116:119], v[84:87]
    v_mfma_f32_16x16x32_bf16 v[88:91], v[176:179], v[120:123], v[88:91]
    v_mfma_f32_16x16x32_bf16 v[92:95], v[176:179], v[124:127], v[92:95]
    v_mfma_f32_16x16x32_bf16 v[96:99], v[176:179], v[128:131], v[96:99]
    s_waitcnt vmcnt(11)
    s_barrier
    ds_read_b128 v[100:103], v209 offset:0
    ds_read_b128 v[104:107], v209 offset:2048
    ds_read_b128 v[108:111], v209 offset:4096
    ds_read_b128 v[112:115], v209 offset:6144
    ds_read_b64_tr_b16 v[132:133], v211 offset:0
    ds_read_b64_tr_b16 v[134:135], v211 offset:3328
    ds_read_b64_tr_b16 v[136:137], v211 offset:32
    ds_read_b64_tr_b16 v[138:139], v211 offset:3360
    ds_read_b64_tr_b16 v[140:141], v211 offset:64
    ds_read_b64_tr_b16 v[142:143], v211 offset:3392
    ds_read_b64_tr_b16 v[144:145], v211 offset:96
    ds_read_b64_tr_b16 v[146:147], v211 offset:3424
    ds_read_b64_tr_b16 v[148:149], v211 offset:128
    ds_read_b64_tr_b16 v[150:151], v211 offset:3456
    ds_read_b64_tr_b16 v[152:153], v211 offset:160
    ds_read_b64_tr_b16 v[154:155], v211 offset:3488
    s_add_u32 m0, s43, 0
    s_nop 0
    buffer_load_dwordx4 v180, s[8:11], s44 offen lds
    s_add_u32 m0, s43, 4096
    s_nop 0
    buffer_load_dwordx4 v181, s[8:11], s44 offen lds
    s_add_u32 m0, s43, 8192
    s_nop 0
    buffer_load_dwordx4 v182, s[8:11], s44 offen lds
    s_add_u32 m0, s43, 12288
    s_nop 0
    buffer_load_dwordx4 v183, s[8:11], s44 offen lds
    s_add_u32 m0, s43, 16384
    s_nop 0
    buffer_load_dwordx4 v184, s[12:15], s45 offen lds
    s_add_u32 m0, s43, 20480
    s_nop 0
    buffer_load_dwordx4 v185, s[12:15], s45 offen lds
    s_add_u32 m0, s43, 24576
    s_nop 0
    buffer_load_dwordx4 v186, s[12:15], s45 offen lds
    s_add_u32 m0, s43, 28672
    s_nop 0
    buffer_load_dwordx4 v187, s[12:15], s45 offen lds
    s_add_u32 m0, s43, 32768
    s_nop 0
    buffer_load_dwordx4 v188, s[12:15], s45 offen lds
    s_add_u32 m0, s43, 36864
    s_nop 0
    buffer_load_dwordx4 v189, s[12:15], s45 offen lds
    s_add_u32 m0, s43, 40960
    s_nop 0
    buffer_load_dwordx4 v190, s[12:15], s45 offen lds
    s_add_u32 s44, s44, 128
    s_add_u32 s45, s45, 393216
    ds_read_b128 v[116:119], v210 offset:0
    ds_read_b128 v[120:123], v210 offset:2048
    ds_read_b128 v[124:127], v210 offset:4096
    ds_read_b128 v[128:131], v210 offset:6144
    ds_read_b64_tr_b16 v[156:157], v211 offset:13312
    ds_read_b64_tr_b16 v[158:159], v211 offset:16640
    ds_read_b64_tr_b16 v[160:161], v211 offset:13344
    ds_read_b64_tr_b16 v[162:163], v211 offset:16672
    ds_read_b64_tr_b16 v[164:165], v211 offset:13376
    ds_read_b64_tr_b16 v[166:167], v211 offset:16704
    ds_read_b64_tr_b16 v[168:169], v211 offset:13408
    ds_read_b64_tr_b16 v[170:171], v211 offset:16736
    ds_read_b64_tr_b16 v[172:173], v211 offset:13440
    ds_read_b64_tr_b16 v[174:175], v211 offset:16768
    ds_read_b64_tr_b16 v[176:177], v211 offset:13472
    ds_read_b64_tr_b16 v[178:179], v211 offset:16800
    s_waitcnt lgkmcnt(15)
    v_mfma_f32_16x16x32_bf16 v[4:7], v[132:135], v[100:103], v[4:7]
    v_mfma_f32_16x16x32_bf16 v[8:11], v[132:135], v[104:107], v[8:11]
    v_mfma_f32_16x16x32_bf16 v[12:15], v[132:135], v[108:111], v[12:15]
    v_mfma_f32_16x16x32_bf16 v[16:19], v[132:135], v[112:115], v[16:19]
    v_mfma_f32_16x16x32_bf16 v[20:23], v[136:139], v[100:103], v[20:23]
    v_mfma_f32_16x16x32_bf16 v[24:27], v[136:139], v[104:107], v[24:27]
    v_mfma_f32_16x16x32_bf16 v[28:31], v[136:139], v[108:111], v[28:31]
    v_mfma_f32_16x16x32_bf16 v[32:35], v[136:139], v[112:115], v[32:35]
    v_mfma_f32_16x16x32_bf16 v[36:39], v[140:143], v[100:103], v[36:39]
    v_mfma_f32_16x16x32_bf16 v[40:43], v[140:143], v[104:107], v[40:43]
    v_mfma_f32_16x16x32_bf16 v[44:47], v[140:143], v[108:111], v[44:47]
    v_mfma_f32_16x16x32_bf16 v[48:51], v[140:143], v[112:115], v[48:51]
    v_mfma_f32_16x16x32_bf16 v[52:55], v[144:147], v[100:103], v[52:55]
    v_mfma_f32_16x16x32_bf16 v[56:59], v[144:147], v[104:107], v[56:59]
    v_mfma_f32_16x16x32_bf16 v[60:63], v[144:147], v[108:111], v[60:63]
    v_mfma_f32_16x16x32_bf16 v[64:67], v[144:147], v[112:115], v[64:67]
    v_mfma_f32_16x16x32_bf16 v[68:71], v[148:151], v[100:103], v[68:71]
    v_mfma_f32_16x16x32_bf16 v[72:75], v[148:151], v[104:107], v[72:75]
    v_mfma_f32_16x16x32_bf16 v[76:79], v[148:151], v[108:111], v[76:79]
    v_mfma_f32_16x16x32_bf16 v[80:83], v[148:151], v[112:115], v[80:83]
    v_mfma_f32_16x16x32_bf16 v[84:87], v[152:155], v[100:103], v[84:87]
    v_mfma_f32_16x16x32_bf16 v[88:91], v[152:155], v[104:107], v[88:91]
    v_mfma_f32_16x16x32_bf16 v[92:95], v[152:155], v[108:111], v[92:95]
    v_mfma_f32_16x16x32_bf16 v[96:99], v[152:155], v[112:115], v[96:99]
    s_waitcnt lgkmcnt(0)
    v_mfma_f32_16x16x32_bf16 v[4:7], v[156:159], v[116:119], v[4:7]
    v_mfma_f32_16x16x32_bf16 v[8:11], v[156:159], v[120:123], v[8:11]
    v_mfma_f32_16x16x32_bf16 v[12:15], v[156:159], v[124:127], v[12:15]
    v_mfma_f32_16x16x32_bf16 v[16:19], v[156:159], v[128:131], v[16:19]
    v_mfma_f32_16x16x32_bf16 v[20:23], v[160:163], v[116:119], v[20:23]
    v_mfma_f32_16x16x32_bf16 v[24:27], v[160:163], v[120:123], v[24:27]
    v_mfma_f32_16x16x32_bf16 v[28:31], v[160:163], v[124:127], v[28:31]
    v_mfma_f32_16x16x32_bf16 v[32:35], v[160:163], v[128:131], v[32:35]
    v_mfma_f32_16x16x32_bf16 v[36:39], v[164:167], v[116:119], v[36:39]
    v_mfma_f32_16x16x32_bf16 v[40:43], v[164:167], v[120:123], v[40:43]
    v_mfma_f32_16x16x32_bf16 v[44:47], v[164:167], v[124:127], v[44:47]
    v_mfma_f32_16x16x32_bf16 v[48:51], v[164:167], v[128:131], v[48:51]
    v_mfma_f32_16x16x32_bf16 v[52:55], v[168:171], v[116:119], v[52:55]
    v_mfma_f32_16x16x32_bf16 v[56:59], v[168:171], v[120:123], v[56:59]
    v_mfma_f32_16x16x32_bf16 v[60:63], v[168:171], v[124:127], v[60:63]
    v_mfma_f32_16x16x32_bf16 v[64:67], v[168:171], v[128:131], v[64:67]
    v_mfma_f32_16x16x32_bf16 v[68:71], v[172:175], v[116:119], v[68:71]
    v_mfma_f32_16x16x32_bf16 v[72:75], v[172:175], v[120:123], v[72:75]
    v_mfma_f32_16x16x32_bf16 v[76:79], v[172:175], v[124:127], v[76:79]
    v_mfma_f32_16x16x32_bf16 v[80:83], v[172:175], v[128:131], v[80:83]
    v_mfma_f32_16x16x32_bf16 v[84:87], v[176:179], v[116:119], v[84:87]
    v_mfma_f32_16x16x32_bf16 v[88:91], v[176:179], v[120:123], v[88:91]
    v_mfma_f32_16x16x32_bf16 v[92:95], v[176:179], v[124:127], v[92:95]
    v_mfma_f32_16x16x32_bf16 v[96:99], v[176:179], v[128:131], v[96:99]
    s_waitcnt vmcnt(11)
    s_barrier
    ds_read_b128 v[100:103], v213 offset:0
    ds_read_b128 v[104:107], v213 offset:2048
    ds_read_b128 v[108:111], v213 offset:4096
    ds_read_b128 v[112:115], v213 offset:6144
    ds_read_b64_tr_b16 v[132:133], v215 offset:0
    ds_read_b64_tr_b16 v[134:135], v215 offset:3328
    ds_read_b64_tr_b16 v[136:137], v215 offset:32
    ds_read_b64_tr_b16 v[138:139], v215 offset:3360
    ds_read_b64_tr_b16 v[140:141], v215 offset:64
    ds_read_b64_tr_b16 v[142:143], v215 offset:3392
    ds_read_b64_tr_b16 v[144:145], v215 offset:96
    ds_read_b64_tr_b16 v[146:147], v215 offset:3424
    ds_read_b64_tr_b16 v[148:149], v215 offset:128
    ds_read_b64_tr_b16 v[150:151], v215 offset:3456
    ds_read_b64_tr_b16 v[152:153], v215 offset:160
    ds_read_b64_tr_b16 v[154:155], v215 offset:3488
    s_add_u32 m0, s43, 45056
    s_nop 0
    buffer_load_dwordx4 v180, s[8:11], s44 offen lds
    s_add_u32 m0, s43, 49152
    s_nop 0
    buffer_load_dwordx4 v181, s[8:11], s44 offen lds
    s_add_u32 m0, s43, 53248
    s_nop 0
    buffer_load_dwordx4 v182, s[8:11], s44 offen lds
    s_add_u32 m0, s43, 57344
    s_nop 0
    buffer_load_dwordx4 v183, s[8:11], s44 offen lds
    s_add_u32 m0, s43, 61440
    s_nop 0
    buffer_load_dwordx4 v184, s[12:15], s45 offen lds
    s_add_u32 m0, s43, 65536
    s_nop 0
    buffer_load_dwordx4 v185, s[12:15], s45 offen lds
    s_add_u32 m0, s43, 69632
    s_nop 0
    buffer_load_dwordx4 v186, s[12:15], s45 offen lds
    s_add_u32 m0, s43, 73728
    s_nop 0
    buffer_load_dwordx4 v187, s[12:15], s45 offen lds
    s_add_u32 m0, s43, 77824
    s_nop 0
    buffer_load_dwordx4 v188, s[12:15], s45 offen lds
    s_add_u32 m0, s43, 81920
    s_nop 0
    buffer_load_dwordx4 v189, s[12:15], s45 offen lds
    s_add_u32 m0, s43, 86016
    s_nop 0
    buffer_load_dwordx4 v190, s[12:15], s45 offen lds
    s_add_u32 s44, s44, 128
    s_add_u32 s45, s45, 393216
    ds_read_b128 v[116:119], v214 offset:0
    ds_read_b128 v[120:123], v214 offset:2048
    ds_read_b128 v[124:127], v214 offset:4096
    ds_read_b128 v[128:131], v214 offset:6144
    ds_read_b64_tr_b16 v[156:157], v215 offset:13312
    ds_read_b64_tr_b16 v[158:159], v215 offset:16640
    ds_read_b64_tr_b16 v[160:161], v215 offset:13344
    ds_read_b64_tr_b16 v[162:163], v215 offset:16672
    ds_read_b64_tr_b16 v[164:165], v215 offset:13376
    ds_read_b64_tr_b16 v[166:167], v215 offset:16704
    ds_read_b64_tr_b16 v[168:169], v215 offset:13408
    ds_read_b64_tr_b16 v[170:171], v215 offset:16736
    ds_read_b64_tr_b16 v[172:173], v215 offset:13440
    ds_read_b64_tr_b16 v[174:175], v215 offset:16768
    ds_read_b64_tr_b16 v[176:177], v215 offset:13472
    ds_read_b64_tr_b16 v[178:179], v215 offset:16800
    s_waitcnt lgkmcnt(15)
    v_mfma_f32_16x16x32_bf16 v[4:7], v[132:135], v[100:103], v[4:7]
    v_mfma_f32_16x16x32_bf16 v[8:11], v[132:135], v[104:107], v[8:11]
    v_mfma_f32_16x16x32_bf16 v[12:15], v[132:135], v[108:111], v[12:15]
    v_mfma_f32_16x16x32_bf16 v[16:19], v[132:135], v[112:115], v[16:19]
    v_mfma_f32_16x16x32_bf16 v[20:23], v[136:139], v[100:103], v[20:23]
    v_mfma_f32_16x16x32_bf16 v[24:27], v[136:139], v[104:107], v[24:27]
    v_mfma_f32_16x16x32_bf16 v[28:31], v[136:139], v[108:111], v[28:31]
    v_mfma_f32_16x16x32_bf16 v[32:35], v[136:139], v[112:115], v[32:35]
    v_mfma_f32_16x16x32_bf16 v[36:39], v[140:143], v[100:103], v[36:39]
    v_mfma_f32_16x16x32_bf16 v[40:43], v[140:143], v[104:107], v[40:43]
    v_mfma_f32_16x16x32_bf16 v[44:47], v[140:143], v[108:111], v[44:47]
    v_mfma_f32_16x16x32_bf16 v[48:51], v[140:143], v[112:115], v[48:51]
    v_mfma_f32_16x16x32_bf16 v[52:55], v[144:147], v[100:103], v[52:55]
    v_mfma_f32_16x16x32_bf16 v[56:59], v[144:147], v[104:107], v[56:59]
    v_mfma_f32_16x16x32_bf16 v[60:63], v[144:147], v[108:111], v[60:63]
    v_mfma_f32_16x16x32_bf16 v[64:67], v[144:147], v[112:115], v[64:67]
    v_mfma_f32_16x16x32_bf16 v[68:71], v[148:151], v[100:103], v[68:71]
    v_mfma_f32_16x16x32_bf16 v[72:75], v[148:151], v[104:107], v[72:75]
    v_mfma_f32_16x16x32_bf16 v[76:79], v[148:151], v[108:111], v[76:79]
    v_mfma_f32_16x16x32_bf16 v[80:83], v[148:151], v[112:115], v[80:83]
    v_mfma_f32_16x16x32_bf16 v[84:87], v[152:155], v[100:103], v[84:87]
    v_mfma_f32_16x16x32_bf16 v[88:91], v[152:155], v[104:107], v[88:91]
    v_mfma_f32_16x16x32_bf16 v[92:95], v[152:155], v[108:111], v[92:95]
    v_mfma_f32_16x16x32_bf16 v[96:99], v[152:155], v[112:115], v[96:99]
    s_waitcnt lgkmcnt(0)
    v_mfma_f32_16x16x32_bf16 v[4:7], v[156:159], v[116:119], v[4:7]
    v_mfma_f32_16x16x32_bf16 v[8:11], v[156:159], v[120:123], v[8:11]
    v_mfma_f32_16x16x32_bf16 v[12:15], v[156:159], v[124:127], v[12:15]
    v_mfma_f32_16x16x32_bf16 v[16:19], v[156:159], v[128:131], v[16:19]
    v_mfma_f32_16x16x32_bf16 v[20:23], v[160:163], v[116:119], v[20:23]
    v_mfma_f32_16x16x32_bf16 v[24:27], v[160:163], v[120:123], v[24:27]
    v_mfma_f32_16x16x32_bf16 v[28:31], v[160:163], v[124:127], v[28:31]
    v_mfma_f32_16x16x32_bf16 v[32:35], v[160:163], v[128:131], v[32:35]
    v_mfma_f32_16x16x32_bf16 v[36:39], v[164:167], v[116:119], v[36:39]
    v_mfma_f32_16x16x32_bf16 v[40:43], v[164:167], v[120:123], v[40:43]
    v_mfma_f32_16x16x32_bf16 v[44:47], v[164:167], v[124:127], v[44:47]
    v_mfma_f32_16x16x32_bf16 v[48:51], v[164:167], v[128:131], v[48:51]
    v_mfma_f32_16x16x32_bf16 v[52:55], v[168:171], v[116:119], v[52:55]
    v_mfma_f32_16x16x32_bf16 v[56:59], v[168:171], v[120:123], v[56:59]
    v_mfma_f32_16x16x32_bf16 v[60:63], v[168:171], v[124:127], v[60:63]
    v_mfma_f32_16x16x32_bf16 v[64:67], v[168:171], v[128:131], v[64:67]
    v_mfma_f32_16x16x32_bf16 v[68:71], v[172:175], v[116:119], v[68:71]
    v_mfma_f32_16x16x32_bf16 v[72:75], v[172:175], v[120:123], v[72:75]
    v_mfma_f32_16x16x32_bf16 v[76:79], v[172:175], v[124:127], v[76:79]
    v_mfma_f32_16x16x32_bf16 v[80:83], v[172:175], v[128:131], v[80:83]
    v_mfma_f32_16x16x32_bf16 v[84:87], v[176:179], v[116:119], v[84:87]
    v_mfma_f32_16x16x32_bf16 v[88:91], v[176:179], v[120:123], v[88:91]
    v_mfma_f32_16x16x32_bf16 v[92:95], v[176:179], v[124:127], v[92:95]
    v_mfma_f32_16x16x32_bf16 v[96:99], v[176:179], v[128:131], v[96:99]
    s_waitcnt vmcnt(11)
    s_barrier
    ds_read_b128 v[100:103], v205 offset:0
    ds_read_b128 v[104:107], v205 offset:2048
    ds_read_b128 v[108:111], v205 offset:4096
    ds_read_b128 v[112:115], v205 offset:6144
    ds_read_b64_tr_b16 v[132:133], v207 offset:0
    ds_read_b64_tr_b16 v[134:135], v207 offset:3328
    ds_read_b64_tr_b16 v[136:137], v207 offset:32
    ds_read_b64_tr_b16 v[138:139], v207 offset:3360
    ds_read_b64_tr_b16 v[140:141], v207 offset:64
    ds_read_b64_tr_b16 v[142:143], v207 offset:3392
    ds_read_b64_tr_b16 v[144:145], v207 offset:96
    ds_read_b64_tr_b16 v[146:147], v207 offset:3424
    ds_read_b64_tr_b16 v[148:149], v207 offset:128
    ds_read_b64_tr_b16 v[150:151], v207 offset:3456
    ds_read_b64_tr_b16 v[152:153], v207 offset:160
    ds_read_b64_tr_b16 v[154:155], v207 offset:3488
    s_add_u32 m0, s43, 90112
    s_nop 0
    buffer_load_dwordx4 v180, s[8:11], s44 offen lds
    s_add_u32 m0, s43, 94208
    s_nop 0
    buffer_load_dwordx4 v181, s[8:11], s44 offen lds
    s_add_u32 m0, s43, 98304
    s_nop 0
    buffer_load_dwordx4 v182, s[8:11], s44 offen lds
    s_add_u32 m0, s43, 102400
    s_nop 0
    buffer_load_dwordx4 v183, s[8:11], s44 offen lds
    s_add_u32 m0, s43, 106496
    s_nop 0
    buffer_load_dwordx4 v184, s[12:15], s45 offen lds
    s_add_u32 m0, s43, 110592
    s_nop 0
    buffer_load_dwordx4 v185, s[12:15], s45 offen lds
    s_add_u32 m0, s43, 114688
    s_nop 0
    buffer_load_dwordx4 v186, s[12:15], s45 offen lds
    s_add_u32 m0, s43, 118784
    s_nop 0
    buffer_load_dwordx4 v187, s[12:15], s45 offen lds
    s_add_u32 m0, s43, 122880
    s_nop 0
    buffer_load_dwordx4 v188, s[12:15], s45 offen lds
    s_add_u32 m0, s43, 126976
    s_nop 0
    buffer_load_dwordx4 v189, s[12:15], s45 offen lds
    s_add_u32 m0, s43, 131072
    s_nop 0
    buffer_load_dwordx4 v190, s[12:15], s45 offen lds
    s_add_u32 s44, s44, 128
    s_add_u32 s45, s45, 393216
    ds_read_b128 v[116:119], v206 offset:0
    ds_read_b128 v[120:123], v206 offset:2048
    ds_read_b128 v[124:127], v206 offset:4096
    ds_read_b128 v[128:131], v206 offset:6144
    ds_read_b64_tr_b16 v[156:157], v207 offset:13312
    ds_read_b64_tr_b16 v[158:159], v207 offset:16640
    ds_read_b64_tr_b16 v[160:161], v207 offset:13344
    ds_read_b64_tr_b16 v[162:163], v207 offset:16672
    ds_read_b64_tr_b16 v[164:165], v207 offset:13376
    ds_read_b64_tr_b16 v[166:167], v207 offset:16704
    ds_read_b64_tr_b16 v[168:169], v207 offset:13408
    ds_read_b64_tr_b16 v[170:171], v207 offset:16736
    ds_read_b64_tr_b16 v[172:173], v207 offset:13440
    ds_read_b64_tr_b16 v[174:175], v207 offset:16768
    ds_read_b64_tr_b16 v[176:177], v207 offset:13472
    ds_read_b64_tr_b16 v[178:179], v207 offset:16800
    s_waitcnt lgkmcnt(15)
    v_mfma_f32_16x16x32_bf16 v[4:7], v[132:135], v[100:103], v[4:7]
    v_mfma_f32_16x16x32_bf16 v[8:11], v[132:135], v[104:107], v[8:11]
    v_mfma_f32_16x16x32_bf16 v[12:15], v[132:135], v[108:111], v[12:15]
    v_mfma_f32_16x16x32_bf16 v[16:19], v[132:135], v[112:115], v[16:19]
    v_mfma_f32_16x16x32_bf16 v[20:23], v[136:139], v[100:103], v[20:23]
    v_mfma_f32_16x16x32_bf16 v[24:27], v[136:139], v[104:107], v[24:27]
    v_mfma_f32_16x16x32_bf16 v[28:31], v[136:139], v[108:111], v[28:31]
    v_mfma_f32_16x16x32_bf16 v[32:35], v[136:139], v[112:115], v[32:35]
    v_mfma_f32_16x16x32_bf16 v[36:39], v[140:143], v[100:103], v[36:39]
    v_mfma_f32_16x16x32_bf16 v[40:43], v[140:143], v[104:107], v[40:43]
    v_mfma_f32_16x16x32_bf16 v[44:47], v[140:143], v[108:111], v[44:47]
    v_mfma_f32_16x16x32_bf16 v[48:51], v[140:143], v[112:115], v[48:51]
    v_mfma_f32_16x16x32_bf16 v[52:55], v[144:147], v[100:103], v[52:55]
    v_mfma_f32_16x16x32_bf16 v[56:59], v[144:147], v[104:107], v[56:59]
    v_mfma_f32_16x16x32_bf16 v[60:63], v[144:147], v[108:111], v[60:63]
    v_mfma_f32_16x16x32_bf16 v[64:67], v[144:147], v[112:115], v[64:67]
    v_mfma_f32_16x16x32_bf16 v[68:71], v[148:151], v[100:103], v[68:71]
    v_mfma_f32_16x16x32_bf16 v[72:75], v[148:151], v[104:107], v[72:75]
    v_mfma_f32_16x16x32_bf16 v[76:79], v[148:151], v[108:111], v[76:79]
    v_mfma_f32_16x16x32_bf16 v[80:83], v[148:151], v[112:115], v[80:83]
    v_mfma_f32_16x16x32_bf16 v[84:87], v[152:155], v[100:103], v[84:87]
    v_mfma_f32_16x16x32_bf16 v[88:91], v[152:155], v[104:107], v[88:91]
    v_mfma_f32_16x16x32_bf16 v[92:95], v[152:155], v[108:111], v[92:95]
    v_mfma_f32_16x16x32_bf16 v[96:99], v[152:155], v[112:115], v[96:99]
    s_waitcnt lgkmcnt(0)
    v_mfma_f32_16x16x32_bf16 v[4:7], v[156:159], v[116:119], v[4:7]
    v_mfma_f32_16x16x32_bf16 v[8:11], v[156:159], v[120:123], v[8:11]
    v_mfma_f32_16x16x32_bf16 v[12:15], v[156:159], v[124:127], v[12:15]
    v_mfma_f32_16x16x32_bf16 v[16:19], v[156:159], v[128:131], v[16:19]
    v_mfma_f32_16x16x32_bf16 v[20:23], v[160:163], v[116:119], v[20:23]
    v_mfma_f32_16x16x32_bf16 v[24:27], v[160:163], v[120:123], v[24:27]
    v_mfma_f32_16x16x32_bf16 v[28:31], v[160:163], v[124:127], v[28:31]
    v_mfma_f32_16x16x32_bf16 v[32:35], v[160:163], v[128:131], v[32:35]
    v_mfma_f32_16x16x32_bf16 v[36:39], v[164:167], v[116:119], v[36:39]
    v_mfma_f32_16x16x32_bf16 v[40:43], v[164:167], v[120:123], v[40:43]
    v_mfma_f32_16x16x32_bf16 v[44:47], v[164:167], v[124:127], v[44:47]
    v_mfma_f32_16x16x32_bf16 v[48:51], v[164:167], v[128:131], v[48:51]
    v_mfma_f32_16x16x32_bf16 v[52:55], v[168:171], v[116:119], v[52:55]
    v_mfma_f32_16x16x32_bf16 v[56:59], v[168:171], v[120:123], v[56:59]
    v_mfma_f32_16x16x32_bf16 v[60:63], v[168:171], v[124:127], v[60:63]
    v_mfma_f32_16x16x32_bf16 v[64:67], v[168:171], v[128:131], v[64:67]
    v_mfma_f32_16x16x32_bf16 v[68:71], v[172:175], v[116:119], v[68:71]
    v_mfma_f32_16x16x32_bf16 v[72:75], v[172:175], v[120:123], v[72:75]
    v_mfma_f32_16x16x32_bf16 v[76:79], v[172:175], v[124:127], v[76:79]
    v_mfma_f32_16x16x32_bf16 v[80:83], v[172:175], v[128:131], v[80:83]
    v_mfma_f32_16x16x32_bf16 v[84:87], v[176:179], v[116:119], v[84:87]
    v_mfma_f32_16x16x32_bf16 v[88:91], v[176:179], v[120:123], v[88:91]
    v_mfma_f32_16x16x32_bf16 v[92:95], v[176:179], v[124:127], v[92:95]
    v_mfma_f32_16x16x32_bf16 v[96:99], v[176:179], v[128:131], v[96:99]
    s_waitcnt vmcnt(11)
    s_barrier
    ds_read_b128 v[100:103], v209 offset:0
    ds_read_b128 v[104:107], v209 offset:2048
    ds_read_b128 v[108:111], v209 offset:4096
    ds_read_b128 v[112:115], v209 offset:6144
    ds_read_b64_tr_b16 v[132:133], v211 offset:0
    ds_read_b64_tr_b16 v[134:135], v211 offset:3328
    ds_read_b64_tr_b16 v[136:137], v211 offset:32
    ds_read_b64_tr_b16 v[138:139], v211 offset:3360
    ds_read_b64_tr_b16 v[140:141], v211 offset:64
    ds_read_b64_tr_b16 v[142:143], v211 offset:3392
    ds_read_b64_tr_b16 v[144:145], v211 offset:96
    ds_read_b64_tr_b16 v[146:147], v211 offset:3424
    ds_read_b64_tr_b16 v[148:149], v211 offset:128
    ds_read_b64_tr_b16 v[150:151], v211 offset:3456
    ds_read_b64_tr_b16 v[152:153], v211 offset:160
    ds_read_b64_tr_b16 v[154:155], v211 offset:3488
    s_add_u32 m0, s43, 0
    s_nop 0
    buffer_load_dwordx4 v180, s[8:11], s44 offen lds
    s_add_u32 m0, s43, 4096
    s_nop 0
    buffer_load_dwordx4 v181, s[8:11], s44 offen lds
    s_add_u32 m0, s43, 8192
    s_nop 0
    buffer_load_dwordx4 v182, s[8:11], s44 offen lds
    s_add_u32 m0, s43, 12288
    s_nop 0
    buffer_load_dwordx4 v183, s[8:11], s44 offen lds
    s_add_u32 m0, s43, 16384
    s_nop 0
    buffer_load_dwordx4 v184, s[12:15], s45 offen lds
    s_add_u32 m0, s43, 20480
    s_nop 0
    buffer_load_dwordx4 v185, s[12:15], s45 offen lds
    s_add_u32 m0, s43, 24576
    s_nop 0
    buffer_load_dwordx4 v186, s[12:15], s45 offen lds
    s_add_u32 m0, s43, 28672
    s_nop 0
    buffer_load_dwordx4 v187, s[12:15], s45 offen lds
    s_add_u32 m0, s43, 32768
    s_nop 0
    buffer_load_dwordx4 v188, s[12:15], s45 offen lds
    s_add_u32 m0, s43, 36864
    s_nop 0
    buffer_load_dwordx4 v189, s[12:15], s45 offen lds
    s_add_u32 m0, s43, 40960
    s_nop 0
    buffer_load_dwordx4 v190, s[12:15], s45 offen lds
    s_add_u32 s44, s44, 128
    s_add_u32 s45, s45, 393216
    ds_read_b128 v[116:119], v210 offset:0
    ds_read_b128 v[120:123], v210 offset:2048
    ds_read_b128 v[124:127], v210 offset:4096
    ds_read_b128 v[128:131], v210 offset:6144
    ds_read_b64_tr_b16 v[156:157], v211 offset:13312
    ds_read_b64_tr_b16 v[158:159], v211 offset:16640
    ds_read_b64_tr_b16 v[160:161], v211 offset:13344
    ds_read_b64_tr_b16 v[162:163], v211 offset:16672
    ds_read_b64_tr_b16 v[164:165], v211 offset:13376
    ds_read_b64_tr_b16 v[166:167], v211 offset:16704
    ds_read_b64_tr_b16 v[168:169], v211 offset:13408
    ds_read_b64_tr_b16 v[170:171], v211 offset:16736
    ds_read_b64_tr_b16 v[172:173], v211 offset:13440
    ds_read_b64_tr_b16 v[174:175], v211 offset:16768
    ds_read_b64_tr_b16 v[176:177], v211 offset:13472
    ds_read_b64_tr_b16 v[178:179], v211 offset:16800
    s_waitcnt lgkmcnt(15)
    v_mfma_f32_16x16x32_bf16 v[4:7], v[132:135], v[100:103], v[4:7]
    v_mfma_f32_16x16x32_bf16 v[8:11], v[132:135], v[104:107], v[8:11]
    v_mfma_f32_16x16x32_bf16 v[12:15], v[132:135], v[108:111], v[12:15]
    v_mfma_f32_16x16x32_bf16 v[16:19], v[132:135], v[112:115], v[16:19]
    v_mfma_f32_16x16x32_bf16 v[20:23], v[136:139], v[100:103], v[20:23]
    v_mfma_f32_16x16x32_bf16 v[24:27], v[136:139], v[104:107], v[24:27]
    v_mfma_f32_16x16x32_bf16 v[28:31], v[136:139], v[108:111], v[28:31]
    v_mfma_f32_16x16x32_bf16 v[32:35], v[136:139], v[112:115], v[32:35]
    v_mfma_f32_16x16x32_bf16 v[36:39], v[140:143], v[100:103], v[36:39]
    v_mfma_f32_16x16x32_bf16 v[40:43], v[140:143], v[104:107], v[40:43]
    v_mfma_f32_16x16x32_bf16 v[44:47], v[140:143], v[108:111], v[44:47]
    v_mfma_f32_16x16x32_bf16 v[48:51], v[140:143], v[112:115], v[48:51]
    v_mfma_f32_16x16x32_bf16 v[52:55], v[144:147], v[100:103], v[52:55]
    v_mfma_f32_16x16x32_bf16 v[56:59], v[144:147], v[104:107], v[56:59]
    v_mfma_f32_16x16x32_bf16 v[60:63], v[144:147], v[108:111], v[60:63]
    v_mfma_f32_16x16x32_bf16 v[64:67], v[144:147], v[112:115], v[64:67]
    v_mfma_f32_16x16x32_bf16 v[68:71], v[148:151], v[100:103], v[68:71]
    v_mfma_f32_16x16x32_bf16 v[72:75], v[148:151], v[104:107], v[72:75]
    v_mfma_f32_16x16x32_bf16 v[76:79], v[148:151], v[108:111], v[76:79]
    v_mfma_f32_16x16x32_bf16 v[80:83], v[148:151], v[112:115], v[80:83]
    v_mfma_f32_16x16x32_bf16 v[84:87], v[152:155], v[100:103], v[84:87]
    v_mfma_f32_16x16x32_bf16 v[88:91], v[152:155], v[104:107], v[88:91]
    v_mfma_f32_16x16x32_bf16 v[92:95], v[152:155], v[108:111], v[92:95]
    v_mfma_f32_16x16x32_bf16 v[96:99], v[152:155], v[112:115], v[96:99]
    s_waitcnt lgkmcnt(0)
    v_mfma_f32_16x16x32_bf16 v[4:7], v[156:159], v[116:119], v[4:7]
    v_mfma_f32_16x16x32_bf16 v[8:11], v[156:159], v[120:123], v[8:11]
    v_mfma_f32_16x16x32_bf16 v[12:15], v[156:159], v[124:127], v[12:15]
    v_mfma_f32_16x16x32_bf16 v[16:19], v[156:159], v[128:131], v[16:19]
    v_mfma_f32_16x16x32_bf16 v[20:23], v[160:163], v[116:119], v[20:23]
    v_mfma_f32_16x16x32_bf16 v[24:27], v[160:163], v[120:123], v[24:27]
    v_mfma_f32_16x16x32_bf16 v[28:31], v[160:163], v[124:127], v[28:31]
    v_mfma_f32_16x16x32_bf16 v[32:35], v[160:163], v[128:131], v[32:35]
    v_mfma_f32_16x16x32_bf16 v[36:39], v[164:167], v[116:119], v[36:39]
    v_mfma_f32_16x16x32_bf16 v[40:43], v[164:167], v[120:123], v[40:43]
    v_mfma_f32_16x16x32_bf16 v[44:47], v[164:167], v[124:127], v[44:47]
    v_mfma_f32_16x16x32_bf16 v[48:51], v[164:167], v[128:131], v[48:51]
    v_mfma_f32_16x16x32_bf16 v[52:55], v[168:171], v[116:119], v[52:55]
    v_mfma_f32_16x16x32_bf16 v[56:59], v[168:171], v[120:123], v[56:59]
    v_mfma_f32_16x16x32_bf16 v[60:63], v[168:171], v[124:127], v[60:63]
    v_mfma_f32_16x16x32_bf16 v[64:67], v[168:171], v[128:131], v[64:67]
    v_mfma_f32_16x16x32_bf16 v[68:71], v[172:175], v[116:119], v[68:71]
    v_mfma_f32_16x16x32_bf16 v[72:75], v[172:175], v[120:123], v[72:75]
    v_mfma_f32_16x16x32_bf16 v[76:79], v[172:175], v[124:127], v[76:79]
    v_mfma_f32_16x16x32_bf16 v[80:83], v[172:175], v[128:131], v[80:83]
    v_mfma_f32_16x16x32_bf16 v[84:87], v[176:179], v[116:119], v[84:87]
    v_mfma_f32_16x16x32_bf16 v[88:91], v[176:179], v[120:123], v[88:91]
    v_mfma_f32_16x16x32_bf16 v[92:95], v[176:179], v[124:127], v[92:95]
    v_mfma_f32_16x16x32_bf16 v[96:99], v[176:179], v[128:131], v[96:99]
    s_waitcnt vmcnt(11)
    s_barrier
    ds_read_b128 v[100:103], v213 offset:0
    ds_read_b128 v[104:107], v213 offset:2048
    ds_read_b128 v[108:111], v213 offset:4096
    ds_read_b128 v[112:115], v213 offset:6144
    ds_read_b64_tr_b16 v[132:133], v215 offset:0
    ds_read_b64_tr_b16 v[134:135], v215 offset:3328
    ds_read_b64_tr_b16 v[136:137], v215 offset:32
    ds_read_b64_tr_b16 v[138:139], v215 offset:3360
    ds_read_b64_tr_b16 v[140:141], v215 offset:64
    ds_read_b64_tr_b16 v[142:143], v215 offset:3392
    ds_read_b64_tr_b16 v[144:145], v215 offset:96
    ds_read_b64_tr_b16 v[146:147], v215 offset:3424
    ds_read_b64_tr_b16 v[148:149], v215 offset:128
    ds_read_b64_tr_b16 v[150:151], v215 offset:3456
    ds_read_b64_tr_b16 v[152:153], v215 offset:160
    ds_read_b64_tr_b16 v[154:155], v215 offset:3488
    s_add_u32 m0, s43, 45056
    s_nop 0
    buffer_load_dwordx4 v180, s[8:11], s44 offen lds
    s_add_u32 m0, s43, 49152
    s_nop 0
    buffer_load_dwordx4 v181, s[8:11], s44 offen lds
    s_add_u32 m0, s43, 53248
    s_nop 0
    buffer_load_dwordx4 v182, s[8:11], s44 offen lds
    s_add_u32 m0, s43, 57344
    s_nop 0
    buffer_load_dwordx4 v183, s[8:11], s44 offen lds
    s_add_u32 m0, s43, 61440
    s_nop 0
    buffer_load_dwordx4 v184, s[12:15], s45 offen lds
    s_add_u32 m0, s43, 65536
    s_nop 0
    buffer_load_dwordx4 v185, s[12:15], s45 offen lds
    s_add_u32 m0, s43, 69632
    s_nop 0
    buffer_load_dwordx4 v186, s[12:15], s45 offen lds
    s_add_u32 m0, s43, 73728
    s_nop 0
    buffer_load_dwordx4 v187, s[12:15], s45 offen lds
    s_add_u32 m0, s43, 77824
    s_nop 0
    buffer_load_dwordx4 v188, s[12:15], s45 offen lds
    s_add_u32 m0, s43, 81920
    s_nop 0
    buffer_load_dwordx4 v189, s[12:15], s45 offen lds
    s_add_u32 m0, s43, 86016
    s_nop 0
    buffer_load_dwordx4 v190, s[12:15], s45 offen lds
    s_add_u32 s44, s44, 128
    s_add_u32 s45, s45, 393216
    ds_read_b128 v[116:119], v214 offset:0
    ds_read_b128 v[120:123], v214 offset:2048
    ds_read_b128 v[124:127], v214 offset:4096
    ds_read_b128 v[128:131], v214 offset:6144
    ds_read_b64_tr_b16 v[156:157], v215 offset:13312
    ds_read_b64_tr_b16 v[158:159], v215 offset:16640
    ds_read_b64_tr_b16 v[160:161], v215 offset:13344
    ds_read_b64_tr_b16 v[162:163], v215 offset:16672
    ds_read_b64_tr_b16 v[164:165], v215 offset:13376
    ds_read_b64_tr_b16 v[166:167], v215 offset:16704
    ds_read_b64_tr_b16 v[168:169], v215 offset:13408
    ds_read_b64_tr_b16 v[170:171], v215 offset:16736
    ds_read_b64_tr_b16 v[172:173], v215 offset:13440
    ds_read_b64_tr_b16 v[174:175], v215 offset:16768
    ds_read_b64_tr_b16 v[176:177], v215 offset:13472
    ds_read_b64_tr_b16 v[178:179], v215 offset:16800
    s_waitcnt lgkmcnt(15)
    v_mfma_f32_16x16x32_bf16 v[4:7], v[132:135], v[100:103], v[4:7]
    v_mfma_f32_16x16x32_bf16 v[8:11], v[132:135], v[104:107], v[8:11]
    v_mfma_f32_16x16x32_bf16 v[12:15], v[132:135], v[108:111], v[12:15]
    v_mfma_f32_16x16x32_bf16 v[16:19], v[132:135], v[112:115], v[16:19]
    v_mfma_f32_16x16x32_bf16 v[20:23], v[136:139], v[100:103], v[20:23]
    v_mfma_f32_16x16x32_bf16 v[24:27], v[136:139], v[104:107], v[24:27]
    v_mfma_f32_16x16x32_bf16 v[28:31], v[136:139], v[108:111], v[28:31]
    v_mfma_f32_16x16x32_bf16 v[32:35], v[136:139], v[112:115], v[32:35]
    v_mfma_f32_16x16x32_bf16 v[36:39], v[140:143], v[100:103], v[36:39]
    v_mfma_f32_16x16x32_bf16 v[40:43], v[140:143], v[104:107], v[40:43]
    v_mfma_f32_16x16x32_bf16 v[44:47], v[140:143], v[108:111], v[44:47]
    v_mfma_f32_16x16x32_bf16 v[48:51], v[140:143], v[112:115], v[48:51]
    v_mfma_f32_16x16x32_bf16 v[52:55], v[144:147], v[100:103], v[52:55]
    v_mfma_f32_16x16x32_bf16 v[56:59], v[144:147], v[104:107], v[56:59]
    v_mfma_f32_16x16x32_bf16 v[60:63], v[144:147], v[108:111], v[60:63]
    v_mfma_f32_16x16x32_bf16 v[64:67], v[144:147], v[112:115], v[64:67]
    v_mfma_f32_16x16x32_bf16 v[68:71], v[148:151], v[100:103], v[68:71]
    v_mfma_f32_16x16x32_bf16 v[72:75], v[148:151], v[104:107], v[72:75]
    v_mfma_f32_16x16x32_bf16 v[76:79], v[148:151], v[108:111], v[76:79]
    v_mfma_f32_16x16x32_bf16 v[80:83], v[148:151], v[112:115], v[80:83]
    v_mfma_f32_16x16x32_bf16 v[84:87], v[152:155], v[100:103], v[84:87]
    v_mfma_f32_16x16x32_bf16 v[88:91], v[152:155], v[104:107], v[88:91]
    v_mfma_f32_16x16x32_bf16 v[92:95], v[152:155], v[108:111], v[92:95]
    v_mfma_f32_16x16x32_bf16 v[96:99], v[152:155], v[112:115], v[96:99]
    s_waitcnt lgkmcnt(0)
    v_mfma_f32_16x16x32_bf16 v[4:7], v[156:159], v[116:119], v[4:7]
    v_mfma_f32_16x16x32_bf16 v[8:11], v[156:159], v[120:123], v[8:11]
    v_mfma_f32_16x16x32_bf16 v[12:15], v[156:159], v[124:127], v[12:15]
    v_mfma_f32_16x16x32_bf16 v[16:19], v[156:159], v[128:131], v[16:19]
    v_mfma_f32_16x16x32_bf16 v[20:23], v[160:163], v[116:119], v[20:23]
    v_mfma_f32_16x16x32_bf16 v[24:27], v[160:163], v[120:123], v[24:27]
    v_mfma_f32_16x16x32_bf16 v[28:31], v[160:163], v[124:127], v[28:31]
    v_mfma_f32_16x16x32_bf16 v[32:35], v[160:163], v[128:131], v[32:35]
    v_mfma_f32_16x16x32_bf16 v[36:39], v[164:167], v[116:119], v[36:39]
    v_mfma_f32_16x16x32_bf16 v[40:43], v[164:167], v[120:123], v[40:43]
    v_mfma_f32_16x16x32_bf16 v[44:47], v[164:167], v[124:127], v[44:47]
    v_mfma_f32_16x16x32_bf16 v[48:51], v[164:167], v[128:131], v[48:51]
    v_mfma_f32_16x16x32_bf16 v[52:55], v[168:171], v[116:119], v[52:55]
    v_mfma_f32_16x16x32_bf16 v[56:59], v[168:171], v[120:123], v[56:59]
    v_mfma_f32_16x16x32_bf16 v[60:63], v[168:171], v[124:127], v[60:63]
    v_mfma_f32_16x16x32_bf16 v[64:67], v[168:171], v[128:131], v[64:67]
    v_mfma_f32_16x16x32_bf16 v[68:71], v[172:175], v[116:119], v[68:71]
    v_mfma_f32_16x16x32_bf16 v[72:75], v[172:175], v[120:123], v[72:75]
    v_mfma_f32_16x16x32_bf16 v[76:79], v[172:175], v[124:127], v[76:79]
    v_mfma_f32_16x16x32_bf16 v[80:83], v[172:175], v[128:131], v[80:83]
    v_mfma_f32_16x16x32_bf16 v[84:87], v[176:179], v[116:119], v[84:87]
    v_mfma_f32_16x16x32_bf16 v[88:91], v[176:179], v[120:123], v[88:91]
    v_mfma_f32_16x16x32_bf16 v[92:95], v[176:179], v[124:127], v[92:95]
    v_mfma_f32_16x16x32_bf16 v[96:99], v[176:179], v[128:131], v[96:99]
    s_waitcnt vmcnt(11)
    s_barrier
    ds_read_b128 v[100:103], v205 offset:0
    ds_read_b128 v[104:107], v205 offset:2048
    ds_read_b128 v[108:111], v205 offset:4096
    ds_read_b128 v[112:115], v205 offset:6144
    ds_read_b64_tr_b16 v[132:133], v207 offset:0
    ds_read_b64_tr_b16 v[134:135], v207 offset:3328
    ds_read_b64_tr_b16 v[136:137], v207 offset:32
    ds_read_b64_tr_b16 v[138:139], v207 offset:3360
    ds_read_b64_tr_b16 v[140:141], v207 offset:64
    ds_read_b64_tr_b16 v[142:143], v207 offset:3392
    ds_read_b64_tr_b16 v[144:145], v207 offset:96
    ds_read_b64_tr_b16 v[146:147], v207 offset:3424
    ds_read_b64_tr_b16 v[148:149], v207 offset:128
    ds_read_b64_tr_b16 v[150:151], v207 offset:3456
    ds_read_b64_tr_b16 v[152:153], v207 offset:160
    ds_read_b64_tr_b16 v[154:155], v207 offset:3488
    s_add_u32 m0, s43, 90112
    s_nop 0
    buffer_load_dwordx4 v180, s[8:11], s44 offen lds
    s_add_u32 m0, s43, 94208
    s_nop 0
    buffer_load_dwordx4 v181, s[8:11], s44 offen lds
    s_add_u32 m0, s43, 98304
    s_nop 0
    buffer_load_dwordx4 v182, s[8:11], s44 offen lds
    s_add_u32 m0, s43, 102400
    s_nop 0
    buffer_load_dwordx4 v183, s[8:11], s44 offen lds
    s_add_u32 m0, s43, 106496
    s_nop 0
    buffer_load_dwordx4 v184, s[12:15], s45 offen lds
    s_add_u32 m0, s43, 110592
    s_nop 0
    buffer_load_dwordx4 v185, s[12:15], s45 offen lds
    s_add_u32 m0, s43, 114688
    s_nop 0
    buffer_load_dwordx4 v186, s[12:15], s45 offen lds
    s_add_u32 m0, s43, 118784
    s_nop 0
    buffer_load_dwordx4 v187, s[12:15], s45 offen lds
    s_add_u32 m0, s43, 122880
    s_nop 0
    buffer_load_dwordx4 v188, s[12:15], s45 offen lds
    s_add_u32 m0, s43, 126976
    s_nop 0
    buffer_load_dwordx4 v189, s[12:15], s45 offen lds
    s_add_u32 m0, s43, 131072
    s_nop 0
    buffer_load_dwordx4 v190, s[12:15], s45 offen lds
    s_add_u32 s44, s44, 128
    s_add_u32 s45, s45, 393216
    ds_read_b128 v[116:119], v206 offset:0
    ds_read_b128 v[120:123], v206 offset:2048
    ds_read_b128 v[124:127], v206 offset:4096
    ds_read_b128 v[128:131], v206 offset:6144
    ds_read_b64_tr_b16 v[156:157], v207 offset:13312
    ds_read_b64_tr_b16 v[158:159], v207 offset:16640
    ds_read_b64_tr_b16 v[160:161], v207 offset:13344
    ds_read_b64_tr_b16 v[162:163], v207 offset:16672
    ds_read_b64_tr_b16 v[164:165], v207 offset:13376
    ds_read_b64_tr_b16 v[166:167], v207 offset:16704
    ds_read_b64_tr_b16 v[168:169], v207 offset:13408
    ds_read_b64_tr_b16 v[170:171], v207 offset:16736
    ds_read_b64_tr_b16 v[172:173], v207 offset:13440
    ds_read_b64_tr_b16 v[174:175], v207 offset:16768
    ds_read_b64_tr_b16 v[176:177], v207 offset:13472
    ds_read_b64_tr_b16 v[178:179], v207 offset:16800
    s_waitcnt lgkmcnt(15)
    v_mfma_f32_16x16x32_bf16 v[4:7], v[132:135], v[100:103], v[4:7]
    v_mfma_f32_16x16x32_bf16 v[8:11], v[132:135], v[104:107], v[8:11]
    v_mfma_f32_16x16x32_bf16 v[12:15], v[132:135], v[108:111], v[12:15]
    v_mfma_f32_16x16x32_bf16 v[16:19], v[132:135], v[112:115], v[16:19]
    v_mfma_f32_16x16x32_bf16 v[20:23], v[136:139], v[100:103], v[20:23]
    v_mfma_f32_16x16x32_bf16 v[24:27], v[136:139], v[104:107], v[24:27]
    v_mfma_f32_16x16x32_bf16 v[28:31], v[136:139], v[108:111], v[28:31]
    v_mfma_f32_16x16x32_bf16 v[32:35], v[136:139], v[112:115], v[32:35]
    v_mfma_f32_16x16x32_bf16 v[36:39], v[140:143], v[100:103], v[36:39]
    v_mfma_f32_16x16x32_bf16 v[40:43], v[140:143], v[104:107], v[40:43]
    v_mfma_f32_16x16x32_bf16 v[44:47], v[140:143], v[108:111], v[44:47]
    v_mfma_f32_16x16x32_bf16 v[48:51], v[140:143], v[112:115], v[48:51]
    v_mfma_f32_16x16x32_bf16 v[52:55], v[144:147], v[100:103], v[52:55]
    v_mfma_f32_16x16x32_bf16 v[56:59], v[144:147], v[104:107], v[56:59]
    v_mfma_f32_16x16x32_bf16 v[60:63], v[144:147], v[108:111], v[60:63]
    v_mfma_f32_16x16x32_bf16 v[64:67], v[144:147], v[112:115], v[64:67]
    v_mfma_f32_16x16x32_bf16 v[68:71], v[148:151], v[100:103], v[68:71]
    v_mfma_f32_16x16x32_bf16 v[72:75], v[148:151], v[104:107], v[72:75]
    v_mfma_f32_16x16x32_bf16 v[76:79], v[148:151], v[108:111], v[76:79]
    v_mfma_f32_16x16x32_bf16 v[80:83], v[148:151], v[112:115], v[80:83]
    v_mfma_f32_16x16x32_bf16 v[84:87], v[152:155], v[100:103], v[84:87]
    v_mfma_f32_16x16x32_bf16 v[88:91], v[152:155], v[104:107], v[88:91]
    v_mfma_f32_16x16x32_bf16 v[92:95], v[152:155], v[108:111], v[92:95]
    v_mfma_f32_16x16x32_bf16 v[96:99], v[152:155], v[112:115], v[96:99]
    s_waitcnt lgkmcnt(0)
    v_mfma_f32_16x16x32_bf16 v[4:7], v[156:159], v[116:119], v[4:7]
    v_mfma_f32_16x16x32_bf16 v[8:11], v[156:159], v[120:123], v[8:11]
    v_mfma_f32_16x16x32_bf16 v[12:15], v[156:159], v[124:127], v[12:15]
    v_mfma_f32_16x16x32_bf16 v[16:19], v[156:159], v[128:131], v[16:19]
    v_mfma_f32_16x16x32_bf16 v[20:23], v[160:163], v[116:119], v[20:23]
    v_mfma_f32_16x16x32_bf16 v[24:27], v[160:163], v[120:123], v[24:27]
    v_mfma_f32_16x16x32_bf16 v[28:31], v[160:163], v[124:127], v[28:31]
    v_mfma_f32_16x16x32_bf16 v[32:35], v[160:163], v[128:131], v[32:35]
    v_mfma_f32_16x16x32_bf16 v[36:39], v[164:167], v[116:119], v[36:39]
    v_mfma_f32_16x16x32_bf16 v[40:43], v[164:167], v[120:123], v[40:43]
    v_mfma_f32_16x16x32_bf16 v[44:47], v[164:167], v[124:127], v[44:47]
    v_mfma_f32_16x16x32_bf16 v[48:51], v[164:167], v[128:131], v[48:51]
    v_mfma_f32_16x16x32_bf16 v[52:55], v[168:171], v[116:119], v[52:55]
    v_mfma_f32_16x16x32_bf16 v[56:59], v[168:171], v[120:123], v[56:59]
    v_mfma_f32_16x16x32_bf16 v[60:63], v[168:171], v[124:127], v[60:63]
    v_mfma_f32_16x16x32_bf16 v[64:67], v[168:171], v[128:131], v[64:67]
    v_mfma_f32_16x16x32_bf16 v[68:71], v[172:175], v[116:119], v[68:71]
    v_mfma_f32_16x16x32_bf16 v[72:75], v[172:175], v[120:123], v[72:75]
    v_mfma_f32_16x16x32_bf16 v[76:79], v[172:175], v[124:127], v[76:79]
    v_mfma_f32_16x16x32_bf16 v[80:83], v[172:175], v[128:131], v[80:83]
    v_mfma_f32_16x16x32_bf16 v[84:87], v[176:179], v[116:119], v[84:87]
    v_mfma_f32_16x16x32_bf16 v[88:91], v[176:179], v[120:123], v[88:91]
    v_mfma_f32_16x16x32_bf16 v[92:95], v[176:179], v[124:127], v[92:95]
    v_mfma_f32_16x16x32_bf16 v[96:99], v[176:179], v[128:131], v[96:99]
    s_waitcnt vmcnt(11)
    s_barrier
    ds_read_b128 v[100:103], v209 offset:0
    ds_read_b128 v[104:107], v209 offset:2048
    ds_read_b128 v[108:111], v209 offset:4096
    ds_read_b128 v[112:115], v209 offset:6144
    ds_read_b64_tr_b16 v[132:133], v211 offset:0
    ds_read_b64_tr_b16 v[134:135], v211 offset:3328
    ds_read_b64_tr_b16 v[136:137], v211 offset:32
    ds_read_b64_tr_b16 v[138:139], v211 offset:3360
    ds_read_b64_tr_b16 v[140:141], v211 offset:64
    ds_read_b64_tr_b16 v[142:143], v211 offset:3392
    ds_read_b64_tr_b16 v[144:145], v211 offset:96
    ds_read_b64_tr_b16 v[146:147], v211 offset:3424
    ds_read_b64_tr_b16 v[148:149], v211 offset:128
    ds_read_b64_tr_b16 v[150:151], v211 offset:3456
    ds_read_b64_tr_b16 v[152:153], v211 offset:160
    ds_read_b64_tr_b16 v[154:155], v211 offset:3488
    s_add_u32 m0, s43, 0
    s_nop 0
    buffer_load_dwordx4 v180, s[8:11], s44 offen lds
    s_add_u32 m0, s43, 4096
    s_nop 0
    buffer_load_dwordx4 v181, s[8:11], s44 offen lds
    s_add_u32 m0, s43, 8192
    s_nop 0
    buffer_load_dwordx4 v182, s[8:11], s44 offen lds
    s_add_u32 m0, s43, 12288
    s_nop 0
    buffer_load_dwordx4 v183, s[8:11], s44 offen lds
    s_add_u32 m0, s43, 16384
    s_nop 0
    buffer_load_dwordx4 v184, s[12:15], s45 offen lds
    s_add_u32 m0, s43, 20480
    s_nop 0
    buffer_load_dwordx4 v185, s[12:15], s45 offen lds
    s_add_u32 m0, s43, 24576
    s_nop 0
    buffer_load_dwordx4 v186, s[12:15], s45 offen lds
    s_add_u32 m0, s43, 28672
    s_nop 0
    buffer_load_dwordx4 v187, s[12:15], s45 offen lds
    s_add_u32 m0, s43, 32768
    s_nop 0
    buffer_load_dwordx4 v188, s[12:15], s45 offen lds
    s_add_u32 m0, s43, 36864
    s_nop 0
    buffer_load_dwordx4 v189, s[12:15], s45 offen lds
    s_add_u32 m0, s43, 40960
    s_nop 0
    buffer_load_dwordx4 v190, s[12:15], s45 offen lds
    s_add_u32 s44, s44, 128
    s_add_u32 s45, s45, 393216
    ds_read_b128 v[116:119], v210 offset:0
    ds_read_b128 v[120:123], v210 offset:2048
    ds_read_b128 v[124:127], v210 offset:4096
    ds_read_b128 v[128:131], v210 offset:6144
    ds_read_b64_tr_b16 v[156:157], v211 offset:13312
    ds_read_b64_tr_b16 v[158:159], v211 offset:16640
    ds_read_b64_tr_b16 v[160:161], v211 offset:13344
    ds_read_b64_tr_b16 v[162:163], v211 offset:16672
    ds_read_b64_tr_b16 v[164:165], v211 offset:13376
    ds_read_b64_tr_b16 v[166:167], v211 offset:16704
    ds_read_b64_tr_b16 v[168:169], v211 offset:13408
    ds_read_b64_tr_b16 v[170:171], v211 offset:16736
    ds_read_b64_tr_b16 v[172:173], v211 offset:13440
    ds_read_b64_tr_b16 v[174:175], v211 offset:16768
    ds_read_b64_tr_b16 v[176:177], v211 offset:13472
    ds_read_b64_tr_b16 v[178:179], v211 offset:16800
    s_waitcnt lgkmcnt(15)
    v_mfma_f32_16x16x32_bf16 v[4:7], v[132:135], v[100:103], v[4:7]
    v_mfma_f32_16x16x32_bf16 v[8:11], v[132:135], v[104:107], v[8:11]
    v_mfma_f32_16x16x32_bf16 v[12:15], v[132:135], v[108:111], v[12:15]
    v_mfma_f32_16x16x32_bf16 v[16:19], v[132:135], v[112:115], v[16:19]
    v_mfma_f32_16x16x32_bf16 v[20:23], v[136:139], v[100:103], v[20:23]
    v_mfma_f32_16x16x32_bf16 v[24:27], v[136:139], v[104:107], v[24:27]
    v_mfma_f32_16x16x32_bf16 v[28:31], v[136:139], v[108:111], v[28:31]
    v_mfma_f32_16x16x32_bf16 v[32:35], v[136:139], v[112:115], v[32:35]
    v_mfma_f32_16x16x32_bf16 v[36:39], v[140:143], v[100:103], v[36:39]
    v_mfma_f32_16x16x32_bf16 v[40:43], v[140:143], v[104:107], v[40:43]
    v_mfma_f32_16x16x32_bf16 v[44:47], v[140:143], v[108:111], v[44:47]
    v_mfma_f32_16x16x32_bf16 v[48:51], v[140:143], v[112:115], v[48:51]
    v_mfma_f32_16x16x32_bf16 v[52:55], v[144:147], v[100:103], v[52:55]
    v_mfma_f32_16x16x32_bf16 v[56:59], v[144:147], v[104:107], v[56:59]
    v_mfma_f32_16x16x32_bf16 v[60:63], v[144:147], v[108:111], v[60:63]
    v_mfma_f32_16x16x32_bf16 v[64:67], v[144:147], v[112:115], v[64:67]
    v_mfma_f32_16x16x32_bf16 v[68:71], v[148:151], v[100:103], v[68:71]
    v_mfma_f32_16x16x32_bf16 v[72:75], v[148:151], v[104:107], v[72:75]
    v_mfma_f32_16x16x32_bf16 v[76:79], v[148:151], v[108:111], v[76:79]
    v_mfma_f32_16x16x32_bf16 v[80:83], v[148:151], v[112:115], v[80:83]
    v_mfma_f32_16x16x32_bf16 v[84:87], v[152:155], v[100:103], v[84:87]
    v_mfma_f32_16x16x32_bf16 v[88:91], v[152:155], v[104:107], v[88:91]
    v_mfma_f32_16x16x32_bf16 v[92:95], v[152:155], v[108:111], v[92:95]
    v_mfma_f32_16x16x32_bf16 v[96:99], v[152:155], v[112:115], v[96:99]
    s_waitcnt lgkmcnt(0)
    v_mfma_f32_16x16x32_bf16 v[4:7], v[156:159], v[116:119], v[4:7]
    v_mfma_f32_16x16x32_bf16 v[8:11], v[156:159], v[120:123], v[8:11]
    v_mfma_f32_16x16x32_bf16 v[12:15], v[156:159], v[124:127], v[12:15]
    v_mfma_f32_16x16x32_bf16 v[16:19], v[156:159], v[128:131], v[16:19]
    v_mfma_f32_16x16x32_bf16 v[20:23], v[160:163], v[116:119], v[20:23]
    v_mfma_f32_16x16x32_bf16 v[24:27], v[160:163], v[120:123], v[24:27]
    v_mfma_f32_16x16x32_bf16 v[28:31], v[160:163], v[124:127], v[28:31]
    v_mfma_f32_16x16x32_bf16 v[32:35], v[160:163], v[128:131], v[32:35]
    v_mfma_f32_16x16x32_bf16 v[36:39], v[164:167], v[116:119], v[36:39]
    v_mfma_f32_16x16x32_bf16 v[40:43], v[164:167], v[120:123], v[40:43]
    v_mfma_f32_16x16x32_bf16 v[44:47], v[164:167], v[124:127], v[44:47]
    v_mfma_f32_16x16x32_bf16 v[48:51], v[164:167], v[128:131], v[48:51]
    v_mfma_f32_16x16x32_bf16 v[52:55], v[168:171], v[116:119], v[52:55]
    v_mfma_f32_16x16x32_bf16 v[56:59], v[168:171], v[120:123], v[56:59]
    v_mfma_f32_16x16x32_bf16 v[60:63], v[168:171], v[124:127], v[60:63]
    v_mfma_f32_16x16x32_bf16 v[64:67], v[168:171], v[128:131], v[64:67]
    v_mfma_f32_16x16x32_bf16 v[68:71], v[172:175], v[116:119], v[68:71]
    v_mfma_f32_16x16x32_bf16 v[72:75], v[172:175], v[120:123], v[72:75]
    v_mfma_f32_16x16x32_bf16 v[76:79], v[172:175], v[124:127], v[76:79]
    v_mfma_f32_16x16x32_bf16 v[80:83], v[172:175], v[128:131], v[80:83]
    v_mfma_f32_16x16x32_bf16 v[84:87], v[176:179], v[116:119], v[84:87]
    v_mfma_f32_16x16x32_bf16 v[88:91], v[176:179], v[120:123], v[88:91]
    v_mfma_f32_16x16x32_bf16 v[92:95], v[176:179], v[124:127], v[92:95]
    v_mfma_f32_16x16x32_bf16 v[96:99], v[176:179], v[128:131], v[96:99]
    s_waitcnt vmcnt(11)
    s_barrier
    ds_read_b128 v[100:103], v213 offset:0
    ds_read_b128 v[104:107], v213 offset:2048
    ds_read_b128 v[108:111], v213 offset:4096
    ds_read_b128 v[112:115], v213 offset:6144
    ds_read_b64_tr_b16 v[132:133], v215 offset:0
    ds_read_b64_tr_b16 v[134:135], v215 offset:3328
    ds_read_b64_tr_b16 v[136:137], v215 offset:32
    ds_read_b64_tr_b16 v[138:139], v215 offset:3360
    ds_read_b64_tr_b16 v[140:141], v215 offset:64
    ds_read_b64_tr_b16 v[142:143], v215 offset:3392
    ds_read_b64_tr_b16 v[144:145], v215 offset:96
    ds_read_b64_tr_b16 v[146:147], v215 offset:3424
    ds_read_b64_tr_b16 v[148:149], v215 offset:128
    ds_read_b64_tr_b16 v[150:151], v215 offset:3456
    ds_read_b64_tr_b16 v[152:153], v215 offset:160
    ds_read_b64_tr_b16 v[154:155], v215 offset:3488
    s_add_u32 m0, s43, 45056
    s_nop 0
    buffer_load_dwordx4 v180, s[8:11], s44 offen lds
    s_add_u32 m0, s43, 49152
    s_nop 0
    buffer_load_dwordx4 v181, s[8:11], s44 offen lds
    s_add_u32 m0, s43, 53248
    s_nop 0
    buffer_load_dwordx4 v182, s[8:11], s44 offen lds
    s_add_u32 m0, s43, 57344
    s_nop 0
    buffer_load_dwordx4 v183, s[8:11], s44 offen lds
    s_add_u32 m0, s43, 61440
    s_nop 0
    buffer_load_dwordx4 v184, s[12:15], s45 offen lds
    s_add_u32 m0, s43, 65536
    s_nop 0
    buffer_load_dwordx4 v185, s[12:15], s45 offen lds
    s_add_u32 m0, s43, 69632
    s_nop 0
    buffer_load_dwordx4 v186, s[12:15], s45 offen lds
    s_add_u32 m0, s43, 73728
    s_nop 0
    buffer_load_dwordx4 v187, s[12:15], s45 offen lds
    s_add_u32 m0, s43, 77824
    s_nop 0
    buffer_load_dwordx4 v188, s[12:15], s45 offen lds
    s_add_u32 m0, s43, 81920
    s_nop 0
    buffer_load_dwordx4 v189, s[12:15], s45 offen lds
    s_add_u32 m0, s43, 86016
    s_nop 0
    buffer_load_dwordx4 v190, s[12:15], s45 offen lds
    s_add_u32 s44, s44, 128
    s_add_u32 s45, s45, 393216
    ds_read_b128 v[116:119], v214 offset:0
    ds_read_b128 v[120:123], v214 offset:2048
    ds_read_b128 v[124:127], v214 offset:4096
    ds_read_b128 v[128:131], v214 offset:6144
    ds_read_b64_tr_b16 v[156:157], v215 offset:13312
    ds_read_b64_tr_b16 v[158:159], v215 offset:16640
    ds_read_b64_tr_b16 v[160:161], v215 offset:13344
    ds_read_b64_tr_b16 v[162:163], v215 offset:16672
    ds_read_b64_tr_b16 v[164:165], v215 offset:13376
    ds_read_b64_tr_b16 v[166:167], v215 offset:16704
    ds_read_b64_tr_b16 v[168:169], v215 offset:13408
    ds_read_b64_tr_b16 v[170:171], v215 offset:16736
    ds_read_b64_tr_b16 v[172:173], v215 offset:13440
    ds_read_b64_tr_b16 v[174:175], v215 offset:16768
    ds_read_b64_tr_b16 v[176:177], v215 offset:13472
    ds_read_b64_tr_b16 v[178:179], v215 offset:16800
    s_waitcnt lgkmcnt(15)
    v_mfma_f32_16x16x32_bf16 v[4:7], v[132:135], v[100:103], v[4:7]
    v_mfma_f32_16x16x32_bf16 v[8:11], v[132:135], v[104:107], v[8:11]
    v_mfma_f32_16x16x32_bf16 v[12:15], v[132:135], v[108:111], v[12:15]
    v_mfma_f32_16x16x32_bf16 v[16:19], v[132:135], v[112:115], v[16:19]
    v_mfma_f32_16x16x32_bf16 v[20:23], v[136:139], v[100:103], v[20:23]
    v_mfma_f32_16x16x32_bf16 v[24:27], v[136:139], v[104:107], v[24:27]
    v_mfma_f32_16x16x32_bf16 v[28:31], v[136:139], v[108:111], v[28:31]
    v_mfma_f32_16x16x32_bf16 v[32:35], v[136:139], v[112:115], v[32:35]
    v_mfma_f32_16x16x32_bf16 v[36:39], v[140:143], v[100:103], v[36:39]
    v_mfma_f32_16x16x32_bf16 v[40:43], v[140:143], v[104:107], v[40:43]
    v_mfma_f32_16x16x32_bf16 v[44:47], v[140:143], v[108:111], v[44:47]
    v_mfma_f32_16x16x32_bf16 v[48:51], v[140:143], v[112:115], v[48:51]
    v_mfma_f32_16x16x32_bf16 v[52:55], v[144:147], v[100:103], v[52:55]
    v_mfma_f32_16x16x32_bf16 v[56:59], v[144:147], v[104:107], v[56:59]
    v_mfma_f32_16x16x32_bf16 v[60:63], v[144:147], v[108:111], v[60:63]
    v_mfma_f32_16x16x32_bf16 v[64:67], v[144:147], v[112:115], v[64:67]
    v_mfma_f32_16x16x32_bf16 v[68:71], v[148:151], v[100:103], v[68:71]
    v_mfma_f32_16x16x32_bf16 v[72:75], v[148:151], v[104:107], v[72:75]
    v_mfma_f32_16x16x32_bf16 v[76:79], v[148:151], v[108:111], v[76:79]
    v_mfma_f32_16x16x32_bf16 v[80:83], v[148:151], v[112:115], v[80:83]
    v_mfma_f32_16x16x32_bf16 v[84:87], v[152:155], v[100:103], v[84:87]
    v_mfma_f32_16x16x32_bf16 v[88:91], v[152:155], v[104:107], v[88:91]
    v_mfma_f32_16x16x32_bf16 v[92:95], v[152:155], v[108:111], v[92:95]
    v_mfma_f32_16x16x32_bf16 v[96:99], v[152:155], v[112:115], v[96:99]
    s_waitcnt lgkmcnt(0)
    v_mfma_f32_16x16x32_bf16 v[4:7], v[156:159], v[116:119], v[4:7]
    v_mfma_f32_16x16x32_bf16 v[8:11], v[156:159], v[120:123], v[8:11]
    v_mfma_f32_16x16x32_bf16 v[12:15], v[156:159], v[124:127], v[12:15]
    v_mfma_f32_16x16x32_bf16 v[16:19], v[156:159], v[128:131], v[16:19]
    v_mfma_f32_16x16x32_bf16 v[20:23], v[160:163], v[116:119], v[20:23]
    v_mfma_f32_16x16x32_bf16 v[24:27], v[160:163], v[120:123], v[24:27]
    v_mfma_f32_16x16x32_bf16 v[28:31], v[160:163], v[124:127], v[28:31]
    v_mfma_f32_16x16x32_bf16 v[32:35], v[160:163], v[128:131], v[32:35]
    v_mfma_f32_16x16x32_bf16 v[36:39], v[164:167], v[116:119], v[36:39]
    v_mfma_f32_16x16x32_bf16 v[40:43], v[164:167], v[120:123], v[40:43]
    v_mfma_f32_16x16x32_bf16 v[44:47], v[164:167], v[124:127], v[44:47]
    v_mfma_f32_16x16x32_bf16 v[48:51], v[164:167], v[128:131], v[48:51]
    v_mfma_f32_16x16x32_bf16 v[52:55], v[168:171], v[116:119], v[52:55]
    v_mfma_f32_16x16x32_bf16 v[56:59], v[168:171], v[120:123], v[56:59]
    v_mfma_f32_16x16x32_bf16 v[60:63], v[168:171], v[124:127], v[60:63]
    v_mfma_f32_16x16x32_bf16 v[64:67], v[168:171], v[128:131], v[64:67]
    v_mfma_f32_16x16x32_bf16 v[68:71], v[172:175], v[116:119], v[68:71]
    v_mfma_f32_16x16x32_bf16 v[72:75], v[172:175], v[120:123], v[72:75]
    v_mfma_f32_16x16x32_bf16 v[76:79], v[172:175], v[124:127], v[76:79]
    v_mfma_f32_16x16x32_bf16 v[80:83], v[172:175], v[128:131], v[80:83]
    v_mfma_f32_16x16x32_bf16 v[84:87], v[176:179], v[116:119], v[84:87]
    v_mfma_f32_16x16x32_bf16 v[88:91], v[176:179], v[120:123], v[88:91]
    v_mfma_f32_16x16x32_bf16 v[92:95], v[176:179], v[124:127], v[92:95]
    v_mfma_f32_16x16x32_bf16 v[96:99], v[176:179], v[128:131], v[96:99]
    s_waitcnt vmcnt(11)
    s_barrier
    ds_read_b128 v[100:103], v205 offset:0
    ds_read_b128 v[104:107], v205 offset:2048
    ds_read_b128 v[108:111], v205 offset:4096
    ds_read_b128 v[112:115], v205 offset:6144
    ds_read_b64_tr_b16 v[132:133], v207 offset:0
    ds_read_b64_tr_b16 v[134:135], v207 offset:3328
    ds_read_b64_tr_b16 v[136:137], v207 offset:32
    ds_read_b64_tr_b16 v[138:139], v207 offset:3360
    ds_read_b64_tr_b16 v[140:141], v207 offset:64
    ds_read_b64_tr_b16 v[142:143], v207 offset:3392
    ds_read_b64_tr_b16 v[144:145], v207 offset:96
    ds_read_b64_tr_b16 v[146:147], v207 offset:3424
    ds_read_b64_tr_b16 v[148:149], v207 offset:128
    ds_read_b64_tr_b16 v[150:151], v207 offset:3456
    ds_read_b64_tr_b16 v[152:153], v207 offset:160
    ds_read_b64_tr_b16 v[154:155], v207 offset:3488
    s_add_u32 m0, s43, 90112
    s_nop 0
    buffer_load_dwordx4 v180, s[8:11], s44 offen lds
    s_add_u32 m0, s43, 94208
    s_nop 0
    buffer_load_dwordx4 v181, s[8:11], s44 offen lds
    s_add_u32 m0, s43, 98304
    s_nop 0
    buffer_load_dwordx4 v182, s[8:11], s44 offen lds
    s_add_u32 m0, s43, 102400
    s_nop 0
    buffer_load_dwordx4 v183, s[8:11], s44 offen lds
    s_add_u32 m0, s43, 106496
    s_nop 0
    buffer_load_dwordx4 v184, s[12:15], s45 offen lds
    s_add_u32 m0, s43, 110592
    s_nop 0
    buffer_load_dwordx4 v185, s[12:15], s45 offen lds
    s_add_u32 m0, s43, 114688
    s_nop 0
    buffer_load_dwordx4 v186, s[12:15], s45 offen lds
    s_add_u32 m0, s43, 118784
    s_nop 0
    buffer_load_dwordx4 v187, s[12:15], s45 offen lds
    s_add_u32 m0, s43, 122880
    s_nop 0
    buffer_load_dwordx4 v188, s[12:15], s45 offen lds
    s_add_u32 m0, s43, 126976
    s_nop 0
    buffer_load_dwordx4 v189, s[12:15], s45 offen lds
    s_add_u32 m0, s43, 131072
    s_nop 0
    buffer_load_dwordx4 v190, s[12:15], s45 offen lds
    s_add_u32 s44, s44, 128
    s_add_u32 s45, s45, 393216
    ds_read_b128 v[116:119], v206 offset:0
    ds_read_b128 v[120:123], v206 offset:2048
    ds_read_b128 v[124:127], v206 offset:4096
    ds_read_b128 v[128:131], v206 offset:6144
    ds_read_b64_tr_b16 v[156:157], v207 offset:13312
    ds_read_b64_tr_b16 v[158:159], v207 offset:16640
    ds_read_b64_tr_b16 v[160:161], v207 offset:13344
    ds_read_b64_tr_b16 v[162:163], v207 offset:16672
    ds_read_b64_tr_b16 v[164:165], v207 offset:13376
    ds_read_b64_tr_b16 v[166:167], v207 offset:16704
    ds_read_b64_tr_b16 v[168:169], v207 offset:13408
    ds_read_b64_tr_b16 v[170:171], v207 offset:16736
    ds_read_b64_tr_b16 v[172:173], v207 offset:13440
    ds_read_b64_tr_b16 v[174:175], v207 offset:16768
    ds_read_b64_tr_b16 v[176:177], v207 offset:13472
    ds_read_b64_tr_b16 v[178:179], v207 offset:16800
    s_waitcnt lgkmcnt(15)
    v_mfma_f32_16x16x32_bf16 v[4:7], v[132:135], v[100:103], v[4:7]
    v_mfma_f32_16x16x32_bf16 v[8:11], v[132:135], v[104:107], v[8:11]
    v_mfma_f32_16x16x32_bf16 v[12:15], v[132:135], v[108:111], v[12:15]
    v_mfma_f32_16x16x32_bf16 v[16:19], v[132:135], v[112:115], v[16:19]
    v_mfma_f32_16x16x32_bf16 v[20:23], v[136:139], v[100:103], v[20:23]
    v_mfma_f32_16x16x32_bf16 v[24:27], v[136:139], v[104:107], v[24:27]
    v_mfma_f32_16x16x32_bf16 v[28:31], v[136:139], v[108:111], v[28:31]
    v_mfma_f32_16x16x32_bf16 v[32:35], v[136:139], v[112:115], v[32:35]
    v_mfma_f32_16x16x32_bf16 v[36:39], v[140:143], v[100:103], v[36:39]
    v_mfma_f32_16x16x32_bf16 v[40:43], v[140:143], v[104:107], v[40:43]
    v_mfma_f32_16x16x32_bf16 v[44:47], v[140:143], v[108:111], v[44:47]
    v_mfma_f32_16x16x32_bf16 v[48:51], v[140:143], v[112:115], v[48:51]
    v_mfma_f32_16x16x32_bf16 v[52:55], v[144:147], v[100:103], v[52:55]
    v_mfma_f32_16x16x32_bf16 v[56:59], v[144:147], v[104:107], v[56:59]
    v_mfma_f32_16x16x32_bf16 v[60:63], v[144:147], v[108:111], v[60:63]
    v_mfma_f32_16x16x32_bf16 v[64:67], v[144:147], v[112:115], v[64:67]
    v_mfma_f32_16x16x32_bf16 v[68:71], v[148:151], v[100:103], v[68:71]
    v_mfma_f32_16x16x32_bf16 v[72:75], v[148:151], v[104:107], v[72:75]
    v_mfma_f32_16x16x32_bf16 v[76:79], v[148:151], v[108:111], v[76:79]
    v_mfma_f32_16x16x32_bf16 v[80:83], v[148:151], v[112:115], v[80:83]
    v_mfma_f32_16x16x32_bf16 v[84:87], v[152:155], v[100:103], v[84:87]
    v_mfma_f32_16x16x32_bf16 v[88:91], v[152:155], v[104:107], v[88:91]
    v_mfma_f32_16x16x32_bf16 v[92:95], v[152:155], v[108:111], v[92:95]
    v_mfma_f32_16x16x32_bf16 v[96:99], v[152:155], v[112:115], v[96:99]
    s_waitcnt lgkmcnt(0)
    v_mfma_f32_16x16x32_bf16 v[4:7], v[156:159], v[116:119], v[4:7]
    v_mfma_f32_16x16x32_bf16 v[8:11], v[156:159], v[120:123], v[8:11]
    v_mfma_f32_16x16x32_bf16 v[12:15], v[156:159], v[124:127], v[12:15]
    v_mfma_f32_16x16x32_bf16 v[16:19], v[156:159], v[128:131], v[16:19]
    v_mfma_f32_16x16x32_bf16 v[20:23], v[160:163], v[116:119], v[20:23]
    v_mfma_f32_16x16x32_bf16 v[24:27], v[160:163], v[120:123], v[24:27]
    v_mfma_f32_16x16x32_bf16 v[28:31], v[160:163], v[124:127], v[28:31]
    v_mfma_f32_16x16x32_bf16 v[32:35], v[160:163], v[128:131], v[32:35]
    v_mfma_f32_16x16x32_bf16 v[36:39], v[164:167], v[116:119], v[36:39]
    v_mfma_f32_16x16x32_bf16 v[40:43], v[164:167], v[120:123], v[40:43]
    v_mfma_f32_16x16x32_bf16 v[44:47], v[164:167], v[124:127], v[44:47]
    v_mfma_f32_16x16x32_bf16 v[48:51], v[164:167], v[128:131], v[48:51]
    v_mfma_f32_16x16x32_bf16 v[52:55], v[168:171], v[116:119], v[52:55]
    v_mfma_f32_16x16x32_bf16 v[56:59], v[168:171], v[120:123], v[56:59]
    v_mfma_f32_16x16x32_bf16 v[60:63], v[168:171], v[124:127], v[60:63]
    v_mfma_f32_16x16x32_bf16 v[64:67], v[168:171], v[128:131], v[64:67]
    v_mfma_f32_16x16x32_bf16 v[68:71], v[172:175], v[116:119], v[68:71]
    v_mfma_f32_16x16x32_bf16 v[72:75], v[172:175], v[120:123], v[72:75]
    v_mfma_f32_16x16x32_bf16 v[76:79], v[172:175], v[124:127], v[76:79]
    v_mfma_f32_16x16x32_bf16 v[80:83], v[172:175], v[128:131], v[80:83]
    v_mfma_f32_16x16x32_bf16 v[84:87], v[176:179], v[116:119], v[84:87]
    v_mfma_f32_16x16x32_bf16 v[88:91], v[176:179], v[120:123], v[88:91]
    v_mfma_f32_16x16x32_bf16 v[92:95], v[176:179], v[124:127], v[92:95]
    v_mfma_f32_16x16x32_bf16 v[96:99], v[176:179], v[128:131], v[96:99]
    s_waitcnt vmcnt(11)
    s_barrier
    ds_read_b128 v[100:103], v209 offset:0
    ds_read_b128 v[104:107], v209 offset:2048
    ds_read_b128 v[108:111], v209 offset:4096
    ds_read_b128 v[112:115], v209 offset:6144
    ds_read_b64_tr_b16 v[132:133], v211 offset:0
    ds_read_b64_tr_b16 v[134:135], v211 offset:3328
    ds_read_b64_tr_b16 v[136:137], v211 offset:32
    ds_read_b64_tr_b16 v[138:139], v211 offset:3360
    ds_read_b64_tr_b16 v[140:141], v211 offset:64
    ds_read_b64_tr_b16 v[142:143], v211 offset:3392
    ds_read_b64_tr_b16 v[144:145], v211 offset:96
    ds_read_b64_tr_b16 v[146:147], v211 offset:3424
    ds_read_b64_tr_b16 v[148:149], v211 offset:128
    ds_read_b64_tr_b16 v[150:151], v211 offset:3456
    ds_read_b64_tr_b16 v[152:153], v211 offset:160
    ds_read_b64_tr_b16 v[154:155], v211 offset:3488
    ds_read_b128 v[116:119], v210 offset:0
    ds_read_b128 v[120:123], v210 offset:2048
    ds_read_b128 v[124:127], v210 offset:4096
    ds_read_b128 v[128:131], v210 offset:6144
    ds_read_b64_tr_b16 v[156:157], v211 offset:13312
    ds_read_b64_tr_b16 v[158:159], v211 offset:16640
    ds_read_b64_tr_b16 v[160:161], v211 offset:13344
    ds_read_b64_tr_b16 v[162:163], v211 offset:16672
    ds_read_b64_tr_b16 v[164:165], v211 offset:13376
    ds_read_b64_tr_b16 v[166:167], v211 offset:16704
    ds_read_b64_tr_b16 v[168:169], v211 offset:13408
    ds_read_b64_tr_b16 v[170:171], v211 offset:16736
    ds_read_b64_tr_b16 v[172:173], v211 offset:13440
    ds_read_b64_tr_b16 v[174:175], v211 offset:16768
    ds_read_b64_tr_b16 v[176:177], v211 offset:13472
    ds_read_b64_tr_b16 v[178:179], v211 offset:16800
    s_waitcnt lgkmcnt(15)
    v_mfma_f32_16x16x32_bf16 v[4:7], v[132:135], v[100:103], v[4:7]
    v_mfma_f32_16x16x32_bf16 v[8:11], v[132:135], v[104:107], v[8:11]
    v_mfma_f32_16x16x32_bf16 v[12:15], v[132:135], v[108:111], v[12:15]
    v_mfma_f32_16x16x32_bf16 v[16:19], v[132:135], v[112:115], v[16:19]
    v_mfma_f32_16x16x32_bf16 v[20:23], v[136:139], v[100:103], v[20:23]
    v_mfma_f32_16x16x32_bf16 v[24:27], v[136:139], v[104:107], v[24:27]
    v_mfma_f32_16x16x32_bf16 v[28:31], v[136:139], v[108:111], v[28:31]
    v_mfma_f32_16x16x32_bf16 v[32:35], v[136:139], v[112:115], v[32:35]
    v_mfma_f32_16x16x32_bf16 v[36:39], v[140:143], v[100:103], v[36:39]
    v_mfma_f32_16x16x32_bf16 v[40:43], v[140:143], v[104:107], v[40:43]
    v_mfma_f32_16x16x32_bf16 v[44:47], v[140:143], v[108:111], v[44:47]
    v_mfma_f32_16x16x32_bf16 v[48:51], v[140:143], v[112:115], v[48:51]
    v_mfma_f32_16x16x32_bf16 v[52:55], v[144:147], v[100:103], v[52:55]
    v_mfma_f32_16x16x32_bf16 v[56:59], v[144:147], v[104:107], v[56:59]
    v_mfma_f32_16x16x32_bf16 v[60:63], v[144:147], v[108:111], v[60:63]
    v_mfma_f32_16x16x32_bf16 v[64:67], v[144:147], v[112:115], v[64:67]
    v_mfma_f32_16x16x32_bf16 v[68:71], v[148:151], v[100:103], v[68:71]
    v_mfma_f32_16x16x32_bf16 v[72:75], v[148:151], v[104:107], v[72:75]
    v_mfma_f32_16x16x32_bf16 v[76:79], v[148:151], v[108:111], v[76:79]
    v_mfma_f32_16x16x32_bf16 v[80:83], v[148:151], v[112:115], v[80:83]
    v_mfma_f32_16x16x32_bf16 v[84:87], v[152:155], v[100:103], v[84:87]
    v_mfma_f32_16x16x32_bf16 v[88:91], v[152:155], v[104:107], v[88:91]
    v_mfma_f32_16x16x32_bf16 v[92:95], v[152:155], v[108:111], v[92:95]
    v_mfma_f32_16x16x32_bf16 v[96:99], v[152:155], v[112:115], v[96:99]
    s_waitcnt lgkmcnt(0)
    v_mfma_f32_16x16x32_bf16 v[4:7], v[156:159], v[116:119], v[4:7]
    v_mfma_f32_16x16x32_bf16 v[8:11], v[156:159], v[120:123], v[8:11]
    v_mfma_f32_16x16x32_bf16 v[12:15], v[156:159], v[124:127], v[12:15]
    v_mfma_f32_16x16x32_bf16 v[16:19], v[156:159], v[128:131], v[16:19]
    v_mfma_f32_16x16x32_bf16 v[20:23], v[160:163], v[116:119], v[20:23]
    v_mfma_f32_16x16x32_bf16 v[24:27], v[160:163], v[120:123], v[24:27]
    v_mfma_f32_16x16x32_bf16 v[28:31], v[160:163], v[124:127], v[28:31]
    v_mfma_f32_16x16x32_bf16 v[32:35], v[160:163], v[128:131], v[32:35]
    v_mfma_f32_16x16x32_bf16 v[36:39], v[164:167], v[116:119], v[36:39]
    v_mfma_f32_16x16x32_bf16 v[40:43], v[164:167], v[120:123], v[40:43]
    v_mfma_f32_16x16x32_bf16 v[44:47], v[164:167], v[124:127], v[44:47]
    v_mfma_f32_16x16x32_bf16 v[48:51], v[164:167], v[128:131], v[48:51]
    v_mfma_f32_16x16x32_bf16 v[52:55], v[168:171], v[116:119], v[52:55]
    v_mfma_f32_16x16x32_bf16 v[56:59], v[168:171], v[120:123], v[56:59]
    v_mfma_f32_16x16x32_bf16 v[60:63], v[168:171], v[124:127], v[60:63]
    v_mfma_f32_16x16x32_bf16 v[64:67], v[168:171], v[128:131], v[64:67]
    v_mfma_f32_16x16x32_bf16 v[68:71], v[172:175], v[116:119], v[68:71]
    v_mfma_f32_16x16x32_bf16 v[72:75], v[172:175], v[120:123], v[72:75]
    v_mfma_f32_16x16x32_bf16 v[76:79], v[172:175], v[124:127], v[76:79]
    v_mfma_f32_16x16x32_bf16 v[80:83], v[172:175], v[128:131], v[80:83]
    v_mfma_f32_16x16x32_bf16 v[84:87], v[176:179], v[116:119], v[84:87]
    v_mfma_f32_16x16x32_bf16 v[88:91], v[176:179], v[120:123], v[88:91]
    v_mfma_f32_16x16x32_bf16 v[92:95], v[176:179], v[124:127], v[92:95]
    v_mfma_f32_16x16x32_bf16 v[96:99], v[176:179], v[128:131], v[96:99]
    s_waitcnt vmcnt(0)
    s_barrier
    ds_read_b128 v[100:103], v213 offset:0
    ds_read_b128 v[104:107], v213 offset:2048
    ds_read_b128 v[108:111], v213 offset:4096
    ds_read_b128 v[112:115], v213 offset:6144
    ds_read_b64_tr_b16 v[132:133], v215 offset:0
    ds_read_b64_tr_b16 v[134:135], v215 offset:3328
    ds_read_b64_tr_b16 v[136:137], v215 offset:32
    ds_read_b64_tr_b16 v[138:139], v215 offset:3360
    ds_read_b64_tr_b16 v[140:141], v215 offset:64
    ds_read_b64_tr_b16 v[142:143], v215 offset:3392
    ds_read_b64_tr_b16 v[144:145], v215 offset:96
    ds_read_b64_tr_b16 v[146:147], v215 offset:3424
    ds_read_b64_tr_b16 v[148:149], v215 offset:128
    ds_read_b64_tr_b16 v[150:151], v215 offset:3456
    ds_read_b64_tr_b16 v[152:153], v215 offset:160
    ds_read_b64_tr_b16 v[154:155], v215 offset:3488
    ds_read_b128 v[116:119], v214 offset:0
    ds_read_b128 v[120:123], v214 offset:2048
    ds_read_b128 v[124:127], v214 offset:4096
    ds_read_b128 v[128:131], v214 offset:6144
    ds_read_b64_tr_b16 v[156:157], v215 offset:13312
    ds_read_b64_tr_b16 v[158:159], v215 offset:16640
    ds_read_b64_tr_b16 v[160:161], v215 offset:13344
    ds_read_b64_tr_b16 v[162:163], v215 offset:16672
    ds_read_b64_tr_b16 v[164:165], v215 offset:13376
    ds_read_b64_tr_b16 v[166:167], v215 offset:16704
    ds_read_b64_tr_b16 v[168:169], v215 offset:13408
    ds_read_b64_tr_b16 v[170:171], v215 offset:16736
    ds_read_b64_tr_b16 v[172:173], v215 offset:13440
    ds_read_b64_tr_b16 v[174:175], v215 offset:16768
    ds_read_b64_tr_b16 v[176:177], v215 offset:13472
    ds_read_b64_tr_b16 v[178:179], v215 offset:16800
    s_waitcnt lgkmcnt(15)
    v_mfma_f32_16x16x32_bf16 v[4:7], v[132:135], v[100:103], v[4:7]
    v_mfma_f32_16x16x32_bf16 v[8:11], v[132:135], v[104:107], v[8:11]
    v_mfma_f32_16x16x32_bf16 v[12:15], v[132:135], v[108:111], v[12:15]
    v_mfma_f32_16x16x32_bf16 v[16:19], v[132:135], v[112:115], v[16:19]
    v_mfma_f32_16x16x32_bf16 v[20:23], v[136:139], v[100:103], v[20:23]
    v_mfma_f32_16x16x32_bf16 v[24:27], v[136:139], v[104:107], v[24:27]
    v_mfma_f32_16x16x32_bf16 v[28:31], v[136:139], v[108:111], v[28:31]
    v_mfma_f32_16x16x32_bf16 v[32:35], v[136:139], v[112:115], v[32:35]
    v_mfma_f32_16x16x32_bf16 v[36:39], v[140:143], v[100:103], v[36:39]
    v_mfma_f32_16x16x32_bf16 v[40:43], v[140:143], v[104:107], v[40:43]
    v_mfma_f32_16x16x32_bf16 v[44:47], v[140:143], v[108:111], v[44:47]
    v_mfma_f32_16x16x32_bf16 v[48:51], v[140:143], v[112:115], v[48:51]
    v_mfma_f32_16x16x32_bf16 v[52:55], v[144:147], v[100:103], v[52:55]
    v_mfma_f32_16x16x32_bf16 v[56:59], v[144:147], v[104:107], v[56:59]
    v_mfma_f32_16x16x32_bf16 v[60:63], v[144:147], v[108:111], v[60:63]
    v_mfma_f32_16x16x32_bf16 v[64:67], v[144:147], v[112:115], v[64:67]
    v_mfma_f32_16x16x32_bf16 v[68:71], v[148:151], v[100:103], v[68:71]
    v_mfma_f32_16x16x32_bf16 v[72:75], v[148:151], v[104:107], v[72:75]
    v_mfma_f32_16x16x32_bf16 v[76:79], v[148:151], v[108:111], v[76:79]
    v_mfma_f32_16x16x32_bf16 v[80:83], v[148:151], v[112:115], v[80:83]
    v_mfma_f32_16x16x32_bf16 v[84:87], v[152:155], v[100:103], v[84:87]
    v_mfma_f32_16x16x32_bf16 v[88:91], v[152:155], v[104:107], v[88:91]
    v_mfma_f32_16x16x32_bf16 v[92:95], v[152:155], v[108:111], v[92:95]
    v_mfma_f32_16x16x32_bf16 v[96:99], v[152:155], v[112:115], v[96:99]
    s_waitcnt lgkmcnt(0)
    v_mfma_f32_16x16x32_bf16 v[4:7], v[156:159], v[116:119], v[4:7]
    v_mfma_f32_16x16x32_bf16 v[8:11], v[156:159], v[120:123], v[8:11]
    v_mfma_f32_16x16x32_bf16 v[12:15], v[156:159], v[124:127], v[12:15]
    v_mfma_f32_16x16x32_bf16 v[16:19], v[156:159], v[128:131], v[16:19]
    v_mfma_f32_16x16x32_bf16 v[20:23], v[160:163], v[116:119], v[20:23]
    v_mfma_f32_16x16x32_bf16 v[24:27], v[160:163], v[120:123], v[24:27]
    v_mfma_f32_16x16x32_bf16 v[28:31], v[160:163], v[124:127], v[28:31]
    v_mfma_f32_16x16x32_bf16 v[32:35], v[160:163], v[128:131], v[32:35]
    v_mfma_f32_16x16x32_bf16 v[36:39], v[164:167], v[116:119], v[36:39]
    v_mfma_f32_16x16x32_bf16 v[40:43], v[164:167], v[120:123], v[40:43]
    v_mfma_f32_16x16x32_bf16 v[44:47], v[164:167], v[124:127], v[44:47]
    v_mfma_f32_16x16x32_bf16 v[48:51], v[164:167], v[128:131], v[48:51]
    v_mfma_f32_16x16x32_bf16 v[52:55], v[168:171], v[116:119], v[52:55]
    v_mfma_f32_16x16x32_bf16 v[56:59], v[168:171], v[120:123], v[56:59]
    v_mfma_f32_16x16x32_bf16 v[60:63], v[168:171], v[124:127], v[60:63]
    v_mfma_f32_16x16x32_bf16 v[64:67], v[168:171], v[128:131], v[64:67]
    v_mfma_f32_16x16x32_bf16 v[68:71], v[172:175], v[116:119], v[68:71]
    v_mfma_f32_16x16x32_bf16 v[72:75], v[172:175], v[120:123], v[72:75]
    v_mfma_f32_16x16x32_bf16 v[76:79], v[172:175], v[124:127], v[76:79]
    v_mfma_f32_16x16x32_bf16 v[80:83], v[172:175], v[128:131], v[80:83]
    v_mfma_f32_16x16x32_bf16 v[84:87], v[176:179], v[116:119], v[84:87]
    v_mfma_f32_16x16x32_bf16 v[88:91], v[176:179], v[120:123], v[88:91]
    v_mfma_f32_16x16x32_bf16 v[92:95], v[176:179], v[124:127], v[92:95]
    v_mfma_f32_16x16x32_bf16 v[96:99], v[176:179], v[128:131], v[96:99]
    v_and_b32 v193, 15, v1
    v_lshrrev_b32 v194, 4, v1
    s_mul_i32 s40, s41, 64
    v_add_u32 v193, s40, v193
    s_mul_i32 s40, s42, 96
    v_lshl_add_u32 v194, v194, 2, s40
    s_mov_b32 s40, 6144
    v_mul_lo_u32 v195, s40, v193
    v_lshl_add_u32 v195, v194, 1, v195
    s_nop 7
    s_nop 7
    v_mul_f32 v203, v4, v4
    v_mov_b32 v204, 0x3d372713
    v_fma_f32 v203, v203, v204, 1.0
    v_mul_f32 v203, v203, v4
    v_mul_f32 v203, 0xc0135761, v203
    v_exp_f32 v203, v203
    s_nop 0
    v_add_f32 v203, 1.0, v203
    v_rcp_f32 v203, v203
    s_nop 0
    v_mul_f32 v4, v4, v203
    v_mul_f32 v203, v5, v5
    v_mov_b32 v204, 0x3d372713
    v_fma_f32 v203, v203, v204, 1.0
    v_mul_f32 v203, v203, v5
    v_mul_f32 v203, 0xc0135761, v203
    v_exp_f32 v203, v203
    s_nop 0
    v_add_f32 v203, 1.0, v203
    v_rcp_f32 v203, v203
    s_nop 0
    v_mul_f32 v5, v5, v203
    v_mul_f32 v203, v6, v6
    v_mov_b32 v204, 0x3d372713
    v_fma_f32 v203, v203, v204, 1.0
    v_mul_f32 v203, v203, v6
    v_mul_f32 v203, 0xc0135761, v203
    v_exp_f32 v203, v203
    s_nop 0
    v_add_f32 v203, 1.0, v203
    v_rcp_f32 v203, v203
    s_nop 0
    v_mul_f32 v6, v6, v203
    v_mul_f32 v203, v7, v7
    v_mov_b32 v204, 0x3d372713
    v_fma_f32 v203, v203, v204, 1.0
    v_mul_f32 v203, v203, v7
    v_mul_f32 v203, 0xc0135761, v203
    v_exp_f32 v203, v203
    s_nop 0
    v_add_f32 v203, 1.0, v203
    v_rcp_f32 v203, v203
    s_nop 0
    v_mul_f32 v7, v7, v203
    v_cvt_pk_bf16_f32 v4, v4, v5
    v_cvt_pk_bf16_f32 v5, v6, v7
    buffer_store_dwordx2 v[4:5], v195, s[16:19], 0 offen offset:0
    v_mul_f32 v203, v8, v8
    v_mov_b32 v204, 0x3d372713
    v_fma_f32 v203, v203, v204, 1.0
    v_mul_f32 v203, v203, v8
    v_mul_f32 v203, 0xc0135761, v203
    v_exp_f32 v203, v203
    s_nop 0
    v_add_f32 v203, 1.0, v203
    v_rcp_f32 v203, v203
    s_nop 0
    v_mul_f32 v8, v8, v203
    v_mul_f32 v203, v9, v9
    v_mov_b32 v204, 0x3d372713
    v_fma_f32 v203, v203, v204, 1.0
    v_mul_f32 v203, v203, v9
    v_mul_f32 v203, 0xc0135761, v203
    v_exp_f32 v203, v203
    s_nop 0
    v_add_f32 v203, 1.0, v203
    v_rcp_f32 v203, v203
    s_nop 0
    v_mul_f32 v9, v9, v203
    v_mul_f32 v203, v10, v10
    v_mov_b32 v204, 0x3d372713
    v_fma_f32 v203, v203, v204, 1.0
    v_mul_f32 v203, v203, v10
    v_mul_f32 v203, 0xc0135761, v203
    v_exp_f32 v203, v203
    s_nop 0
    v_add_f32 v203, 1.0, v203
    v_rcp_f32 v203, v203
    s_nop 0
    v_mul_f32 v10, v10, v203
    v_mul_f32 v203, v11, v11
    v_mov_b32 v204, 0x3d372713
    v_fma_f32 v203, v203, v204, 1.0
    v_mul_f32 v203, v203, v11
    v_mul_f32 v203, 0xc0135761, v203
    v_exp_f32 v203, v203
    s_nop 0
    v_add_f32 v203, 1.0, v203
    v_rcp_f32 v203, v203
    s_nop 0
    v_mul_f32 v11, v11, v203
    v_cvt_pk_bf16_f32 v8, v8, v9
    v_cvt_pk_bf16_f32 v9, v10, v11
    v_add_u32 v197, 98304, v195
    buffer_store_dwordx2 v[8:9], v197, s[16:19], 0 offen
    v_mul_f32 v203, v12, v12
    v_mov_b32 v204, 0x3d372713
    v_fma_f32 v203, v203, v204, 1.0
    v_mul_f32 v203, v203, v12
    v_mul_f32 v203, 0xc0135761, v203
    v_exp_f32 v203, v203
    s_nop 0
    v_add_f32 v203, 1.0, v203
    v_rcp_f32 v203, v203
    s_nop 0
    v_mul_f32 v12, v12, v203
    v_mul_f32 v203, v13, v13
    v_mov_b32 v204, 0x3d372713
    v_fma_f32 v203, v203, v204, 1.0
    v_mul_f32 v203, v203, v13
    v_mul_f32 v203, 0xc0135761, v203
    v_exp_f32 v203, v203
    s_nop 0
    v_add_f32 v203, 1.0, v203
    v_rcp_f32 v203, v203
    s_nop 0
    v_mul_f32 v13, v13, v203
    v_mul_f32 v203, v14, v14
    v_mov_b32 v204, 0x3d372713
    v_fma_f32 v203, v203, v204, 1.0
    v_mul_f32 v203, v203, v14
    v_mul_f32 v203, 0xc0135761, v203
    v_exp_f32 v203, v203
    s_nop 0
    v_add_f32 v203, 1.0, v203
    v_rcp_f32 v203, v203
    s_nop 0
    v_mul_f32 v14, v14, v203
    v_mul_f32 v203, v15, v15
    v_mov_b32 v204, 0x3d372713
    v_fma_f32 v203, v203, v204, 1.0
    v_mul_f32 v203, v203, v15
    v_mul_f32 v203, 0xc0135761, v203
    v_exp_f32 v203, v203
    s_nop 0
    v_add_f32 v203, 1.0, v203
    v_rcp_f32 v203, v203
    s_nop 0
    v_mul_f32 v15, v15, v203
    v_cvt_pk_bf16_f32 v12, v12, v13
    v_cvt_pk_bf16_f32 v13, v14, v15
    v_add_u32 v197, 196608, v195
    buffer_store_dwordx2 v[12:13], v197, s[16:19], 0 offen
    v_mul_f32 v203, v16, v16
    v_mov_b32 v204, 0x3d372713
    v_fma_f32 v203, v203, v204, 1.0
    v_mul_f32 v203, v203, v16
    v_mul_f32 v203, 0xc0135761, v203
    v_exp_f32 v203, v203
    s_nop 0
    v_add_f32 v203, 1.0, v203
    v_rcp_f32 v203, v203
    s_nop 0
    v_mul_f32 v16, v16, v203
    v_mul_f32 v203, v17, v17
    v_mov_b32 v204, 0x3d372713
    v_fma_f32 v203, v203, v204, 1.0
    v_mul_f32 v203, v203, v17
    v_mul_f32 v203, 0xc0135761, v203
    v_exp_f32 v203, v203
    s_nop 0
    v_add_f32 v203, 1.0, v203
    v_rcp_f32 v203, v203
    s_nop 0
    v_mul_f32 v17, v17, v203
    v_mul_f32 v203, v18, v18
    v_mov_b32 v204, 0x3d372713
    v_fma_f32 v203, v203, v204, 1.0
    v_mul_f32 v203, v203, v18
    v_mul_f32 v203, 0xc0135761, v203
    v_exp_f32 v203, v203
    s_nop 0
    v_add_f32 v203, 1.0, v203
    v_rcp_f32 v203, v203
    s_nop 0
    v_mul_f32 v18, v18, v203
    v_mul_f32 v203, v19, v19
    v_mov_b32 v204, 0x3d372713
    v_fma_f32 v203, v203, v204, 1.0
    v_mul_f32 v203, v203, v19
    v_mul_f32 v203, 0xc0135761, v203
    v_exp_f32 v203, v203
    s_nop 0
    v_add_f32 v203, 1.0, v203
    v_rcp_f32 v203, v203
    s_nop 0
    v_mul_f32 v19, v19, v203
    v_cvt_pk_bf16_f32 v16, v16, v17
    v_cvt_pk_bf16_f32 v17, v18, v19
    v_add_u32 v197, 294912, v195
    buffer_store_dwordx2 v[16:17], v197, s[16:19], 0 offen
    v_mul_f32 v203, v20, v20
    v_mov_b32 v204, 0x3d372713
    v_fma_f32 v203, v203, v204, 1.0
    v_mul_f32 v203, v203, v20
    v_mul_f32 v203, 0xc0135761, v203
    v_exp_f32 v203, v203
    s_nop 0
    v_add_f32 v203, 1.0, v203
    v_rcp_f32 v203, v203
    s_nop 0
    v_mul_f32 v20, v20, v203
    v_mul_f32 v203, v21, v21
    v_mov_b32 v204, 0x3d372713
    v_fma_f32 v203, v203, v204, 1.0
    v_mul_f32 v203, v203, v21
    v_mul_f32 v203, 0xc0135761, v203
    v_exp_f32 v203, v203
    s_nop 0
    v_add_f32 v203, 1.0, v203
    v_rcp_f32 v203, v203
    s_nop 0
    v_mul_f32 v21, v21, v203
    v_mul_f32 v203, v22, v22
    v_mov_b32 v204, 0x3d372713
    v_fma_f32 v203, v203, v204, 1.0
    v_mul_f32 v203, v203, v22
    v_mul_f32 v203, 0xc0135761, v203
    v_exp_f32 v203, v203
    s_nop 0
    v_add_f32 v203, 1.0, v203
    v_rcp_f32 v203, v203
    s_nop 0
    v_mul_f32 v22, v22, v203
    v_mul_f32 v203, v23, v23
    v_mov_b32 v204, 0x3d372713
    v_fma_f32 v203, v203, v204, 1.0
    v_mul_f32 v203, v203, v23
    v_mul_f32 v203, 0xc0135761, v203
    v_exp_f32 v203, v203
    s_nop 0
    v_add_f32 v203, 1.0, v203
    v_rcp_f32 v203, v203
    s_nop 0
    v_mul_f32 v23, v23, v203
    v_cvt_pk_bf16_f32 v20, v20, v21
    v_cvt_pk_bf16_f32 v21, v22, v23
    buffer_store_dwordx2 v[20:21], v195, s[16:19], 0 offen offset:32
    v_mul_f32 v203, v24, v24
    v_mov_b32 v204, 0x3d372713
    v_fma_f32 v203, v203, v204, 1.0
    v_mul_f32 v203, v203, v24
    v_mul_f32 v203, 0xc0135761, v203
    v_exp_f32 v203, v203
    s_nop 0
    v_add_f32 v203, 1.0, v203
    v_rcp_f32 v203, v203
    s_nop 0
    v_mul_f32 v24, v24, v203
    v_mul_f32 v203, v25, v25
    v_mov_b32 v204, 0x3d372713
    v_fma_f32 v203, v203, v204, 1.0
    v_mul_f32 v203, v203, v25
    v_mul_f32 v203, 0xc0135761, v203
    v_exp_f32 v203, v203
    s_nop 0
    v_add_f32 v203, 1.0, v203
    v_rcp_f32 v203, v203
    s_nop 0
    v_mul_f32 v25, v25, v203
    v_mul_f32 v203, v26, v26
    v_mov_b32 v204, 0x3d372713
    v_fma_f32 v203, v203, v204, 1.0
    v_mul_f32 v203, v203, v26
    v_mul_f32 v203, 0xc0135761, v203
    v_exp_f32 v203, v203
    s_nop 0
    v_add_f32 v203, 1.0, v203
    v_rcp_f32 v203, v203
    s_nop 0
    v_mul_f32 v26, v26, v203
    v_mul_f32 v203, v27, v27
    v_mov_b32 v204, 0x3d372713
    v_fma_f32 v203, v203, v204, 1.0
    v_mul_f32 v203, v203, v27
    v_mul_f32 v203, 0xc0135761, v203
    v_exp_f32 v203, v203
    s_nop 0
    v_add_f32 v203, 1.0, v203
    v_rcp_f32 v203, v203
    s_nop 0
    v_mul_f32 v27, v27, v203
    v_cvt_pk_bf16_f32 v24, v24, v25
    v_cvt_pk_bf16_f32 v25, v26, v27
    v_add_u32 v197, 98336, v195
    buffer_store_dwordx2 v[24:25], v197, s[16:19], 0 offen
    v_mul_f32 v203, v28, v28
    v_mov_b32 v204, 0x3d372713
    v_fma_f32 v203, v203, v204, 1.0
    v_mul_f32 v203, v203, v28
    v_mul_f32 v203, 0xc0135761, v203
    v_exp_f32 v203, v203
    s_nop 0
    v_add_f32 v203, 1.0, v203
    v_rcp_f32 v203, v203
    s_nop 0
    v_mul_f32 v28, v28, v203
    v_mul_f32 v203, v29, v29
    v_mov_b32 v204, 0x3d372713
    v_fma_f32 v203, v203, v204, 1.0
    v_mul_f32 v203, v203, v29
    v_mul_f32 v203, 0xc0135761, v203
    v_exp_f32 v203, v203
    s_nop 0
    v_add_f32 v203, 1.0, v203
    v_rcp_f32 v203, v203
    s_nop 0
    v_mul_f32 v29, v29, v203
    v_mul_f32 v203, v30, v30
    v_mov_b32 v204, 0x3d372713
    v_fma_f32 v203, v203, v204, 1.0
    v_mul_f32 v203, v203, v30
    v_mul_f32 v203, 0xc0135761, v203
    v_exp_f32 v203, v203
    s_nop 0
    v_add_f32 v203, 1.0, v203
    v_rcp_f32 v203, v203
    s_nop 0
    v_mul_f32 v30, v30, v203
    v_mul_f32 v203, v31, v31
    v_mov_b32 v204, 0x3d372713
    v_fma_f32 v203, v203, v204, 1.0
    v_mul_f32 v203, v203, v31
    v_mul_f32 v203, 0xc0135761, v203
    v_exp_f32 v203, v203
    s_nop 0
    v_add_f32 v203, 1.0, v203
    v_rcp_f32 v203, v203
    s_nop 0
    v_mul_f32 v31, v31, v203
    v_cvt_pk_bf16_f32 v28, v28, v29
    v_cvt_pk_bf16_f32 v29, v30, v31
    v_add_u32 v197, 196640, v195
    buffer_store_dwordx2 v[28:29], v197, s[16:19], 0 offen
    v_mul_f32 v203, v32, v32
    v_mov_b32 v204, 0x3d372713
    v_fma_f32 v203, v203, v204, 1.0
    v_mul_f32 v203, v203, v32
    v_mul_f32 v203, 0xc0135761, v203
    v_exp_f32 v203, v203
    s_nop 0
    v_add_f32 v203, 1.0, v203
    v_rcp_f32 v203, v203
    s_nop 0
    v_mul_f32 v32, v32, v203
    v_mul_f32 v203, v33, v33
    v_mov_b32 v204, 0x3d372713
    v_fma_f32 v203, v203, v204, 1.0
    v_mul_f32 v203, v203, v33
    v_mul_f32 v203, 0xc0135761, v203
    v_exp_f32 v203, v203
    s_nop 0
    v_add_f32 v203, 1.0, v203
    v_rcp_f32 v203, v203
    s_nop 0
    v_mul_f32 v33, v33, v203
    v_mul_f32 v203, v34, v34
    v_mov_b32 v204, 0x3d372713
    v_fma_f32 v203, v203, v204, 1.0
    v_mul_f32 v203, v203, v34
    v_mul_f32 v203, 0xc0135761, v203
    v_exp_f32 v203, v203
    s_nop 0
    v_add_f32 v203, 1.0, v203
    v_rcp_f32 v203, v203
    s_nop 0
    v_mul_f32 v34, v34, v203
    v_mul_f32 v203, v35, v35
    v_mov_b32 v204, 0x3d372713
    v_fma_f32 v203, v203, v204, 1.0
    v_mul_f32 v203, v203, v35
    v_mul_f32 v203, 0xc0135761, v203
    v_exp_f32 v203, v203
    s_nop 0
    v_add_f32 v203, 1.0, v203
    v_rcp_f32 v203, v203
    s_nop 0
    v_mul_f32 v35, v35, v203
    v_cvt_pk_bf16_f32 v32, v32, v33
    v_cvt_pk_bf16_f32 v33, v34, v35
    v_add_u32 v197, 294944, v195
    buffer_store_dwordx2 v[32:33], v197, s[16:19], 0 offen
    v_mul_f32 v203, v36, v36
    v_mov_b32 v204, 0x3d372713
    v_fma_f32 v203, v203, v204, 1.0
    v_mul_f32 v203, v203, v36
    v_mul_f32 v203, 0xc0135761, v203
    v_exp_f32 v203, v203
    s_nop 0
    v_add_f32 v203, 1.0, v203
    v_rcp_f32 v203, v203
    s_nop 0
    v_mul_f32 v36, v36, v203
    v_mul_f32 v203, v37, v37
    v_mov_b32 v204, 0x3d372713
    v_fma_f32 v203, v203, v204, 1.0
    v_mul_f32 v203, v203, v37
    v_mul_f32 v203, 0xc0135761, v203
    v_exp_f32 v203, v203
    s_nop 0
    v_add_f32 v203, 1.0, v203
    v_rcp_f32 v203, v203
    s_nop 0
    v_mul_f32 v37, v37, v203
    v_mul_f32 v203, v38, v38
    v_mov_b32 v204, 0x3d372713
    v_fma_f32 v203, v203, v204, 1.0
    v_mul_f32 v203, v203, v38
    v_mul_f32 v203, 0xc0135761, v203
    v_exp_f32 v203, v203
    s_nop 0
    v_add_f32 v203, 1.0, v203
    v_rcp_f32 v203, v203
    s_nop 0
    v_mul_f32 v38, v38, v203
    v_mul_f32 v203, v39, v39
    v_mov_b32 v204, 0x3d372713
    v_fma_f32 v203, v203, v204, 1.0
    v_mul_f32 v203, v203, v39
    v_mul_f32 v203, 0xc0135761, v203
    v_exp_f32 v203, v203
    s_nop 0
    v_add_f32 v203, 1.0, v203
    v_rcp_f32 v203, v203
    s_nop 0
    v_mul_f32 v39, v39, v203
    v_cvt_pk_bf16_f32 v36, v36, v37
    v_cvt_pk_bf16_f32 v37, v38, v39
    buffer_store_dwordx2 v[36:37], v195, s[16:19], 0 offen offset:64
    v_mul_f32 v203, v40, v40
    v_mov_b32 v204, 0x3d372713
    v_fma_f32 v203, v203, v204, 1.0
    v_mul_f32 v203, v203, v40
    v_mul_f32 v203, 0xc0135761, v203
    v_exp_f32 v203, v203
    s_nop 0
    v_add_f32 v203, 1.0, v203
    v_rcp_f32 v203, v203
    s_nop 0
    v_mul_f32 v40, v40, v203
    v_mul_f32 v203, v41, v41
    v_mov_b32 v204, 0x3d372713
    v_fma_f32 v203, v203, v204, 1.0
    v_mul_f32 v203, v203, v41
    v_mul_f32 v203, 0xc0135761, v203
    v_exp_f32 v203, v203
    s_nop 0
    v_add_f32 v203, 1.0, v203
    v_rcp_f32 v203, v203
    s_nop 0
    v_mul_f32 v41, v41, v203
    v_mul_f32 v203, v42, v42
    v_mov_b32 v204, 0x3d372713
    v_fma_f32 v203, v203, v204, 1.0
    v_mul_f32 v203, v203, v42
    v_mul_f32 v203, 0xc0135761, v203
    v_exp_f32 v203, v203
    s_nop 0
    v_add_f32 v203, 1.0, v203
    v_rcp_f32 v203, v203
    s_nop 0
    v_mul_f32 v42, v42, v203
    v_mul_f32 v203, v43, v43
    v_mov_b32 v204, 0x3d372713
    v_fma_f32 v203, v203, v204, 1.0
    v_mul_f32 v203, v203, v43
    v_mul_f32 v203, 0xc0135761, v203
    v_exp_f32 v203, v203
    s_nop 0
    v_add_f32 v203, 1.0, v203
    v_rcp_f32 v203, v203
    s_nop 0
    v_mul_f32 v43, v43, v203
    v_cvt_pk_bf16_f32 v40, v40, v41
    v_cvt_pk_bf16_f32 v41, v42, v43
    v_add_u32 v197, 98368, v195
    buffer_store_dwordx2 v[40:41], v197, s[16:19], 0 offen
    v_mul_f32 v203, v44, v44
    v_mov_b32 v204, 0x3d372713
    v_fma_f32 v203, v203, v204, 1.0
    v_mul_f32 v203, v203, v44
    v_mul_f32 v203, 0xc0135761, v203
    v_exp_f32 v203, v203
    s_nop 0
    v_add_f32 v203, 1.0, v203
    v_rcp_f32 v203, v203
    s_nop 0
    v_mul_f32 v44, v44, v203
    v_mul_f32 v203, v45, v45
    v_mov_b32 v204, 0x3d372713
    v_fma_f32 v203, v203, v204, 1.0
    v_mul_f32 v203, v203, v45
    v_mul_f32 v203, 0xc0135761, v203
    v_exp_f32 v203, v203
    s_nop 0
    v_add_f32 v203, 1.0, v203
    v_rcp_f32 v203, v203
    s_nop 0
    v_mul_f32 v45, v45, v203
    v_mul_f32 v203, v46, v46
    v_mov_b32 v204, 0x3d372713
    v_fma_f32 v203, v203, v204, 1.0
    v_mul_f32 v203, v203, v46
    v_mul_f32 v203, 0xc0135761, v203
    v_exp_f32 v203, v203
    s_nop 0
    v_add_f32 v203, 1.0, v203
    v_rcp_f32 v203, v203
    s_nop 0
    v_mul_f32 v46, v46, v203
    v_mul_f32 v203, v47, v47
    v_mov_b32 v204, 0x3d372713
    v_fma_f32 v203, v203, v204, 1.0
    v_mul_f32 v203, v203, v47
    v_mul_f32 v203, 0xc0135761, v203
    v_exp_f32 v203, v203
    s_nop 0
    v_add_f32 v203, 1.0, v203
    v_rcp_f32 v203, v203
    s_nop 0
    v_mul_f32 v47, v47, v203
    v_cvt_pk_bf16_f32 v44, v44, v45
    v_cvt_pk_bf16_f32 v45, v46, v47
    v_add_u32 v197, 196672, v195
    buffer_store_dwordx2 v[44:45], v197, s[16:19], 0 offen
    v_mul_f32 v203, v48, v48
    v_mov_b32 v204, 0x3d372713
    v_fma_f32 v203, v203, v204, 1.0
    v_mul_f32 v203, v203, v48
    v_mul_f32 v203, 0xc0135761, v203
    v_exp_f32 v203, v203
    s_nop 0
    v_add_f32 v203, 1.0, v203
    v_rcp_f32 v203, v203
    s_nop 0
    v_mul_f32 v48, v48, v203
    v_mul_f32 v203, v49, v49
    v_mov_b32 v204, 0x3d372713
    v_fma_f32 v203, v203, v204, 1.0
    v_mul_f32 v203, v203, v49
    v_mul_f32 v203, 0xc0135761, v203
    v_exp_f32 v203, v203
    s_nop 0
    v_add_f32 v203, 1.0, v203
    v_rcp_f32 v203, v203
    s_nop 0
    v_mul_f32 v49, v49, v203
    v_mul_f32 v203, v50, v50
    v_mov_b32 v204, 0x3d372713
    v_fma_f32 v203, v203, v204, 1.0
    v_mul_f32 v203, v203, v50
    v_mul_f32 v203, 0xc0135761, v203
    v_exp_f32 v203, v203
    s_nop 0
    v_add_f32 v203, 1.0, v203
    v_rcp_f32 v203, v203
    s_nop 0
    v_mul_f32 v50, v50, v203
    v_mul_f32 v203, v51, v51
    v_mov_b32 v204, 0x3d372713
    v_fma_f32 v203, v203, v204, 1.0
    v_mul_f32 v203, v203, v51
    v_mul_f32 v203, 0xc0135761, v203
    v_exp_f32 v203, v203
    s_nop 0
    v_add_f32 v203, 1.0, v203
    v_rcp_f32 v203, v203
    s_nop 0
    v_mul_f32 v51, v51, v203
    v_cvt_pk_bf16_f32 v48, v48, v49
    v_cvt_pk_bf16_f32 v49, v50, v51
    v_add_u32 v197, 294976, v195
    buffer_store_dwordx2 v[48:49], v197, s[16:19], 0 offen
    v_mul_f32 v203, v52, v52
    v_mov_b32 v204, 0x3d372713
    v_fma_f32 v203, v203, v204, 1.0
    v_mul_f32 v203, v203, v52
    v_mul_f32 v203, 0xc0135761, v203
    v_exp_f32 v203, v203
    s_nop 0
    v_add_f32 v203, 1.0, v203
    v_rcp_f32 v203, v203
    s_nop 0
    v_mul_f32 v52, v52, v203
    v_mul_f32 v203, v53, v53
    v_mov_b32 v204, 0x3d372713
    v_fma_f32 v203, v203, v204, 1.0
    v_mul_f32 v203, v203, v53
    v_mul_f32 v203, 0xc0135761, v203
    v_exp_f32 v203, v203
    s_nop 0
    v_add_f32 v203, 1.0, v203
    v_rcp_f32 v203, v203
    s_nop 0
    v_mul_f32 v53, v53, v203
    v_mul_f32 v203, v54, v54
    v_mov_b32 v204, 0x3d372713
    v_fma_f32 v203, v203, v204, 1.0
    v_mul_f32 v203, v203, v54
    v_mul_f32 v203, 0xc0135761, v203
    v_exp_f32 v203, v203
    s_nop 0
    v_add_f32 v203, 1.0, v203
    v_rcp_f32 v203, v203
    s_nop 0
    v_mul_f32 v54, v54, v203
    v_mul_f32 v203, v55, v55
    v_mov_b32 v204, 0x3d372713
    v_fma_f32 v203, v203, v204, 1.0
    v_mul_f32 v203, v203, v55
    v_mul_f32 v203, 0xc0135761, v203
    v_exp_f32 v203, v203
    s_nop 0
    v_add_f32 v203, 1.0, v203
    v_rcp_f32 v203, v203
    s_nop 0
    v_mul_f32 v55, v55, v203
    v_cvt_pk_bf16_f32 v52, v52, v53
    v_cvt_pk_bf16_f32 v53, v54, v55
    buffer_store_dwordx2 v[52:53], v195, s[16:19], 0 offen offset:96
    v_mul_f32 v203, v56, v56
    v_mov_b32 v204, 0x3d372713
    v_fma_f32 v203, v203, v204, 1.0
    v_mul_f32 v203, v203, v56
    v_mul_f32 v203, 0xc0135761, v203
    v_exp_f32 v203, v203
    s_nop 0
    v_add_f32 v203, 1.0, v203
    v_rcp_f32 v203, v203
    s_nop 0
    v_mul_f32 v56, v56, v203
    v_mul_f32 v203, v57, v57
    v_mov_b32 v204, 0x3d372713
    v_fma_f32 v203, v203, v204, 1.0
    v_mul_f32 v203, v203, v57
    v_mul_f32 v203, 0xc0135761, v203
    v_exp_f32 v203, v203
    s_nop 0
    v_add_f32 v203, 1.0, v203
    v_rcp_f32 v203, v203
    s_nop 0
    v_mul_f32 v57, v57, v203
    v_mul_f32 v203, v58, v58
    v_mov_b32 v204, 0x3d372713
    v_fma_f32 v203, v203, v204, 1.0
    v_mul_f32 v203, v203, v58
    v_mul_f32 v203, 0xc0135761, v203
    v_exp_f32 v203, v203
    s_nop 0
    v_add_f32 v203, 1.0, v203
    v_rcp_f32 v203, v203
    s_nop 0
    v_mul_f32 v58, v58, v203
    v_mul_f32 v203, v59, v59
    v_mov_b32 v204, 0x3d372713
    v_fma_f32 v203, v203, v204, 1.0
    v_mul_f32 v203, v203, v59
    v_mul_f32 v203, 0xc0135761, v203
    v_exp_f32 v203, v203
    s_nop 0
    v_add_f32 v203, 1.0, v203
    v_rcp_f32 v203, v203
    s_nop 0
    v_mul_f32 v59, v59, v203
    v_cvt_pk_bf16_f32 v56, v56, v57
    v_cvt_pk_bf16_f32 v57, v58, v59
    v_add_u32 v197, 98400, v195
    buffer_store_dwordx2 v[56:57], v197, s[16:19], 0 offen
    v_mul_f32 v203, v60, v60
    v_mov_b32 v204, 0x3d372713
    v_fma_f32 v203, v203, v204, 1.0
    v_mul_f32 v203, v203, v60
    v_mul_f32 v203, 0xc0135761, v203
    v_exp_f32 v203, v203
    s_nop 0
    v_add_f32 v203, 1.0, v203
    v_rcp_f32 v203, v203
    s_nop 0
    v_mul_f32 v60, v60, v203
    v_mul_f32 v203, v61, v61
    v_mov_b32 v204, 0x3d372713
    v_fma_f32 v203, v203, v204, 1.0
    v_mul_f32 v203, v203, v61
    v_mul_f32 v203, 0xc0135761, v203
    v_exp_f32 v203, v203
    s_nop 0
    v_add_f32 v203, 1.0, v203
    v_rcp_f32 v203, v203
    s_nop 0
    v_mul_f32 v61, v61, v203
    v_mul_f32 v203, v62, v62
    v_mov_b32 v204, 0x3d372713
    v_fma_f32 v203, v203, v204, 1.0
    v_mul_f32 v203, v203, v62
    v_mul_f32 v203, 0xc0135761, v203
    v_exp_f32 v203, v203
    s_nop 0
    v_add_f32 v203, 1.0, v203
    v_rcp_f32 v203, v203
    s_nop 0
    v_mul_f32 v62, v62, v203
    v_mul_f32 v203, v63, v63
    v_mov_b32 v204, 0x3d372713
    v_fma_f32 v203, v203, v204, 1.0
    v_mul_f32 v203, v203, v63
    v_mul_f32 v203, 0xc0135761, v203
    v_exp_f32 v203, v203
    s_nop 0
    v_add_f32 v203, 1.0, v203
    v_rcp_f32 v203, v203
    s_nop 0
    v_mul_f32 v63, v63, v203
    v_cvt_pk_bf16_f32 v60, v60, v61
    v_cvt_pk_bf16_f32 v61, v62, v63
    v_add_u32 v197, 196704, v195
    buffer_store_dwordx2 v[60:61], v197, s[16:19], 0 offen
    v_mul_f32 v203, v64, v64
    v_mov_b32 v204, 0x3d372713
    v_fma_f32 v203, v203, v204, 1.0
    v_mul_f32 v203, v203, v64
    v_mul_f32 v203, 0xc0135761, v203
    v_exp_f32 v203, v203
    s_nop 0
    v_add_f32 v203, 1.0, v203
    v_rcp_f32 v203, v203
    s_nop 0
    v_mul_f32 v64, v64, v203
    v_mul_f32 v203, v65, v65
    v_mov_b32 v204, 0x3d372713
    v_fma_f32 v203, v203, v204, 1.0
    v_mul_f32 v203, v203, v65
    v_mul_f32 v203, 0xc0135761, v203
    v_exp_f32 v203, v203
    s_nop 0
    v_add_f32 v203, 1.0, v203
    v_rcp_f32 v203, v203
    s_nop 0
    v_mul_f32 v65, v65, v203
    v_mul_f32 v203, v66, v66
    v_mov_b32 v204, 0x3d372713
    v_fma_f32 v203, v203, v204, 1.0
    v_mul_f32 v203, v203, v66
    v_mul_f32 v203, 0xc0135761, v203
    v_exp_f32 v203, v203
    s_nop 0
    v_add_f32 v203, 1.0, v203
    v_rcp_f32 v203, v203
    s_nop 0
    v_mul_f32 v66, v66, v203
    v_mul_f32 v203, v67, v67
    v_mov_b32 v204, 0x3d372713
    v_fma_f32 v203, v203, v204, 1.0
    v_mul_f32 v203, v203, v67
    v_mul_f32 v203, 0xc0135761, v203
    v_exp_f32 v203, v203
    s_nop 0
    v_add_f32 v203, 1.0, v203
    v_rcp_f32 v203, v203
    s_nop 0
    v_mul_f32 v67, v67, v203
    v_cvt_pk_bf16_f32 v64, v64, v65
    v_cvt_pk_bf16_f32 v65, v66, v67
    v_add_u32 v197, 295008, v195
    buffer_store_dwordx2 v[64:65], v197, s[16:19], 0 offen
    v_mul_f32 v203, v68, v68
    v_mov_b32 v204, 0x3d372713
    v_fma_f32 v203, v203, v204, 1.0
    v_mul_f32 v203, v203, v68
    v_mul_f32 v203, 0xc0135761, v203
    v_exp_f32 v203, v203
    s_nop 0
    v_add_f32 v203, 1.0, v203
    v_rcp_f32 v203, v203
    s_nop 0
    v_mul_f32 v68, v68, v203
    v_mul_f32 v203, v69, v69
    v_mov_b32 v204, 0x3d372713
    v_fma_f32 v203, v203, v204, 1.0
    v_mul_f32 v203, v203, v69
    v_mul_f32 v203, 0xc0135761, v203
    v_exp_f32 v203, v203
    s_nop 0
    v_add_f32 v203, 1.0, v203
    v_rcp_f32 v203, v203
    s_nop 0
    v_mul_f32 v69, v69, v203
    v_mul_f32 v203, v70, v70
    v_mov_b32 v204, 0x3d372713
    v_fma_f32 v203, v203, v204, 1.0
    v_mul_f32 v203, v203, v70
    v_mul_f32 v203, 0xc0135761, v203
    v_exp_f32 v203, v203
    s_nop 0
    v_add_f32 v203, 1.0, v203
    v_rcp_f32 v203, v203
    s_nop 0
    v_mul_f32 v70, v70, v203
    v_mul_f32 v203, v71, v71
    v_mov_b32 v204, 0x3d372713
    v_fma_f32 v203, v203, v204, 1.0
    v_mul_f32 v203, v203, v71
    v_mul_f32 v203, 0xc0135761, v203
    v_exp_f32 v203, v203
    s_nop 0
    v_add_f32 v203, 1.0, v203
    v_rcp_f32 v203, v203
    s_nop 0
    v_mul_f32 v71, v71, v203
    v_cvt_pk_bf16_f32 v68, v68, v69
    v_cvt_pk_bf16_f32 v69, v70, v71
    buffer_store_dwordx2 v[68:69], v195, s[16:19], 0 offen offset:128
    v_mul_f32 v203, v72, v72
    v_mov_b32 v204, 0x3d372713
    v_fma_f32 v203, v203, v204, 1.0
    v_mul_f32 v203, v203, v72
    v_mul_f32 v203, 0xc0135761, v203
    v_exp_f32 v203, v203
    s_nop 0
    v_add_f32 v203, 1.0, v203
    v_rcp_f32 v203, v203
    s_nop 0
    v_mul_f32 v72, v72, v203
    v_mul_f32 v203, v73, v73
    v_mov_b32 v204, 0x3d372713
    v_fma_f32 v203, v203, v204, 1.0
    v_mul_f32 v203, v203, v73
    v_mul_f32 v203, 0xc0135761, v203
    v_exp_f32 v203, v203
    s_nop 0
    v_add_f32 v203, 1.0, v203
    v_rcp_f32 v203, v203
    s_nop 0
    v_mul_f32 v73, v73, v203
    v_mul_f32 v203, v74, v74
    v_mov_b32 v204, 0x3d372713
    v_fma_f32 v203, v203, v204, 1.0
    v_mul_f32 v203, v203, v74
    v_mul_f32 v203, 0xc0135761, v203
    v_exp_f32 v203, v203
    s_nop 0
    v_add_f32 v203, 1.0, v203
    v_rcp_f32 v203, v203
    s_nop 0
    v_mul_f32 v74, v74, v203
    v_mul_f32 v203, v75, v75
    v_mov_b32 v204, 0x3d372713
    v_fma_f32 v203, v203, v204, 1.0
    v_mul_f32 v203, v203, v75
    v_mul_f32 v203, 0xc0135761, v203
    v_exp_f32 v203, v203
    s_nop 0
    v_add_f32 v203, 1.0, v203
    v_rcp_f32 v203, v203
    s_nop 0
    v_mul_f32 v75, v75, v203
    v_cvt_pk_bf16_f32 v72, v72, v73
    v_cvt_pk_bf16_f32 v73, v74, v75
    v_add_u32 v197, 98432, v195
    buffer_store_dwordx2 v[72:73], v197, s[16:19], 0 offen
    v_mul_f32 v203, v76, v76
    v_mov_b32 v204, 0x3d372713
    v_fma_f32 v203, v203, v204, 1.0
    v_mul_f32 v203, v203, v76
    v_mul_f32 v203, 0xc0135761, v203
    v_exp_f32 v203, v203
    s_nop 0
    v_add_f32 v203, 1.0, v203
    v_rcp_f32 v203, v203
    s_nop 0
    v_mul_f32 v76, v76, v203
    v_mul_f32 v203, v77, v77
    v_mov_b32 v204, 0x3d372713
    v_fma_f32 v203, v203, v204, 1.0
    v_mul_f32 v203, v203, v77
    v_mul_f32 v203, 0xc0135761, v203
    v_exp_f32 v203, v203
    s_nop 0
    v_add_f32 v203, 1.0, v203
    v_rcp_f32 v203, v203
    s_nop 0
    v_mul_f32 v77, v77, v203
    v_mul_f32 v203, v78, v78
    v_mov_b32 v204, 0x3d372713
    v_fma_f32 v203, v203, v204, 1.0
    v_mul_f32 v203, v203, v78
    v_mul_f32 v203, 0xc0135761, v203
    v_exp_f32 v203, v203
    s_nop 0
    v_add_f32 v203, 1.0, v203
    v_rcp_f32 v203, v203
    s_nop 0
    v_mul_f32 v78, v78, v203
    v_mul_f32 v203, v79, v79
    v_mov_b32 v204, 0x3d372713
    v_fma_f32 v203, v203, v204, 1.0
    v_mul_f32 v203, v203, v79
    v_mul_f32 v203, 0xc0135761, v203
    v_exp_f32 v203, v203
    s_nop 0
    v_add_f32 v203, 1.0, v203
    v_rcp_f32 v203, v203
    s_nop 0
    v_mul_f32 v79, v79, v203
    v_cvt_pk_bf16_f32 v76, v76, v77
    v_cvt_pk_bf16_f32 v77, v78, v79
    v_add_u32 v197, 196736, v195
    buffer_store_dwordx2 v[76:77], v197, s[16:19], 0 offen
    v_mul_f32 v203, v80, v80
    v_mov_b32 v204, 0x3d372713
    v_fma_f32 v203, v203, v204, 1.0
    v_mul_f32 v203, v203, v80
    v_mul_f32 v203, 0xc0135761, v203
    v_exp_f32 v203, v203
    s_nop 0
    v_add_f32 v203, 1.0, v203
    v_rcp_f32 v203, v203
    s_nop 0
    v_mul_f32 v80, v80, v203
    v_mul_f32 v203, v81, v81
    v_mov_b32 v204, 0x3d372713
    v_fma_f32 v203, v203, v204, 1.0
    v_mul_f32 v203, v203, v81
    v_mul_f32 v203, 0xc0135761, v203
    v_exp_f32 v203, v203
    s_nop 0
    v_add_f32 v203, 1.0, v203
    v_rcp_f32 v203, v203
    s_nop 0
    v_mul_f32 v81, v81, v203
    v_mul_f32 v203, v82, v82
    v_mov_b32 v204, 0x3d372713
    v_fma_f32 v203, v203, v204, 1.0
    v_mul_f32 v203, v203, v82
    v_mul_f32 v203, 0xc0135761, v203
    v_exp_f32 v203, v203
    s_nop 0
    v_add_f32 v203, 1.0, v203
    v_rcp_f32 v203, v203
    s_nop 0
    v_mul_f32 v82, v82, v203
    v_mul_f32 v203, v83, v83
    v_mov_b32 v204, 0x3d372713
    v_fma_f32 v203, v203, v204, 1.0
    v_mul_f32 v203, v203, v83
    v_mul_f32 v203, 0xc0135761, v203
    v_exp_f32 v203, v203
    s_nop 0
    v_add_f32 v203, 1.0, v203
    v_rcp_f32 v203, v203
    s_nop 0
    v_mul_f32 v83, v83, v203
    v_cvt_pk_bf16_f32 v80, v80, v81
    v_cvt_pk_bf16_f32 v81, v82, v83
    v_add_u32 v197, 295040, v195
    buffer_store_dwordx2 v[80:81], v197, s[16:19], 0 offen
    v_mul_f32 v203, v84, v84
    v_mov_b32 v204, 0x3d372713
    v_fma_f32 v203, v203, v204, 1.0
    v_mul_f32 v203, v203, v84
    v_mul_f32 v203, 0xc0135761, v203
    v_exp_f32 v203, v203
    s_nop 0
    v_add_f32 v203, 1.0, v203
    v_rcp_f32 v203, v203
    s_nop 0
    v_mul_f32 v84, v84, v203
    v_mul_f32 v203, v85, v85
    v_mov_b32 v204, 0x3d372713
    v_fma_f32 v203, v203, v204, 1.0
    v_mul_f32 v203, v203, v85
    v_mul_f32 v203, 0xc0135761, v203
    v_exp_f32 v203, v203
    s_nop 0
    v_add_f32 v203, 1.0, v203
    v_rcp_f32 v203, v203
    s_nop 0
    v_mul_f32 v85, v85, v203
    v_mul_f32 v203, v86, v86
    v_mov_b32 v204, 0x3d372713
    v_fma_f32 v203, v203, v204, 1.0
    v_mul_f32 v203, v203, v86
    v_mul_f32 v203, 0xc0135761, v203
    v_exp_f32 v203, v203
    s_nop 0
    v_add_f32 v203, 1.0, v203
    v_rcp_f32 v203, v203
    s_nop 0
    v_mul_f32 v86, v86, v203
    v_mul_f32 v203, v87, v87
    v_mov_b32 v204, 0x3d372713
    v_fma_f32 v203, v203, v204, 1.0
    v_mul_f32 v203, v203, v87
    v_mul_f32 v203, 0xc0135761, v203
    v_exp_f32 v203, v203
    s_nop 0
    v_add_f32 v203, 1.0, v203
    v_rcp_f32 v203, v203
    s_nop 0
    v_mul_f32 v87, v87, v203
    v_cvt_pk_bf16_f32 v84, v84, v85
    v_cvt_pk_bf16_f32 v85, v86, v87
    buffer_store_dwordx2 v[84:85], v195, s[16:19], 0 offen offset:160
    v_mul_f32 v203, v88, v88
    v_mov_b32 v204, 0x3d372713
    v_fma_f32 v203, v203, v204, 1.0
    v_mul_f32 v203, v203, v88
    v_mul_f32 v203, 0xc0135761, v203
    v_exp_f32 v203, v203
    s_nop 0
    v_add_f32 v203, 1.0, v203
    v_rcp_f32 v203, v203
    s_nop 0
    v_mul_f32 v88, v88, v203
    v_mul_f32 v203, v89, v89
    v_mov_b32 v204, 0x3d372713
    v_fma_f32 v203, v203, v204, 1.0
    v_mul_f32 v203, v203, v89
    v_mul_f32 v203, 0xc0135761, v203
    v_exp_f32 v203, v203
    s_nop 0
    v_add_f32 v203, 1.0, v203
    v_rcp_f32 v203, v203
    s_nop 0
    v_mul_f32 v89, v89, v203
    v_mul_f32 v203, v90, v90
    v_mov_b32 v204, 0x3d372713
    v_fma_f32 v203, v203, v204, 1.0
    v_mul_f32 v203, v203, v90
    v_mul_f32 v203, 0xc0135761, v203
    v_exp_f32 v203, v203
    s_nop 0
    v_add_f32 v203, 1.0, v203
    v_rcp_f32 v203, v203
    s_nop 0
    v_mul_f32 v90, v90, v203
    v_mul_f32 v203, v91, v91
    v_mov_b32 v204, 0x3d372713
    v_fma_f32 v203, v203, v204, 1.0
    v_mul_f32 v203, v203, v91
    v_mul_f32 v203, 0xc0135761, v203
    v_exp_f32 v203, v203
    s_nop 0
    v_add_f32 v203, 1.0, v203
    v_rcp_f32 v203, v203
    s_nop 0
    v_mul_f32 v91, v91, v203
    v_cvt_pk_bf16_f32 v88, v88, v89
    v_cvt_pk_bf16_f32 v89, v90, v91
    v_add_u32 v197, 98464, v195
    buffer_store_dwordx2 v[88:89], v197, s[16:19], 0 offen
    v_mul_f32 v203, v92, v92
    v_mov_b32 v204, 0x3d372713
    v_fma_f32 v203, v203, v204, 1.0
    v_mul_f32 v203, v203, v92
    v_mul_f32 v203, 0xc0135761, v203
    v_exp_f32 v203, v203
    s_nop 0
    v_add_f32 v203, 1.0, v203
    v_rcp_f32 v203, v203
    s_nop 0
    v_mul_f32 v92, v92, v203
    v_mul_f32 v203, v93, v93
    v_mov_b32 v204, 0x3d372713
    v_fma_f32 v203, v203, v204, 1.0
    v_mul_f32 v203, v203, v93
    v_mul_f32 v203, 0xc0135761, v203
    v_exp_f32 v203, v203
    s_nop 0
    v_add_f32 v203, 1.0, v203
    v_rcp_f32 v203, v203
    s_nop 0
    v_mul_f32 v93, v93, v203
    v_mul_f32 v203, v94, v94
    v_mov_b32 v204, 0x3d372713
    v_fma_f32 v203, v203, v204, 1.0
    v_mul_f32 v203, v203, v94
    v_mul_f32 v203, 0xc0135761, v203
    v_exp_f32 v203, v203
    s_nop 0
    v_add_f32 v203, 1.0, v203
    v_rcp_f32 v203, v203
    s_nop 0
    v_mul_f32 v94, v94, v203
    v_mul_f32 v203, v95, v95
    v_mov_b32 v204, 0x3d372713
    v_fma_f32 v203, v203, v204, 1.0
    v_mul_f32 v203, v203, v95
    v_mul_f32 v203, 0xc0135761, v203
    v_exp_f32 v203, v203
    s_nop 0
    v_add_f32 v203, 1.0, v203
    v_rcp_f32 v203, v203
    s_nop 0
    v_mul_f32 v95, v95, v203
    v_cvt_pk_bf16_f32 v92, v92, v93
    v_cvt_pk_bf16_f32 v93, v94, v95
    v_add_u32 v197, 196768, v195
    buffer_store_dwordx2 v[92:93], v197, s[16:19], 0 offen
    v_mul_f32 v203, v96, v96
    v_mov_b32 v204, 0x3d372713
    v_fma_f32 v203, v203, v204, 1.0
    v_mul_f32 v203, v203, v96
    v_mul_f32 v203, 0xc0135761, v203
    v_exp_f32 v203, v203
    s_nop 0
    v_add_f32 v203, 1.0, v203
    v_rcp_f32 v203, v203
    s_nop 0
    v_mul_f32 v96, v96, v203
    v_mul_f32 v203, v97, v97
    v_mov_b32 v204, 0x3d372713
    v_fma_f32 v203, v203, v204, 1.0
    v_mul_f32 v203, v203, v97
    v_mul_f32 v203, 0xc0135761, v203
    v_exp_f32 v203, v203
    s_nop 0
    v_add_f32 v203, 1.0, v203
    v_rcp_f32 v203, v203
    s_nop 0
    v_mul_f32 v97, v97, v203
    v_mul_f32 v203, v98, v98
    v_mov_b32 v204, 0x3d372713
    v_fma_f32 v203, v203, v204, 1.0
    v_mul_f32 v203, v203, v98
    v_mul_f32 v203, 0xc0135761, v203
    v_exp_f32 v203, v203
    s_nop 0
    v_add_f32 v203, 1.0, v203
    v_rcp_f32 v203, v203
    s_nop 0
    v_mul_f32 v98, v98, v203
    v_mul_f32 v203, v99, v99
    v_mov_b32 v204, 0x3d372713
    v_fma_f32 v203, v203, v204, 1.0
    v_mul_f32 v203, v203, v99
    v_mul_f32 v203, 0xc0135761, v203
    v_exp_f32 v203, v203
    s_nop 0
    v_add_f32 v203, 1.0, v203
    v_rcp_f32 v203, v203
    s_nop 0
    v_mul_f32 v99, v99, v203
    v_cvt_pk_bf16_f32 v96, v96, v97
    v_cvt_pk_bf16_f32 v97, v98, v99
    v_add_u32 v197, 295072, v195
    buffer_store_dwordx2 v[96:97], v197, s[16:19], 0 offen
fc1_kernel_end:
    s_endpgm
.text
.globl fc2_kernel
.p2align 8
.type fc2_kernel,@function
fc2_kernel:
    s_cmp_ge_u32 s2, 256
    s_cbranch_scc1 fc2_kernel_end
    s_load_dwordx2 s[20:21], s[0:1], 72
    s_load_dwordx2 s[22:23], s[0:1], 48
    s_load_dwordx2 s[24:25], s[0:1], 56
    s_load_dwordx2 s[26:27], s[0:1], 72
    s_load_dwordx2 s[28:29], s[0:1], 0
    s_and_b32 s40, s2, 7
    s_mul_i32 s40, s40, 32
    s_lshr_b32 s2, s2, 3
    s_add_u32 s2, s2, s40
    s_lshr_b32 s30, s2, 8
    s_mul_i32 s31, s30, 256
    s_sub_u32 s31, s2, s31
    s_lshr_b32 s32, s31, 3
    s_mul_i32 s33, s32, 8
    s_sub_u32 s33, s31, s33
    s_lshr_b32 s34, s30, 1
    s_and_b32 s35, s30, 1
    v_lshrrev_b32 v200, 6, v0
    s_nop 0
    v_readfirstlane_b32 s36, v200
    v_and_b32 v1, 63, v0
    s_mul_i32 s37, s34, 0
    s_mul_i32 s40, s35, 0
    s_add_u32 s37, s37, s40
    s_mul_i32 s40, s32, 393216
    s_add_u32 s37, s37, s40
    s_mul_i32 s38, s34, 0
    s_mul_i32 s40, s35, 0
    s_add_u32 s38, s38, s40
    s_mul_i32 s40, s33, 192
    s_add_u32 s38, s38, s40
    s_mul_i32 s39, s34, 0
    s_mul_i32 s40, s35, 0
    s_add_u32 s39, s39, s40
    s_mul_i32 s40, s32, 98304
    s_add_u32 s39, s39, s40
    s_mul_i32 s40, s33, 192
    s_add_u32 s39, s39, s40
    s_waitcnt lgkmcnt(0)
    s_add_u32 s8, s20, 46137344
    s_addc_u32 s9, s21, 0
    s_add_u32 s8, s8, s37
    s_addc_u32 s9, s9, 0
    s_mov_b32 s11, 0x00020000
    s_add_u32 s12, s22, 0
    s_addc_u32 s13, s23, 0
    s_add_u32 s12, s12, s38
    s_addc_u32 s13, s13, 0
    s_mov_b32 s15, 0x00020000
    s_add_u32 s16, s24, 0
    s_addc_u32 s17, s25, 0
    s_add_u32 s16, s16, s39
    s_addc_u32 s17, s17, 0
    s_mov_b32 s19, 0x00020000
    s_mov_b32 s10, 393216
    s_mov_b32 s14, 4717248
    s_mov_b32 s18, 96960
    s_lshl_b32 s40, s36, 6
    v_add_u32 v76, s40, v1
    v_add_u32 v76, 0, v76
    v_lshrrev_b32 v77, 3, v76
    v_and_b32 v78, 7, v76
    v_and_b32 v79, 7, v77
    v_xor_b32 v78, v78, v79
    s_mov_b32 s40, 6144
    v_mul_lo_u32 v77, s40, v77
    v_lshl_add_u32 v68, v78, 4, v77
    s_lshl_b32 s40, s36, 6
    v_add_u32 v76, s40, v1
    v_add_u32 v76, 256, v76
    v_lshrrev_b32 v77, 3, v76
    v_and_b32 v78, 7, v76
    v_and_b32 v79, 7, v77
    v_xor_b32 v78, v78, v79
    s_mov_b32 s40, 6144
    v_mul_lo_u32 v77, s40, v77
    v_lshl_add_u32 v69, v78, 4, v77
    s_lshl_b32 s40, s36, 6
    v_add_u32 v76, s40, v1
    v_add_u32 v76, 0, v76
    s_mov_b32 s40, 306783379
    v_mul_hi_u32 v77, s40, v76
    v_mul_u32_u24 v78, 14, v77
    v_sub_u32 v78, v76, v78
    v_cmp_gt_u32 vcc, 12, v78
    s_nop 1
    v_cndmask_b32 v78, 0, v78, vcc
    v_min_u32 v77, 63, v77
    v_and_b32 v79, 0xfffffff3, v77
    v_lshlrev_b32 v80, 1, v77
    v_and_b32 v80, 8, v80
    v_or_b32 v79, v79, v80
    v_lshrrev_b32 v80, 1, v77
    v_and_b32 v80, 4, v80
    v_or_b32 v79, v79, v80
    s_mov_b32 s40, 1536
    v_mul_lo_u32 v79, s40, v79
    v_lshl_add_u32 v70, v78, 4, v79
    s_lshl_b32 s40, s36, 6
    v_add_u32 v76, s40, v1
    v_add_u32 v76, 256, v76
    s_mov_b32 s40, 306783379
    v_mul_hi_u32 v77, s40, v76
    v_mul_u32_u24 v78, 14, v77
    v_sub_u32 v78, v76, v78
    v_cmp_gt_u32 vcc, 12, v78
    s_nop 1
    v_cndmask_b32 v78, 0, v78, vcc
    v_min_u32 v77, 63, v77
    v_and_b32 v79, 0xfffffff3, v77
    v_lshlrev_b32 v80, 1, v77
    v_and_b32 v80, 8, v80
    v_or_b32 v79, v79, v80
    v_lshrrev_b32 v80, 1, v77
    v_and_b32 v80, 4, v80
    v_or_b32 v79, v79, v80
    s_mov_b32 s40, 1536
    v_mul_lo_u32 v79, s40, v79
    v_lshl_add_u32 v71, v78, 4, v79
    s_lshl_b32 s40, s36, 6
    v_add_u32 v76, s40, v1
    v_add_u32 v76, 512, v76
    s_mov_b32 s40, 306783379
    v_mul_hi_u32 v77, s40, v76
    v_mul_u32_u24 v78, 14, v77
    v_sub_u32 v78, v76, v78
    v_cmp_gt_u32 vcc, 12, v78
    s_nop 1
    v_cndmask_b32 v78, 0, v78, vcc
    v_min_u32 v77, 63, v77
    v_and_b32 v79, 0xfffffff3, v77
    v_lshlrev_b32 v80, 1, v77
    v_and_b32 v80, 8, v80
    v_or_b32 v79, v79, v80
    v_lshrrev_b32 v80, 1, v77
    v_and_b32 v80, 4, v80
    v_or_b32 v79, v79, v80
    s_mov_b32 s40, 1536
    v_mul_lo_u32 v79, s40, v79
    v_lshl_add_u32 v72, v78, 4, v79
    s_lshl_b32 s40, s36, 6
    v_add_u32 v76, s40, v1
    v_add_u32 v76, 768, v76
    s_mov_b32 s40, 306783379
    v_mul_hi_u32 v77, s40, v76
    v_mul_u32_u24 v78, 14, v77
    v_sub_u32 v78, v76, v78
    v_cmp_gt_u32 vcc, 12, v78
    s_nop 1
    v_cndmask_b32 v78, 0, v78, vcc
    v_min_u32 v77, 63, v77
    v_and_b32 v79, 0xfffffff3, v77
    v_lshlrev_b32 v80, 1, v77
    v_and_b32 v80, 8, v80
    v_or_b32 v79, v79, v80
    v_lshrrev_b32 v80, 1, v77
    v_and_b32 v80, 4, v80
    v_or_b32 v79, v79, v80
    s_mov_b32 s40, 1536
    v_mul_lo_u32 v79, s40, v79
    v_lshl_add_u32 v73, v78, 4, v79
    s_lshr_b32 s41, s36, 1
    s_mul_i32 s42, s41, 2
    s_sub_u32 s42, s36, s42
    v_and_b32 v76, 15, v1
    v_lshrrev_b32 v77, 4, v1
    s_mul_i32 s40, s41, 32
    v_add_u32 v78, s40, v76
    v_and_b32 v79, 7, v78
    v_xor_b32 v79, v79, v77
    v_lshlrev_b32 v78, 7, v78
    v_lshl_add_u32 v74, v79, 4, v78
    v_lshrrev_b32 v78, 2, v1
    v_and_b32 v78, 3, v78
    v_and_b32 v79, 1, v77
    v_lshl_add_u32 v78, v79, 2, v78
    v_lshrrev_b32 v79, 1, v77
    v_lshl_add_u32 v78, v79, 4, v78
    v_mul_u32_u24 v78, 224, v78
    v_and_b32 v79, 3, v1
    v_lshl_add_u32 v78, v79, 3, v78
    s_mul_i32 s40, s42, 96
    v_add_u32 v75, s40, v78
    v_add_u32 v75, 8192, v75
    s_lshl_b32 s43, s36, 10
    s_mov_b32 s44, 0
    s_mov_b32 s45, 0
    v_xor_b32 v84, 64, v74
    v_xor_b32 v85, 64, v75
    v_add_u32 v88, 0, v74
    v_add_u32 v89, 0, v84
    v_add_u32 v90, 0, v75
    v_add_u32 v91, 0, v85
    v_add_u32 v92, 24576, v74
    v_add_u32 v93, 24576, v84
    v_add_u32 v94, 24576, v75
    v_add_u32 v95, 24576, v85
    v_add_u32 v96, 49152, v74
    v_add_u32 v97, 49152, v84
    v_add_u32 v98, 49152, v75
    v_add_u32 v99, 49152, v85
    v_add_u32 v100, 73728, v74
    v_add_u32 v101, 73728, v84
    v_add_u32 v102, 73728, v75
    v_add_u32 v103, 73728, v85
    v_add_u32 v104, 98304, v74
    v_add_u32 v105, 98304, v84
    v_add_u32 v106, 98304, v75
    v_add_u32 v107, 98304, v85
    v_add_u32 v108, 122880, v74
    v_add_u32 v109, 122880, v84
    v_add_u32 v110, 122880, v75
    v_add_u32 v111, 122880, v85
    s_add_u32 m0, s43, 0
    s_nop 0
    buffer_load_dwordx4 v68, s[8:11], s44 offen lds
    s_add_u32 m0, s43, 4096
    s_nop 0
    buffer_load_dwordx4 v69, s[8:11], s44 offen lds
    s_add_u32 m0, s43, 8192
    s_nop 0
    buffer_load_dwordx4 v70, s[12:15], s45 offen lds
    s_add_u32 m0, s43, 12288
    s_nop 0
    buffer_load_dwordx4 v71, s[12:15], s45 offen lds
    s_add_u32 m0, s43, 16384
    s_nop 0
    buffer_load_dwordx4 v72, s[12:15], s45 offen lds
    s_add_u32 m0, s43, 20480
    s_nop 0
    buffer_load_dwordx4 v73, s[12:15], s45 offen lds
    s_add_u32 s44, s44, 128
    s_add_u32 s45, s45, 98304
    s_add_u32 m0, s43, 24576
    s_nop 0
    buffer_load_dwordx4 v68, s[8:11], s44 offen lds
    s_add_u32 m0, s43, 28672
    s_nop 0
    buffer_load_dwordx4 v69, s[8:11], s44 offen lds
    s_add_u32 m0, s43, 32768
    s_nop 0
    buffer_load_dwordx4 v70, s[12:15], s45 offen lds
    s_add_u32 m0, s43, 36864
    s_nop 0
    buffer_load_dwordx4 v71, s[12:15], s45 offen lds
    s_add_u32 m0, s43, 40960
    s_nop 0
    buffer_load_dwordx4 v72, s[12:15], s45 offen lds
    s_add_u32 m0, s43, 45056
    s_nop 0
    buffer_load_dwordx4 v73, s[12:15], s45 offen lds
    s_add_u32 s44, s44, 128
    s_add_u32 s45, s45, 98304
    s_add_u32 m0, s43, 49152
    s_nop 0
    buffer_load_dwordx4 v68, s[8:11], s44 offen lds
    s_add_u32 m0, s43, 53248
    s_nop 0
    buffer_load_dwordx4 v69, s[8:11], s44 offen lds
    s_add_u32 m0, s43, 57344
    s_nop 0
    buffer_load_dwordx4 v70, s[12:15], s45 offen lds
    s_add_u32 m0, s43, 61440
    s_nop 0
    buffer_load_dwordx4 v71, s[12:15], s45 offen lds
    s_add_u32 m0, s43, 65536
    s_nop 0
    buffer_load_dwordx4 v72, s[12:15], s45 offen lds
    s_add_u32 m0, s43, 69632
    s_nop 0
    buffer_load_dwordx4 v73, s[12:15], s45 offen lds
    s_add_u32 s44, s44, 128
    s_add_u32 s45, s45, 98304
    s_add_u32 m0, s43, 73728
    s_nop 0
    buffer_load_dwordx4 v68, s[8:11], s44 offen lds
    s_add_u32 m0, s43, 77824
    s_nop 0
    buffer_load_dwordx4 v69, s[8:11], s44 offen lds
    s_add_u32 m0, s43, 81920
    s_nop 0
    buffer_load_dwordx4 v70, s[12:15], s45 offen lds
    s_add_u32 m0, s43, 86016
    s_nop 0
    buffer_load_dwordx4 v71, s[12:15], s45 offen lds
    s_add_u32 m0, s43, 90112
    s_nop 0
    buffer_load_dwordx4 v72, s[12:15], s45 offen lds
    s_add_u32 m0, s43, 94208
    s_nop 0
    buffer_load_dwordx4 v73, s[12:15], s45 offen lds
    s_add_u32 s44, s44, 128
    s_add_u32 s45, s45, 98304
    s_waitcnt vmcnt(12)
    s_barrier
    ds_read_b128 v[28:31], v88 offset:0
    ds_read_b128 v[32:35], v88 offset:2048
    ds_read_b64_tr_b16 v[44:45], v90 offset:0
    ds_read_b64_tr_b16 v[46:47], v90 offset:1792
    ds_read_b64_tr_b16 v[48:49], v90 offset:32
    ds_read_b64_tr_b16 v[50:51], v90 offset:1824
    ds_read_b64_tr_b16 v[52:53], v90 offset:64
    ds_read_b64_tr_b16 v[54:55], v90 offset:1856
    s_add_u32 m0, s43, 98304
    s_nop 0
    buffer_load_dwordx4 v68, s[8:11], s44 offen lds
    s_add_u32 m0, s43, 102400
    s_nop 0
    buffer_load_dwordx4 v69, s[8:11], s44 offen lds
    s_add_u32 m0, s43, 106496
    s_nop 0
    buffer_load_dwordx4 v70, s[12:15], s45 offen lds
    s_add_u32 m0, s43, 110592
    s_nop 0
    buffer_load_dwordx4 v71, s[12:15], s45 offen lds
    s_add_u32 m0, s43, 114688
    s_nop 0
    buffer_load_dwordx4 v72, s[12:15], s45 offen lds
    s_add_u32 m0, s43, 118784
    s_nop 0
    buffer_load_dwordx4 v73, s[12:15], s45 offen lds
    s_add_u32 s44, s44, 128
    s_add_u32 s45, s45, 98304
    s_add_u32 m0, s43, 122880
    s_nop 0
    buffer_load_dwordx4 v68, s[8:11], s44 offen lds
    s_add_u32 m0, s43, 126976
    s_nop 0
    buffer_load_dwordx4 v69, s[8:11], s44 offen lds
    s_add_u32 m0, s43, 131072
    s_nop 0
    buffer_load_dwordx4 v70, s[12:15], s45 offen lds
    s_add_u32 m0, s43, 135168
    s_nop 0
    buffer_load_dwordx4 v71, s[12:15], s45 offen lds
    s_add_u32 m0, s43, 139264
    s_nop 0
    buffer_load_dwordx4 v72, s[12:15], s45 offen lds
    s_add_u32 m0, s43, 143360
    s_nop 0
    buffer_load_dwordx4 v73, s[12:15], s45 offen lds
    s_add_u32 s44, s44, 128
    s_add_u32 s45, s45, 98304
    ds_read_b128 v[36:39], v89 offset:0
    ds_read_b128 v[40:43], v89 offset:2048
    ds_read_b64_tr_b16 v[56:57], v90 offset:7168
    ds_read_b64_tr_b16 v[58:59], v90 offset:8960
    ds_read_b64_tr_b16 v[60:61], v90 offset:7200
    ds_read_b64_tr_b16 v[62:63], v90 offset:8992
    ds_read_b64_tr_b16 v[64:65], v90 offset:7232
    ds_read_b64_tr_b16 v[66:67], v90 offset:9024
    s_waitcnt lgkmcnt(8)
    v_mfma_f32_16x16x32_bf16 v[4:7], v[44:47], v[28:31], 0
    v_mfma_f32_16x16x32_bf16 v[8:11], v[44:47], v[32:35], 0
    v_mfma_f32_16x16x32_bf16 v[12:15], v[48:51], v[28:31], 0
    v_mfma_f32_16x16x32_bf16 v[16:19], v[48:51], v[32:35], 0
    v_mfma_f32_16x16x32_bf16 v[20:23], v[52:55], v[28:31], 0
    v_mfma_f32_16x16x32_bf16 v[24:27], v[52:55], v[32:35], 0
    ds_read_b128 v[28:31], v92 offset:0
    ds_read_b128 v[32:35], v92 offset:2048
    ds_read_b64_tr_b16 v[44:45], v94 offset:0
    ds_read_b64_tr_b16 v[46:47], v94 offset:1792
    ds_read_b64_tr_b16 v[48:49], v94 offset:32
    ds_read_b64_tr_b16 v[50:51], v94 offset:1824
    ds_read_b64_tr_b16 v[52:53], v94 offset:64
    ds_read_b64_tr_b16 v[54:55], v94 offset:1856
    s_waitcnt lgkmcnt(8)
    v_mfma_f32_16x16x32_bf16 v[4:7], v[56:59], v[36:39], v[4:7]
    v_mfma_f32_16x16x32_bf16 v[8:11], v[56:59], v[40:43], v[8:11]
    v_mfma_f32_16x16x32_bf16 v[12:15], v[60:63], v[36:39], v[12:15]
    v_mfma_f32_16x16x32_bf16 v[16:19], v[60:63], v[40:43], v[16:19]
    v_mfma_f32_16x16x32_bf16 v[20:23], v[64:67], v[36:39], v[20:23]
    v_mfma_f32_16x16x32_bf16 v[24:27], v[64:67], v[40:43], v[24:27]
    ds_read_b128 v[36:39], v93 offset:0
    ds_read_b128 v[40:43], v93 offset:2048
    ds_read_b64_tr_b16 v[56:57], v94 offset:7168
    ds_read_b64_tr_b16 v[58:59], v94 offset:8960
    ds_read_b64_tr_b16 v[60:61], v94 offset:7200
    ds_read_b64_tr_b16 v[62:63], v94 offset:8992
    ds_read_b64_tr_b16 v[64:65], v94 offset:7232
    ds_read_b64_tr_b16 v[66:67], v94 offset:9024
    s_waitcnt lgkmcnt(8)
    v_mfma_f32_16x16x32_bf16 v[4:7], v[44:47], v[28:31], v[4:7]
    v_mfma_f32_16x16x32_bf16 v[8:11], v[44:47], v[32:35], v[8:11]
    v_mfma_f32_16x16x32_bf16 v[12:15], v[48:51], v[28:31], v[12:15]
    v_mfma_f32_16x16x32_bf16 v[16:19], v[48:51], v[32:35], v[16:19]
    v_mfma_f32_16x16x32_bf16 v[20:23], v[52:55], v[28:31], v[20:23]
    v_mfma_f32_16x16x32_bf16 v[24:27], v[52:55], v[32:35], v[24:27]
    s_waitcnt lgkmcnt(0)
    v_mfma_f32_16x16x32_bf16 v[4:7], v[56:59], v[36:39], v[4:7]
    v_mfma_f32_16x16x32_bf16 v[8:11], v[56:59], v[40:43], v[8:11]
    v_mfma_f32_16x16x32_bf16 v[12:15], v[60:63], v[36:39], v[12:15]
    v_mfma_f32_16x16x32_bf16 v[16:19], v[60:63], v[40:43], v[16:19]
    v_mfma_f32_16x16x32_bf16 v[20:23], v[64:67], v[36:39], v[20:23]
    v_mfma_f32_16x16x32_bf16 v[24:27], v[64:67], v[40:43], v[24:27]
    s_waitcnt vmcnt(12)
    s_barrier
    ds_read_b128 v[28:31], v96 offset:0
    ds_read_b128 v[32:35], v96 offset:2048
    ds_read_b64_tr_b16 v[44:45], v98 offset:0
    ds_read_b64_tr_b16 v[46:47], v98 offset:1792
    ds_read_b64_tr_b16 v[48:49], v98 offset:32
    ds_read_b64_tr_b16 v[50:51], v98 offset:1824
    ds_read_b64_tr_b16 v[52:53], v98 offset:64
    ds_read_b64_tr_b16 v[54:55], v98 offset:1856
    s_add_u32 m0, s43, 0
    s_nop 0
    buffer_load_dwordx4 v68, s[8:11], s44 offen lds
    s_add_u32 m0, s43, 4096
    s_nop 0
    buffer_load_dwordx4 v69, s[8:11], s44 offen lds
    s_add_u32 m0, s43, 8192
    s_nop 0
    buffer_load_dwordx4 v70, s[12:15], s45 offen lds
    s_add_u32 m0, s43, 12288
    s_nop 0
    buffer_load_dwordx4 v71, s[12:15], s45 offen lds
    s_add_u32 m0, s43, 16384
    s_nop 0
    buffer_load_dwordx4 v72, s[12:15], s45 offen lds
    s_add_u32 m0, s43, 20480
    s_nop 0
    buffer_load_dwordx4 v73, s[12:15], s45 offen lds
    s_add_u32 s44, s44, 128
    s_add_u32 s45, s45, 98304
    s_add_u32 m0, s43, 24576
    s_nop 0
    buffer_load_dwordx4 v68, s[8:11], s44 offen lds
    s_add_u32 m0, s43, 28672
    s_nop 0
    buffer_load_dwordx4 v69, s[8:11], s44 offen lds
    s_add_u32 m0, s43, 32768
    s_nop 0
    buffer_load_dwordx4 v70, s[12:15], s45 offen lds
    s_add_u32 m0, s43, 36864
    s_nop 0
    buffer_load_dwordx4 v71, s[12:15], s45 offen lds
    s_add_u32 m0, s43, 40960
    s_nop 0
    buffer_load_dwordx4 v72, s[12:15], s45 offen lds
    s_add_u32 m0, s43, 45056
    s_nop 0
    buffer_load_dwordx4 v73, s[12:15], s45 offen lds
    s_add_u32 s44, s44, 128
    s_add_u32 s45, s45, 98304
    ds_read_b128 v[36:39], v97 offset:0
    ds_read_b128 v[40:43], v97 offset:2048
    ds_read_b64_tr_b16 v[56:57], v98 offset:7168
    ds_read_b64_tr_b16 v[58:59], v98 offset:8960
    ds_read_b64_tr_b16 v[60:61], v98 offset:7200
    ds_read_b64_tr_b16 v[62:63], v98 offset:8992
    ds_read_b64_tr_b16 v[64:65], v98 offset:7232
    ds_read_b64_tr_b16 v[66:67], v98 offset:9024
    s_waitcnt lgkmcnt(8)
    v_mfma_f32_16x16x32_bf16 v[4:7], v[44:47], v[28:31], v[4:7]
    v_mfma_f32_16x16x32_bf16 v[8:11], v[44:47], v[32:35], v[8:11]
    v_mfma_f32_16x16x32_bf16 v[12:15], v[48:51], v[28:31], v[12:15]
    v_mfma_f32_16x16x32_bf16 v[16:19], v[48:51], v[32:35], v[16:19]
    v_mfma_f32_16x16x32_bf16 v[20:23], v[52:55], v[28:31], v[20:23]
    v_mfma_f32_16x16x32_bf16 v[24:27], v[52:55], v[32:35], v[24:27]
    ds_read_b128 v[28:31], v100 offset:0
    ds_read_b128 v[32:35], v100 offset:2048
    ds_read_b64_tr_b16 v[44:45], v102 offset:0
    ds_read_b64_tr_b16 v[46:47], v102 offset:1792
    ds_read_b64_tr_b16 v[48:49], v102 offset:32
    ds_read_b64_tr_b16 v[50:51], v102 offset:1824
    ds_read_b64_tr_b16 v[52:53], v102 offset:64
    ds_read_b64_tr_b16 v[54:55], v102 offset:1856
    s_waitcnt lgkmcnt(8)
    v_mfma_f32_16x16x32_bf16 v[4:7], v[56:59], v[36:39], v[4:7]
    v_mfma_f32_16x16x32_bf16 v[8:11], v[56:59], v[40:43], v[8:11]
    v_mfma_f32_16x16x32_bf16 v[12:15], v[60:63], v[36:39], v[12:15]
    v_mfma_f32_16x16x32_bf16 v[16:19], v[60:63], v[40:43], v[16:19]
    v_mfma_f32_16x16x32_bf16 v[20:23], v[64:67], v[36:39], v[20:23]
    v_mfma_f32_16x16x32_bf16 v[24:27], v[64:67], v[40:43], v[24:27]
    ds_read_b128 v[36:39], v101 offset:0
    ds_read_b128 v[40:43], v101 offset:2048
    ds_read_b64_tr_b16 v[56:57], v102 offset:7168
    ds_read_b64_tr_b16 v[58:59], v102 offset:8960
    ds_read_b64_tr_b16 v[60:61], v102 offset:7200
    ds_read_b64_tr_b16 v[62:63], v102 offset:8992
    ds_read_b64_tr_b16 v[64:65], v102 offset:7232
    ds_read_b64_tr_b16 v[66:67], v102 offset:9024
    s_waitcnt lgkmcnt(8)
    v_mfma_f32_16x16x32_bf16 v[4:7], v[44:47], v[28:31], v[4:7]
    v_mfma_f32_16x16x32_bf16 v[8:11], v[44:47], v[32:35], v[8:11]
    v_mfma_f32_16x16x32_bf16 v[12:15], v[48:51], v[28:31], v[12:15]
    v_mfma_f32_16x16x32_bf16 v[16:19], v[48:51], v[32:35], v[16:19]
    v_mfma_f32_16x16x32_bf16 v[20:23], v[52:55], v[28:31], v[20:23]
    v_mfma_f32_16x16x32_bf16 v[24:27], v[52:55], v[32:35], v[24:27]
    s_waitcnt lgkmcnt(0)
    v_mfma_f32_16x16x32_bf16 v[4:7], v[56:59], v[36:39], v[4:7]
    v_mfma_f32_16x16x32_bf16 v[8:11], v[56:59], v[40:43], v[8:11]
    v_mfma_f32_16x16x32_bf16 v[12:15], v[60:63], v[36:39], v[12:15]
    v_mfma_f32_16x16x32_bf16 v[16:19], v[60:63], v[40:43], v[16:19]
    v_mfma_f32_16x16x32_bf16 v[20:23], v[64:67], v[36:39], v[20:23]
    v_mfma_f32_16x16x32_bf16 v[24:27], v[64:67], v[40:43], v[24:27]
    s_waitcnt vmcnt(12)
    s_barrier
    ds_read_b128 v[28:31], v104 offset:0
    ds_read_b128 v[32:35], v104 offset:2048
    ds_read_b64_tr_b16 v[44:45], v106 offset:0
    ds_read_b64_tr_b16 v[46:47], v106 offset:1792
    ds_read_b64_tr_b16 v[48:49], v106 offset:32
    ds_read_b64_tr_b16 v[50:51], v106 offset:1824
    ds_read_b64_tr_b16 v[52:53], v106 offset:64
    ds_read_b64_tr_b16 v[54:55], v106 offset:1856
    s_add_u32 m0, s43, 49152
    s_nop 0
    buffer_load_dwordx4 v68, s[8:11], s44 offen lds
    s_add_u32 m0, s43, 53248
    s_nop 0
    buffer_load_dwordx4 v69, s[8:11], s44 offen lds
    s_add_u32 m0, s43, 57344
    s_nop 0
    buffer_load_dwordx4 v70, s[12:15], s45 offen lds
    s_add_u32 m0, s43, 61440
    s_nop 0
    buffer_load_dwordx4 v71, s[12:15], s45 offen lds
    s_add_u32 m0, s43, 65536
    s_nop 0
    buffer_load_dwordx4 v72, s[12:15], s45 offen lds
    s_add_u32 m0, s43, 69632
    s_nop 0
    buffer_load_dwordx4 v73, s[12:15], s45 offen lds
    s_add_u32 s44, s44, 128
    s_add_u32 s45, s45, 98304
    s_add_u32 m0, s43, 73728
    s_nop 0
    buffer_load_dwordx4 v68, s[8:11], s44 offen lds
    s_add_u32 m0, s43, 77824
    s_nop 0
    buffer_load_dwordx4 v69, s[8:11], s44 offen lds
    s_add_u32 m0, s43, 81920
    s_nop 0
    buffer_load_dwordx4 v70, s[12:15], s45 offen lds
    s_add_u32 m0, s43, 86016
    s_nop 0
    buffer_load_dwordx4 v71, s[12:15], s45 offen lds
    s_add_u32 m0, s43, 90112
    s_nop 0
    buffer_load_dwordx4 v72, s[12:15], s45 offen lds
    s_add_u32 m0, s43, 94208
    s_nop 0
    buffer_load_dwordx4 v73, s[12:15], s45 offen lds
    s_add_u32 s44, s44, 128
    s_add_u32 s45, s45, 98304
    ds_read_b128 v[36:39], v105 offset:0
    ds_read_b128 v[40:43], v105 offset:2048
    ds_read_b64_tr_b16 v[56:57], v106 offset:7168
    ds_read_b64_tr_b16 v[58:59], v106 offset:8960
    ds_read_b64_tr_b16 v[60:61], v106 offset:7200
    ds_read_b64_tr_b16 v[62:63], v106 offset:8992
    ds_read_b64_tr_b16 v[64:65], v106 offset:7232
    ds_read_b64_tr_b16 v[66:67], v106 offset:9024
    s_waitcnt lgkmcnt(8)
    v_mfma_f32_16x16x32_bf16 v[4:7], v[44:47], v[28:31], v[4:7]
    v_mfma_f32_16x16x32_bf16 v[8:11], v[44:47], v[32:35], v[8:11]
    v_mfma_f32_16x16x32_bf16 v[12:15], v[48:51], v[28:31], v[12:15]
    v_mfma_f32_16x16x32_bf16 v[16:19], v[48:51], v[32:35], v[16:19]
    v_mfma_f32_16x16x32_bf16 v[20:23], v[52:55], v[28:31], v[20:23]
    v_mfma_f32_16x16x32_bf16 v[24:27], v[52:55], v[32:35], v[24:27]
    ds_read_b128 v[28:31], v108 offset:0
    ds_read_b128 v[32:35], v108 offset:2048
    ds_read_b64_tr_b16 v[44:45], v110 offset:0
    ds_read_b64_tr_b16 v[46:47], v110 offset:1792
    ds_read_b64_tr_b16 v[48:49], v110 offset:32
    ds_read_b64_tr_b16 v[50:51], v110 offset:1824
    ds_read_b64_tr_b16 v[52:53], v110 offset:64
    ds_read_b64_tr_b16 v[54:55], v110 offset:1856
    s_waitcnt lgkmcnt(8)
    v_mfma_f32_16x16x32_bf16 v[4:7], v[56:59], v[36:39], v[4:7]
    v_mfma_f32_16x16x32_bf16 v[8:11], v[56:59], v[40:43], v[8:11]
    v_mfma_f32_16x16x32_bf16 v[12:15], v[60:63], v[36:39], v[12:15]
    v_mfma_f32_16x16x32_bf16 v[16:19], v[60:63], v[40:43], v[16:19]
    v_mfma_f32_16x16x32_bf16 v[20:23], v[64:67], v[36:39], v[20:23]
    v_mfma_f32_16x16x32_bf16 v[24:27], v[64:67], v[40:43], v[24:27]
    ds_read_b128 v[36:39], v109 offset:0
    ds_read_b128 v[40:43], v109 offset:2048
    ds_read_b64_tr_b16 v[56:57], v110 offset:7168
    ds_read_b64_tr_b16 v[58:59], v110 offset:8960
    ds_read_b64_tr_b16 v[60:61], v110 offset:7200
    ds_read_b64_tr_b16 v[62:63], v110 offset:8992
    ds_read_b64_tr_b16 v[64:65], v110 offset:7232
    ds_read_b64_tr_b16 v[66:67], v110 offset:9024
    s_waitcnt lgkmcnt(8)
    v_mfma_f32_16x16x32_bf16 v[4:7], v[44:47], v[28:31], v[4:7]
    v_mfma_f32_16x16x32_bf16 v[8:11], v[44:47], v[32:35], v[8:11]
    v_mfma_f32_16x16x32_bf16 v[12:15], v[48:51], v[28:31], v[12:15]
    v_mfma_f32_16x16x32_bf16 v[16:19], v[48:51], v[32:35], v[16:19]
    v_mfma_f32_16x16x32_bf16 v[20:23], v[52:55], v[28:31], v[20:23]
    v_mfma_f32_16x16x32_bf16 v[24:27], v[52:55], v[32:35], v[24:27]
    s_waitcnt lgkmcnt(0)
    v_mfma_f32_16x16x32_bf16 v[4:7], v[56:59], v[36:39], v[4:7]
    v_mfma_f32_16x16x32_bf16 v[8:11], v[56:59], v[40:43], v[8:11]
    v_mfma_f32_16x16x32_bf16 v[12:15], v[60:63], v[36:39], v[12:15]
    v_mfma_f32_16x16x32_bf16 v[16:19], v[60:63], v[40:43], v[16:19]
    v_mfma_f32_16x16x32_bf16 v[20:23], v[64:67], v[36:39], v[20:23]
    v_mfma_f32_16x16x32_bf16 v[24:27], v[64:67], v[40:43], v[24:27]
    s_waitcnt vmcnt(12)
    s_barrier
    ds_read_b128 v[28:31], v88 offset:0
    ds_read_b128 v[32:35], v88 offset:2048
    ds_read_b64_tr_b16 v[44:45], v90 offset:0
    ds_read_b64_tr_b16 v[46:47], v90 offset:1792
    ds_read_b64_tr_b16 v[48:49], v90 offset:32
    ds_read_b64_tr_b16 v[50:51], v90 offset:1824
    ds_read_b64_tr_b16 v[52:53], v90 offset:64
    ds_read_b64_tr_b16 v[54:55], v90 offset:1856
    s_add_u32 m0, s43, 98304
    s_nop 0
    buffer_load_dwordx4 v68, s[8:11], s44 offen lds
    s_add_u32 m0, s43, 102400
    s_nop 0
    buffer_load_dwordx4 v69, s[8:11], s44 offen lds
    s_add_u32 m0, s43, 106496
    s_nop 0
    buffer_load_dwordx4 v70, s[12:15], s45 offen lds
    s_add_u32 m0, s43, 110592
    s_nop 0
    buffer_load_dwordx4 v71, s[12:15], s45 offen lds
    s_add_u32 m0, s43, 114688
    s_nop 0
    buffer_load_dwordx4 v72, s[12:15], s45 offen lds
    s_add_u32 m0, s43, 118784
    s_nop 0
    buffer_load_dwordx4 v73, s[12:15], s45 offen lds
    s_add_u32 s44, s44, 128
    s_add_u32 s45, s45, 98304
    s_add_u32 m0, s43, 122880
    s_nop 0
    buffer_load_dwordx4 v68, s[8:11], s44 offen lds
    s_add_u32 m0, s43, 126976
    s_nop 0
    buffer_load_dwordx4 v69, s[8:11], s44 offen lds
    s_add_u32 m0, s43, 131072
    s_nop 0
    buffer_load_dwordx4 v70, s[12:15], s45 offen lds
    s_add_u32 m0, s43, 135168
    s_nop 0
    buffer_load_dwordx4 v71, s[12:15], s45 offen lds
    s_add_u32 m0, s43, 139264
    s_nop 0
    buffer_load_dwordx4 v72, s[12:15], s45 offen lds
    s_add_u32 m0, s43, 143360
    s_nop 0
    buffer_load_dwordx4 v73, s[12:15], s45 offen lds
    s_add_u32 s44, s44, 128
    s_add_u32 s45, s45, 98304
    ds_read_b128 v[36:39], v89 offset:0
    ds_read_b128 v[40:43], v89 offset:2048
    ds_read_b64_tr_b16 v[56:57], v90 offset:7168
    ds_read_b64_tr_b16 v[58:59], v90 offset:8960
    ds_read_b64_tr_b16 v[60:61], v90 offset:7200
    ds_read_b64_tr_b16 v[62:63], v90 offset:8992
    ds_read_b64_tr_b16 v[64:65], v90 offset:7232
    ds_read_b64_tr_b16 v[66:67], v90 offset:9024
    s_waitcnt lgkmcnt(8)
    v_mfma_f32_16x16x32_bf16 v[4:7], v[44:47], v[28:31], v[4:7]
    v_mfma_f32_16x16x32_bf16 v[8:11], v[44:47], v[32:35], v[8:11]
    v_mfma_f32_16x16x32_bf16 v[12:15], v[48:51], v[28:31], v[12:15]
    v_mfma_f32_16x16x32_bf16 v[16:19], v[48:51], v[32:35], v[16:19]
    v_mfma_f32_16x16x32_bf16 v[20:23], v[52:55], v[28:31], v[20:23]
    v_mfma_f32_16x16x32_bf16 v[24:27], v[52:55], v[32:35], v[24:27]
    ds_read_b128 v[28:31], v92 offset:0
    ds_read_b128 v[32:35], v92 offset:2048
    ds_read_b64_tr_b16 v[44:45], v94 offset:0
    ds_read_b64_tr_b16 v[46:47], v94 offset:1792
    ds_read_b64_tr_b16 v[48:49], v94 offset:32
    ds_read_b64_tr_b16 v[50:51], v94 offset:1824
    ds_read_b64_tr_b16 v[52:53], v94 offset:64
    ds_read_b64_tr_b16 v[54:55], v94 offset:1856
    s_waitcnt lgkmcnt(8)
    v_mfma_f32_16x16x32_bf16 v[4:7], v[56:59], v[36:39], v[4:7]
    v_mfma_f32_16x16x32_bf16 v[8:11], v[56:59], v[40:43], v[8:11]
    v_mfma_f32_16x16x32_bf16 v[12:15], v[60:63], v[36:39], v[12:15]
    v_mfma_f32_16x16x32_bf16 v[16:19], v[60:63], v[40:43], v[16:19]
    v_mfma_f32_16x16x32_bf16 v[20:23], v[64:67], v[36:39], v[20:23]
    v_mfma_f32_16x16x32_bf16 v[24:27], v[64:67], v[40:43], v[24:27]
    ds_read_b128 v[36:39], v93 offset:0
    ds_read_b128 v[40:43], v93 offset:2048
    ds_read_b64_tr_b16 v[56:57], v94 offset:7168
    ds_read_b64_tr_b16 v[58:59], v94 offset:8960
    ds_read_b64_tr_b16 v[60:61], v94 offset:7200
    ds_read_b64_tr_b16 v[62:63], v94 offset:8992
    ds_read_b64_tr_b16 v[64:65], v94 offset:7232
    ds_read_b64_tr_b16 v[66:67], v94 offset:9024
    s_waitcnt lgkmcnt(8)
    v_mfma_f32_16x16x32_bf16 v[4:7], v[44:47], v[28:31], v[4:7]
    v_mfma_f32_16x16x32_bf16 v[8:11], v[44:47], v[32:35], v[8:11]
    v_mfma_f32_16x16x32_bf16 v[12:15], v[48:51], v[28:31], v[12:15]
    v_mfma_f32_16x16x32_bf16 v[16:19], v[48:51], v[32:35], v[16:19]
    v_mfma_f32_16x16x32_bf16 v[20:23], v[52:55], v[28:31], v[20:23]
    v_mfma_f32_16x16x32_bf16 v[24:27], v[52:55], v[32:35], v[24:27]
    s_waitcnt lgkmcnt(0)
    v_mfma_f32_16x16x32_bf16 v[4:7], v[56:59], v[36:39], v[4:7]
    v_mfma_f32_16x16x32_bf16 v[8:11], v[56:59], v[40:43], v[8:11]
    v_mfma_f32_16x16x32_bf16 v[12:15], v[60:63], v[36:39], v[12:15]
    v_mfma_f32_16x16x32_bf16 v[16:19], v[60:63], v[40:43], v[16:19]
    v_mfma_f32_16x16x32_bf16 v[20:23], v[64:67], v[36:39], v[20:23]
    v_mfma_f32_16x16x32_bf16 v[24:27], v[64:67], v[40:43], v[24:27]
    s_waitcnt vmcnt(12)
    s_barrier
    ds_read_b128 v[28:31], v96 offset:0
    ds_read_b128 v[32:35], v96 offset:2048
    ds_read_b64_tr_b16 v[44:45], v98 offset:0
    ds_read_b64_tr_b16 v[46:47], v98 offset:1792
    ds_read_b64_tr_b16 v[48:49], v98 offset:32
    ds_read_b64_tr_b16 v[50:51], v98 offset:1824
    ds_read_b64_tr_b16 v[52:53], v98 offset:64
    ds_read_b64_tr_b16 v[54:55], v98 offset:1856
    s_add_u32 m0, s43, 0
    s_nop 0
    buffer_load_dwordx4 v68, s[8:11], s44 offen lds
    s_add_u32 m0, s43, 4096
    s_nop 0
    buffer_load_dwordx4 v69, s[8:11], s44 offen lds
    s_add_u32 m0, s43, 8192
    s_nop 0
    buffer_load_dwordx4 v70, s[12:15], s45 offen lds
    s_add_u32 m0, s43, 12288
    s_nop 0
    buffer_load_dwordx4 v71, s[12:15], s45 offen lds
    s_add_u32 m0, s43, 16384
    s_nop 0
    buffer_load_dwordx4 v72, s[12:15], s45 offen lds
    s_add_u32 m0, s43, 20480
    s_nop 0
    buffer_load_dwordx4 v73, s[12:15], s45 offen lds
    s_add_u32 s44, s44, 128
    s_add_u32 s45, s45, 98304
    s_add_u32 m0, s43, 24576
    s_nop 0
    buffer_load_dwordx4 v68, s[8:11], s44 offen lds
    s_add_u32 m0, s43, 28672
    s_nop 0
    buffer_load_dwordx4 v69, s[8:11], s44 offen lds
    s_add_u32 m0, s43, 32768
    s_nop 0
    buffer_load_dwordx4 v70, s[12:15], s45 offen lds
    s_add_u32 m0, s43, 36864
    s_nop 0
    buffer_load_dwordx4 v71, s[12:15], s45 offen lds
    s_add_u32 m0, s43, 40960
    s_nop 0
    buffer_load_dwordx4 v72, s[12:15], s45 offen lds
    s_add_u32 m0, s43, 45056
    s_nop 0
    buffer_load_dwordx4 v73, s[12:15], s45 offen lds
    s_add_u32 s44, s44, 128
    s_add_u32 s45, s45, 98304
    ds_read_b128 v[36:39], v97 offset:0
    ds_read_b128 v[40:43], v97 offset:2048
    ds_read_b64_tr_b16 v[56:57], v98 offset:7168
    ds_read_b64_tr_b16 v[58:59], v98 offset:8960
    ds_read_b64_tr_b16 v[60:61], v98 offset:7200
    ds_read_b64_tr_b16 v[62:63], v98 offset:8992
    ds_read_b64_tr_b16 v[64:65], v98 offset:7232
    ds_read_b64_tr_b16 v[66:67], v98 offset:9024
    s_waitcnt lgkmcnt(8)
    v_mfma_f32_16x16x32_bf16 v[4:7], v[44:47], v[28:31], v[4:7]
    v_mfma_f32_16x16x32_bf16 v[8:11], v[44:47], v[32:35], v[8:11]
    v_mfma_f32_16x16x32_bf16 v[12:15], v[48:51], v[28:31], v[12:15]
    v_mfma_f32_16x16x32_bf16 v[16:19], v[48:51], v[32:35], v[16:19]
    v_mfma_f32_16x16x32_bf16 v[20:23], v[52:55], v[28:31], v[20:23]
    v_mfma_f32_16x16x32_bf16 v[24:27], v[52:55], v[32:35], v[24:27]
    ds_read_b128 v[28:31], v100 offset:0
    ds_read_b128 v[32:35], v100 offset:2048
    ds_read_b64_tr_b16 v[44:45], v102 offset:0
    ds_read_b64_tr_b16 v[46:47], v102 offset:1792
    ds_read_b64_tr_b16 v[48:49], v102 offset:32
    ds_read_b64_tr_b16 v[50:51], v102 offset:1824
    ds_read_b64_tr_b16 v[52:53], v102 offset:64
    ds_read_b64_tr_b16 v[54:55], v102 offset:1856
    s_waitcnt lgkmcnt(8)
    v_mfma_f32_16x16x32_bf16 v[4:7], v[56:59], v[36:39], v[4:7]
    v_mfma_f32_16x16x32_bf16 v[8:11], v[56:59], v[40:43], v[8:11]
    v_mfma_f32_16x16x32_bf16 v[12:15], v[60:63], v[36:39], v[12:15]
    v_mfma_f32_16x16x32_bf16 v[16:19], v[60:63], v[40:43], v[16:19]
    v_mfma_f32_16x16x32_bf16 v[20:23], v[64:67], v[36:39], v[20:23]
    v_mfma_f32_16x16x32_bf16 v[24:27], v[64:67], v[40:43], v[24:27]
    ds_read_b128 v[36:39], v101 offset:0
    ds_read_b128 v[40:43], v101 offset:2048
    ds_read_b64_tr_b16 v[56:57], v102 offset:7168
    ds_read_b64_tr_b16 v[58:59], v102 offset:8960
    ds_read_b64_tr_b16 v[60:61], v102 offset:7200
    ds_read_b64_tr_b16 v[62:63], v102 offset:8992
    ds_read_b64_tr_b16 v[64:65], v102 offset:7232
    ds_read_b64_tr_b16 v[66:67], v102 offset:9024
    s_waitcnt lgkmcnt(8)
    v_mfma_f32_16x16x32_bf16 v[4:7], v[44:47], v[28:31], v[4:7]
    v_mfma_f32_16x16x32_bf16 v[8:11], v[44:47], v[32:35], v[8:11]
    v_mfma_f32_16x16x32_bf16 v[12:15], v[48:51], v[28:31], v[12:15]
    v_mfma_f32_16x16x32_bf16 v[16:19], v[48:51], v[32:35], v[16:19]
    v_mfma_f32_16x16x32_bf16 v[20:23], v[52:55], v[28:31], v[20:23]
    v_mfma_f32_16x16x32_bf16 v[24:27], v[52:55], v[32:35], v[24:27]
    s_waitcnt lgkmcnt(0)
    v_mfma_f32_16x16x32_bf16 v[4:7], v[56:59], v[36:39], v[4:7]
    v_mfma_f32_16x16x32_bf16 v[8:11], v[56:59], v[40:43], v[8:11]
    v_mfma_f32_16x16x32_bf16 v[12:15], v[60:63], v[36:39], v[12:15]
    v_mfma_f32_16x16x32_bf16 v[16:19], v[60:63], v[40:43], v[16:19]
    v_mfma_f32_16x16x32_bf16 v[20:23], v[64:67], v[36:39], v[20:23]
    v_mfma_f32_16x16x32_bf16 v[24:27], v[64:67], v[40:43], v[24:27]
    s_waitcnt vmcnt(12)
    s_barrier
    ds_read_b128 v[28:31], v104 offset:0
    ds_read_b128 v[32:35], v104 offset:2048
    ds_read_b64_tr_b16 v[44:45], v106 offset:0
    ds_read_b64_tr_b16 v[46:47], v106 offset:1792
    ds_read_b64_tr_b16 v[48:49], v106 offset:32
    ds_read_b64_tr_b16 v[50:51], v106 offset:1824
    ds_read_b64_tr_b16 v[52:53], v106 offset:64
    ds_read_b64_tr_b16 v[54:55], v106 offset:1856
    s_add_u32 m0, s43, 49152
    s_nop 0
    buffer_load_dwordx4 v68, s[8:11], s44 offen lds
    s_add_u32 m0, s43, 53248
    s_nop 0
    buffer_load_dwordx4 v69, s[8:11], s44 offen lds
    s_add_u32 m0, s43, 57344
    s_nop 0
    buffer_load_dwordx4 v70, s[12:15], s45 offen lds
    s_add_u32 m0, s43, 61440
    s_nop 0
    buffer_load_dwordx4 v71, s[12:15], s45 offen lds
    s_add_u32 m0, s43, 65536
    s_nop 0
    buffer_load_dwordx4 v72, s[12:15], s45 offen lds
    s_add_u32 m0, s43, 69632
    s_nop 0
    buffer_load_dwordx4 v73, s[12:15], s45 offen lds
    s_add_u32 s44, s44, 128
    s_add_u32 s45, s45, 98304
    s_add_u32 m0, s43, 73728
    s_nop 0
    buffer_load_dwordx4 v68, s[8:11], s44 offen lds
    s_add_u32 m0, s43, 77824
    s_nop 0
    buffer_load_dwordx4 v69, s[8:11], s44 offen lds
    s_add_u32 m0, s43, 81920
    s_nop 0
    buffer_load_dwordx4 v70, s[12:15], s45 offen lds
    s_add_u32 m0, s43, 86016
    s_nop 0
    buffer_load_dwordx4 v71, s[12:15], s45 offen lds
    s_add_u32 m0, s43, 90112
    s_nop 0
    buffer_load_dwordx4 v72, s[12:15], s45 offen lds
    s_add_u32 m0, s43, 94208
    s_nop 0
    buffer_load_dwordx4 v73, s[12:15], s45 offen lds
    s_add_u32 s44, s44, 128
    s_add_u32 s45, s45, 98304
    ds_read_b128 v[36:39], v105 offset:0
    ds_read_b128 v[40:43], v105 offset:2048
    ds_read_b64_tr_b16 v[56:57], v106 offset:7168
    ds_read_b64_tr_b16 v[58:59], v106 offset:8960
    ds_read_b64_tr_b16 v[60:61], v106 offset:7200
    ds_read_b64_tr_b16 v[62:63], v106 offset:8992
    ds_read_b64_tr_b16 v[64:65], v106 offset:7232
    ds_read_b64_tr_b16 v[66:67], v106 offset:9024
    s_waitcnt lgkmcnt(8)
    v_mfma_f32_16x16x32_bf16 v[4:7], v[44:47], v[28:31], v[4:7]
    v_mfma_f32_16x16x32_bf16 v[8:11], v[44:47], v[32:35], v[8:11]
    v_mfma_f32_16x16x32_bf16 v[12:15], v[48:51], v[28:31], v[12:15]
    v_mfma_f32_16x16x32_bf16 v[16:19], v[48:51], v[32:35], v[16:19]
    v_mfma_f32_16x16x32_bf16 v[20:23], v[52:55], v[28:31], v[20:23]
    v_mfma_f32_16x16x32_bf16 v[24:27], v[52:55], v[32:35], v[24:27]
    ds_read_b128 v[28:31], v108 offset:0
    ds_read_b128 v[32:35], v108 offset:2048
    ds_read_b64_tr_b16 v[44:45], v110 offset:0
    ds_read_b64_tr_b16 v[46:47], v110 offset:1792
    ds_read_b64_tr_b16 v[48:49], v110 offset:32
    ds_read_b64_tr_b16 v[50:51], v110 offset:1824
    ds_read_b64_tr_b16 v[52:53], v110 offset:64
    ds_read_b64_tr_b16 v[54:55], v110 offset:1856
    s_waitcnt lgkmcnt(8)
    v_mfma_f32_16x16x32_bf16 v[4:7], v[56:59], v[36:39], v[4:7]
    v_mfma_f32_16x16x32_bf16 v[8:11], v[56:59], v[40:43], v[8:11]
    v_mfma_f32_16x16x32_bf16 v[12:15], v[60:63], v[36:39], v[12:15]
    v_mfma_f32_16x16x32_bf16 v[16:19], v[60:63], v[40:43], v[16:19]
    v_mfma_f32_16x16x32_bf16 v[20:23], v[64:67], v[36:39], v[20:23]
    v_mfma_f32_16x16x32_bf16 v[24:27], v[64:67], v[40:43], v[24:27]
    ds_read_b128 v[36:39], v109 offset:0
    ds_read_b128 v[40:43], v109 offset:2048
    ds_read_b64_tr_b16 v[56:57], v110 offset:7168
    ds_read_b64_tr_b16 v[58:59], v110 offset:8960
    ds_read_b64_tr_b16 v[60:61], v110 offset:7200
    ds_read_b64_tr_b16 v[62:63], v110 offset:8992
    ds_read_b64_tr_b16 v[64:65], v110 offset:7232
    ds_read_b64_tr_b16 v[66:67], v110 offset:9024
    s_waitcnt lgkmcnt(8)
    v_mfma_f32_16x16x32_bf16 v[4:7], v[44:47], v[28:31], v[4:7]
    v_mfma_f32_16x16x32_bf16 v[8:11], v[44:47], v[32:35], v[8:11]
    v_mfma_f32_16x16x32_bf16 v[12:15], v[48:51], v[28:31], v[12:15]
    v_mfma_f32_16x16x32_bf16 v[16:19], v[48:51], v[32:35], v[16:19]
    v_mfma_f32_16x16x32_bf16 v[20:23], v[52:55], v[28:31], v[20:23]
    v_mfma_f32_16x16x32_bf16 v[24:27], v[52:55], v[32:35], v[24:27]
    s_waitcnt lgkmcnt(0)
    v_mfma_f32_16x16x32_bf16 v[4:7], v[56:59], v[36:39], v[4:7]
    v_mfma_f32_16x16x32_bf16 v[8:11], v[56:59], v[40:43], v[8:11]
    v_mfma_f32_16x16x32_bf16 v[12:15], v[60:63], v[36:39], v[12:15]
    v_mfma_f32_16x16x32_bf16 v[16:19], v[60:63], v[40:43], v[16:19]
    v_mfma_f32_16x16x32_bf16 v[20:23], v[64:67], v[36:39], v[20:23]
    v_mfma_f32_16x16x32_bf16 v[24:27], v[64:67], v[40:43], v[24:27]
    s_waitcnt vmcnt(12)
    s_barrier
    ds_read_b128 v[28:31], v88 offset:0
    ds_read_b128 v[32:35], v88 offset:2048
    ds_read_b64_tr_b16 v[44:45], v90 offset:0
    ds_read_b64_tr_b16 v[46:47], v90 offset:1792
    ds_read_b64_tr_b16 v[48:49], v90 offset:32
    ds_read_b64_tr_b16 v[50:51], v90 offset:1824
    ds_read_b64_tr_b16 v[52:53], v90 offset:64
    ds_read_b64_tr_b16 v[54:55], v90 offset:1856
    s_add_u32 m0, s43, 98304
    s_nop 0
    buffer_load_dwordx4 v68, s[8:11], s44 offen lds
    s_add_u32 m0, s43, 102400
    s_nop 0
    buffer_load_dwordx4 v69, s[8:11], s44 offen lds
    s_add_u32 m0, s43, 106496
    s_nop 0
    buffer_load_dwordx4 v70, s[12:15], s45 offen lds
    s_add_u32 m0, s43, 110592
    s_nop 0
    buffer_load_dwordx4 v71, s[12:15], s45 offen lds
    s_add_u32 m0, s43, 114688
    s_nop 0
    buffer_load_dwordx4 v72, s[12:15], s45 offen lds
    s_add_u32 m0, s43, 118784
    s_nop 0
    buffer_load_dwordx4 v73, s[12:15], s45 offen lds
    s_add_u32 s44, s44, 128
    s_add_u32 s45, s45, 98304
    s_add_u32 m0, s43, 122880
    s_nop 0
    buffer_load_dwordx4 v68, s[8:11], s44 offen lds
    s_add_u32 m0, s43, 126976
    s_nop 0
    buffer_load_dwordx4 v69, s[8:11], s44 offen lds
    s_add_u32 m0, s43, 131072
    s_nop 0
    buffer_load_dwordx4 v70, s[12:15], s45 offen lds
    s_add_u32 m0, s43, 135168
    s_nop 0
    buffer_load_dwordx4 v71, s[12:15], s45 offen lds
    s_add_u32 m0, s43, 139264
    s_nop 0
    buffer_load_dwordx4 v72, s[12:15], s45 offen lds
    s_add_u32 m0, s43, 143360
    s_nop 0
    buffer_load_dwordx4 v73, s[12:15], s45 offen lds
    s_add_u32 s44, s44, 128
    s_add_u32 s45, s45, 98304
    ds_read_b128 v[36:39], v89 offset:0
    ds_read_b128 v[40:43], v89 offset:2048
    ds_read_b64_tr_b16 v[56:57], v90 offset:7168
    ds_read_b64_tr_b16 v[58:59], v90 offset:8960
    ds_read_b64_tr_b16 v[60:61], v90 offset:7200
    ds_read_b64_tr_b16 v[62:63], v90 offset:8992
    ds_read_b64_tr_b16 v[64:65], v90 offset:7232
    ds_read_b64_tr_b16 v[66:67], v90 offset:9024
    s_waitcnt lgkmcnt(8)
    v_mfma_f32_16x16x32_bf16 v[4:7], v[44:47], v[28:31], v[4:7]
    v_mfma_f32_16x16x32_bf16 v[8:11], v[44:47], v[32:35], v[8:11]
    v_mfma_f32_16x16x32_bf16 v[12:15], v[48:51], v[28:31], v[12:15]
    v_mfma_f32_16x16x32_bf16 v[16:19], v[48:51], v[32:35], v[16:19]
    v_mfma_f32_16x16x32_bf16 v[20:23], v[52:55], v[28:31], v[20:23]
    v_mfma_f32_16x16x32_bf16 v[24:27], v[52:55], v[32:35], v[24:27]
    ds_read_b128 v[28:31], v92 offset:0
    ds_read_b128 v[32:35], v92 offset:2048
    ds_read_b64_tr_b16 v[44:45], v94 offset:0
    ds_read_b64_tr_b16 v[46:47], v94 offset:1792
    ds_read_b64_tr_b16 v[48:49], v94 offset:32
    ds_read_b64_tr_b16 v[50:51], v94 offset:1824
    ds_read_b64_tr_b16 v[52:53], v94 offset:64
    ds_read_b64_tr_b16 v[54:55], v94 offset:1856
    s_waitcnt lgkmcnt(8)
    v_mfma_f32_16x16x32_bf16 v[4:7], v[56:59], v[36:39], v[4:7]
    v_mfma_f32_16x16x32_bf16 v[8:11], v[56:59], v[40:43], v[8:11]
    v_mfma_f32_16x16x32_bf16 v[12:15], v[60:63], v[36:39], v[12:15]
    v_mfma_f32_16x16x32_bf16 v[16:19], v[60:63], v[40:43], v[16:19]
    v_mfma_f32_16x16x32_bf16 v[20:23], v[64:67], v[36:39], v[20:23]
    v_mfma_f32_16x16x32_bf16 v[24:27], v[64:67], v[40:43], v[24:27]
    ds_read_b128 v[36:39], v93 offset:0
    ds_read_b128 v[40:43], v93 offset:2048
    ds_read_b64_tr_b16 v[56:57], v94 offset:7168
    ds_read_b64_tr_b16 v[58:59], v94 offset:8960
    ds_read_b64_tr_b16 v[60:61], v94 offset:7200
    ds_read_b64_tr_b16 v[62:63], v94 offset:8992
    ds_read_b64_tr_b16 v[64:65], v94 offset:7232
    ds_read_b64_tr_b16 v[66:67], v94 offset:9024
    s_waitcnt lgkmcnt(8)
    v_mfma_f32_16x16x32_bf16 v[4:7], v[44:47], v[28:31], v[4:7]
    v_mfma_f32_16x16x32_bf16 v[8:11], v[44:47], v[32:35], v[8:11]
    v_mfma_f32_16x16x32_bf16 v[12:15], v[48:51], v[28:31], v[12:15]
    v_mfma_f32_16x16x32_bf16 v[16:19], v[48:51], v[32:35], v[16:19]
    v_mfma_f32_16x16x32_bf16 v[20:23], v[52:55], v[28:31], v[20:23]
    v_mfma_f32_16x16x32_bf16 v[24:27], v[52:55], v[32:35], v[24:27]
    s_waitcnt lgkmcnt(0)
    v_mfma_f32_16x16x32_bf16 v[4:7], v[56:59], v[36:39], v[4:7]
    v_mfma_f32_16x16x32_bf16 v[8:11], v[56:59], v[40:43], v[8:11]
    v_mfma_f32_16x16x32_bf16 v[12:15], v[60:63], v[36:39], v[12:15]
    v_mfma_f32_16x16x32_bf16 v[16:19], v[60:63], v[40:43], v[16:19]
    v_mfma_f32_16x16x32_bf16 v[20:23], v[64:67], v[36:39], v[20:23]
    v_mfma_f32_16x16x32_bf16 v[24:27], v[64:67], v[40:43], v[24:27]
    s_waitcnt vmcnt(12)
    s_barrier
    ds_read_b128 v[28:31], v96 offset:0
    ds_read_b128 v[32:35], v96 offset:2048
    ds_read_b64_tr_b16 v[44:45], v98 offset:0
    ds_read_b64_tr_b16 v[46:47], v98 offset:1792
    ds_read_b64_tr_b16 v[48:49], v98 offset:32
    ds_read_b64_tr_b16 v[50:51], v98 offset:1824
    ds_read_b64_tr_b16 v[52:53], v98 offset:64
    ds_read_b64_tr_b16 v[54:55], v98 offset:1856
    s_add_u32 m0, s43, 0
    s_nop 0
    buffer_load_dwordx4 v68, s[8:11], s44 offen lds
    s_add_u32 m0, s43, 4096
    s_nop 0
    buffer_load_dwordx4 v69, s[8:11], s44 offen lds
    s_add_u32 m0, s43, 8192
    s_nop 0
    buffer_load_dwordx4 v70, s[12:15], s45 offen lds
    s_add_u32 m0, s43, 12288
    s_nop 0
    buffer_load_dwordx4 v71, s[12:15], s45 offen lds
    s_add_u32 m0, s43, 16384
    s_nop 0
    buffer_load_dwordx4 v72, s[12:15], s45 offen lds
    s_add_u32 m0, s43, 20480
    s_nop 0
    buffer_load_dwordx4 v73, s[12:15], s45 offen lds
    s_add_u32 s44, s44, 128
    s_add_u32 s45, s45, 98304
    s_add_u32 m0, s43, 24576
    s_nop 0
    buffer_load_dwordx4 v68, s[8:11], s44 offen lds
    s_add_u32 m0, s43, 28672
    s_nop 0
    buffer_load_dwordx4 v69, s[8:11], s44 offen lds
    s_add_u32 m0, s43, 32768
    s_nop 0
    buffer_load_dwordx4 v70, s[12:15], s45 offen lds
    s_add_u32 m0, s43, 36864
    s_nop 0
    buffer_load_dwordx4 v71, s[12:15], s45 offen lds
    s_add_u32 m0, s43, 40960
    s_nop 0
    buffer_load_dwordx4 v72, s[12:15], s45 offen lds
    s_add_u32 m0, s43, 45056
    s_nop 0
    buffer_load_dwordx4 v73, s[12:15], s45 offen lds
    s_add_u32 s44, s44, 128
    s_add_u32 s45, s45, 98304
    ds_read_b128 v[36:39], v97 offset:0
    ds_read_b128 v[40:43], v97 offset:2048
    ds_read_b64_tr_b16 v[56:57], v98 offset:7168
    ds_read_b64_tr_b16 v[58:59], v98 offset:8960
    ds_read_b64_tr_b16 v[60:61], v98 offset:7200
    ds_read_b64_tr_b16 v[62:63], v98 offset:8992
    ds_read_b64_tr_b16 v[64:65], v98 offset:7232
    ds_read_b64_tr_b16 v[66:67], v98 offset:9024
    s_waitcnt lgkmcnt(8)
    v_mfma_f32_16x16x32_bf16 v[4:7], v[44:47], v[28:31], v[4:7]
    v_mfma_f32_16x16x32_bf16 v[8:11], v[44:47], v[32:35], v[8:11]
    v_mfma_f32_16x16x32_bf16 v[12:15], v[48:51], v[28:31], v[12:15]
    v_mfma_f32_16x16x32_bf16 v[16:19], v[48:51], v[32:35], v[16:19]
    v_mfma_f32_16x16x32_bf16 v[20:23], v[52:55], v[28:31], v[20:23]
    v_mfma_f32_16x16x32_bf16 v[24:27], v[52:55], v[32:35], v[24:27]
    ds_read_b128 v[28:31], v100 offset:0
    ds_read_b128 v[32:35], v100 offset:2048
    ds_read_b64_tr_b16 v[44:45], v102 offset:0
    ds_read_b64_tr_b16 v[46:47], v102 offset:1792
    ds_read_b64_tr_b16 v[48:49], v102 offset:32
    ds_read_b64_tr_b16 v[50:51], v102 offset:1824
    ds_read_b64_tr_b16 v[52:53], v102 offset:64
    ds_read_b64_tr_b16 v[54:55], v102 offset:1856
    s_waitcnt lgkmcnt(8)
    v_mfma_f32_16x16x32_bf16 v[4:7], v[56:59], v[36:39], v[4:7]
    v_mfma_f32_16x16x32_bf16 v[8:11], v[56:59], v[40:43], v[8:11]
    v_mfma_f32_16x16x32_bf16 v[12:15], v[60:63], v[36:39], v[12:15]
    v_mfma_f32_16x16x32_bf16 v[16:19], v[60:63], v[40:43], v[16:19]
    v_mfma_f32_16x16x32_bf16 v[20:23], v[64:67], v[36:39], v[20:23]
    v_mfma_f32_16x16x32_bf16 v[24:27], v[64:67], v[40:43], v[24:27]
    ds_read_b128 v[36:39], v101 offset:0
    ds_read_b128 v[40:43], v101 offset:2048
    ds_read_b64_tr_b16 v[56:57], v102 offset:7168
    ds_read_b64_tr_b16 v[58:59], v102 offset:8960
    ds_read_b64_tr_b16 v[60:61], v102 offset:7200
    ds_read_b64_tr_b16 v[62:63], v102 offset:8992
    ds_read_b64_tr_b16 v[64:65], v102 offset:7232
    ds_read_b64_tr_b16 v[66:67], v102 offset:9024
    s_waitcnt lgkmcnt(8)
    v_mfma_f32_16x16x32_bf16 v[4:7], v[44:47], v[28:31], v[4:7]
    v_mfma_f32_16x16x32_bf16 v[8:11], v[44:47], v[32:35], v[8:11]
    v_mfma_f32_16x16x32_bf16 v[12:15], v[48:51], v[28:31], v[12:15]
    v_mfma_f32_16x16x32_bf16 v[16:19], v[48:51], v[32:35], v[16:19]
    v_mfma_f32_16x16x32_bf16 v[20:23], v[52:55], v[28:31], v[20:23]
    v_mfma_f32_16x16x32_bf16 v[24:27], v[52:55], v[32:35], v[24:27]
    s_waitcnt lgkmcnt(0)
    v_mfma_f32_16x16x32_bf16 v[4:7], v[56:59], v[36:39], v[4:7]
    v_mfma_f32_16x16x32_bf16 v[8:11], v[56:59], v[40:43], v[8:11]
    v_mfma_f32_16x16x32_bf16 v[12:15], v[60:63], v[36:39], v[12:15]
    v_mfma_f32_16x16x32_bf16 v[16:19], v[60:63], v[40:43], v[16:19]
    v_mfma_f32_16x16x32_bf16 v[20:23], v[64:67], v[36:39], v[20:23]
    v_mfma_f32_16x16x32_bf16 v[24:27], v[64:67], v[40:43], v[24:27]
    s_waitcnt vmcnt(12)
    s_barrier
    ds_read_b128 v[28:31], v104 offset:0
    ds_read_b128 v[32:35], v104 offset:2048
    ds_read_b64_tr_b16 v[44:45], v106 offset:0
    ds_read_b64_tr_b16 v[46:47], v106 offset:1792
    ds_read_b64_tr_b16 v[48:49], v106 offset:32
    ds_read_b64_tr_b16 v[50:51], v106 offset:1824
    ds_read_b64_tr_b16 v[52:53], v106 offset:64
    ds_read_b64_tr_b16 v[54:55], v106 offset:1856
    s_add_u32 m0, s43, 49152
    s_nop 0
    buffer_load_dwordx4 v68, s[8:11], s44 offen lds
    s_add_u32 m0, s43, 53248
    s_nop 0
    buffer_load_dwordx4 v69, s[8:11], s44 offen lds
    s_add_u32 m0, s43, 57344
    s_nop 0
    buffer_load_dwordx4 v70, s[12:15], s45 offen lds
    s_add_u32 m0, s43, 61440
    s_nop 0
    buffer_load_dwordx4 v71, s[12:15], s45 offen lds
    s_add_u32 m0, s43, 65536
    s_nop 0
    buffer_load_dwordx4 v72, s[12:15], s45 offen lds
    s_add_u32 m0, s43, 69632
    s_nop 0
    buffer_load_dwordx4 v73, s[12:15], s45 offen lds
    s_add_u32 s44, s44, 128
    s_add_u32 s45, s45, 98304
    s_add_u32 m0, s43, 73728
    s_nop 0
    buffer_load_dwordx4 v68, s[8:11], s44 offen lds
    s_add_u32 m0, s43, 77824
    s_nop 0
    buffer_load_dwordx4 v69, s[8:11], s44 offen lds
    s_add_u32 m0, s43, 81920
    s_nop 0
    buffer_load_dwordx4 v70, s[12:15], s45 offen lds
    s_add_u32 m0, s43, 86016
    s_nop 0
    buffer_load_dwordx4 v71, s[12:15], s45 offen lds
    s_add_u32 m0, s43, 90112
    s_nop 0
    buffer_load_dwordx4 v72, s[12:15], s45 offen lds
    s_add_u32 m0, s43, 94208
    s_nop 0
    buffer_load_dwordx4 v73, s[12:15], s45 offen lds
    s_add_u32 s44, s44, 128
    s_add_u32 s45, s45, 98304
    ds_read_b128 v[36:39], v105 offset:0
    ds_read_b128 v[40:43], v105 offset:2048
    ds_read_b64_tr_b16 v[56:57], v106 offset:7168
    ds_read_b64_tr_b16 v[58:59], v106 offset:8960
    ds_read_b64_tr_b16 v[60:61], v106 offset:7200
    ds_read_b64_tr_b16 v[62:63], v106 offset:8992
    ds_read_b64_tr_b16 v[64:65], v106 offset:7232
    ds_read_b64_tr_b16 v[66:67], v106 offset:9024
    s_waitcnt lgkmcnt(8)
    v_mfma_f32_16x16x32_bf16 v[4:7], v[44:47], v[28:31], v[4:7]
    v_mfma_f32_16x16x32_bf16 v[8:11], v[44:47], v[32:35], v[8:11]
    v_mfma_f32_16x16x32_bf16 v[12:15], v[48:51], v[28:31], v[12:15]
    v_mfma_f32_16x16x32_bf16 v[16:19], v[48:51], v[32:35], v[16:19]
    v_mfma_f32_16x16x32_bf16 v[20:23], v[52:55], v[28:31], v[20:23]
    v_mfma_f32_16x16x32_bf16 v[24:27], v[52:55], v[32:35], v[24:27]
    ds_read_b128 v[28:31], v108 offset:0
    ds_read_b128 v[32:35], v108 offset:2048
    ds_read_b64_tr_b16 v[44:45], v110 offset:0
    ds_read_b64_tr_b16 v[46:47], v110 offset:1792
    ds_read_b64_tr_b16 v[48:49], v110 offset:32
    ds_read_b64_tr_b16 v[50:51], v110 offset:1824
    ds_read_b64_tr_b16 v[52:53], v110 offset:64
    ds_read_b64_tr_b16 v[54:55], v110 offset:1856
    s_waitcnt lgkmcnt(8)
    v_mfma_f32_16x16x32_bf16 v[4:7], v[56:59], v[36:39], v[4:7]
    v_mfma_f32_16x16x32_bf16 v[8:11], v[56:59], v[40:43], v[8:11]
    v_mfma_f32_16x16x32_bf16 v[12:15], v[60:63], v[36:39], v[12:15]
    v_mfma_f32_16x16x32_bf16 v[16:19], v[60:63], v[40:43], v[16:19]
    v_mfma_f32_16x16x32_bf16 v[20:23], v[64:67], v[36:39], v[20:23]
    v_mfma_f32_16x16x32_bf16 v[24:27], v[64:67], v[40:43], v[24:27]
    ds_read_b128 v[36:39], v109 offset:0
    ds_read_b128 v[40:43], v109 offset:2048
    ds_read_b64_tr_b16 v[56:57], v110 offset:7168
    ds_read_b64_tr_b16 v[58:59], v110 offset:8960
    ds_read_b64_tr_b16 v[60:61], v110 offset:7200
    ds_read_b64_tr_b16 v[62:63], v110 offset:8992
    ds_read_b64_tr_b16 v[64:65], v110 offset:7232
    ds_read_b64_tr_b16 v[66:67], v110 offset:9024
    s_waitcnt lgkmcnt(8)
    v_mfma_f32_16x16x32_bf16 v[4:7], v[44:47], v[28:31], v[4:7]
    v_mfma_f32_16x16x32_bf16 v[8:11], v[44:47], v[32:35], v[8:11]
    v_mfma_f32_16x16x32_bf16 v[12:15], v[48:51], v[28:31], v[12:15]
    v_mfma_f32_16x16x32_bf16 v[16:19], v[48:51], v[32:35], v[16:19]
    v_mfma_f32_16x16x32_bf16 v[20:23], v[52:55], v[28:31], v[20:23]
    v_mfma_f32_16x16x32_bf16 v[24:27], v[52:55], v[32:35], v[24:27]
    s_waitcnt lgkmcnt(0)
    v_mfma_f32_16x16x32_bf16 v[4:7], v[56:59], v[36:39], v[4:7]
    v_mfma_f32_16x16x32_bf16 v[8:11], v[56:59], v[40:43], v[8:11]
    v_mfma_f32_16x16x32_bf16 v[12:15], v[60:63], v[36:39], v[12:15]
    v_mfma_f32_16x16x32_bf16 v[16:19], v[60:63], v[40:43], v[16:19]
    v_mfma_f32_16x16x32_bf16 v[20:23], v[64:67], v[36:39], v[20:23]
    v_mfma_f32_16x16x32_bf16 v[24:27], v[64:67], v[40:43], v[24:27]
    s_waitcnt vmcnt(12)
    s_barrier
    ds_read_b128 v[28:31], v88 offset:0
    ds_read_b128 v[32:35], v88 offset:2048
    ds_read_b64_tr_b16 v[44:45], v90 offset:0
    ds_read_b64_tr_b16 v[46:47], v90 offset:1792
    ds_read_b64_tr_b16 v[48:49], v90 offset:32
    ds_read_b64_tr_b16 v[50:51], v90 offset:1824
    ds_read_b64_tr_b16 v[52:53], v90 offset:64
    ds_read_b64_tr_b16 v[54:55], v90 offset:1856
    s_add_u32 m0, s43, 98304
    s_nop 0
    buffer_load_dwordx4 v68, s[8:11], s44 offen lds
    s_add_u32 m0, s43, 102400
    s_nop 0
    buffer_load_dwordx4 v69, s[8:11], s44 offen lds
    s_add_u32 m0, s43, 106496
    s_nop 0
    buffer_load_dwordx4 v70, s[12:15], s45 offen lds
    s_add_u32 m0, s43, 110592
    s_nop 0
    buffer_load_dwordx4 v71, s[12:15], s45 offen lds
    s_add_u32 m0, s43, 114688
    s_nop 0
    buffer_load_dwordx4 v72, s[12:15], s45 offen lds
    s_add_u32 m0, s43, 118784
    s_nop 0
    buffer_load_dwordx4 v73, s[12:15], s45 offen lds
    s_add_u32 s44, s44, 128
    s_add_u32 s45, s45, 98304
    s_add_u32 m0, s43, 122880
    s_nop 0
    buffer_load_dwordx4 v68, s[8:11], s44 offen lds
    s_add_u32 m0, s43, 126976
    s_nop 0
    buffer_load_dwordx4 v69, s[8:11], s44 offen lds
    s_add_u32 m0, s43, 131072
    s_nop 0
    buffer_load_dwordx4 v70, s[12:15], s45 offen lds
    s_add_u32 m0, s43, 135168
    s_nop 0
    buffer_load_dwordx4 v71, s[12:15], s45 offen lds
    s_add_u32 m0, s43, 139264
    s_nop 0
    buffer_load_dwordx4 v72, s[12:15], s45 offen lds
    s_add_u32 m0, s43, 143360
    s_nop 0
    buffer_load_dwordx4 v73, s[12:15], s45 offen lds
    s_add_u32 s44, s44, 128
    s_add_u32 s45, s45, 98304
    ds_read_b128 v[36:39], v89 offset:0
    ds_read_b128 v[40:43], v89 offset:2048
    ds_read_b64_tr_b16 v[56:57], v90 offset:7168
    ds_read_b64_tr_b16 v[58:59], v90 offset:8960
    ds_read_b64_tr_b16 v[60:61], v90 offset:7200
    ds_read_b64_tr_b16 v[62:63], v90 offset:8992
    ds_read_b64_tr_b16 v[64:65], v90 offset:7232
    ds_read_b64_tr_b16 v[66:67], v90 offset:9024
    s_waitcnt lgkmcnt(8)
    v_mfma_f32_16x16x32_bf16 v[4:7], v[44:47], v[28:31], v[4:7]
    v_mfma_f32_16x16x32_bf16 v[8:11], v[44:47], v[32:35], v[8:11]
    v_mfma_f32_16x16x32_bf16 v[12:15], v[48:51], v[28:31], v[12:15]
    v_mfma_f32_16x16x32_bf16 v[16:19], v[48:51], v[32:35], v[16:19]
    v_mfma_f32_16x16x32_bf16 v[20:23], v[52:55], v[28:31], v[20:23]
    v_mfma_f32_16x16x32_bf16 v[24:27], v[52:55], v[32:35], v[24:27]
    ds_read_b128 v[28:31], v92 offset:0
    ds_read_b128 v[32:35], v92 offset:2048
    ds_read_b64_tr_b16 v[44:45], v94 offset:0
    ds_read_b64_tr_b16 v[46:47], v94 offset:1792
    ds_read_b64_tr_b16 v[48:49], v94 offset:32
    ds_read_b64_tr_b16 v[50:51], v94 offset:1824
    ds_read_b64_tr_b16 v[52:53], v94 offset:64
    ds_read_b64_tr_b16 v[54:55], v94 offset:1856
    s_waitcnt lgkmcnt(8)
    v_mfma_f32_16x16x32_bf16 v[4:7], v[56:59], v[36:39], v[4:7]
    v_mfma_f32_16x16x32_bf16 v[8:11], v[56:59], v[40:43], v[8:11]
    v_mfma_f32_16x16x32_bf16 v[12:15], v[60:63], v[36:39], v[12:15]
    v_mfma_f32_16x16x32_bf16 v[16:19], v[60:63], v[40:43], v[16:19]
    v_mfma_f32_16x16x32_bf16 v[20:23], v[64:67], v[36:39], v[20:23]
    v_mfma_f32_16x16x32_bf16 v[24:27], v[64:67], v[40:43], v[24:27]
    ds_read_b128 v[36:39], v93 offset:0
    ds_read_b128 v[40:43], v93 offset:2048
    ds_read_b64_tr_b16 v[56:57], v94 offset:7168
    ds_read_b64_tr_b16 v[58:59], v94 offset:8960
    ds_read_b64_tr_b16 v[60:61], v94 offset:7200
    ds_read_b64_tr_b16 v[62:63], v94 offset:8992
    ds_read_b64_tr_b16 v[64:65], v94 offset:7232
    ds_read_b64_tr_b16 v[66:67], v94 offset:9024
    s_waitcnt lgkmcnt(8)
    v_mfma_f32_16x16x32_bf16 v[4:7], v[44:47], v[28:31], v[4:7]
    v_mfma_f32_16x16x32_bf16 v[8:11], v[44:47], v[32:35], v[8:11]
    v_mfma_f32_16x16x32_bf16 v[12:15], v[48:51], v[28:31], v[12:15]
    v_mfma_f32_16x16x32_bf16 v[16:19], v[48:51], v[32:35], v[16:19]
    v_mfma_f32_16x16x32_bf16 v[20:23], v[52:55], v[28:31], v[20:23]
    v_mfma_f32_16x16x32_bf16 v[24:27], v[52:55], v[32:35], v[24:27]
    s_waitcnt lgkmcnt(0)
    v_mfma_f32_16x16x32_bf16 v[4:7], v[56:59], v[36:39], v[4:7]
    v_mfma_f32_16x16x32_bf16 v[8:11], v[56:59], v[40:43], v[8:11]
    v_mfma_f32_16x16x32_bf16 v[12:15], v[60:63], v[36:39], v[12:15]
    v_mfma_f32_16x16x32_bf16 v[16:19], v[60:63], v[40:43], v[16:19]
    v_mfma_f32_16x16x32_bf16 v[20:23], v[64:67], v[36:39], v[20:23]
    v_mfma_f32_16x16x32_bf16 v[24:27], v[64:67], v[40:43], v[24:27]
    s_waitcnt vmcnt(12)
    s_barrier
    ds_read_b128 v[28:31], v96 offset:0
    ds_read_b128 v[32:35], v96 offset:2048
    ds_read_b64_tr_b16 v[44:45], v98 offset:0
    ds_read_b64_tr_b16 v[46:47], v98 offset:1792
    ds_read_b64_tr_b16 v[48:49], v98 offset:32
    ds_read_b64_tr_b16 v[50:51], v98 offset:1824
    ds_read_b64_tr_b16 v[52:53], v98 offset:64
    ds_read_b64_tr_b16 v[54:55], v98 offset:1856
    s_add_u32 m0, s43, 0
    s_nop 0
    buffer_load_dwordx4 v68, s[8:11], s44 offen lds
    s_add_u32 m0, s43, 4096
    s_nop 0
    buffer_load_dwordx4 v69, s[8:11], s44 offen lds
    s_add_u32 m0, s43, 8192
    s_nop 0
    buffer_load_dwordx4 v70, s[12:15], s45 offen lds
    s_add_u32 m0, s43, 12288
    s_nop 0
    buffer_load_dwordx4 v71, s[12:15], s45 offen lds
    s_add_u32 m0, s43, 16384
    s_nop 0
    buffer_load_dwordx4 v72, s[12:15], s45 offen lds
    s_add_u32 m0, s43, 20480
    s_nop 0
    buffer_load_dwordx4 v73, s[12:15], s45 offen lds
    s_add_u32 s44, s44, 128
    s_add_u32 s45, s45, 98304
    s_add_u32 m0, s43, 24576
    s_nop 0
    buffer_load_dwordx4 v68, s[8:11], s44 offen lds
    s_add_u32 m0, s43, 28672
    s_nop 0
    buffer_load_dwordx4 v69, s[8:11], s44 offen lds
    s_add_u32 m0, s43, 32768
    s_nop 0
    buffer_load_dwordx4 v70, s[12:15], s45 offen lds
    s_add_u32 m0, s43, 36864
    s_nop 0
    buffer_load_dwordx4 v71, s[12:15], s45 offen lds
    s_add_u32 m0, s43, 40960
    s_nop 0
    buffer_load_dwordx4 v72, s[12:15], s45 offen lds
    s_add_u32 m0, s43, 45056
    s_nop 0
    buffer_load_dwordx4 v73, s[12:15], s45 offen lds
    s_add_u32 s44, s44, 128
    s_add_u32 s45, s45, 98304
    ds_read_b128 v[36:39], v97 offset:0
    ds_read_b128 v[40:43], v97 offset:2048
    ds_read_b64_tr_b16 v[56:57], v98 offset:7168
    ds_read_b64_tr_b16 v[58:59], v98 offset:8960
    ds_read_b64_tr_b16 v[60:61], v98 offset:7200
    ds_read_b64_tr_b16 v[62:63], v98 offset:8992
    ds_read_b64_tr_b16 v[64:65], v98 offset:7232
    ds_read_b64_tr_b16 v[66:67], v98 offset:9024
    s_waitcnt lgkmcnt(8)
    v_mfma_f32_16x16x32_bf16 v[4:7], v[44:47], v[28:31], v[4:7]
    v_mfma_f32_16x16x32_bf16 v[8:11], v[44:47], v[32:35], v[8:11]
    v_mfma_f32_16x16x32_bf16 v[12:15], v[48:51], v[28:31], v[12:15]
    v_mfma_f32_16x16x32_bf16 v[16:19], v[48:51], v[32:35], v[16:19]
    v_mfma_f32_16x16x32_bf16 v[20:23], v[52:55], v[28:31], v[20:23]
    v_mfma_f32_16x16x32_bf16 v[24:27], v[52:55], v[32:35], v[24:27]
    ds_read_b128 v[28:31], v100 offset:0
    ds_read_b128 v[32:35], v100 offset:2048
    ds_read_b64_tr_b16 v[44:45], v102 offset:0
    ds_read_b64_tr_b16 v[46:47], v102 offset:1792
    ds_read_b64_tr_b16 v[48:49], v102 offset:32
    ds_read_b64_tr_b16 v[50:51], v102 offset:1824
    ds_read_b64_tr_b16 v[52:53], v102 offset:64
    ds_read_b64_tr_b16 v[54:55], v102 offset:1856
    s_waitcnt lgkmcnt(8)
    v_mfma_f32_16x16x32_bf16 v[4:7], v[56:59], v[36:39], v[4:7]
    v_mfma_f32_16x16x32_bf16 v[8:11], v[56:59], v[40:43], v[8:11]
    v_mfma_f32_16x16x32_bf16 v[12:15], v[60:63], v[36:39], v[12:15]
    v_mfma_f32_16x16x32_bf16 v[16:19], v[60:63], v[40:43], v[16:19]
    v_mfma_f32_16x16x32_bf16 v[20:23], v[64:67], v[36:39], v[20:23]
    v_mfma_f32_16x16x32_bf16 v[24:27], v[64:67], v[40:43], v[24:27]
    ds_read_b128 v[36:39], v101 offset:0
    ds_read_b128 v[40:43], v101 offset:2048
    ds_read_b64_tr_b16 v[56:57], v102 offset:7168
    ds_read_b64_tr_b16 v[58:59], v102 offset:8960
    ds_read_b64_tr_b16 v[60:61], v102 offset:7200
    ds_read_b64_tr_b16 v[62:63], v102 offset:8992
    ds_read_b64_tr_b16 v[64:65], v102 offset:7232
    ds_read_b64_tr_b16 v[66:67], v102 offset:9024
    s_waitcnt lgkmcnt(8)
    v_mfma_f32_16x16x32_bf16 v[4:7], v[44:47], v[28:31], v[4:7]
    v_mfma_f32_16x16x32_bf16 v[8:11], v[44:47], v[32:35], v[8:11]
    v_mfma_f32_16x16x32_bf16 v[12:15], v[48:51], v[28:31], v[12:15]
    v_mfma_f32_16x16x32_bf16 v[16:19], v[48:51], v[32:35], v[16:19]
    v_mfma_f32_16x16x32_bf16 v[20:23], v[52:55], v[28:31], v[20:23]
    v_mfma_f32_16x16x32_bf16 v[24:27], v[52:55], v[32:35], v[24:27]
    s_waitcnt lgkmcnt(0)
    v_mfma_f32_16x16x32_bf16 v[4:7], v[56:59], v[36:39], v[4:7]
    v_mfma_f32_16x16x32_bf16 v[8:11], v[56:59], v[40:43], v[8:11]
    v_mfma_f32_16x16x32_bf16 v[12:15], v[60:63], v[36:39], v[12:15]
    v_mfma_f32_16x16x32_bf16 v[16:19], v[60:63], v[40:43], v[16:19]
    v_mfma_f32_16x16x32_bf16 v[20:23], v[64:67], v[36:39], v[20:23]
    v_mfma_f32_16x16x32_bf16 v[24:27], v[64:67], v[40:43], v[24:27]
    s_waitcnt vmcnt(12)
    s_barrier
    ds_read_b128 v[28:31], v104 offset:0
    ds_read_b128 v[32:35], v104 offset:2048
    ds_read_b64_tr_b16 v[44:45], v106 offset:0
    ds_read_b64_tr_b16 v[46:47], v106 offset:1792
    ds_read_b64_tr_b16 v[48:49], v106 offset:32
    ds_read_b64_tr_b16 v[50:51], v106 offset:1824
    ds_read_b64_tr_b16 v[52:53], v106 offset:64
    ds_read_b64_tr_b16 v[54:55], v106 offset:1856
    s_add_u32 m0, s43, 49152
    s_nop 0
    buffer_load_dwordx4 v68, s[8:11], s44 offen lds
    s_add_u32 m0, s43, 53248
    s_nop 0
    buffer_load_dwordx4 v69, s[8:11], s44 offen lds
    s_add_u32 m0, s43, 57344
    s_nop 0
    buffer_load_dwordx4 v70, s[12:15], s45 offen lds
    s_add_u32 m0, s43, 61440
    s_nop 0
    buffer_load_dwordx4 v71, s[12:15], s45 offen lds
    s_add_u32 m0, s43, 65536
    s_nop 0
    buffer_load_dwordx4 v72, s[12:15], s45 offen lds
    s_add_u32 m0, s43, 69632
    s_nop 0
    buffer_load_dwordx4 v73, s[12:15], s45 offen lds
    s_add_u32 s44, s44, 128
    s_add_u32 s45, s45, 98304
    s_add_u32 m0, s43, 73728
    s_nop 0
    buffer_load_dwordx4 v68, s[8:11], s44 offen lds
    s_add_u32 m0, s43, 77824
    s_nop 0
    buffer_load_dwordx4 v69, s[8:11], s44 offen lds
    s_add_u32 m0, s43, 81920
    s_nop 0
    buffer_load_dwordx4 v70, s[12:15], s45 offen lds
    s_add_u32 m0, s43, 86016
    s_nop 0
    buffer_load_dwordx4 v71, s[12:15], s45 offen lds
    s_add_u32 m0, s43, 90112
    s_nop 0
    buffer_load_dwordx4 v72, s[12:15], s45 offen lds
    s_add_u32 m0, s43, 94208
    s_nop 0
    buffer_load_dwordx4 v73, s[12:15], s45 offen lds
    s_add_u32 s44, s44, 128
    s_add_u32 s45, s45, 98304
    ds_read_b128 v[36:39], v105 offset:0
    ds_read_b128 v[40:43], v105 offset:2048
    ds_read_b64_tr_b16 v[56:57], v106 offset:7168
    ds_read_b64_tr_b16 v[58:59], v106 offset:8960
    ds_read_b64_tr_b16 v[60:61], v106 offset:7200
    ds_read_b64_tr_b16 v[62:63], v106 offset:8992
    ds_read_b64_tr_b16 v[64:65], v106 offset:7232
    ds_read_b64_tr_b16 v[66:67], v106 offset:9024
    s_waitcnt lgkmcnt(8)
    v_mfma_f32_16x16x32_bf16 v[4:7], v[44:47], v[28:31], v[4:7]
    v_mfma_f32_16x16x32_bf16 v[8:11], v[44:47], v[32:35], v[8:11]
    v_mfma_f32_16x16x32_bf16 v[12:15], v[48:51], v[28:31], v[12:15]
    v_mfma_f32_16x16x32_bf16 v[16:19], v[48:51], v[32:35], v[16:19]
    v_mfma_f32_16x16x32_bf16 v[20:23], v[52:55], v[28:31], v[20:23]
    v_mfma_f32_16x16x32_bf16 v[24:27], v[52:55], v[32:35], v[24:27]
    ds_read_b128 v[28:31], v108 offset:0
    ds_read_b128 v[32:35], v108 offset:2048
    ds_read_b64_tr_b16 v[44:45], v110 offset:0
    ds_read_b64_tr_b16 v[46:47], v110 offset:1792
    ds_read_b64_tr_b16 v[48:49], v110 offset:32
    ds_read_b64_tr_b16 v[50:51], v110 offset:1824
    ds_read_b64_tr_b16 v[52:53], v110 offset:64
    ds_read_b64_tr_b16 v[54:55], v110 offset:1856
    s_waitcnt lgkmcnt(8)
    v_mfma_f32_16x16x32_bf16 v[4:7], v[56:59], v[36:39], v[4:7]
    v_mfma_f32_16x16x32_bf16 v[8:11], v[56:59], v[40:43], v[8:11]
    v_mfma_f32_16x16x32_bf16 v[12:15], v[60:63], v[36:39], v[12:15]
    v_mfma_f32_16x16x32_bf16 v[16:19], v[60:63], v[40:43], v[16:19]
    v_mfma_f32_16x16x32_bf16 v[20:23], v[64:67], v[36:39], v[20:23]
    v_mfma_f32_16x16x32_bf16 v[24:27], v[64:67], v[40:43], v[24:27]
    ds_read_b128 v[36:39], v109 offset:0
    ds_read_b128 v[40:43], v109 offset:2048
    ds_read_b64_tr_b16 v[56:57], v110 offset:7168
    ds_read_b64_tr_b16 v[58:59], v110 offset:8960
    ds_read_b64_tr_b16 v[60:61], v110 offset:7200
    ds_read_b64_tr_b16 v[62:63], v110 offset:8992
    ds_read_b64_tr_b16 v[64:65], v110 offset:7232
    ds_read_b64_tr_b16 v[66:67], v110 offset:9024
    s_waitcnt lgkmcnt(8)
    v_mfma_f32_16x16x32_bf16 v[4:7], v[44:47], v[28:31], v[4:7]
    v_mfma_f32_16x16x32_bf16 v[8:11], v[44:47], v[32:35], v[8:11]
    v_mfma_f32_16x16x32_bf16 v[12:15], v[48:51], v[28:31], v[12:15]
    v_mfma_f32_16x16x32_bf16 v[16:19], v[48:51], v[32:35], v[16:19]
    v_mfma_f32_16x16x32_bf16 v[20:23], v[52:55], v[28:31], v[20:23]
    v_mfma_f32_16x16x32_bf16 v[24:27], v[52:55], v[32:35], v[24:27]
    s_waitcnt lgkmcnt(0)
    v_mfma_f32_16x16x32_bf16 v[4:7], v[56:59], v[36:39], v[4:7]
    v_mfma_f32_16x16x32_bf16 v[8:11], v[56:59], v[40:43], v[8:11]
    v_mfma_f32_16x16x32_bf16 v[12:15], v[60:63], v[36:39], v[12:15]
    v_mfma_f32_16x16x32_bf16 v[16:19], v[60:63], v[40:43], v[16:19]
    v_mfma_f32_16x16x32_bf16 v[20:23], v[64:67], v[36:39], v[20:23]
    v_mfma_f32_16x16x32_bf16 v[24:27], v[64:67], v[40:43], v[24:27]
    s_waitcnt vmcnt(12)
    s_barrier
    ds_read_b128 v[28:31], v88 offset:0
    ds_read_b128 v[32:35], v88 offset:2048
    ds_read_b64_tr_b16 v[44:45], v90 offset:0
    ds_read_b64_tr_b16 v[46:47], v90 offset:1792
    ds_read_b64_tr_b16 v[48:49], v90 offset:32
    ds_read_b64_tr_b16 v[50:51], v90 offset:1824
    ds_read_b64_tr_b16 v[52:53], v90 offset:64
    ds_read_b64_tr_b16 v[54:55], v90 offset:1856
    s_add_u32 m0, s43, 98304
    s_nop 0
    buffer_load_dwordx4 v68, s[8:11], s44 offen lds
    s_add_u32 m0, s43, 102400
    s_nop 0
    buffer_load_dwordx4 v69, s[8:11], s44 offen lds
    s_add_u32 m0, s43, 106496
    s_nop 0
    buffer_load_dwordx4 v70, s[12:15], s45 offen lds
    s_add_u32 m0, s43, 110592
    s_nop 0
    buffer_load_dwordx4 v71, s[12:15], s45 offen lds
    s_add_u32 m0, s43, 114688
    s_nop 0
    buffer_load_dwordx4 v72, s[12:15], s45 offen lds
    s_add_u32 m0, s43, 118784
    s_nop 0
    buffer_load_dwordx4 v73, s[12:15], s45 offen lds
    s_add_u32 s44, s44, 128
    s_add_u32 s45, s45, 98304
    s_add_u32 m0, s43, 122880
    s_nop 0
    buffer_load_dwordx4 v68, s[8:11], s44 offen lds
    s_add_u32 m0, s43, 126976
    s_nop 0
    buffer_load_dwordx4 v69, s[8:11], s44 offen lds
    s_add_u32 m0, s43, 131072
    s_nop 0
    buffer_load_dwordx4 v70, s[12:15], s45 offen lds
    s_add_u32 m0, s43, 135168
    s_nop 0
    buffer_load_dwordx4 v71, s[12:15], s45 offen lds
    s_add_u32 m0, s43, 139264
    s_nop 0
    buffer_load_dwordx4 v72, s[12:15], s45 offen lds
    s_add_u32 m0, s43, 143360
    s_nop 0
    buffer_load_dwordx4 v73, s[12:15], s45 offen lds
    s_add_u32 s44, s44, 128
    s_add_u32 s45, s45, 98304
    ds_read_b128 v[36:39], v89 offset:0
    ds_read_b128 v[40:43], v89 offset:2048
    ds_read_b64_tr_b16 v[56:57], v90 offset:7168
    ds_read_b64_tr_b16 v[58:59], v90 offset:8960
    ds_read_b64_tr_b16 v[60:61], v90 offset:7200
    ds_read_b64_tr_b16 v[62:63], v90 offset:8992
    ds_read_b64_tr_b16 v[64:65], v90 offset:7232
    ds_read_b64_tr_b16 v[66:67], v90 offset:9024
    s_waitcnt lgkmcnt(8)
    v_mfma_f32_16x16x32_bf16 v[4:7], v[44:47], v[28:31], v[4:7]
    v_mfma_f32_16x16x32_bf16 v[8:11], v[44:47], v[32:35], v[8:11]
    v_mfma_f32_16x16x32_bf16 v[12:15], v[48:51], v[28:31], v[12:15]
    v_mfma_f32_16x16x32_bf16 v[16:19], v[48:51], v[32:35], v[16:19]
    v_mfma_f32_16x16x32_bf16 v[20:23], v[52:55], v[28:31], v[20:23]
    v_mfma_f32_16x16x32_bf16 v[24:27], v[52:55], v[32:35], v[24:27]
    ds_read_b128 v[28:31], v92 offset:0
    ds_read_b128 v[32:35], v92 offset:2048
    ds_read_b64_tr_b16 v[44:45], v94 offset:0
    ds_read_b64_tr_b16 v[46:47], v94 offset:1792
    ds_read_b64_tr_b16 v[48:49], v94 offset:32
    ds_read_b64_tr_b16 v[50:51], v94 offset:1824
    ds_read_b64_tr_b16 v[52:53], v94 offset:64
    ds_read_b64_tr_b16 v[54:55], v94 offset:1856
    s_waitcnt lgkmcnt(8)
    v_mfma_f32_16x16x32_bf16 v[4:7], v[56:59], v[36:39], v[4:7]
    v_mfma_f32_16x16x32_bf16 v[8:11], v[56:59], v[40:43], v[8:11]
    v_mfma_f32_16x16x32_bf16 v[12:15], v[60:63], v[36:39], v[12:15]
    v_mfma_f32_16x16x32_bf16 v[16:19], v[60:63], v[40:43], v[16:19]
    v_mfma_f32_16x16x32_bf16 v[20:23], v[64:67], v[36:39], v[20:23]
    v_mfma_f32_16x16x32_bf16 v[24:27], v[64:67], v[40:43], v[24:27]
    ds_read_b128 v[36:39], v93 offset:0
    ds_read_b128 v[40:43], v93 offset:2048
    ds_read_b64_tr_b16 v[56:57], v94 offset:7168
    ds_read_b64_tr_b16 v[58:59], v94 offset:8960
    ds_read_b64_tr_b16 v[60:61], v94 offset:7200
    ds_read_b64_tr_b16 v[62:63], v94 offset:8992
    ds_read_b64_tr_b16 v[64:65], v94 offset:7232
    ds_read_b64_tr_b16 v[66:67], v94 offset:9024
    s_waitcnt lgkmcnt(8)
    v_mfma_f32_16x16x32_bf16 v[4:7], v[44:47], v[28:31], v[4:7]
    v_mfma_f32_16x16x32_bf16 v[8:11], v[44:47], v[32:35], v[8:11]
    v_mfma_f32_16x16x32_bf16 v[12:15], v[48:51], v[28:31], v[12:15]
    v_mfma_f32_16x16x32_bf16 v[16:19], v[48:51], v[32:35], v[16:19]
    v_mfma_f32_16x16x32_bf16 v[20:23], v[52:55], v[28:31], v[20:23]
    v_mfma_f32_16x16x32_bf16 v[24:27], v[52:55], v[32:35], v[24:27]
    s_waitcnt lgkmcnt(0)
    v_mfma_f32_16x16x32_bf16 v[4:7], v[56:59], v[36:39], v[4:7]
    v_mfma_f32_16x16x32_bf16 v[8:11], v[56:59], v[40:43], v[8:11]
    v_mfma_f32_16x16x32_bf16 v[12:15], v[60:63], v[36:39], v[12:15]
    v_mfma_f32_16x16x32_bf16 v[16:19], v[60:63], v[40:43], v[16:19]
    v_mfma_f32_16x16x32_bf16 v[20:23], v[64:67], v[36:39], v[20:23]
    v_mfma_f32_16x16x32_bf16 v[24:27], v[64:67], v[40:43], v[24:27]
    s_waitcnt vmcnt(12)
    s_barrier
    ds_read_b128 v[28:31], v96 offset:0
    ds_read_b128 v[32:35], v96 offset:2048
    ds_read_b64_tr_b16 v[44:45], v98 offset:0
    ds_read_b64_tr_b16 v[46:47], v98 offset:1792
    ds_read_b64_tr_b16 v[48:49], v98 offset:32
    ds_read_b64_tr_b16 v[50:51], v98 offset:1824
    ds_read_b64_tr_b16 v[52:53], v98 offset:64
    ds_read_b64_tr_b16 v[54:55], v98 offset:1856
    s_add_u32 m0, s43, 0
    s_nop 0
    buffer_load_dwordx4 v68, s[8:11], s44 offen lds
    s_add_u32 m0, s43, 4096
    s_nop 0
    buffer_load_dwordx4 v69, s[8:11], s44 offen lds
    s_add_u32 m0, s43, 8192
    s_nop 0
    buffer_load_dwordx4 v70, s[12:15], s45 offen lds
    s_add_u32 m0, s43, 12288
    s_nop 0
    buffer_load_dwordx4 v71, s[12:15], s45 offen lds
    s_add_u32 m0, s43, 16384
    s_nop 0
    buffer_load_dwordx4 v72, s[12:15], s45 offen lds
    s_add_u32 m0, s43, 20480
    s_nop 0
    buffer_load_dwordx4 v73, s[12:15], s45 offen lds
    s_add_u32 s44, s44, 128
    s_add_u32 s45, s45, 98304
    s_add_u32 m0, s43, 24576
    s_nop 0
    buffer_load_dwordx4 v68, s[8:11], s44 offen lds
    s_add_u32 m0, s43, 28672
    s_nop 0
    buffer_load_dwordx4 v69, s[8:11], s44 offen lds
    s_add_u32 m0, s43, 32768
    s_nop 0
    buffer_load_dwordx4 v70, s[12:15], s45 offen lds
    s_add_u32 m0, s43, 36864
    s_nop 0
    buffer_load_dwordx4 v71, s[12:15], s45 offen lds
    s_add_u32 m0, s43, 40960
    s_nop 0
    buffer_load_dwordx4 v72, s[12:15], s45 offen lds
    s_add_u32 m0, s43, 45056
    s_nop 0
    buffer_load_dwordx4 v73, s[12:15], s45 offen lds
    s_add_u32 s44, s44, 128
    s_add_u32 s45, s45, 98304
    ds_read_b128 v[36:39], v97 offset:0
    ds_read_b128 v[40:43], v97 offset:2048
    ds_read_b64_tr_b16 v[56:57], v98 offset:7168
    ds_read_b64_tr_b16 v[58:59], v98 offset:8960
    ds_read_b64_tr_b16 v[60:61], v98 offset:7200
    ds_read_b64_tr_b16 v[62:63], v98 offset:8992
    ds_read_b64_tr_b16 v[64:65], v98 offset:7232
    ds_read_b64_tr_b16 v[66:67], v98 offset:9024
    s_waitcnt lgkmcnt(8)
    v_mfma_f32_16x16x32_bf16 v[4:7], v[44:47], v[28:31], v[4:7]
    v_mfma_f32_16x16x32_bf16 v[8:11], v[44:47], v[32:35], v[8:11]
    v_mfma_f32_16x16x32_bf16 v[12:15], v[48:51], v[28:31], v[12:15]
    v_mfma_f32_16x16x32_bf16 v[16:19], v[48:51], v[32:35], v[16:19]
    v_mfma_f32_16x16x32_bf16 v[20:23], v[52:55], v[28:31], v[20:23]
    v_mfma_f32_16x16x32_bf16 v[24:27], v[52:55], v[32:35], v[24:27]
    ds_read_b128 v[28:31], v100 offset:0
    ds_read_b128 v[32:35], v100 offset:2048
    ds_read_b64_tr_b16 v[44:45], v102 offset:0
    ds_read_b64_tr_b16 v[46:47], v102 offset:1792
    ds_read_b64_tr_b16 v[48:49], v102 offset:32
    ds_read_b64_tr_b16 v[50:51], v102 offset:1824
    ds_read_b64_tr_b16 v[52:53], v102 offset:64
    ds_read_b64_tr_b16 v[54:55], v102 offset:1856
    s_waitcnt lgkmcnt(8)
    v_mfma_f32_16x16x32_bf16 v[4:7], v[56:59], v[36:39], v[4:7]
    v_mfma_f32_16x16x32_bf16 v[8:11], v[56:59], v[40:43], v[8:11]
    v_mfma_f32_16x16x32_bf16 v[12:15], v[60:63], v[36:39], v[12:15]
    v_mfma_f32_16x16x32_bf16 v[16:19], v[60:63], v[40:43], v[16:19]
    v_mfma_f32_16x16x32_bf16 v[20:23], v[64:67], v[36:39], v[20:23]
    v_mfma_f32_16x16x32_bf16 v[24:27], v[64:67], v[40:43], v[24:27]
    ds_read_b128 v[36:39], v101 offset:0
    ds_read_b128 v[40:43], v101 offset:2048
    ds_read_b64_tr_b16 v[56:57], v102 offset:7168
    ds_read_b64_tr_b16 v[58:59], v102 offset:8960
    ds_read_b64_tr_b16 v[60:61], v102 offset:7200
    ds_read_b64_tr_b16 v[62:63], v102 offset:8992
    ds_read_b64_tr_b16 v[64:65], v102 offset:7232
    ds_read_b64_tr_b16 v[66:67], v102 offset:9024
    s_waitcnt lgkmcnt(8)
    v_mfma_f32_16x16x32_bf16 v[4:7], v[44:47], v[28:31], v[4:7]
    v_mfma_f32_16x16x32_bf16 v[8:11], v[44:47], v[32:35], v[8:11]
    v_mfma_f32_16x16x32_bf16 v[12:15], v[48:51], v[28:31], v[12:15]
    v_mfma_f32_16x16x32_bf16 v[16:19], v[48:51], v[32:35], v[16:19]
    v_mfma_f32_16x16x32_bf16 v[20:23], v[52:55], v[28:31], v[20:23]
    v_mfma_f32_16x16x32_bf16 v[24:27], v[52:55], v[32:35], v[24:27]
    s_waitcnt lgkmcnt(0)
    v_mfma_f32_16x16x32_bf16 v[4:7], v[56:59], v[36:39], v[4:7]
    v_mfma_f32_16x16x32_bf16 v[8:11], v[56:59], v[40:43], v[8:11]
    v_mfma_f32_16x16x32_bf16 v[12:15], v[60:63], v[36:39], v[12:15]
    v_mfma_f32_16x16x32_bf16 v[16:19], v[60:63], v[40:43], v[16:19]
    v_mfma_f32_16x16x32_bf16 v[20:23], v[64:67], v[36:39], v[20:23]
    v_mfma_f32_16x16x32_bf16 v[24:27], v[64:67], v[40:43], v[24:27]
    s_waitcnt vmcnt(12)
    s_barrier
    ds_read_b128 v[28:31], v104 offset:0
    ds_read_b128 v[32:35], v104 offset:2048
    ds_read_b64_tr_b16 v[44:45], v106 offset:0
    ds_read_b64_tr_b16 v[46:47], v106 offset:1792
    ds_read_b64_tr_b16 v[48:49], v106 offset:32
    ds_read_b64_tr_b16 v[50:51], v106 offset:1824
    ds_read_b64_tr_b16 v[52:53], v106 offset:64
    ds_read_b64_tr_b16 v[54:55], v106 offset:1856
    s_add_u32 m0, s43, 49152
    s_nop 0
    buffer_load_dwordx4 v68, s[8:11], s44 offen lds
    s_add_u32 m0, s43, 53248
    s_nop 0
    buffer_load_dwordx4 v69, s[8:11], s44 offen lds
    s_add_u32 m0, s43, 57344
    s_nop 0
    buffer_load_dwordx4 v70, s[12:15], s45 offen lds
    s_add_u32 m0, s43, 61440
    s_nop 0
    buffer_load_dwordx4 v71, s[12:15], s45 offen lds
    s_add_u32 m0, s43, 65536
    s_nop 0
    buffer_load_dwordx4 v72, s[12:15], s45 offen lds
    s_add_u32 m0, s43, 69632
    s_nop 0
    buffer_load_dwordx4 v73, s[12:15], s45 offen lds
    s_add_u32 s44, s44, 128
    s_add_u32 s45, s45, 98304
    s_add_u32 m0, s43, 73728
    s_nop 0
    buffer_load_dwordx4 v68, s[8:11], s44 offen lds
    s_add_u32 m0, s43, 77824
    s_nop 0
    buffer_load_dwordx4 v69, s[8:11], s44 offen lds
    s_add_u32 m0, s43, 81920
    s_nop 0
    buffer_load_dwordx4 v70, s[12:15], s45 offen lds
    s_add_u32 m0, s43, 86016
    s_nop 0
    buffer_load_dwordx4 v71, s[12:15], s45 offen lds
    s_add_u32 m0, s43, 90112
    s_nop 0
    buffer_load_dwordx4 v72, s[12:15], s45 offen lds
    s_add_u32 m0, s43, 94208
    s_nop 0
    buffer_load_dwordx4 v73, s[12:15], s45 offen lds
    s_add_u32 s44, s44, 128
    s_add_u32 s45, s45, 98304
    ds_read_b128 v[36:39], v105 offset:0
    ds_read_b128 v[40:43], v105 offset:2048
    ds_read_b64_tr_b16 v[56:57], v106 offset:7168
    ds_read_b64_tr_b16 v[58:59], v106 offset:8960
    ds_read_b64_tr_b16 v[60:61], v106 offset:7200
    ds_read_b64_tr_b16 v[62:63], v106 offset:8992
    ds_read_b64_tr_b16 v[64:65], v106 offset:7232
    ds_read_b64_tr_b16 v[66:67], v106 offset:9024
    s_waitcnt lgkmcnt(8)
    v_mfma_f32_16x16x32_bf16 v[4:7], v[44:47], v[28:31], v[4:7]
    v_mfma_f32_16x16x32_bf16 v[8:11], v[44:47], v[32:35], v[8:11]
    v_mfma_f32_16x16x32_bf16 v[12:15], v[48:51], v[28:31], v[12:15]
    v_mfma_f32_16x16x32_bf16 v[16:19], v[48:51], v[32:35], v[16:19]
    v_mfma_f32_16x16x32_bf16 v[20:23], v[52:55], v[28:31], v[20:23]
    v_mfma_f32_16x16x32_bf16 v[24:27], v[52:55], v[32:35], v[24:27]
    ds_read_b128 v[28:31], v108 offset:0
    ds_read_b128 v[32:35], v108 offset:2048
    ds_read_b64_tr_b16 v[44:45], v110 offset:0
    ds_read_b64_tr_b16 v[46:47], v110 offset:1792
    ds_read_b64_tr_b16 v[48:49], v110 offset:32
    ds_read_b64_tr_b16 v[50:51], v110 offset:1824
    ds_read_b64_tr_b16 v[52:53], v110 offset:64
    ds_read_b64_tr_b16 v[54:55], v110 offset:1856
    s_waitcnt lgkmcnt(8)
    v_mfma_f32_16x16x32_bf16 v[4:7], v[56:59], v[36:39], v[4:7]
    v_mfma_f32_16x16x32_bf16 v[8:11], v[56:59], v[40:43], v[8:11]
    v_mfma_f32_16x16x32_bf16 v[12:15], v[60:63], v[36:39], v[12:15]
    v_mfma_f32_16x16x32_bf16 v[16:19], v[60:63], v[40:43], v[16:19]
    v_mfma_f32_16x16x32_bf16 v[20:23], v[64:67], v[36:39], v[20:23]
    v_mfma_f32_16x16x32_bf16 v[24:27], v[64:67], v[40:43], v[24:27]
    ds_read_b128 v[36:39], v109 offset:0
    ds_read_b128 v[40:43], v109 offset:2048
    ds_read_b64_tr_b16 v[56:57], v110 offset:7168
    ds_read_b64_tr_b16 v[58:59], v110 offset:8960
    ds_read_b64_tr_b16 v[60:61], v110 offset:7200
    ds_read_b64_tr_b16 v[62:63], v110 offset:8992
    ds_read_b64_tr_b16 v[64:65], v110 offset:7232
    ds_read_b64_tr_b16 v[66:67], v110 offset:9024
    s_waitcnt lgkmcnt(8)
    v_mfma_f32_16x16x32_bf16 v[4:7], v[44:47], v[28:31], v[4:7]
    v_mfma_f32_16x16x32_bf16 v[8:11], v[44:47], v[32:35], v[8:11]
    v_mfma_f32_16x16x32_bf16 v[12:15], v[48:51], v[28:31], v[12:15]
    v_mfma_f32_16x16x32_bf16 v[16:19], v[48:51], v[32:35], v[16:19]
    v_mfma_f32_16x16x32_bf16 v[20:23], v[52:55], v[28:31], v[20:23]
    v_mfma_f32_16x16x32_bf16 v[24:27], v[52:55], v[32:35], v[24:27]
    s_waitcnt lgkmcnt(0)
    v_mfma_f32_16x16x32_bf16 v[4:7], v[56:59], v[36:39], v[4:7]
    v_mfma_f32_16x16x32_bf16 v[8:11], v[56:59], v[40:43], v[8:11]
    v_mfma_f32_16x16x32_bf16 v[12:15], v[60:63], v[36:39], v[12:15]
    v_mfma_f32_16x16x32_bf16 v[16:19], v[60:63], v[40:43], v[16:19]
    v_mfma_f32_16x16x32_bf16 v[20:23], v[64:67], v[36:39], v[20:23]
    v_mfma_f32_16x16x32_bf16 v[24:27], v[64:67], v[40:43], v[24:27]
    s_waitcnt vmcnt(12)
    s_barrier
    ds_read_b128 v[28:31], v88 offset:0
    ds_read_b128 v[32:35], v88 offset:2048
    ds_read_b64_tr_b16 v[44:45], v90 offset:0
    ds_read_b64_tr_b16 v[46:47], v90 offset:1792
    ds_read_b64_tr_b16 v[48:49], v90 offset:32
    ds_read_b64_tr_b16 v[50:51], v90 offset:1824
    ds_read_b64_tr_b16 v[52:53], v90 offset:64
    ds_read_b64_tr_b16 v[54:55], v90 offset:1856
    s_add_u32 m0, s43, 98304
    s_nop 0
    buffer_load_dwordx4 v68, s[8:11], s44 offen lds
    s_add_u32 m0, s43, 102400
    s_nop 0
    buffer_load_dwordx4 v69, s[8:11], s44 offen lds
    s_add_u32 m0, s43, 106496
    s_nop 0
    buffer_load_dwordx4 v70, s[12:15], s45 offen lds
    s_add_u32 m0, s43, 110592
    s_nop 0
    buffer_load_dwordx4 v71, s[12:15], s45 offen lds
    s_add_u32 m0, s43, 114688
    s_nop 0
    buffer_load_dwordx4 v72, s[12:15], s45 offen lds
    s_add_u32 m0, s43, 118784
    s_nop 0
    buffer_load_dwordx4 v73, s[12:15], s45 offen lds
    s_add_u32 s44, s44, 128
    s_add_u32 s45, s45, 98304
    s_add_u32 m0, s43, 122880
    s_nop 0
    buffer_load_dwordx4 v68, s[8:11], s44 offen lds
    s_add_u32 m0, s43, 126976
    s_nop 0
    buffer_load_dwordx4 v69, s[8:11], s44 offen lds
    s_add_u32 m0, s43, 131072
    s_nop 0
    buffer_load_dwordx4 v70, s[12:15], s45 offen lds
    s_add_u32 m0, s43, 135168
    s_nop 0
    buffer_load_dwordx4 v71, s[12:15], s45 offen lds
    s_add_u32 m0, s43, 139264
    s_nop 0
    buffer_load_dwordx4 v72, s[12:15], s45 offen lds
    s_add_u32 m0, s43, 143360
    s_nop 0
    buffer_load_dwordx4 v73, s[12:15], s45 offen lds
    s_add_u32 s44, s44, 128
    s_add_u32 s45, s45, 98304
    ds_read_b128 v[36:39], v89 offset:0
    ds_read_b128 v[40:43], v89 offset:2048
    ds_read_b64_tr_b16 v[56:57], v90 offset:7168
    ds_read_b64_tr_b16 v[58:59], v90 offset:8960
    ds_read_b64_tr_b16 v[60:61], v90 offset:7200
    ds_read_b64_tr_b16 v[62:63], v90 offset:8992
    ds_read_b64_tr_b16 v[64:65], v90 offset:7232
    ds_read_b64_tr_b16 v[66:67], v90 offset:9024
    s_waitcnt lgkmcnt(8)
    v_mfma_f32_16x16x32_bf16 v[4:7], v[44:47], v[28:31], v[4:7]
    v_mfma_f32_16x16x32_bf16 v[8:11], v[44:47], v[32:35], v[8:11]
    v_mfma_f32_16x16x32_bf16 v[12:15], v[48:51], v[28:31], v[12:15]
    v_mfma_f32_16x16x32_bf16 v[16:19], v[48:51], v[32:35], v[16:19]
    v_mfma_f32_16x16x32_bf16 v[20:23], v[52:55], v[28:31], v[20:23]
    v_mfma_f32_16x16x32_bf16 v[24:27], v[52:55], v[32:35], v[24:27]
    ds_read_b128 v[28:31], v92 offset:0
    ds_read_b128 v[32:35], v92 offset:2048
    ds_read_b64_tr_b16 v[44:45], v94 offset:0
    ds_read_b64_tr_b16 v[46:47], v94 offset:1792
    ds_read_b64_tr_b16 v[48:49], v94 offset:32
    ds_read_b64_tr_b16 v[50:51], v94 offset:1824
    ds_read_b64_tr_b16 v[52:53], v94 offset:64
    ds_read_b64_tr_b16 v[54:55], v94 offset:1856
    s_waitcnt lgkmcnt(8)
    v_mfma_f32_16x16x32_bf16 v[4:7], v[56:59], v[36:39], v[4:7]
    v_mfma_f32_16x16x32_bf16 v[8:11], v[56:59], v[40:43], v[8:11]
    v_mfma_f32_16x16x32_bf16 v[12:15], v[60:63], v[36:39], v[12:15]
    v_mfma_f32_16x16x32_bf16 v[16:19], v[60:63], v[40:43], v[16:19]
    v_mfma_f32_16x16x32_bf16 v[20:23], v[64:67], v[36:39], v[20:23]
    v_mfma_f32_16x16x32_bf16 v[24:27], v[64:67], v[40:43], v[24:27]
    ds_read_b128 v[36:39], v93 offset:0
    ds_read_b128 v[40:43], v93 offset:2048
    ds_read_b64_tr_b16 v[56:57], v94 offset:7168
    ds_read_b64_tr_b16 v[58:59], v94 offset:8960
    ds_read_b64_tr_b16 v[60:61], v94 offset:7200
    ds_read_b64_tr_b16 v[62:63], v94 offset:8992
    ds_read_b64_tr_b16 v[64:65], v94 offset:7232
    ds_read_b64_tr_b16 v[66:67], v94 offset:9024
    s_waitcnt lgkmcnt(8)
    v_mfma_f32_16x16x32_bf16 v[4:7], v[44:47], v[28:31], v[4:7]
    v_mfma_f32_16x16x32_bf16 v[8:11], v[44:47], v[32:35], v[8:11]
    v_mfma_f32_16x16x32_bf16 v[12:15], v[48:51], v[28:31], v[12:15]
    v_mfma_f32_16x16x32_bf16 v[16:19], v[48:51], v[32:35], v[16:19]
    v_mfma_f32_16x16x32_bf16 v[20:23], v[52:55], v[28:31], v[20:23]
    v_mfma_f32_16x16x32_bf16 v[24:27], v[52:55], v[32:35], v[24:27]
    s_waitcnt lgkmcnt(0)
    v_mfma_f32_16x16x32_bf16 v[4:7], v[56:59], v[36:39], v[4:7]
    v_mfma_f32_16x16x32_bf16 v[8:11], v[56:59], v[40:43], v[8:11]
    v_mfma_f32_16x16x32_bf16 v[12:15], v[60:63], v[36:39], v[12:15]
    v_mfma_f32_16x16x32_bf16 v[16:19], v[60:63], v[40:43], v[16:19]
    v_mfma_f32_16x16x32_bf16 v[20:23], v[64:67], v[36:39], v[20:23]
    v_mfma_f32_16x16x32_bf16 v[24:27], v[64:67], v[40:43], v[24:27]
    s_waitcnt vmcnt(12)
    s_barrier
    ds_read_b128 v[28:31], v96 offset:0
    ds_read_b128 v[32:35], v96 offset:2048
    ds_read_b64_tr_b16 v[44:45], v98 offset:0
    ds_read_b64_tr_b16 v[46:47], v98 offset:1792
    ds_read_b64_tr_b16 v[48:49], v98 offset:32
    ds_read_b64_tr_b16 v[50:51], v98 offset:1824
    ds_read_b64_tr_b16 v[52:53], v98 offset:64
    ds_read_b64_tr_b16 v[54:55], v98 offset:1856
    s_add_u32 m0, s43, 0
    s_nop 0
    buffer_load_dwordx4 v68, s[8:11], s44 offen lds
    s_add_u32 m0, s43, 4096
    s_nop 0
    buffer_load_dwordx4 v69, s[8:11], s44 offen lds
    s_add_u32 m0, s43, 8192
    s_nop 0
    buffer_load_dwordx4 v70, s[12:15], s45 offen lds
    s_add_u32 m0, s43, 12288
    s_nop 0
    buffer_load_dwordx4 v71, s[12:15], s45 offen lds
    s_add_u32 m0, s43, 16384
    s_nop 0
    buffer_load_dwordx4 v72, s[12:15], s45 offen lds
    s_add_u32 m0, s43, 20480
    s_nop 0
    buffer_load_dwordx4 v73, s[12:15], s45 offen lds
    s_add_u32 s44, s44, 128
    s_add_u32 s45, s45, 98304
    s_add_u32 m0, s43, 24576
    s_nop 0
    buffer_load_dwordx4 v68, s[8:11], s44 offen lds
    s_add_u32 m0, s43, 28672
    s_nop 0
    buffer_load_dwordx4 v69, s[8:11], s44 offen lds
    s_add_u32 m0, s43, 32768
    s_nop 0
    buffer_load_dwordx4 v70, s[12:15], s45 offen lds
    s_add_u32 m0, s43, 36864
    s_nop 0
    buffer_load_dwordx4 v71, s[12:15], s45 offen lds
    s_add_u32 m0, s43, 40960
    s_nop 0
    buffer_load_dwordx4 v72, s[12:15], s45 offen lds
    s_add_u32 m0, s43, 45056
    s_nop 0
    buffer_load_dwordx4 v73, s[12:15], s45 offen lds
    s_add_u32 s44, s44, 128
    s_add_u32 s45, s45, 98304
    ds_read_b128 v[36:39], v97 offset:0
    ds_read_b128 v[40:43], v97 offset:2048
    ds_read_b64_tr_b16 v[56:57], v98 offset:7168
    ds_read_b64_tr_b16 v[58:59], v98 offset:8960
    ds_read_b64_tr_b16 v[60:61], v98 offset:7200
    ds_read_b64_tr_b16 v[62:63], v98 offset:8992
    ds_read_b64_tr_b16 v[64:65], v98 offset:7232
    ds_read_b64_tr_b16 v[66:67], v98 offset:9024
    s_waitcnt lgkmcnt(8)
    v_mfma_f32_16x16x32_bf16 v[4:7], v[44:47], v[28:31], v[4:7]
    v_mfma_f32_16x16x32_bf16 v[8:11], v[44:47], v[32:35], v[8:11]
    v_mfma_f32_16x16x32_bf16 v[12:15], v[48:51], v[28:31], v[12:15]
    v_mfma_f32_16x16x32_bf16 v[16:19], v[48:51], v[32:35], v[16:19]
    v_mfma_f32_16x16x32_bf16 v[20:23], v[52:55], v[28:31], v[20:23]
    v_mfma_f32_16x16x32_bf16 v[24:27], v[52:55], v[32:35], v[24:27]
    ds_read_b128 v[28:31], v100 offset:0
    ds_read_b128 v[32:35], v100 offset:2048
    ds_read_b64_tr_b16 v[44:45], v102 offset:0
    ds_read_b64_tr_b16 v[46:47], v102 offset:1792
    ds_read_b64_tr_b16 v[48:49], v102 offset:32
    ds_read_b64_tr_b16 v[50:51], v102 offset:1824
    ds_read_b64_tr_b16 v[52:53], v102 offset:64
    ds_read_b64_tr_b16 v[54:55], v102 offset:1856
    s_waitcnt lgkmcnt(8)
    v_mfma_f32_16x16x32_bf16 v[4:7], v[56:59], v[36:39], v[4:7]
    v_mfma_f32_16x16x32_bf16 v[8:11], v[56:59], v[40:43], v[8:11]
    v_mfma_f32_16x16x32_bf16 v[12:15], v[60:63], v[36:39], v[12:15]
    v_mfma_f32_16x16x32_bf16 v[16:19], v[60:63], v[40:43], v[16:19]
    v_mfma_f32_16x16x32_bf16 v[20:23], v[64:67], v[36:39], v[20:23]
    v_mfma_f32_16x16x32_bf16 v[24:27], v[64:67], v[40:43], v[24:27]
    ds_read_b128 v[36:39], v101 offset:0
    ds_read_b128 v[40:43], v101 offset:2048
    ds_read_b64_tr_b16 v[56:57], v102 offset:7168
    ds_read_b64_tr_b16 v[58:59], v102 offset:8960
    ds_read_b64_tr_b16 v[60:61], v102 offset:7200
    ds_read_b64_tr_b16 v[62:63], v102 offset:8992
    ds_read_b64_tr_b16 v[64:65], v102 offset:7232
    ds_read_b64_tr_b16 v[66:67], v102 offset:9024
    s_waitcnt lgkmcnt(8)
    v_mfma_f32_16x16x32_bf16 v[4:7], v[44:47], v[28:31], v[4:7]
    v_mfma_f32_16x16x32_bf16 v[8:11], v[44:47], v[32:35], v[8:11]
    v_mfma_f32_16x16x32_bf16 v[12:15], v[48:51], v[28:31], v[12:15]
    v_mfma_f32_16x16x32_bf16 v[16:19], v[48:51], v[32:35], v[16:19]
    v_mfma_f32_16x16x32_bf16 v[20:23], v[52:55], v[28:31], v[20:23]
    v_mfma_f32_16x16x32_bf16 v[24:27], v[52:55], v[32:35], v[24:27]
    s_waitcnt lgkmcnt(0)
    v_mfma_f32_16x16x32_bf16 v[4:7], v[56:59], v[36:39], v[4:7]
    v_mfma_f32_16x16x32_bf16 v[8:11], v[56:59], v[40:43], v[8:11]
    v_mfma_f32_16x16x32_bf16 v[12:15], v[60:63], v[36:39], v[12:15]
    v_mfma_f32_16x16x32_bf16 v[16:19], v[60:63], v[40:43], v[16:19]
    v_mfma_f32_16x16x32_bf16 v[20:23], v[64:67], v[36:39], v[20:23]
    v_mfma_f32_16x16x32_bf16 v[24:27], v[64:67], v[40:43], v[24:27]
    s_waitcnt vmcnt(12)
    s_barrier
    ds_read_b128 v[28:31], v104 offset:0
    ds_read_b128 v[32:35], v104 offset:2048
    ds_read_b64_tr_b16 v[44:45], v106 offset:0
    ds_read_b64_tr_b16 v[46:47], v106 offset:1792
    ds_read_b64_tr_b16 v[48:49], v106 offset:32
    ds_read_b64_tr_b16 v[50:51], v106 offset:1824
    ds_read_b64_tr_b16 v[52:53], v106 offset:64
    ds_read_b64_tr_b16 v[54:55], v106 offset:1856
    s_add_u32 m0, s43, 49152
    s_nop 0
    buffer_load_dwordx4 v68, s[8:11], s44 offen lds
    s_add_u32 m0, s43, 53248
    s_nop 0
    buffer_load_dwordx4 v69, s[8:11], s44 offen lds
    s_add_u32 m0, s43, 57344
    s_nop 0
    buffer_load_dwordx4 v70, s[12:15], s45 offen lds
    s_add_u32 m0, s43, 61440
    s_nop 0
    buffer_load_dwordx4 v71, s[12:15], s45 offen lds
    s_add_u32 m0, s43, 65536
    s_nop 0
    buffer_load_dwordx4 v72, s[12:15], s45 offen lds
    s_add_u32 m0, s43, 69632
    s_nop 0
    buffer_load_dwordx4 v73, s[12:15], s45 offen lds
    s_add_u32 s44, s44, 128
    s_add_u32 s45, s45, 98304
    s_add_u32 m0, s43, 73728
    s_nop 0
    buffer_load_dwordx4 v68, s[8:11], s44 offen lds
    s_add_u32 m0, s43, 77824
    s_nop 0
    buffer_load_dwordx4 v69, s[8:11], s44 offen lds
    s_add_u32 m0, s43, 81920
    s_nop 0
    buffer_load_dwordx4 v70, s[12:15], s45 offen lds
    s_add_u32 m0, s43, 86016
    s_nop 0
    buffer_load_dwordx4 v71, s[12:15], s45 offen lds
    s_add_u32 m0, s43, 90112
    s_nop 0
    buffer_load_dwordx4 v72, s[12:15], s45 offen lds
    s_add_u32 m0, s43, 94208
    s_nop 0
    buffer_load_dwordx4 v73, s[12:15], s45 offen lds
    s_add_u32 s44, s44, 128
    s_add_u32 s45, s45, 98304
    ds_read_b128 v[36:39], v105 offset:0
    ds_read_b128 v[40:43], v105 offset:2048
    ds_read_b64_tr_b16 v[56:57], v106 offset:7168
    ds_read_b64_tr_b16 v[58:59], v106 offset:8960
    ds_read_b64_tr_b16 v[60:61], v106 offset:7200
    ds_read_b64_tr_b16 v[62:63], v106 offset:8992
    ds_read_b64_tr_b16 v[64:65], v106 offset:7232
    ds_read_b64_tr_b16 v[66:67], v106 offset:9024
    s_waitcnt lgkmcnt(8)
    v_mfma_f32_16x16x32_bf16 v[4:7], v[44:47], v[28:31], v[4:7]
    v_mfma_f32_16x16x32_bf16 v[8:11], v[44:47], v[32:35], v[8:11]
    v_mfma_f32_16x16x32_bf16 v[12:15], v[48:51], v[28:31], v[12:15]
    v_mfma_f32_16x16x32_bf16 v[16:19], v[48:51], v[32:35], v[16:19]
    v_mfma_f32_16x16x32_bf16 v[20:23], v[52:55], v[28:31], v[20:23]
    v_mfma_f32_16x16x32_bf16 v[24:27], v[52:55], v[32:35], v[24:27]
    ds_read_b128 v[28:31], v108 offset:0
    ds_read_b128 v[32:35], v108 offset:2048
    ds_read_b64_tr_b16 v[44:45], v110 offset:0
    ds_read_b64_tr_b16 v[46:47], v110 offset:1792
    ds_read_b64_tr_b16 v[48:49], v110 offset:32
    ds_read_b64_tr_b16 v[50:51], v110 offset:1824
    ds_read_b64_tr_b16 v[52:53], v110 offset:64
    ds_read_b64_tr_b16 v[54:55], v110 offset:1856
    s_waitcnt lgkmcnt(8)
    v_mfma_f32_16x16x32_bf16 v[4:7], v[56:59], v[36:39], v[4:7]
    v_mfma_f32_16x16x32_bf16 v[8:11], v[56:59], v[40:43], v[8:11]
    v_mfma_f32_16x16x32_bf16 v[12:15], v[60:63], v[36:39], v[12:15]
    v_mfma_f32_16x16x32_bf16 v[16:19], v[60:63], v[40:43], v[16:19]
    v_mfma_f32_16x16x32_bf16 v[20:23], v[64:67], v[36:39], v[20:23]
    v_mfma_f32_16x16x32_bf16 v[24:27], v[64:67], v[40:43], v[24:27]
    ds_read_b128 v[36:39], v109 offset:0
    ds_read_b128 v[40:43], v109 offset:2048
    ds_read_b64_tr_b16 v[56:57], v110 offset:7168
    ds_read_b64_tr_b16 v[58:59], v110 offset:8960
    ds_read_b64_tr_b16 v[60:61], v110 offset:7200
    ds_read_b64_tr_b16 v[62:63], v110 offset:8992
    ds_read_b64_tr_b16 v[64:65], v110 offset:7232
    ds_read_b64_tr_b16 v[66:67], v110 offset:9024
    s_waitcnt lgkmcnt(8)
    v_mfma_f32_16x16x32_bf16 v[4:7], v[44:47], v[28:31], v[4:7]
    v_mfma_f32_16x16x32_bf16 v[8:11], v[44:47], v[32:35], v[8:11]
    v_mfma_f32_16x16x32_bf16 v[12:15], v[48:51], v[28:31], v[12:15]
    v_mfma_f32_16x16x32_bf16 v[16:19], v[48:51], v[32:35], v[16:19]
    v_mfma_f32_16x16x32_bf16 v[20:23], v[52:55], v[28:31], v[20:23]
    v_mfma_f32_16x16x32_bf16 v[24:27], v[52:55], v[32:35], v[24:27]
    s_waitcnt lgkmcnt(0)
    v_mfma_f32_16x16x32_bf16 v[4:7], v[56:59], v[36:39], v[4:7]
    v_mfma_f32_16x16x32_bf16 v[8:11], v[56:59], v[40:43], v[8:11]
    v_mfma_f32_16x16x32_bf16 v[12:15], v[60:63], v[36:39], v[12:15]
    v_mfma_f32_16x16x32_bf16 v[16:19], v[60:63], v[40:43], v[16:19]
    v_mfma_f32_16x16x32_bf16 v[20:23], v[64:67], v[36:39], v[20:23]
    v_mfma_f32_16x16x32_bf16 v[24:27], v[64:67], v[40:43], v[24:27]
    s_waitcnt vmcnt(12)
    s_barrier
    ds_read_b128 v[28:31], v88 offset:0
    ds_read_b128 v[32:35], v88 offset:2048
    ds_read_b64_tr_b16 v[44:45], v90 offset:0
    ds_read_b64_tr_b16 v[46:47], v90 offset:1792
    ds_read_b64_tr_b16 v[48:49], v90 offset:32
    ds_read_b64_tr_b16 v[50:51], v90 offset:1824
    ds_read_b64_tr_b16 v[52:53], v90 offset:64
    ds_read_b64_tr_b16 v[54:55], v90 offset:1856
    s_add_u32 m0, s43, 98304
    s_nop 0
    buffer_load_dwordx4 v68, s[8:11], s44 offen lds
    s_add_u32 m0, s43, 102400
    s_nop 0
    buffer_load_dwordx4 v69, s[8:11], s44 offen lds
    s_add_u32 m0, s43, 106496
    s_nop 0
    buffer_load_dwordx4 v70, s[12:15], s45 offen lds
    s_add_u32 m0, s43, 110592
    s_nop 0
    buffer_load_dwordx4 v71, s[12:15], s45 offen lds
    s_add_u32 m0, s43, 114688
    s_nop 0
    buffer_load_dwordx4 v72, s[12:15], s45 offen lds
    s_add_u32 m0, s43, 118784
    s_nop 0
    buffer_load_dwordx4 v73, s[12:15], s45 offen lds
    s_add_u32 s44, s44, 128
    s_add_u32 s45, s45, 98304
    s_add_u32 m0, s43, 122880
    s_nop 0
    buffer_load_dwordx4 v68, s[8:11], s44 offen lds
    s_add_u32 m0, s43, 126976
    s_nop 0
    buffer_load_dwordx4 v69, s[8:11], s44 offen lds
    s_add_u32 m0, s43, 131072
    s_nop 0
    buffer_load_dwordx4 v70, s[12:15], s45 offen lds
    s_add_u32 m0, s43, 135168
    s_nop 0
    buffer_load_dwordx4 v71, s[12:15], s45 offen lds
    s_add_u32 m0, s43, 139264
    s_nop 0
    buffer_load_dwordx4 v72, s[12:15], s45 offen lds
    s_add_u32 m0, s43, 143360
    s_nop 0
    buffer_load_dwordx4 v73, s[12:15], s45 offen lds
    s_add_u32 s44, s44, 128
    s_add_u32 s45, s45, 98304
    ds_read_b128 v[36:39], v89 offset:0
    ds_read_b128 v[40:43], v89 offset:2048
    ds_read_b64_tr_b16 v[56:57], v90 offset:7168
    ds_read_b64_tr_b16 v[58:59], v90 offset:8960
    ds_read_b64_tr_b16 v[60:61], v90 offset:7200
    ds_read_b64_tr_b16 v[62:63], v90 offset:8992
    ds_read_b64_tr_b16 v[64:65], v90 offset:7232
    ds_read_b64_tr_b16 v[66:67], v90 offset:9024
    s_waitcnt lgkmcnt(8)
    v_mfma_f32_16x16x32_bf16 v[4:7], v[44:47], v[28:31], v[4:7]
    v_mfma_f32_16x16x32_bf16 v[8:11], v[44:47], v[32:35], v[8:11]
    v_mfma_f32_16x16x32_bf16 v[12:15], v[48:51], v[28:31], v[12:15]
    v_mfma_f32_16x16x32_bf16 v[16:19], v[48:51], v[32:35], v[16:19]
    v_mfma_f32_16x16x32_bf16 v[20:23], v[52:55], v[28:31], v[20:23]
    v_mfma_f32_16x16x32_bf16 v[24:27], v[52:55], v[32:35], v[24:27]
    ds_read_b128 v[28:31], v92 offset:0
    ds_read_b128 v[32:35], v92 offset:2048
    ds_read_b64_tr_b16 v[44:45], v94 offset:0
    ds_read_b64_tr_b16 v[46:47], v94 offset:1792
    ds_read_b64_tr_b16 v[48:49], v94 offset:32
    ds_read_b64_tr_b16 v[50:51], v94 offset:1824
    ds_read_b64_tr_b16 v[52:53], v94 offset:64
    ds_read_b64_tr_b16 v[54:55], v94 offset:1856
    s_waitcnt lgkmcnt(8)
    v_mfma_f32_16x16x32_bf16 v[4:7], v[56:59], v[36:39], v[4:7]
    v_mfma_f32_16x16x32_bf16 v[8:11], v[56:59], v[40:43], v[8:11]
    v_mfma_f32_16x16x32_bf16 v[12:15], v[60:63], v[36:39], v[12:15]
    v_mfma_f32_16x16x32_bf16 v[16:19], v[60:63], v[40:43], v[16:19]
    v_mfma_f32_16x16x32_bf16 v[20:23], v[64:67], v[36:39], v[20:23]
    v_mfma_f32_16x16x32_bf16 v[24:27], v[64:67], v[40:43], v[24:27]
    ds_read_b128 v[36:39], v93 offset:0
    ds_read_b128 v[40:43], v93 offset:2048
    ds_read_b64_tr_b16 v[56:57], v94 offset:7168
    ds_read_b64_tr_b16 v[58:59], v94 offset:8960
    ds_read_b64_tr_b16 v[60:61], v94 offset:7200
    ds_read_b64_tr_b16 v[62:63], v94 offset:8992
    ds_read_b64_tr_b16 v[64:65], v94 offset:7232
    ds_read_b64_tr_b16 v[66:67], v94 offset:9024
    s_waitcnt lgkmcnt(8)
    v_mfma_f32_16x16x32_bf16 v[4:7], v[44:47], v[28:31], v[4:7]
    v_mfma_f32_16x16x32_bf16 v[8:11], v[44:47], v[32:35], v[8:11]
    v_mfma_f32_16x16x32_bf16 v[12:15], v[48:51], v[28:31], v[12:15]
    v_mfma_f32_16x16x32_bf16 v[16:19], v[48:51], v[32:35], v[16:19]
    v_mfma_f32_16x16x32_bf16 v[20:23], v[52:55], v[28:31], v[20:23]
    v_mfma_f32_16x16x32_bf16 v[24:27], v[52:55], v[32:35], v[24:27]
    s_waitcnt lgkmcnt(0)
    v_mfma_f32_16x16x32_bf16 v[4:7], v[56:59], v[36:39], v[4:7]
    v_mfma_f32_16x16x32_bf16 v[8:11], v[56:59], v[40:43], v[8:11]
    v_mfma_f32_16x16x32_bf16 v[12:15], v[60:63], v[36:39], v[12:15]
    v_mfma_f32_16x16x32_bf16 v[16:19], v[60:63], v[40:43], v[16:19]
    v_mfma_f32_16x16x32_bf16 v[20:23], v[64:67], v[36:39], v[20:23]
    v_mfma_f32_16x16x32_bf16 v[24:27], v[64:67], v[40:43], v[24:27]
    s_waitcnt vmcnt(12)
    s_barrier
    ds_read_b128 v[28:31], v96 offset:0
    ds_read_b128 v[32:35], v96 offset:2048
    ds_read_b64_tr_b16 v[44:45], v98 offset:0
    ds_read_b64_tr_b16 v[46:47], v98 offset:1792
    ds_read_b64_tr_b16 v[48:49], v98 offset:32
    ds_read_b64_tr_b16 v[50:51], v98 offset:1824
    ds_read_b64_tr_b16 v[52:53], v98 offset:64
    ds_read_b64_tr_b16 v[54:55], v98 offset:1856
    s_add_u32 m0, s43, 0
    s_nop 0
    buffer_load_dwordx4 v68, s[8:11], s44 offen lds
    s_add_u32 m0, s43, 4096
    s_nop 0
    buffer_load_dwordx4 v69, s[8:11], s44 offen lds
    s_add_u32 m0, s43, 8192
    s_nop 0
    buffer_load_dwordx4 v70, s[12:15], s45 offen lds
    s_add_u32 m0, s43, 12288
    s_nop 0
    buffer_load_dwordx4 v71, s[12:15], s45 offen lds
    s_add_u32 m0, s43, 16384
    s_nop 0
    buffer_load_dwordx4 v72, s[12:15], s45 offen lds
    s_add_u32 m0, s43, 20480
    s_nop 0
    buffer_load_dwordx4 v73, s[12:15], s45 offen lds
    s_add_u32 s44, s44, 128
    s_add_u32 s45, s45, 98304
    s_add_u32 m0, s43, 24576
    s_nop 0
    buffer_load_dwordx4 v68, s[8:11], s44 offen lds
    s_add_u32 m0, s43, 28672
    s_nop 0
    buffer_load_dwordx4 v69, s[8:11], s44 offen lds
    s_add_u32 m0, s43, 32768
    s_nop 0
    buffer_load_dwordx4 v70, s[12:15], s45 offen lds
    s_add_u32 m0, s43, 36864
    s_nop 0
    buffer_load_dwordx4 v71, s[12:15], s45 offen lds
    s_add_u32 m0, s43, 40960
    s_nop 0
    buffer_load_dwordx4 v72, s[12:15], s45 offen lds
    s_add_u32 m0, s43, 45056
    s_nop 0
    buffer_load_dwordx4 v73, s[12:15], s45 offen lds
    s_add_u32 s44, s44, 128
    s_add_u32 s45, s45, 98304
    ds_read_b128 v[36:39], v97 offset:0
    ds_read_b128 v[40:43], v97 offset:2048
    ds_read_b64_tr_b16 v[56:57], v98 offset:7168
    ds_read_b64_tr_b16 v[58:59], v98 offset:8960
    ds_read_b64_tr_b16 v[60:61], v98 offset:7200
    ds_read_b64_tr_b16 v[62:63], v98 offset:8992
    ds_read_b64_tr_b16 v[64:65], v98 offset:7232
    ds_read_b64_tr_b16 v[66:67], v98 offset:9024
    s_waitcnt lgkmcnt(8)
    v_mfma_f32_16x16x32_bf16 v[4:7], v[44:47], v[28:31], v[4:7]
    v_mfma_f32_16x16x32_bf16 v[8:11], v[44:47], v[32:35], v[8:11]
    v_mfma_f32_16x16x32_bf16 v[12:15], v[48:51], v[28:31], v[12:15]
    v_mfma_f32_16x16x32_bf16 v[16:19], v[48:51], v[32:35], v[16:19]
    v_mfma_f32_16x16x32_bf16 v[20:23], v[52:55], v[28:31], v[20:23]
    v_mfma_f32_16x16x32_bf16 v[24:27], v[52:55], v[32:35], v[24:27]
    ds_read_b128 v[28:31], v100 offset:0
    ds_read_b128 v[32:35], v100 offset:2048
    ds_read_b64_tr_b16 v[44:45], v102 offset:0
    ds_read_b64_tr_b16 v[46:47], v102 offset:1792
    ds_read_b64_tr_b16 v[48:49], v102 offset:32
    ds_read_b64_tr_b16 v[50:51], v102 offset:1824
    ds_read_b64_tr_b16 v[52:53], v102 offset:64
    ds_read_b64_tr_b16 v[54:55], v102 offset:1856
    s_waitcnt lgkmcnt(8)
    v_mfma_f32_16x16x32_bf16 v[4:7], v[56:59], v[36:39], v[4:7]
    v_mfma_f32_16x16x32_bf16 v[8:11], v[56:59], v[40:43], v[8:11]
    v_mfma_f32_16x16x32_bf16 v[12:15], v[60:63], v[36:39], v[12:15]
    v_mfma_f32_16x16x32_bf16 v[16:19], v[60:63], v[40:43], v[16:19]
    v_mfma_f32_16x16x32_bf16 v[20:23], v[64:67], v[36:39], v[20:23]
    v_mfma_f32_16x16x32_bf16 v[24:27], v[64:67], v[40:43], v[24:27]
    ds_read_b128 v[36:39], v101 offset:0
    ds_read_b128 v[40:43], v101 offset:2048
    ds_read_b64_tr_b16 v[56:57], v102 offset:7168
    ds_read_b64_tr_b16 v[58:59], v102 offset:8960
    ds_read_b64_tr_b16 v[60:61], v102 offset:7200
    ds_read_b64_tr_b16 v[62:63], v102 offset:8992
    ds_read_b64_tr_b16 v[64:65], v102 offset:7232
    ds_read_b64_tr_b16 v[66:67], v102 offset:9024
    s_waitcnt lgkmcnt(8)
    v_mfma_f32_16x16x32_bf16 v[4:7], v[44:47], v[28:31], v[4:7]
    v_mfma_f32_16x16x32_bf16 v[8:11], v[44:47], v[32:35], v[8:11]
    v_mfma_f32_16x16x32_bf16 v[12:15], v[48:51], v[28:31], v[12:15]
    v_mfma_f32_16x16x32_bf16 v[16:19], v[48:51], v[32:35], v[16:19]
    v_mfma_f32_16x16x32_bf16 v[20:23], v[52:55], v[28:31], v[20:23]
    v_mfma_f32_16x16x32_bf16 v[24:27], v[52:55], v[32:35], v[24:27]
    s_waitcnt lgkmcnt(0)
    v_mfma_f32_16x16x32_bf16 v[4:7], v[56:59], v[36:39], v[4:7]
    v_mfma_f32_16x16x32_bf16 v[8:11], v[56:59], v[40:43], v[8:11]
    v_mfma_f32_16x16x32_bf16 v[12:15], v[60:63], v[36:39], v[12:15]
    v_mfma_f32_16x16x32_bf16 v[16:19], v[60:63], v[40:43], v[16:19]
    v_mfma_f32_16x16x32_bf16 v[20:23], v[64:67], v[36:39], v[20:23]
    v_mfma_f32_16x16x32_bf16 v[24:27], v[64:67], v[40:43], v[24:27]
    s_waitcnt vmcnt(12)
    s_barrier
    ds_read_b128 v[28:31], v104 offset:0
    ds_read_b128 v[32:35], v104 offset:2048
    ds_read_b64_tr_b16 v[44:45], v106 offset:0
    ds_read_b64_tr_b16 v[46:47], v106 offset:1792
    ds_read_b64_tr_b16 v[48:49], v106 offset:32
    ds_read_b64_tr_b16 v[50:51], v106 offset:1824
    ds_read_b64_tr_b16 v[52:53], v106 offset:64
    ds_read_b64_tr_b16 v[54:55], v106 offset:1856
    s_add_u32 m0, s43, 49152
    s_nop 0
    buffer_load_dwordx4 v68, s[8:11], s44 offen lds
    s_add_u32 m0, s43, 53248
    s_nop 0
    buffer_load_dwordx4 v69, s[8:11], s44 offen lds
    s_add_u32 m0, s43, 57344
    s_nop 0
    buffer_load_dwordx4 v70, s[12:15], s45 offen lds
    s_add_u32 m0, s43, 61440
    s_nop 0
    buffer_load_dwordx4 v71, s[12:15], s45 offen lds
    s_add_u32 m0, s43, 65536
    s_nop 0
    buffer_load_dwordx4 v72, s[12:15], s45 offen lds
    s_add_u32 m0, s43, 69632
    s_nop 0
    buffer_load_dwordx4 v73, s[12:15], s45 offen lds
    s_add_u32 s44, s44, 128
    s_add_u32 s45, s45, 98304
    s_add_u32 m0, s43, 73728
    s_nop 0
    buffer_load_dwordx4 v68, s[8:11], s44 offen lds
    s_add_u32 m0, s43, 77824
    s_nop 0
    buffer_load_dwordx4 v69, s[8:11], s44 offen lds
    s_add_u32 m0, s43, 81920
    s_nop 0
    buffer_load_dwordx4 v70, s[12:15], s45 offen lds
    s_add_u32 m0, s43, 86016
    s_nop 0
    buffer_load_dwordx4 v71, s[12:15], s45 offen lds
    s_add_u32 m0, s43, 90112
    s_nop 0
    buffer_load_dwordx4 v72, s[12:15], s45 offen lds
    s_add_u32 m0, s43, 94208
    s_nop 0
    buffer_load_dwordx4 v73, s[12:15], s45 offen lds
    s_add_u32 s44, s44, 128
    s_add_u32 s45, s45, 98304
    ds_read_b128 v[36:39], v105 offset:0
    ds_read_b128 v[40:43], v105 offset:2048
    ds_read_b64_tr_b16 v[56:57], v106 offset:7168
    ds_read_b64_tr_b16 v[58:59], v106 offset:8960
    ds_read_b64_tr_b16 v[60:61], v106 offset:7200
    ds_read_b64_tr_b16 v[62:63], v106 offset:8992
    ds_read_b64_tr_b16 v[64:65], v106 offset:7232
    ds_read_b64_tr_b16 v[66:67], v106 offset:9024
    s_waitcnt lgkmcnt(8)
    v_mfma_f32_16x16x32_bf16 v[4:7], v[44:47], v[28:31], v[4:7]
    v_mfma_f32_16x16x32_bf16 v[8:11], v[44:47], v[32:35], v[8:11]
    v_mfma_f32_16x16x32_bf16 v[12:15], v[48:51], v[28:31], v[12:15]
    v_mfma_f32_16x16x32_bf16 v[16:19], v[48:51], v[32:35], v[16:19]
    v_mfma_f32_16x16x32_bf16 v[20:23], v[52:55], v[28:31], v[20:23]
    v_mfma_f32_16x16x32_bf16 v[24:27], v[52:55], v[32:35], v[24:27]
    ds_read_b128 v[28:31], v108 offset:0
    ds_read_b128 v[32:35], v108 offset:2048
    ds_read_b64_tr_b16 v[44:45], v110 offset:0
    ds_read_b64_tr_b16 v[46:47], v110 offset:1792
    ds_read_b64_tr_b16 v[48:49], v110 offset:32
    ds_read_b64_tr_b16 v[50:51], v110 offset:1824
    ds_read_b64_tr_b16 v[52:53], v110 offset:64
    ds_read_b64_tr_b16 v[54:55], v110 offset:1856
    s_waitcnt lgkmcnt(8)
    v_mfma_f32_16x16x32_bf16 v[4:7], v[56:59], v[36:39], v[4:7]
    v_mfma_f32_16x16x32_bf16 v[8:11], v[56:59], v[40:43], v[8:11]
    v_mfma_f32_16x16x32_bf16 v[12:15], v[60:63], v[36:39], v[12:15]
    v_mfma_f32_16x16x32_bf16 v[16:19], v[60:63], v[40:43], v[16:19]
    v_mfma_f32_16x16x32_bf16 v[20:23], v[64:67], v[36:39], v[20:23]
    v_mfma_f32_16x16x32_bf16 v[24:27], v[64:67], v[40:43], v[24:27]
    ds_read_b128 v[36:39], v109 offset:0
    ds_read_b128 v[40:43], v109 offset:2048
    ds_read_b64_tr_b16 v[56:57], v110 offset:7168
    ds_read_b64_tr_b16 v[58:59], v110 offset:8960
    ds_read_b64_tr_b16 v[60:61], v110 offset:7200
    ds_read_b64_tr_b16 v[62:63], v110 offset:8992
    ds_read_b64_tr_b16 v[64:65], v110 offset:7232
    ds_read_b64_tr_b16 v[66:67], v110 offset:9024
    s_waitcnt lgkmcnt(8)
    v_mfma_f32_16x16x32_bf16 v[4:7], v[44:47], v[28:31], v[4:7]
    v_mfma_f32_16x16x32_bf16 v[8:11], v[44:47], v[32:35], v[8:11]
    v_mfma_f32_16x16x32_bf16 v[12:15], v[48:51], v[28:31], v[12:15]
    v_mfma_f32_16x16x32_bf16 v[16:19], v[48:51], v[32:35], v[16:19]
    v_mfma_f32_16x16x32_bf16 v[20:23], v[52:55], v[28:31], v[20:23]
    v_mfma_f32_16x16x32_bf16 v[24:27], v[52:55], v[32:35], v[24:27]
    s_waitcnt lgkmcnt(0)
    v_mfma_f32_16x16x32_bf16 v[4:7], v[56:59], v[36:39], v[4:7]
    v_mfma_f32_16x16x32_bf16 v[8:11], v[56:59], v[40:43], v[8:11]
    v_mfma_f32_16x16x32_bf16 v[12:15], v[60:63], v[36:39], v[12:15]
    v_mfma_f32_16x16x32_bf16 v[16:19], v[60:63], v[40:43], v[16:19]
    v_mfma_f32_16x16x32_bf16 v[20:23], v[64:67], v[36:39], v[20:23]
    v_mfma_f32_16x16x32_bf16 v[24:27], v[64:67], v[40:43], v[24:27]
    s_waitcnt vmcnt(12)
    s_barrier
    ds_read_b128 v[28:31], v88 offset:0
    ds_read_b128 v[32:35], v88 offset:2048
    ds_read_b64_tr_b16 v[44:45], v90 offset:0
    ds_read_b64_tr_b16 v[46:47], v90 offset:1792
    ds_read_b64_tr_b16 v[48:49], v90 offset:32
    ds_read_b64_tr_b16 v[50:51], v90 offset:1824
    ds_read_b64_tr_b16 v[52:53], v90 offset:64
    ds_read_b64_tr_b16 v[54:55], v90 offset:1856
    s_add_u32 m0, s43, 98304
    s_nop 0
    buffer_load_dwordx4 v68, s[8:11], s44 offen lds
    s_add_u32 m0, s43, 102400
    s_nop 0
    buffer_load_dwordx4 v69, s[8:11], s44 offen lds
    s_add_u32 m0, s43, 106496
    s_nop 0
    buffer_load_dwordx4 v70, s[12:15], s45 offen lds
    s_add_u32 m0, s43, 110592
    s_nop 0
    buffer_load_dwordx4 v71, s[12:15], s45 offen lds
    s_add_u32 m0, s43, 114688
    s_nop 0
    buffer_load_dwordx4 v72, s[12:15], s45 offen lds
    s_add_u32 m0, s43, 118784
    s_nop 0
    buffer_load_dwordx4 v73, s[12:15], s45 offen lds
    s_add_u32 s44, s44, 128
    s_add_u32 s45, s45, 98304
    s_add_u32 m0, s43, 122880
    s_nop 0
    buffer_load_dwordx4 v68, s[8:11], s44 offen lds
    s_add_u32 m0, s43, 126976
    s_nop 0
    buffer_load_dwordx4 v69, s[8:11], s44 offen lds
    s_add_u32 m0, s43, 131072
    s_nop 0
    buffer_load_dwordx4 v70, s[12:15], s45 offen lds
    s_add_u32 m0, s43, 135168
    s_nop 0
    buffer_load_dwordx4 v71, s[12:15], s45 offen lds
    s_add_u32 m0, s43, 139264
    s_nop 0
    buffer_load_dwordx4 v72, s[12:15], s45 offen lds
    s_add_u32 m0, s43, 143360
    s_nop 0
    buffer_load_dwordx4 v73, s[12:15], s45 offen lds
    s_add_u32 s44, s44, 128
    s_add_u32 s45, s45, 98304
    ds_read_b128 v[36:39], v89 offset:0
    ds_read_b128 v[40:43], v89 offset:2048
    ds_read_b64_tr_b16 v[56:57], v90 offset:7168
    ds_read_b64_tr_b16 v[58:59], v90 offset:8960
    ds_read_b64_tr_b16 v[60:61], v90 offset:7200
    ds_read_b64_tr_b16 v[62:63], v90 offset:8992
    ds_read_b64_tr_b16 v[64:65], v90 offset:7232
    ds_read_b64_tr_b16 v[66:67], v90 offset:9024
    s_waitcnt lgkmcnt(8)
    v_mfma_f32_16x16x32_bf16 v[4:7], v[44:47], v[28:31], v[4:7]
    v_mfma_f32_16x16x32_bf16 v[8:11], v[44:47], v[32:35], v[8:11]
    v_mfma_f32_16x16x32_bf16 v[12:15], v[48:51], v[28:31], v[12:15]
    v_mfma_f32_16x16x32_bf16 v[16:19], v[48:51], v[32:35], v[16:19]
    v_mfma_f32_16x16x32_bf16 v[20:23], v[52:55], v[28:31], v[20:23]
    v_mfma_f32_16x16x32_bf16 v[24:27], v[52:55], v[32:35], v[24:27]
    ds_read_b128 v[28:31], v92 offset:0
    ds_read_b128 v[32:35], v92 offset:2048
    ds_read_b64_tr_b16 v[44:45], v94 offset:0
    ds_read_b64_tr_b16 v[46:47], v94 offset:1792
    ds_read_b64_tr_b16 v[48:49], v94 offset:32
    ds_read_b64_tr_b16 v[50:51], v94 offset:1824
    ds_read_b64_tr_b16 v[52:53], v94 offset:64
    ds_read_b64_tr_b16 v[54:55], v94 offset:1856
    s_waitcnt lgkmcnt(8)
    v_mfma_f32_16x16x32_bf16 v[4:7], v[56:59], v[36:39], v[4:7]
    v_mfma_f32_16x16x32_bf16 v[8:11], v[56:59], v[40:43], v[8:11]
    v_mfma_f32_16x16x32_bf16 v[12:15], v[60:63], v[36:39], v[12:15]
    v_mfma_f32_16x16x32_bf16 v[16:19], v[60:63], v[40:43], v[16:19]
    v_mfma_f32_16x16x32_bf16 v[20:23], v[64:67], v[36:39], v[20:23]
    v_mfma_f32_16x16x32_bf16 v[24:27], v[64:67], v[40:43], v[24:27]
    ds_read_b128 v[36:39], v93 offset:0
    ds_read_b128 v[40:43], v93 offset:2048
    ds_read_b64_tr_b16 v[56:57], v94 offset:7168
    ds_read_b64_tr_b16 v[58:59], v94 offset:8960
    ds_read_b64_tr_b16 v[60:61], v94 offset:7200
    ds_read_b64_tr_b16 v[62:63], v94 offset:8992
    ds_read_b64_tr_b16 v[64:65], v94 offset:7232
    ds_read_b64_tr_b16 v[66:67], v94 offset:9024
    s_waitcnt lgkmcnt(8)
    v_mfma_f32_16x16x32_bf16 v[4:7], v[44:47], v[28:31], v[4:7]
    v_mfma_f32_16x16x32_bf16 v[8:11], v[44:47], v[32:35], v[8:11]
    v_mfma_f32_16x16x32_bf16 v[12:15], v[48:51], v[28:31], v[12:15]
    v_mfma_f32_16x16x32_bf16 v[16:19], v[48:51], v[32:35], v[16:19]
    v_mfma_f32_16x16x32_bf16 v[20:23], v[52:55], v[28:31], v[20:23]
    v_mfma_f32_16x16x32_bf16 v[24:27], v[52:55], v[32:35], v[24:27]
    s_waitcnt lgkmcnt(0)
    v_mfma_f32_16x16x32_bf16 v[4:7], v[56:59], v[36:39], v[4:7]
    v_mfma_f32_16x16x32_bf16 v[8:11], v[56:59], v[40:43], v[8:11]
    v_mfma_f32_16x16x32_bf16 v[12:15], v[60:63], v[36:39], v[12:15]
    v_mfma_f32_16x16x32_bf16 v[16:19], v[60:63], v[40:43], v[16:19]
    v_mfma_f32_16x16x32_bf16 v[20:23], v[64:67], v[36:39], v[20:23]
    v_mfma_f32_16x16x32_bf16 v[24:27], v[64:67], v[40:43], v[24:27]
    s_waitcnt vmcnt(12)
    s_barrier
    ds_read_b128 v[28:31], v96 offset:0
    ds_read_b128 v[32:35], v96 offset:2048
    ds_read_b64_tr_b16 v[44:45], v98 offset:0
    ds_read_b64_tr_b16 v[46:47], v98 offset:1792
    ds_read_b64_tr_b16 v[48:49], v98 offset:32
    ds_read_b64_tr_b16 v[50:51], v98 offset:1824
    ds_read_b64_tr_b16 v[52:53], v98 offset:64
    ds_read_b64_tr_b16 v[54:55], v98 offset:1856
    ds_read_b128 v[36:39], v97 offset:0
    ds_read_b128 v[40:43], v97 offset:2048
    ds_read_b64_tr_b16 v[56:57], v98 offset:7168
    ds_read_b64_tr_b16 v[58:59], v98 offset:8960
    ds_read_b64_tr_b16 v[60:61], v98 offset:7200
    ds_read_b64_tr_b16 v[62:63], v98 offset:8992
    ds_read_b64_tr_b16 v[64:65], v98 offset:7232
    ds_read_b64_tr_b16 v[66:67], v98 offset:9024
    s_waitcnt lgkmcnt(8)
    v_mfma_f32_16x16x32_bf16 v[4:7], v[44:47], v[28:31], v[4:7]
    v_mfma_f32_16x16x32_bf16 v[8:11], v[44:47], v[32:35], v[8:11]
    v_mfma_f32_16x16x32_bf16 v[12:15], v[48:51], v[28:31], v[12:15]
    v_mfma_f32_16x16x32_bf16 v[16:19], v[48:51], v[32:35], v[16:19]
    v_mfma_f32_16x16x32_bf16 v[20:23], v[52:55], v[28:31], v[20:23]
    v_mfma_f32_16x16x32_bf16 v[24:27], v[52:55], v[32:35], v[24:27]
    ds_read_b128 v[28:31], v100 offset:0
    ds_read_b128 v[32:35], v100 offset:2048
    ds_read_b64_tr_b16 v[44:45], v102 offset:0
    ds_read_b64_tr_b16 v[46:47], v102 offset:1792
    ds_read_b64_tr_b16 v[48:49], v102 offset:32
    ds_read_b64_tr_b16 v[50:51], v102 offset:1824
    ds_read_b64_tr_b16 v[52:53], v102 offset:64
    ds_read_b64_tr_b16 v[54:55], v102 offset:1856
    s_waitcnt lgkmcnt(8)
    v_mfma_f32_16x16x32_bf16 v[4:7], v[56:59], v[36:39], v[4:7]
    v_mfma_f32_16x16x32_bf16 v[8:11], v[56:59], v[40:43], v[8:11]
    v_mfma_f32_16x16x32_bf16 v[12:15], v[60:63], v[36:39], v[12:15]
    v_mfma_f32_16x16x32_bf16 v[16:19], v[60:63], v[40:43], v[16:19]
    v_mfma_f32_16x16x32_bf16 v[20:23], v[64:67], v[36:39], v[20:23]
    v_mfma_f32_16x16x32_bf16 v[24:27], v[64:67], v[40:43], v[24:27]
    ds_read_b128 v[36:39], v101 offset:0
    ds_read_b128 v[40:43], v101 offset:2048
    ds_read_b64_tr_b16 v[56:57], v102 offset:7168
    ds_read_b64_tr_b16 v[58:59], v102 offset:8960
    ds_read_b64_tr_b16 v[60:61], v102 offset:7200
    ds_read_b64_tr_b16 v[62:63], v102 offset:8992
    ds_read_b64_tr_b16 v[64:65], v102 offset:7232
    ds_read_b64_tr_b16 v[66:67], v102 offset:9024
    s_waitcnt lgkmcnt(8)
    v_mfma_f32_16x16x32_bf16 v[4:7], v[44:47], v[28:31], v[4:7]
    v_mfma_f32_16x16x32_bf16 v[8:11], v[44:47], v[32:35], v[8:11]
    v_mfma_f32_16x16x32_bf16 v[12:15], v[48:51], v[28:31], v[12:15]
    v_mfma_f32_16x16x32_bf16 v[16:19], v[48:51], v[32:35], v[16:19]
    v_mfma_f32_16x16x32_bf16 v[20:23], v[52:55], v[28:31], v[20:23]
    v_mfma_f32_16x16x32_bf16 v[24:27], v[52:55], v[32:35], v[24:27]
    s_waitcnt lgkmcnt(0)
    v_mfma_f32_16x16x32_bf16 v[4:7], v[56:59], v[36:39], v[4:7]
    v_mfma_f32_16x16x32_bf16 v[8:11], v[56:59], v[40:43], v[8:11]
    v_mfma_f32_16x16x32_bf16 v[12:15], v[60:63], v[36:39], v[12:15]
    v_mfma_f32_16x16x32_bf16 v[16:19], v[60:63], v[40:43], v[16:19]
    v_mfma_f32_16x16x32_bf16 v[20:23], v[64:67], v[36:39], v[20:23]
    v_mfma_f32_16x16x32_bf16 v[24:27], v[64:67], v[40:43], v[24:27]
    s_waitcnt vmcnt(0)
    s_barrier
    ds_read_b128 v[28:31], v104 offset:0
    ds_read_b128 v[32:35], v104 offset:2048
    ds_read_b64_tr_b16 v[44:45], v106 offset:0
    ds_read_b64_tr_b16 v[46:47], v106 offset:1792
    ds_read_b64_tr_b16 v[48:49], v106 offset:32
    ds_read_b64_tr_b16 v[50:51], v106 offset:1824
    ds_read_b64_tr_b16 v[52:53], v106 offset:64
    ds_read_b64_tr_b16 v[54:55], v106 offset:1856
    ds_read_b128 v[36:39], v105 offset:0
    ds_read_b128 v[40:43], v105 offset:2048
    ds_read_b64_tr_b16 v[56:57], v106 offset:7168
    ds_read_b64_tr_b16 v[58:59], v106 offset:8960
    ds_read_b64_tr_b16 v[60:61], v106 offset:7200
    ds_read_b64_tr_b16 v[62:63], v106 offset:8992
    ds_read_b64_tr_b16 v[64:65], v106 offset:7232
    ds_read_b64_tr_b16 v[66:67], v106 offset:9024
    s_waitcnt lgkmcnt(8)
    v_mfma_f32_16x16x32_bf16 v[4:7], v[44:47], v[28:31], v[4:7]
    v_mfma_f32_16x16x32_bf16 v[8:11], v[44:47], v[32:35], v[8:11]
    v_mfma_f32_16x16x32_bf16 v[12:15], v[48:51], v[28:31], v[12:15]
    v_mfma_f32_16x16x32_bf16 v[16:19], v[48:51], v[32:35], v[16:19]
    v_mfma_f32_16x16x32_bf16 v[20:23], v[52:55], v[28:31], v[20:23]
    v_mfma_f32_16x16x32_bf16 v[24:27], v[52:55], v[32:35], v[24:27]
    ds_read_b128 v[28:31], v108 offset:0
    ds_read_b128 v[32:35], v108 offset:2048
    ds_read_b64_tr_b16 v[44:45], v110 offset:0
    ds_read_b64_tr_b16 v[46:47], v110 offset:1792
    ds_read_b64_tr_b16 v[48:49], v110 offset:32
    ds_read_b64_tr_b16 v[50:51], v110 offset:1824
    ds_read_b64_tr_b16 v[52:53], v110 offset:64
    ds_read_b64_tr_b16 v[54:55], v110 offset:1856
    s_waitcnt lgkmcnt(8)
    v_mfma_f32_16x16x32_bf16 v[4:7], v[56:59], v[36:39], v[4:7]
    v_mfma_f32_16x16x32_bf16 v[8:11], v[56:59], v[40:43], v[8:11]
    v_mfma_f32_16x16x32_bf16 v[12:15], v[60:63], v[36:39], v[12:15]
    v_mfma_f32_16x16x32_bf16 v[16:19], v[60:63], v[40:43], v[16:19]
    v_mfma_f32_16x16x32_bf16 v[20:23], v[64:67], v[36:39], v[20:23]
    v_mfma_f32_16x16x32_bf16 v[24:27], v[64:67], v[40:43], v[24:27]
    ds_read_b128 v[36:39], v109 offset:0
    ds_read_b128 v[40:43], v109 offset:2048
    ds_read_b64_tr_b16 v[56:57], v110 offset:7168
    ds_read_b64_tr_b16 v[58:59], v110 offset:8960
    ds_read_b64_tr_b16 v[60:61], v110 offset:7200
    ds_read_b64_tr_b16 v[62:63], v110 offset:8992
    ds_read_b64_tr_b16 v[64:65], v110 offset:7232
    ds_read_b64_tr_b16 v[66:67], v110 offset:9024
    s_waitcnt lgkmcnt(8)
    v_mfma_f32_16x16x32_bf16 v[4:7], v[44:47], v[28:31], v[4:7]
    v_mfma_f32_16x16x32_bf16 v[8:11], v[44:47], v[32:35], v[8:11]
    v_mfma_f32_16x16x32_bf16 v[12:15], v[48:51], v[28:31], v[12:15]
    v_mfma_f32_16x16x32_bf16 v[16:19], v[48:51], v[32:35], v[16:19]
    v_mfma_f32_16x16x32_bf16 v[20:23], v[52:55], v[28:31], v[20:23]
    v_mfma_f32_16x16x32_bf16 v[24:27], v[52:55], v[32:35], v[24:27]
    s_waitcnt lgkmcnt(0)
    v_mfma_f32_16x16x32_bf16 v[4:7], v[56:59], v[36:39], v[4:7]
    v_mfma_f32_16x16x32_bf16 v[8:11], v[56:59], v[40:43], v[8:11]
    v_mfma_f32_16x16x32_bf16 v[12:15], v[60:63], v[36:39], v[12:15]
    v_mfma_f32_16x16x32_bf16 v[16:19], v[60:63], v[40:43], v[16:19]
    v_mfma_f32_16x16x32_bf16 v[20:23], v[64:67], v[36:39], v[20:23]
    v_mfma_f32_16x16x32_bf16 v[24:27], v[64:67], v[40:43], v[24:27]
    v_and_b32 v76, 15, v1
    v_lshrrev_b32 v77, 4, v1
    s_mul_i32 s40, s41, 32
    v_add_u32 v76, s40, v76
    s_mul_i32 s40, s42, 48
    v_lshl_add_u32 v77, v77, 2, s40
    s_mov_b32 s40, 1536
    v_mul_lo_u32 v78, s40, v76
    v_lshl_add_u32 v78, v77, 1, v78
    s_mul_i32 s46, s32, 64
    s_lshr_b32 s46, s46, 10
    s_mul_i32 s46, s46, 18432
    s_mul_i32 s40, s33, 384
    s_add_u32 s46, s46, s40
    s_add_u32 s46, s46, 15360
    s_mov_b32 s48, s26
    s_mov_b32 s49, s27
    s_mov_b32 s50, 36864
    s_mov_b32 s51, 0x00020000
    s_add_u32 s52, s26, 37748736
    s_addc_u32 s53, s27, 0
    s_add_u32 s52, s52, s39
    s_addc_u32 s53, s53, 0
    s_mov_b32 s54, 96960
    s_mov_b32 s55, 0x00020000
    v_lshlrev_b32 v79, 2, v77
    s_nop 7
    s_nop 7
    buffer_load_dwordx4 v[28:31], v79, s[48:51], s46 offen offset:0
    buffer_load_dwordx2 v[32:33], v78, s[52:55], 0 offen offset:0
    v_add_u32 v80, 24576, v78
    buffer_load_dwordx2 v[34:35], v80, s[52:55], 0 offen
    s_waitcnt vmcnt(0)
    v_lshlrev_b32 v86, 16, v32
    v_fma_f32 v4, v4, v28, v86
    v_and_b32 v86, 0xffff0000, v32
    v_fma_f32 v5, v5, v29, v86
    v_lshlrev_b32 v86, 16, v33
    v_fma_f32 v6, v6, v30, v86
    v_and_b32 v86, 0xffff0000, v33
    v_fma_f32 v7, v7, v31, v86
    v_cvt_pk_bf16_f32 v4, v4, v5
    v_cvt_pk_bf16_f32 v5, v6, v7
    buffer_store_dwordx2 v[4:5], v78, s[16:19], 0 offen offset:0
    v_lshlrev_b32 v86, 16, v34
    v_fma_f32 v8, v8, v28, v86
    v_and_b32 v86, 0xffff0000, v34
    v_fma_f32 v9, v9, v29, v86
    v_lshlrev_b32 v86, 16, v35
    v_fma_f32 v10, v10, v30, v86
    v_and_b32 v86, 0xffff0000, v35
    v_fma_f32 v11, v11, v31, v86
    v_cvt_pk_bf16_f32 v8, v8, v9
    v_cvt_pk_bf16_f32 v9, v10, v11
    v_add_u32 v80, 24576, v78
    buffer_store_dwordx2 v[8:9], v80, s[16:19], 0 offen
    buffer_load_dwordx4 v[28:31], v79, s[48:51], s46 offen offset:64
    buffer_load_dwordx2 v[32:33], v78, s[52:55], 0 offen offset:32
    v_add_u32 v80, 24608, v78
    buffer_load_dwordx2 v[34:35], v80, s[52:55], 0 offen
    s_waitcnt vmcnt(0)
    v_lshlrev_b32 v86, 16, v32
    v_fma_f32 v12, v12, v28, v86
    v_and_b32 v86, 0xffff0000, v32
    v_fma_f32 v13, v13, v29, v86
    v_lshlrev_b32 v86, 16, v33
    v_fma_f32 v14, v14, v30, v86
    v_and_b32 v86, 0xffff0000, v33
    v_fma_f32 v15, v15, v31, v86
    v_cvt_pk_bf16_f32 v12, v12, v13
    v_cvt_pk_bf16_f32 v13, v14, v15
    buffer_store_dwordx2 v[12:13], v78, s[16:19], 0 offen offset:32
    v_lshlrev_b32 v86, 16, v34
    v_fma_f32 v16, v16, v28, v86
    v_and_b32 v86, 0xffff0000, v34
    v_fma_f32 v17, v17, v29, v86
    v_lshlrev_b32 v86, 16, v35
    v_fma_f32 v18, v18, v30, v86
    v_and_b32 v86, 0xffff0000, v35
    v_fma_f32 v19, v19, v31, v86
    v_cvt_pk_bf16_f32 v16, v16, v17
    v_cvt_pk_bf16_f32 v17, v18, v19
    v_add_u32 v80, 24608, v78
    buffer_store_dwordx2 v[16:17], v80, s[16:19], 0 offen
    buffer_load_dwordx4 v[28:31], v79, s[48:51], s46 offen offset:128
    buffer_load_dwordx2 v[32:33], v78, s[52:55], 0 offen offset:64
    v_add_u32 v80, 24640, v78
    buffer_load_dwordx2 v[34:35], v80, s[52:55], 0 offen
    s_waitcnt vmcnt(0)
    v_lshlrev_b32 v86, 16, v32
    v_fma_f32 v20, v20, v28, v86
    v_and_b32 v86, 0xffff0000, v32
    v_fma_f32 v21, v21, v29, v86
    v_lshlrev_b32 v86, 16, v33
    v_fma_f32 v22, v22, v30, v86
    v_and_b32 v86, 0xffff0000, v33
    v_fma_f32 v23, v23, v31, v86
    v_cvt_pk_bf16_f32 v20, v20, v21
    v_cvt_pk_bf16_f32 v21, v22, v23
    buffer_store_dwordx2 v[20:21], v78, s[16:19], 0 offen offset:64
    v_lshlrev_b32 v86, 16, v34
    v_fma_f32 v24, v24, v28, v86
    v_and_b32 v86, 0xffff0000, v34
    v_fma_f32 v25, v25, v29, v86
    v_lshlrev_b32 v86, 16, v35
    v_fma_f32 v26, v26, v30, v86
    v_and_b32 v86, 0xffff0000, v35
    v_fma_f32 v27, v27, v31, v86
    v_cvt_pk_bf16_f32 v24, v24, v25
    v_cvt_pk_bf16_f32 v25, v26, v27
    v_add_u32 v80, 24640, v78
    buffer_store_dwordx2 v[24:25], v80, s[16:19], 0 offen
fc2_kernel_end:
    s_endpgm
.section .rodata,"a"
.p2align 6
.amdhsa_kernel mod_kernel
  .amdhsa_next_free_vgpr 136
  .amdhsa_next_free_sgpr 64
  .amdhsa_accum_offset 136
  .amdhsa_group_segment_fixed_size 0
  .amdhsa_kernarg_size 80
  .amdhsa_user_sgpr_count 2
  .amdhsa_user_sgpr_kernarg_segment_ptr 1
  .amdhsa_system_sgpr_workgroup_id_x 1
.end_amdhsa_kernel
.p2align 6
.amdhsa_kernel ln1_kernel
  .amdhsa_next_free_vgpr 72
  .amdhsa_next_free_sgpr 64
  .amdhsa_accum_offset 72
  .amdhsa_group_segment_fixed_size 0
  .amdhsa_kernarg_size 80
  .amdhsa_user_sgpr_count 2
  .amdhsa_user_sgpr_kernarg_segment_ptr 1
  .amdhsa_system_sgpr_workgroup_id_x 1
.end_amdhsa_kernel
.p2align 6
.amdhsa_kernel qkv_kernel
  .amdhsa_next_free_vgpr 204
  .amdhsa_next_free_sgpr 64
  .amdhsa_accum_offset 204
  .amdhsa_group_segment_fixed_size 0
  .amdhsa_kernarg_size 80
  .amdhsa_user_sgpr_count 2
  .amdhsa_user_sgpr_kernarg_segment_ptr 1
  .amdhsa_system_sgpr_workgroup_id_x 1
.end_amdhsa_kernel
.p2align 6
.amdhsa_kernel s_kernel
  .amdhsa_next_free_vgpr 204
  .amdhsa_next_free_sgpr 64
  .amdhsa_accum_offset 204
  .amdhsa_group_segment_fixed_size 0
  .amdhsa_kernarg_size 80
  .amdhsa_user_sgpr_count 2
  .amdhsa_user_sgpr_kernarg_segment_ptr 1
  .amdhsa_system_sgpr_workgroup_id_x 1
.end_amdhsa_kernel
.p2align 6
.amdhsa_kernel sm_kernel
  .amdhsa_next_free_vgpr 40
  .amdhsa_next_free_sgpr 64
  .amdhsa_accum_offset 40
  .amdhsa_group_segment_fixed_size 0
  .amdhsa_kernarg_size 80
  .amdhsa_user_sgpr_count 2
  .amdhsa_user_sgpr_kernarg_segment_ptr 1
  .amdhsa_system_sgpr_workgroup_id_x 1
.end_amdhsa_kernel
.p2align 6
.amdhsa_kernel pv_kernel
  .amdhsa_next_free_vgpr 204
  .amdhsa_next_free_sgpr 64
  .amdhsa_accum_offset 204
  .amdhsa_group_segment_fixed_size 0
  .amdhsa_kernarg_size 80
  .amdhsa_user_sgpr_count 2
  .amdhsa_user_sgpr_kernarg_segment_ptr 1
  .amdhsa_system_sgpr_workgroup_id_x 1
.end_amdhsa_kernel
.p2align 6
.amdhsa_kernel wo_kernel
  .amdhsa_next_free_vgpr 204
  .amdhsa_next_free_sgpr 64
  .amdhsa_accum_offset 204
  .amdhsa_group_segment_fixed_size 0
  .amdhsa_kernarg_size 80
  .amdhsa_user_sgpr_count 2
  .amdhsa_user_sgpr_kernarg_segment_ptr 1
  .amdhsa_system_sgpr_workgroup_id_x 1
.end_amdhsa_kernel
.p2align 6
.amdhsa_kernel ln2_kernel
  .amdhsa_next_free_vgpr 72
  .amdhsa_next_free_sgpr 64
  .amdhsa_accum_offset 72
  .amdhsa_group_segment_fixed_size 0
  .amdhsa_kernarg_size 80
  .amdhsa_user_sgpr_count 2
  .amdhsa_user_sgpr_kernarg_segment_ptr 1
  .amdhsa_system_sgpr_workgroup_id_x 1
.end_amdhsa_kernel
.p2align 6
.amdhsa_kernel fc1_kernel
  .amdhsa_next_free_vgpr 224
  .amdhsa_next_free_sgpr 64
  .amdhsa_accum_offset 224
  .amdhsa_group_segment_fixed_size 0
  .amdhsa_kernarg_size 80
  .amdhsa_user_sgpr_count 2
  .amdhsa_user_sgpr_kernarg_segment_ptr 1
  .amdhsa_system_sgpr_workgroup_id_x 1
.end_amdhsa_kernel
.p2align 6
.amdhsa_kernel fc2_kernel
  .amdhsa_next_free_vgpr 204
  .amdhsa_next_free_sgpr 64
  .amdhsa_accum_offset 204
  .amdhsa_group_segment_fixed_size 0
  .amdhsa_kernarg_size 80
  .amdhsa_user_sgpr_count 2
  .amdhsa_user_sgpr_kernarg_segment_ptr 1
  .amdhsa_system_sgpr_workgroup_id_x 1
.end_amdhsa_kernel
```
